```python
import torch

def _softmax(x, axis=-1):
    return torch.softmax(x, dim=axis)

def _gelu(x):
    return torch.nn.functional.gelu(x, approximate='tanh')

def _silu(x):
    return torch.nn.functional.silu(x)

def _sigmoid(x):
    return torch.sigmoid(x)

def _layernorm(x, axis=-1, eps=1e-05):
    m = x.mean(dim=axis, keepdim=True)
    v = x.var(dim=axis, keepdim=True, unbiased=False)
    return (x - m) / torch.sqrt(v + eps)

def _scatter_add(tgt, idx, src, axis=0):
    return tgt.clone().index_add_(axis, idx, src)

def _segment_sum(src, seg, n):
    out = torch.zeros((n,) + src.shape[1:], dtype=src.dtype)
    return out.index_add_(0, seg, src)

def _pad(x, pw):
    flat = tuple((v for pair in reversed(pw) for v in pair))
    return torch.nn.functional.pad(x, flat)
kernel_name = 'standalone__varlen_attn_packed__ragged'

def setup_inputs():

    _w = lambda a: (lambda t: t.to(torch.bfloat16) if t.is_floating_point() else t)(torch.as_tensor(a))
    cu = torch.tensor([0, 534, 1426, 1714, 2675, 3469, 4036, 4628, 4845], dtype=torch.int64)
    T, H, D = (int(cu[-1]), 16, 128)
    return {'q': _w((lambda *s: torch.randn(*s, dtype=torch.bfloat16) * 0.8)(T, H, D)), 'k': _w((lambda *s: torch.randn(*s, dtype=torch.bfloat16) * 0.8)(T, H, D)), 'v': _w((lambda *s: torch.randn(*s, dtype=torch.bfloat16) * 0.05)(T, H, D)), 'cu': _w(cu)}

def reference(q, k, v, cu):
    T, H, D = q.shape
    out = torch.zeros_like(q)
    scale = D ** (-0.5)
    outs = []
    for i in range(len(cu) - 1):
        s, e = (int(cu[i]), int(cu[i + 1]))
        qi, ki, vi = (q[s:e].clone(), k[s:e].clone(), v[s:e].clone())
        p = _softmax(torch.einsum('qhd,khd->hqk', qi, ki) * scale, axis=-1)
        outs.append(torch.einsum('hqk,khd->qhd', p, vi))
    return torch.concatenate(outs, axis=0)
```

```asm
; @launch grid=(256,1,1) block=(256,1,1) lds=163840
.amdgcn_target "amdgcn-amd-amdhsa--gfx950"
.text
.globl standalone__varlen_attn_packed__ragged_kernel
.p2align 8
.type standalone__varlen_attn_packed__ragged_kernel,@function
standalone__varlen_attn_packed__ragged_kernel:
    s_cmp_ge_u32 s2, 256
    s_cbranch_scc1 Lend
    s_getpc_b64 s[52:53]
Lpc:
    s_add_u32 s4, s52, Ltab-Lpc
    s_addc_u32 s5, s53, 0
    s_lshl_b32 s3, s2, 5
    s_load_dwordx8 s[28:35], s[4:5], s3
    s_load_dwordx2 s[16:17], s[0:1], 8
    s_load_dwordx2 s[12:13], s[0:1], 0
    s_load_dwordx2 s[20:21], s[0:1], 16
    s_load_dwordx2 s[24:25], s[0:1], 32
    s_load_dwordx2 s[8:9], s[0:1], 0
    s_lshr_b32 s3, s2, 3
    s_mul_i32 s3, s3, 2560
    v_lshrrev_b32 v1, 6, v0
    v_mul_u32_u24 v1, 640, v1
    v_and_b32 v2, 7, v0
    v_min_u32 v2, 4, v2
    v_lshl_add_u32 v1, v2, 7, v1
    v_add_u32 v1, s3, v1
    v_min_u32 v1, Lcold-Lpc, v1
    global_load_dword v2, v1, s[52:53]
    v_lshrrev_b32 v244, 6, v0
    v_and_b32 v245, 63, v0
    v_readfirstlane_b32 s47, v244
    v_and_b32 v246, 15, v245
    v_lshrrev_b32 v247, 4, v245
    v_xor_b32 v250, v246, v247
    v_lshlrev_b32 v250, 4, v250
    v_lshlrev_b32 v242, 2, v247
    v_lshl_add_u32 v220, v247, 12, v250
    v_xor_b32 v221, 64, v220
    v_add_u32 v221, 15360, v221
    v_xor_b32 v222, 128, v220
    v_add_u32 v222, 30720, v222
    v_xor_b32 v223, 192, v220
    v_add_u32 v223, 46080, v223
    v_lshl_add_u32 v249, v244, 3, v247
    v_xor_b32 v248, v242, v246
    v_lshlrev_b32 v248, 4, v248
    v_lshl_add_u32 v218, v249, 12, v248
    v_xor_b32 v219, 32, v218
    v_add_u32 v219, 15360, v219
    v_and_b32 v248, 15, v249
    v_xor_b32 v248, v248, v246
    v_lshlrev_b32 v248, 4, v248
    v_lshl_add_u32 v216, v249, 12, v248
    v_xor_b32 v217, 64, v216
    v_add_u32 v216, 2048, v216
    v_add_u32 v217, 17408, v217
    s_lshl_b32 s41, s47, 12
    s_mov_b32 s44, 0x41a00000
    s_mov_b32 s45, 0x3e0293ee
    s_mov_b32 s46, 0xf149f2ca
    s_mov_b32 s57, 0x40000000
    s_mov_b32 s64, 1
    s_mov_b32 s65, 0
    s_mov_b32 s66, 0x53800000
    s_mul_i32 s3, s47, 20480
    s_add_u32 s3, s3, 65536
    s_mov_b32 s14, 0
    s_mov_b32 s15, 0x20000
    s_mov_b32 s18, 0
    s_mov_b32 s19, 0x20000
    s_mov_b32 s22, 0
    s_mov_b32 s23, 0x20000
    s_mov_b32 s26, 0
    s_mov_b32 s27, 0x20000
    s_mov_b32 s10, 0
    s_mov_b32 s11, 0x20000
    s_mov_b32 m0, s41
    s_waitcnt lgkmcnt(0)
    s_sub_u32 s16, s16, 4096
    s_subb_u32 s17, s17, 0
    s_add_u32 s18, s30, 4096
    buffer_load_dwordx4 v216, s[16:19], s31 offen offset:2048 lds
    buffer_load_dwordx4 v217, s[16:19], s31 offen offset:3072 lds
    s_mov_b32 s14, s30
    s_bfe_u32 s50, s29, 0x30018
    s_mul_i32 s61, s50, s47
    s_lshl_b32 s61, s61, 16
    s_and_b32 s55, s29, 0xfff000
    s_add_u32 s55, s55, s28
    s_add_u32 s55, s55, s61
    s_mov_b32 m0, s3
    s_add_u32 s61, s55, 0
    buffer_load_dwordx4 v220, s[12:15], s61 offen offset:0 nt lds
    v_bfe_u32 v248, v245, 3, 1
    v_lshlrev_b32 v248, 12, v248
    v_and_b32 v249, 7, v245
    v_lshl_add_u32 v248, v249, 8, v248
    v_add3_u32 v204, v248, v250, 0
    buffer_load_dwordx4 v221, s[12:15], s61 offen offset:1024 nt lds
    v_add_u32 v204, 2048, v204
    v_xor_b32 v205, 64, v204
    v_xor_b32 v206, 128, v204
    v_xor_b32 v207, 192, v204
    v_mul_u32_u24 v248, 20480, v244
    buffer_load_dwordx4 v222, s[12:15], s61 offen offset:2048 nt lds
    v_lshl_add_u32 v248, v246, 8, v248
    v_add3_u32 v248, v248, v250, 0
    v_add_u32 v239, 65536, v248
    v_lshlrev_b32 v248, 12, v244
    v_add_u32 v248, 147456, v248
    buffer_load_dwordx4 v223, s[12:15], s61 offen offset:3072 nt lds
    v_lshl_add_u32 v241, v245, 4, v248
    v_lshl_add_u32 v248, v246, 8, v248
    v_lshrrev_b32 v249, 1, v247
    v_xor_b32 v249, v249, v246
    v_lshl_add_u32 v248, v249, 4, v248
    s_add_u32 m0, s3, 4096
    s_add_u32 s61, s55, 65536
    buffer_load_dwordx4 v220, s[12:15], s61 offen offset:0 nt lds
    v_and_b32 v249, 1, v247
    v_lshl_add_u32 v240, v249, 3, v248
    v_lshrrev_b32 v248, 1, v247
    v_lshlrev_b32 v248, 12, v248
    v_mul_u32_u24 v249, 1056, v249
    buffer_load_dwordx4 v221, s[12:15], s61 offen offset:1024 nt lds
    v_add_u32 v248, v248, v249
    v_lshrrev_b32 v249, 2, v246
    v_mul_u32_u24 v249, 320, v249
    v_add_u32 v248, v248, v249
    v_and_b32 v249, 3, v245
    buffer_load_dwordx4 v222, s[12:15], s61 offen offset:2048 nt lds
    v_lshl_add_u32 v208, v249, 3, v248
    v_xor_b32 v209, 32, v208
    v_xor_b32 v210, 64, v208
    v_xor_b32 v211, 96, v208
    v_xor_b32 v212, 128, v208
    buffer_load_dwordx4 v223, s[12:15], s61 offen offset:3072 nt lds
    v_xor_b32 v213, 160, v208
    v_xor_b32 v214, 192, v208
    v_xor_b32 v215, 224, v208
    v_mov_b32 v228, 0x3f803f80
    v_mov_b32 v229, 0x3f803f80
    s_add_u32 m0, s41, 16384
    s_nop 0
    buffer_load_dwordx4 v216, s[16:19], s28 offen offset:2048 lds
    v_mov_b32 v230, 0x3f803f80
    v_mov_b32 v231, 0x3f803f80
    v_and_b32 v236, 3, v245
    v_and_b32 v248, 1, v245
    v_lshlrev_b32 v248, 4, v248
    buffer_load_dwordx4 v217, s[16:19], s28 offen offset:3072 lds
    v_lshlrev_b32 v248, v248, 1
    v_lshrrev_b32 v249, 1, v246
    v_lshlrev_b32 v243, 1, v247
    v_cmp_eq_u32 vcc, v249, v243
    v_add_u32 v243, 1, v243
    v_cmp_eq_u32 s[68:69], v249, v243
    v_cndmask_b32 v238, 0, v248, vcc
    s_nop 0
    v_cndmask_b32 v243, 0, v248, s[68:69]
    v_mul_u32_u24 v236, 20480, v236
    v_add_u32 v236, 81920, v236
Lstart:
    s_mov_b64 s[36:37], s[28:29]
    s_mov_b32 s43, s31
    s_mov_b32 s26, s30
    s_mov_b32 s22, s30
    s_mov_b32 s10, s30
    s_mov_b32 s56, s55
    s_mov_b64 s[28:29], s[32:33]
    s_mov_b64 s[30:31], s[34:35]
    s_mov_b64 s[32:33], 0
    s_mov_b64 s[34:35], 0
    s_mov_b32 s14, s30
    s_bfe_u32 s50, s29, 0x30018
    s_mul_i32 s61, s50, s47
    s_lshl_b32 s61, s61, 16
    s_and_b32 s55, s29, 0xfff000
    s_add_u32 s55, s55, s28
    s_add_u32 s55, s55, s61
    s_and_b32 s42, s37, 63
    s_bfe_u32 s54, s37, 0x60006
    s_mov_b32 s40, s36
    s_add_u32 s63, s36, 262144
    s_bfe_u32 s61, s37, 0x30018
    s_cmp_eq_u32 s61, 5
    s_cbranch_scc1 Lpro5
    s_cmp_eq_u32 s61, 3
    s_cbranch_scc1 Lpro3
    s_cmp_eq_u32 s61, 2
    s_cbranch_scc1 Lpro2
Lpro4:
    s_add_u32 m0, s3, 8192
    s_add_u32 s61, s56, 131072
    buffer_load_dwordx4 v220, s[8:11], s61 offen offset:0 nt lds
    v_xor_b32 v252, 0, v239
    v_add_u32 v176, 8, v252
    v_xor_b32 v254, 128, v239
    v_add_u32 v178, 8, v254
    v_xor_b32 v253, 64, v239
    v_add_u32 v177, 8, v253
    v_xor_b32 v255, 192, v239
    v_add_u32 v179, 8, v255
    v_mul_u32_u24 v172, 15875, v238
    v_mul_u32_u24 v173, 15875, v243
    v_mul_u32_u24 v174, 47576, v238
    v_mul_u32_u24 v175, 47576, v243
    v_sub_u32 v244, s54, v242
    v_cmp_lt_i32 s[68:69], 0, v244
    v_cmp_lt_i32 s[70:71], 1, v244
    v_cmp_lt_i32 s[72:73], 2, v244
    v_cmp_lt_i32 s[74:75], 3, v244
    v_mov_b32 v245, s46
    v_cndmask_b32 v164, v245, 0, s[68:69]
    v_cndmask_b32 v165, v245, 0, s[70:71]
    v_cndmask_b32 v166, v245, 0, s[72:73]
    v_cndmask_b32 v167, v245, 0, s[74:75]
    v_cmp_lt_i32 s[68:69], 16, v244
    v_cmp_lt_i32 s[70:71], 17, v244
    v_cmp_lt_i32 s[72:73], 18, v244
    v_cmp_lt_i32 s[74:75], 19, v244
    v_cndmask_b32 v168, v245, 0, s[68:69]
    v_cndmask_b32 v169, v245, 0, s[70:71]
    v_cndmask_b32 v170, v245, 0, s[72:73]
    v_cndmask_b32 v171, v245, 0, s[74:75]
    buffer_load_dwordx4 v221, s[8:11], s61 offen offset:1024 nt lds
    buffer_load_dwordx4 v222, s[8:11], s61 offen offset:2048 nt lds
    buffer_load_dwordx4 v223, s[8:11], s61 offen offset:3072 nt lds
    s_cmp_eq_u32 s64, 0
    s_cbranch_scc1 Lw196042
    s_waitcnt vmcnt(10)
Lw196042:
    ds_read2st64_b64 a[4:7], v176 offset0:0 offset1:0
    s_barrier
    ds_read2st64_b64 a[0:3], v252 offset0:0 offset1:0
    s_add_u32 m0, s3, 12288
    ds_read2st64_b64 a[20:23], v178 offset0:0 offset1:0
    s_add_u32 s61, s56, 196608
    ds_read2st64_b64 a[8:11], v253 offset0:0 offset1:0
    ds_read2st64_b64 a[12:15], v177 offset0:0 offset1:0
    ds_read2st64_b64 a[16:19], v254 offset0:0 offset1:0
    ds_read_b128 a[176:179], v204 offset:8192
    buffer_load_dwordx4 v220, s[8:11], s61 offen offset:0 nt lds
    ds_read2st64_b64 a[24:27], v255 offset0:0 offset1:0
    ds_read2st64_b64 a[28:31], v179 offset0:0 offset1:0
    ds_read_b128 a[180:183], v205 offset:8192
    s_waitcnt lgkmcnt(9)
    v_mfma_f32_16x16x32_bf16 v[68:71], v[172:175], a[4:7], 0
    ds_read_b128 a[184:187], v206 offset:8192
    ds_read_b128 a[160:163], v204 offset:0
    ds_read_b128 a[188:191], v207 offset:8192
    buffer_load_dwordx4 v221, s[8:11], s61 offen offset:1024 nt lds
    s_waitcnt lgkmcnt(10)
    v_mfma_f32_16x16x32_bf16 v[64:67], v[172:175], a[0:3], 0
    ds_read_b128 a[164:167], v205 offset:0
    s_nop 0
    v_cvt_pk_bf16_f32 v2, v68, v69
    s_waitcnt lgkmcnt(8)
    v_mfma_f32_16x16x32_bf16 v[104:107], v[172:175], a[8:11], 0
    ds_read_b128 a[168:171], v206 offset:0
    v_cvt_pk_bf16_f32 v3, v70, v71
    v_mfma_f32_16x16x32_bf16 v[68:71], v[172:175], a[20:23], 0
    ds_read_b128 a[172:175], v207 offset:0
    v_cvt_pk_bf16_f32 v0, v64, v65
    v_mfma_f32_16x16x32_bf16 v[108:111], v[172:175], a[12:15], 0
    buffer_load_dwordx4 v222, s[8:11], s61 offen offset:2048 nt lds
    v_cvt_pk_bf16_f32 v1, v66, v67
    v_mfma_f32_16x16x32_bf16 v[64:67], v[172:175], a[16:19], 0
    v_cvt_pk_bf16_f32 v4, v104, v105
    v_cvt_pk_bf16_f32 v5, v106, v107
    s_waitcnt lgkmcnt(4)
    v_mfma_f32_16x16x32_bf16 v[104:107], v[172:175], a[24:27], 0
    v_cvt_pk_bf16_f32 v10, v68, v69
    v_cvt_pk_bf16_f32 v11, v70, v71
    v_mfma_f32_16x16x32_bf16 v[68:71], a[176:179], v[0:3], v[168:171]
    v_cvt_pk_bf16_f32 v6, v108, v109
    v_cvt_pk_bf16_f32 v7, v110, v111
    v_mfma_f32_16x16x32_bf16 v[108:111], v[172:175], a[28:31], 0
    buffer_load_dwordx4 v223, s[8:11], s61 offen offset:3072 nt lds
    v_cvt_pk_bf16_f32 v8, v64, v65
    v_mfma_f32_16x16x32_bf16 v[68:71], a[180:183], v[4:7], v[68:71]
    v_cvt_pk_bf16_f32 v9, v66, v67
    v_cvt_pk_bf16_f32 v12, v104, v105
    v_mfma_f32_16x16x32_bf16 v[64:67], a[160:163], v[0:3], v[164:167]
    v_cvt_pk_bf16_f32 v13, v106, v107
    v_mfma_f32_16x16x32_bf16 v[68:71], a[184:187], v[8:11], v[68:71]
    v_cvt_pk_bf16_f32 v14, v108, v109
    v_cvt_pk_bf16_f32 v15, v110, v111
    s_waitcnt lgkmcnt(0)
    v_mfma_f32_16x16x32_bf16 v[64:67], a[164:167], v[4:7], v[64:67]
    v_mfma_f32_16x16x32_bf16 v[68:71], a[188:191], v[12:15], v[68:71]
    s_cmp_eq_u32 s64, 0
    s_cbranch_scc1 Lw196115
    s_waitcnt vmcnt(8)
Lw196115:
    ds_read2st64_b64 a[32:35], v252 offset0:8 offset1:8
    v_mfma_f32_16x16x32_bf16 v[64:67], a[168:171], v[8:11], v[64:67]
    ds_read2st64_b64 a[36:39], v176 offset0:8 offset1:8
    s_barrier
    v_mfma_f32_16x16x32_bf16 v[64:67], a[172:175], v[12:15], v[64:67]
    ds_read_b128 a[192:195], v204 offset:16384
    ds_read_b128 a[208:211], v204 offset:24576
    ds_read_b128 a[196:199], v205 offset:16384
    ds_read_b128 a[212:215], v205 offset:24576
    ds_read_b128 a[200:203], v206 offset:16384
    ds_read_b128 a[216:219], v206 offset:24576
    ds_read_b128 a[204:207], v207 offset:16384
    s_nop 0
    v_max3_f32 v246, v64, v65, v66
    s_waitcnt lgkmcnt(8)
    v_mfma_f32_16x16x32_bf16 v[72:75], v[172:175], a[32:35], 0
    ds_read_b128 a[220:223], v207 offset:24576
    v_max3_f32 v246, v246, v67, v68
    s_waitcnt lgkmcnt(8)
    v_mfma_f32_16x16x32_bf16 v[76:79], v[172:175], a[36:39], 0
    ds_read2st64_b64 a[48:51], v254 offset0:8 offset1:8
    v_max3_f32 v246, v246, v69, v70
    v_max_f32 v246, v246, v71
    v_mov_b32 v247, v246
    v_cvt_pk_bf16_f32 v16, v72, v73
    v_cvt_pk_bf16_f32 v17, v74, v75
    v_permlane32_swap_b32 v246, v247
    v_max_f32 v246, v246, v247
    v_mov_b32 v247, v246
    v_cvt_pk_bf16_f32 v18, v76, v77
    v_cvt_pk_bf16_f32 v19, v78, v79
    v_permlane16_swap_b32 v246, v247
    v_max_f32 v246, v246, v247
    v_add_f32 v246, s44, v246
    v_sub_f32 v184, 0, v246
    v_sub_f32 v185, 0, v246
    v_sub_f32 v186, 0, v246
    v_sub_f32 v187, 0, v246
    v_sub_f32 v64, v64, v246
    v_sub_f32 v65, v65, v246
    s_waitcnt lgkmcnt(2)
    v_mfma_f32_16x16x32_bf16 v[104:107], a[192:195], v[0:3], v[184:187]
    ds_read2st64_b64 a[52:55], v178 offset0:8 offset1:8
    v_sub_f32 v66, v66, v246
    v_mfma_f32_16x16x32_bf16 v[108:111], a[208:211], v[0:3], v[184:187]
    ds_read2st64_b64 a[40:43], v253 offset0:8 offset1:8
    v_sub_f32 v67, v67, v246
    v_mfma_f32_16x16x32_bf16 v[104:107], a[196:199], v[4:7], v[104:107]
    ds_read2st64_b64 a[44:47], v177 offset0:8 offset1:8
    v_exp_f32 v224, v64
    v_mfma_f32_16x16x32_bf16 v[108:111], a[212:215], v[4:7], v[108:111]
    ds_read2st64_b64 a[56:59], v255 offset0:8 offset1:8
    v_exp_f32 v225, v65
    v_mfma_f32_16x16x32_bf16 v[104:107], a[200:203], v[8:11], v[104:107]
    ds_read2st64_b64 a[60:63], v179 offset0:8 offset1:8
    v_exp_f32 v226, v66
    v_mfma_f32_16x16x32_bf16 v[108:111], a[216:219], v[8:11], v[108:111]
    v_exp_f32 v227, v67
    v_mfma_f32_16x16x32_bf16 v[104:107], a[204:207], v[12:15], v[104:107]
    v_sub_f32 v68, v68, v246
    v_sub_f32 v69, v69, v246
    s_waitcnt lgkmcnt(4)
    v_mfma_f32_16x16x32_bf16 v[108:111], a[220:223], v[12:15], v[108:111]
    v_sub_f32 v70, v70, v246
    v_sub_f32 v71, v71, v246
    v_mfma_f32_16x16x32_bf16 v[72:75], v[172:175], a[48:51], 0
    v_cvt_pk_bf16_f32 v144, v224, v225
    v_cvt_pk_bf16_f32 v145, v226, v227
    v_mfma_f32_16x16x32_bf16 v[76:79], v[172:175], a[52:55], 0
    v_exp_f32 v224, v68
    s_waitcnt lgkmcnt(1)
    v_mfma_f32_16x16x32_bf16 v[112:115], v[172:175], a[40:43], 0
    v_exp_f32 v225, v69
    v_mfma_f32_16x16x32_bf16 v[116:119], v[172:175], a[44:47], 0
    v_exp_f32 v226, v70
    v_exp_f32 v227, v71
    v_cvt_pk_bf16_f32 v146, v224, v225
    v_cvt_pk_bf16_f32 v147, v226, v227
    s_waitcnt vmcnt(4)
    s_add_u32 m0, s41, 32768
    ds_read2st64_b64 a[64:67], v252 offset0:16 offset1:16
    s_add_u32 s61, s36, 131072
    ds_read2st64_b64 a[68:71], v176 offset0:16 offset1:16
    v_cvt_pk_bf16_f32 v24, v72, v73
    v_cvt_pk_bf16_f32 v25, v74, v75
    v_mfma_f32_16x16x32_bf16 v[72:75], a[160:163], v[16:19], v[164:167]
    buffer_load_dwordx4 v216, s[16:19], s61 offen offset:2048 lds
    v_cvt_pk_bf16_f32 v26, v76, v77
    v_cvt_pk_bf16_f32 v27, v78, v79
    v_mfma_f32_16x16x32_bf16 v[76:79], a[176:179], v[16:19], v[168:171]
    ds_read2st64_b64 a[80:83], v254 offset0:16 offset1:16
    v_cvt_pk_bf16_f32 v20, v112, v113
    v_cvt_pk_bf16_f32 v21, v114, v115
    v_mfma_f32_16x16x32_bf16 v[112:115], v[172:175], a[56:59], 0
    ds_read2st64_b64 a[84:87], v178 offset0:16 offset1:16
    v_cvt_pk_bf16_f32 v22, v116, v117
    v_cvt_pk_bf16_f32 v23, v118, v119
    s_waitcnt lgkmcnt(4)
    v_mfma_f32_16x16x32_bf16 v[116:119], v[172:175], a[60:63], 0
    ds_read2st64_b64 a[72:75], v253 offset0:16 offset1:16
    s_barrier
    s_waitcnt lgkmcnt(3)
    v_mfma_f32_16x16x32_bf16 v[80:83], v[172:175], a[64:67], 0
    s_add_u32 s40, s40, 131072
    ds_read2st64_b64 a[76:79], v177 offset0:16 offset1:16
    v_cvt_pk_bf16_f32 v28, v112, v113
    v_mfma_f32_16x16x32_bf16 v[84:87], v[172:175], a[68:71], 0
    s_add_u32 s63, s63, 131072
    buffer_load_dwordx4 v217, s[16:19], s61 offen offset:3072 lds
    s_add_u32 m0, s41, 32768
    v_mfma_f32_16x16x32_bf16 v[72:75], a[164:167], v[20:23], v[72:75]
    s_add_u32 s61, s36, 262144
    ds_read2st64_b64 a[88:91], v255 offset0:16 offset1:16
    v_cvt_pk_bf16_f32 v32, v80, v81
    v_mfma_f32_16x16x32_bf16 v[76:79], a[180:183], v[20:23], v[76:79]
    ds_read2st64_b64 a[92:95], v179 offset0:16 offset1:16
    v_cvt_pk_bf16_f32 v33, v82, v83
    s_waitcnt lgkmcnt(4)
    v_mfma_f32_16x16x32_bf16 v[80:83], v[172:175], a[80:83], 0
    v_cvt_pk_bf16_f32 v34, v84, v85
    v_cvt_pk_bf16_f32 v35, v86, v87
    v_mfma_f32_16x16x32_bf16 v[72:75], a[168:171], v[24:27], v[72:75]
    buffer_load_dwordx4 v218, s[20:23], s43 offen lds
    v_cvt_pk_bf16_f32 v29, v114, v115
    v_mfma_f32_16x16x32_bf16 v[84:87], v[172:175], a[84:87], 0
    v_cvt_pk_bf16_f32 v30, v116, v117
    v_cvt_pk_bf16_f32 v31, v118, v119
    v_mfma_f32_16x16x32_bf16 v[76:79], a[184:187], v[24:27], v[76:79]
    v_cvt_pk_bf16_f32 v40, v80, v81
    v_cvt_pk_bf16_f32 v41, v82, v83
    s_waitcnt lgkmcnt(2)
    v_mfma_f32_16x16x32_bf16 v[120:123], v[172:175], a[72:75], 0
    s_nop 0
    v_cvt_pk_bf16_f32 v42, v84, v85
    v_mfma_f32_16x16x32_bf16 v[124:127], v[172:175], a[76:79], 0
    buffer_load_dwordx4 v219, s[20:23], s43 offen offset:1024 lds
    v_cvt_pk_bf16_f32 v43, v86, v87
    v_mfma_f32_16x16x32_bf16 v[72:75], a[172:175], v[28:31], v[72:75]
    s_add_u32 m0, s41, 49152
    s_nop 0
    v_cvt_pk_bf16_f32 v36, v120, v121
    v_mfma_f32_16x16x32_bf16 v[76:79], a[188:191], v[28:31], v[76:79]
    v_cvt_pk_bf16_f32 v37, v122, v123
    v_cvt_pk_bf16_f32 v38, v124, v125
    v_mfma_f32_16x16x32_bf16 v[80:83], a[160:163], v[32:35], v[164:167]
    v_cvt_pk_bf16_f32 v39, v126, v127
    v_max3_f32 v244, v72, v73, v74
    v_mfma_f32_16x16x32_bf16 v[84:87], a[176:179], v[32:35], v[168:171]
    buffer_load_dwordx4 v216, s[16:19], s61 offen offset:2048 lds
    s_waitcnt lgkmcnt(0)
    v_mfma_f32_16x16x32_bf16 v[120:123], v[172:175], a[88:91], 0
    v_max3_f32 v244, v244, v75, v76
    v_max3_f32 v244, v244, v77, v78
    v_mfma_f32_16x16x32_bf16 v[124:127], v[172:175], a[92:95], 0
    v_max_f32 v244, v244, v79
    v_mov_b32 v245, v244
    v_mfma_f32_16x16x32_bf16 v[80:83], a[164:167], v[36:39], v[80:83]
    s_nop 0
    v_permlane32_swap_b32 v244, v245
    v_mfma_f32_16x16x32_bf16 v[84:87], a[180:183], v[36:39], v[84:87]
    buffer_load_dwordx4 v217, s[16:19], s61 offen offset:3072 lds
    v_max_f32 v244, v244, v245
    v_mfma_f32_16x16x32_bf16 v[80:83], a[168:171], v[40:43], v[80:83]
    s_add_u32 m0, s41, 49152
    v_cvt_pk_bf16_f32 v44, v120, v121
    v_cvt_pk_bf16_f32 v45, v122, v123
    v_mfma_f32_16x16x32_bf16 v[84:87], a[184:187], v[40:43], v[84:87]
    v_cvt_pk_bf16_f32 v46, v124, v125
    v_cvt_pk_bf16_f32 v47, v126, v127
    v_mov_b32 v245, v244
    s_nop 0
    v_mfma_f32_16x16x32_bf16 v[80:83], a[172:175], v[44:47], v[80:83]
    v_permlane16_swap_b32 v244, v245
    v_mfma_f32_16x16x32_bf16 v[84:87], a[188:191], v[44:47], v[84:87]
    buffer_load_dwordx4 v218, s[20:23], s36 offen lds
    v_max_f32 v244, v244, v245
    v_add_f32 v244, s44, v244
    v_sub_f32 v188, 0, v244
    v_sub_f32 v189, 0, v244
    v_sub_f32 v190, 0, v244
    v_sub_f32 v191, 0, v244
    v_max3_f32 v246, v80, v81, v82
    v_max3_f32 v246, v246, v83, v84
    v_mfma_f32_16x16x32_bf16 v[112:115], a[192:195], v[16:19], v[188:191]
    v_max3_f32 v246, v246, v85, v86
    v_max_f32 v246, v246, v87
    v_mfma_f32_16x16x32_bf16 v[116:119], a[208:211], v[16:19], v[188:191]
    buffer_load_dwordx4 v219, s[20:23], s36 offen offset:1024 lds
    v_mfma_f32_16x16x32_bf16 v[112:115], a[196:199], v[20:23], v[112:115]
    s_mov_b32 m0, s41
    v_mov_b32 v247, v246
    v_sub_f32 v72, v72, v244
    v_mfma_f32_16x16x32_bf16 v[116:119], a[212:215], v[20:23], v[116:119]
    v_permlane32_swap_b32 v246, v247
    v_mfma_f32_16x16x32_bf16 v[112:115], a[200:203], v[24:27], v[112:115]
    v_sub_f32 v73, v73, v244
    v_sub_f32 v74, v74, v244
    v_mfma_f32_16x16x32_bf16 v[116:119], a[216:219], v[24:27], v[116:119]
    buffer_load_dwordx4 v218, s[20:23], s40 offen lds
    v_mfma_f32_16x16x32_bf16 v[112:115], a[204:207], v[28:31], v[112:115]
    v_sub_f32 v75, v75, v244
    v_max_f32 v246, v246, v247
    v_mfma_f32_16x16x32_bf16 v[116:119], a[220:223], v[28:31], v[116:119]
    v_exp_f32 v248, v72
    v_exp_f32 v249, v73
    v_exp_f32 v250, v74
    v_exp_f32 v251, v75
    v_mov_b32 v247, v246
    v_sub_f32 v76, v76, v244
    v_sub_f32 v77, v77, v244
    v_sub_f32 v78, v78, v244
    v_sub_f32 v79, v79, v244
    v_cvt_pk_bf16_f32 v148, v248, v249
    v_cvt_pk_bf16_f32 v149, v250, v251
    v_permlane16_swap_b32 v246, v247
    v_exp_f32 v248, v76
    v_exp_f32 v249, v77
    v_exp_f32 v250, v78
    v_exp_f32 v251, v79
    v_max_f32 v246, v246, v247
    v_add_f32 v246, s44, v246
    v_cvt_pk_bf16_f32 v150, v248, v249
    v_cvt_pk_bf16_f32 v151, v250, v251
    v_sub_f32 v192, 0, v246
    v_sub_f32 v193, 0, v246
    v_sub_f32 v194, 0, v246
    v_sub_f32 v195, 0, v246
    v_sub_f32 v80, v80, v246
    v_sub_f32 v81, v81, v246
    v_mfma_f32_16x16x32_bf16 v[120:123], a[192:195], v[32:35], v[192:195]
    buffer_load_dwordx4 v219, s[20:23], s40 offen offset:1024 lds
    v_sub_f32 v82, v82, v246
    v_mfma_f32_16x16x32_bf16 v[124:127], a[208:211], v[32:35], v[192:195]
    s_add_u32 s40, s40, 131072
    v_sub_f32 v83, v83, v246
    v_sub_f32 v84, v84, v246
    v_mfma_f32_16x16x32_bf16 v[120:123], a[196:199], v[36:39], v[120:123]
    v_sub_f32 v85, v85, v246
    v_sub_f32 v86, v86, v246
    v_mfma_f32_16x16x32_bf16 v[124:127], a[212:215], v[36:39], v[124:127]
    v_sub_f32 v87, v87, v246
    s_waitcnt vmcnt(10)
    v_mfma_f32_16x16x32_bf16 v[120:123], a[200:203], v[40:43], v[120:123]
    ds_read2st64_b64 a[96:99], v252 offset0:24 offset1:24
    v_exp_f32 v224, v80
    v_mfma_f32_16x16x32_bf16 v[124:127], a[216:219], v[40:43], v[124:127]
    ds_read2st64_b64 a[100:103], v176 offset0:24 offset1:24
    v_exp_f32 v225, v81
    v_mfma_f32_16x16x32_bf16 v[120:123], a[204:207], v[44:47], v[120:123]
    ds_read2st64_b64 a[112:115], v254 offset0:24 offset1:24
    v_exp_f32 v226, v82
    v_mfma_f32_16x16x32_bf16 v[124:127], a[220:223], v[44:47], v[124:127]
    ds_read2st64_b64 a[116:119], v178 offset0:24 offset1:24
    v_exp_f32 v227, v83
    v_cvt_pk_bf16_f32 v152, v224, v225
    v_cvt_pk_bf16_f32 v153, v226, v227
    v_exp_f32 v224, v84
    v_exp_f32 v225, v85
    v_exp_f32 v226, v86
    v_exp_f32 v227, v87
    v_cvt_pk_bf16_f32 v154, v224, v225
    v_cvt_pk_bf16_f32 v155, v226, v227
    s_waitcnt lgkmcnt(3)
    v_mfma_f32_16x16x32_bf16 v[88:91], v[172:175], a[96:99], 0
    ds_read2st64_b64 a[104:107], v253 offset0:24 offset1:24
    ds_read2st64_b64 a[108:111], v177 offset0:24 offset1:24
    s_waitcnt lgkmcnt(4)
    v_mfma_f32_16x16x32_bf16 v[92:95], v[172:175], a[100:103], 0
    ds_read2st64_b64 a[120:123], v255 offset0:24 offset1:24
    ds_read2st64_b64 a[124:127], v179 offset0:24 offset1:24
    buffer_load_dwordx4 v216, s[16:19], s63 offen offset:2048 lds
    s_nop 0
    v_cvt_pk_bf16_f32 v48, v88, v89
    v_cvt_pk_bf16_f32 v49, v90, v91
    s_waitcnt lgkmcnt(4)
    v_mfma_f32_16x16x32_bf16 v[88:91], v[172:175], a[112:115], 0
    v_cvt_pk_bf16_f32 v50, v92, v93
    v_cvt_pk_bf16_f32 v51, v94, v95
    v_mfma_f32_16x16x32_bf16 v[92:95], v[172:175], a[116:119], 0
    buffer_load_dwordx4 v217, s[16:19], s63 offen offset:3072 lds
    s_add_u32 m0, s41, 16384
    s_add_u32 s63, s63, 131072
    s_nop 1
    v_cvt_pk_bf16_f32 v56, v88, v89
    s_waitcnt lgkmcnt(2)
    v_mfma_f32_16x16x32_bf16 v[128:131], v[172:175], a[104:107], 0
    v_cvt_pk_bf16_f32 v57, v90, v91
    v_cvt_pk_bf16_f32 v58, v92, v93
    v_mfma_f32_16x16x32_bf16 v[132:135], v[172:175], a[108:111], 0
    v_cvt_pk_bf16_f32 v59, v94, v95
    v_mfma_f32_16x16x32_bf16 v[88:91], a[160:163], v[48:51], v[164:167]
    buffer_load_dwordx4 v218, s[20:23], s40 offen lds
    v_mfma_f32_16x16x32_bf16 v[92:95], a[176:179], v[48:51], v[168:171]
    s_nop 0
    v_cvt_pk_bf16_f32 v52, v128, v129
    v_cvt_pk_bf16_f32 v53, v130, v131
    s_waitcnt lgkmcnt(0)
    v_mfma_f32_16x16x32_bf16 v[128:131], v[172:175], a[120:123], 0
    v_cvt_pk_bf16_f32 v54, v132, v133
    v_cvt_pk_bf16_f32 v55, v134, v135
    v_mfma_f32_16x16x32_bf16 v[132:135], v[172:175], a[124:127], 0
    buffer_load_dwordx4 v219, s[20:23], s40 offen offset:1024 lds
    v_mfma_f32_16x16x32_bf16 v[88:91], a[164:167], v[52:55], v[88:91]
    v_mfma_f32_16x16x32_bf16 v[92:95], a[180:183], v[52:55], v[92:95]
    v_mfma_f32_16x16x32_bf16 v[88:91], a[168:171], v[56:59], v[88:91]
    s_nop 0
    v_cvt_pk_bf16_f32 v60, v128, v129
    v_mfma_f32_16x16x32_bf16 v[92:95], a[184:187], v[56:59], v[92:95]
    buffer_load_dwordx4 v216, s[16:19], s63 offen offset:2048 lds
    v_cvt_pk_bf16_f32 v61, v130, v131
    v_cvt_pk_bf16_f32 v62, v132, v133
    v_cvt_pk_bf16_f32 v63, v134, v135
    s_nop 1
    v_mfma_f32_16x16x32_bf16 v[88:91], a[172:175], v[60:63], v[88:91]
    v_mfma_f32_16x16x32_bf16 v[92:95], a[188:191], v[60:63], v[92:95]
    buffer_load_dwordx4 v217, s[16:19], s63 offen offset:3072 lds
    s_nop 5
    v_max3_f32 v244, v88, v89, v90
    v_max3_f32 v244, v244, v91, v92
    v_max3_f32 v244, v244, v93, v94
    v_max_f32 v244, v244, v95
    v_mov_b32 v245, v244
    s_nop 1
    v_permlane32_swap_b32 v244, v245
    v_max_f32 v244, v244, v245
    v_mov_b32 v245, v244
    s_nop 1
    v_permlane16_swap_b32 v244, v245
    v_max_f32 v244, v244, v245
    v_add_f32 v244, s44, v244
    v_sub_f32 v196, 0, v244
    v_sub_f32 v197, 0, v244
    v_sub_f32 v198, 0, v244
    v_sub_f32 v199, 0, v244
    v_sub_f32 v88, v88, v244
    v_sub_f32 v89, v89, v244
    v_mfma_f32_16x16x32_bf16 v[128:131], a[192:195], v[48:51], v[196:199]
    v_sub_f32 v90, v90, v244
    v_sub_f32 v91, v91, v244
    v_mfma_f32_16x16x32_bf16 v[132:135], a[208:211], v[48:51], v[196:199]
    v_sub_f32 v92, v92, v244
    v_sub_f32 v93, v93, v244
    v_mfma_f32_16x16x32_bf16 v[128:131], a[196:199], v[52:55], v[128:131]
    v_sub_f32 v94, v94, v244
    v_sub_f32 v95, v95, v244
    v_mfma_f32_16x16x32_bf16 v[132:135], a[212:215], v[52:55], v[132:135]
    s_waitcnt vmcnt(12)
    s_barrier
    v_mfma_f32_16x16x32_bf16 v[128:131], a[200:203], v[56:59], v[128:131]
    ds_read_b128 a[160:163], v204 offset:32768
    v_exp_f32 v248, v88
    v_mfma_f32_16x16x32_bf16 v[132:135], a[216:219], v[56:59], v[132:135]
    ds_read_b128 a[164:167], v205 offset:32768
    v_exp_f32 v249, v89
    v_mfma_f32_16x16x32_bf16 v[128:131], a[204:207], v[60:63], v[128:131]
    ds_read_b128 a[168:171], v206 offset:32768
    v_exp_f32 v250, v90
    v_mfma_f32_16x16x32_bf16 v[132:135], a[220:223], v[60:63], v[132:135]
    ds_read_b128 a[172:175], v207 offset:32768
    v_exp_f32 v251, v91
    v_cvt_pk_bf16_f32 v156, v248, v249
    v_cvt_pk_bf16_f32 v157, v250, v251
    v_exp_f32 v248, v92
    v_exp_f32 v249, v93
    v_exp_f32 v250, v94
    v_exp_f32 v251, v95
    v_cvt_pk_bf16_f32 v158, v248, v249
    v_cvt_pk_bf16_f32 v159, v250, v251
    ds_read_b128 a[176:179], v204 offset:40960
    ds_read_b128 a[180:183], v205 offset:40960
    ds_read_b128 a[184:187], v206 offset:40960
    ds_read_b128 a[188:191], v207 offset:40960
    s_sub_u32 s42, s42, 1
    s_cmp_lg_u32 s65, 0
    s_cbranch_scc1 Lsafe4
    s_waitcnt lgkmcnt(0)
    v_mfma_f32_16x16x32_bf16 v[64:67], a[160:163], v[0:3], v[184:187]
    ds_read_b64_tr_b16 a[192:193], v208 offset:32768
    v_mfma_f32_16x16x32_bf16 v[72:75], a[160:163], v[16:19], v[188:191]
    ds_read_b64_tr_b16 a[194:195], v208 offset:40960
    v_mfma_f32_16x16x32_bf16 v[80:83], a[160:163], v[32:35], v[192:195]
    v_exp_f32 v224, v128
    v_mfma_f32_16x16x32_bf16 v[88:91], a[160:163], v[48:51], v[196:199]
    ds_read_b64_tr_b16 a[196:197], v209 offset:32768
    v_mfma_f32_16x16x32_bf16 v[64:67], a[164:167], v[4:7], v[64:67]
    ds_read_b64_tr_b16 a[198:199], v209 offset:40960
    v_mfma_f32_16x16x32_bf16 v[72:75], a[164:167], v[20:23], v[72:75]
    v_exp_f32 v225, v129
    v_mfma_f32_16x16x32_bf16 v[80:83], a[164:167], v[36:39], v[80:83]
    ds_read_b64_tr_b16 a[200:201], v210 offset:32768
    v_cvt_pk_bf16_f32 v176, v224, v225
    v_mfma_f32_16x16x32_bf16 v[88:91], a[164:167], v[52:55], v[88:91]
    v_exp_f32 v226, v130
    v_mfma_f32_16x16x32_bf16 v[64:67], a[168:171], v[8:11], v[64:67]
    ds_read_b64_tr_b16 a[202:203], v210 offset:40960
    v_mfma_f32_16x16x32_bf16 v[72:75], a[168:171], v[24:27], v[72:75]
    ds_read_b64_tr_b16 a[204:205], v211 offset:32768
    v_mfma_f32_16x16x32_bf16 v[80:83], a[168:171], v[40:43], v[80:83]
    v_exp_f32 v227, v131
    v_mfma_f32_16x16x32_bf16 v[88:91], a[168:171], v[56:59], v[88:91]
    ds_read_b64_tr_b16 a[206:207], v211 offset:40960
    v_cvt_pk_bf16_f32 v177, v226, v227
    v_mfma_f32_16x16x32_bf16 v[64:67], a[172:175], v[12:15], v[64:67]
    v_exp_f32 v248, v132
    v_mfma_f32_16x16x32_bf16 v[72:75], a[172:175], v[28:31], v[72:75]
    ds_read_b64_tr_b16 a[208:209], v212 offset:32768
    v_mfma_f32_16x16x32_bf16 v[80:83], a[172:175], v[44:47], v[80:83]
    ds_read_b64_tr_b16 a[210:211], v212 offset:40960
    v_mfma_f32_16x16x32_bf16 v[88:91], a[172:175], v[60:63], v[88:91]
    v_exp_f32 v249, v133
    v_mfma_f32_16x16x32_bf16 v[68:71], a[176:179], v[0:3], v[184:187]
    ds_read_b64_tr_b16 a[212:213], v213 offset:32768
    v_cvt_pk_bf16_f32 v178, v248, v249
    v_mfma_f32_16x16x32_bf16 v[76:79], a[176:179], v[16:19], v[188:191]
    ds_read_b64_tr_b16 a[214:215], v213 offset:40960
    v_mfma_f32_16x16x32_bf16 v[84:87], a[176:179], v[32:35], v[192:195]
    v_exp_f32 v250, v134
    v_mfma_f32_16x16x32_bf16 v[92:95], a[176:179], v[48:51], v[196:199]
    ds_read_b64_tr_b16 a[216:217], v214 offset:32768
    v_mfma_f32_16x16x32_bf16 v[68:71], a[180:183], v[4:7], v[68:71]
    v_exp_f32 v251, v135
    v_mfma_f32_16x16x32_bf16 v[76:79], a[180:183], v[20:23], v[76:79]
    ds_read_b64_tr_b16 a[218:219], v214 offset:40960
    v_cvt_pk_bf16_f32 v179, v250, v251
    v_mfma_f32_16x16x32_bf16 v[84:87], a[180:183], v[36:39], v[84:87]
    ds_read_b64_tr_b16 a[220:221], v215 offset:32768
    v_mfma_f32_16x16x32_bf16 v[92:95], a[180:183], v[52:55], v[92:95]
    v_exp_f32 v224, v120
    v_mfma_f32_16x16x32_bf16 v[68:71], a[184:187], v[8:11], v[68:71]
    ds_read_b64_tr_b16 a[222:223], v215 offset:40960
    v_mfma_f32_16x16x32_bf16 v[76:79], a[184:187], v[24:27], v[76:79]
    v_exp_f32 v225, v121
    v_mfma_f32_16x16x32_bf16 v[84:87], a[184:187], v[40:43], v[84:87]
    v_exp_f32 v226, v122
    v_mfma_f32_16x16x32_bf16 v[92:95], a[184:187], v[56:59], v[92:95]
    s_add_u32 m0, s41, 32768
    v_exp_f32 v227, v123
    v_mfma_f32_16x16x32_bf16 v[68:71], a[188:191], v[12:15], v[68:71]
    s_add_u32 s40, s40, 131072
    v_exp_f32 v248, v124
    v_mfma_f32_16x16x32_bf16 v[76:79], a[188:191], v[28:31], v[76:79]
    s_add_u32 s63, s63, 131072
    v_exp_f32 v249, v125
    v_mfma_f32_16x16x32_bf16 v[84:87], a[188:191], v[44:47], v[84:87]
    s_waitcnt vmcnt(8) lgkmcnt(0)
    v_exp_f32 v250, v126
    v_mfma_f32_16x16x32_bf16 v[92:95], a[188:191], v[60:63], v[92:95]
    s_barrier
    v_mfma_f32_16x16x32_bf16 a[0:3], a[192:195], v[144:147], 0
    ds_read_b128 a[160:163], v204 offset:49152
    v_cvt_pk_bf16_f32 v172, v224, v225
    v_mfma_f32_16x16x32_bf16 a[32:35], a[192:195], v[148:151], 0
    v_exp_f32 v251, v127
    v_mfma_f32_16x16x32_bf16 a[64:67], a[192:195], v[152:155], 0
    ds_read_b128 a[164:167], v205 offset:49152
    v_cvt_pk_bf16_f32 v173, v226, v227
    v_mfma_f32_16x16x32_bf16 a[96:99], a[192:195], v[156:159], 0
    v_exp_f32 v224, v112
    v_mfma_f32_16x16x32_bf16 a[4:7], a[196:199], v[144:147], 0
    v_exp_f32 v225, v113
    v_mfma_f32_16x16x32_bf16 a[36:39], a[196:199], v[148:151], 0
    buffer_load_dwordx4 v218, s[20:23], s40 offen lds
    v_cvt_pk_bf16_f32 v174, v248, v249
    v_mfma_f32_16x16x32_bf16 a[68:71], a[196:199], v[152:155], 0
    v_exp_f32 v226, v114
    v_mfma_f32_16x16x32_bf16 a[100:103], a[196:199], v[156:159], 0
    ds_read_b128 a[168:171], v206 offset:49152
    v_cvt_pk_bf16_f32 v175, v250, v251
    v_mfma_f32_16x16x32_bf16 a[8:11], a[200:203], v[144:147], 0
    v_exp_f32 v227, v115
    v_mfma_f32_16x16x32_bf16 a[40:43], a[200:203], v[148:151], 0
    v_exp_f32 v248, v116
    v_mfma_f32_16x16x32_bf16 a[72:75], a[200:203], v[152:155], 0
    ds_read_b128 a[172:175], v207 offset:49152
    v_cvt_pk_bf16_f32 v168, v224, v225
    v_mfma_f32_16x16x32_bf16 a[104:107], a[200:203], v[156:159], 0
    v_exp_f32 v249, v117
    v_mfma_f32_16x16x32_bf16 a[12:15], a[204:207], v[144:147], 0
    v_exp_f32 v250, v118
    v_mfma_f32_16x16x32_bf16 a[44:47], a[204:207], v[148:151], 0
    buffer_load_dwordx4 v219, s[20:23], s40 offen offset:1024 lds
    v_cvt_pk_bf16_f32 v169, v226, v227
    v_mfma_f32_16x16x32_bf16 a[76:79], a[204:207], v[152:155], 0
    v_exp_f32 v251, v119
    v_mfma_f32_16x16x32_bf16 a[108:111], a[204:207], v[156:159], 0
    ds_read_b128 a[176:179], v204 offset:57344
    v_cvt_pk_bf16_f32 v170, v248, v249
    v_mfma_f32_16x16x32_bf16 a[16:19], a[208:211], v[144:147], 0
    v_exp_f32 v224, v104
    v_mfma_f32_16x16x32_bf16 a[48:51], a[208:211], v[148:151], 0
    v_exp_f32 v225, v105
    v_mfma_f32_16x16x32_bf16 a[80:83], a[208:211], v[152:155], 0
    ds_read_b128 a[180:183], v205 offset:57344
    v_cvt_pk_bf16_f32 v171, v250, v251
    v_mfma_f32_16x16x32_bf16 a[112:115], a[208:211], v[156:159], 0
    v_exp_f32 v226, v106
    v_mfma_f32_16x16x32_bf16 a[20:23], a[212:215], v[144:147], 0
    v_exp_f32 v227, v107
    v_mfma_f32_16x16x32_bf16 a[52:55], a[212:215], v[148:151], 0
    ds_read_b128 a[184:187], v206 offset:57344
    v_cvt_pk_bf16_f32 v164, v224, v225
    v_mfma_f32_16x16x32_bf16 a[84:87], a[212:215], v[152:155], 0
    v_exp_f32 v248, v108
    v_mfma_f32_16x16x32_bf16 a[116:119], a[212:215], v[156:159], 0
    buffer_load_dwordx4 v216, s[16:19], s63 offen offset:2048 lds
    v_cvt_pk_bf16_f32 v165, v226, v227
    v_mfma_f32_16x16x32_bf16 a[24:27], a[216:219], v[144:147], 0
    v_exp_f32 v249, v109
    v_mfma_f32_16x16x32_bf16 a[56:59], a[216:219], v[148:151], 0
    v_exp_f32 v250, v110
    v_mfma_f32_16x16x32_bf16 a[88:91], a[216:219], v[152:155], 0
    ds_read_b128 a[188:191], v207 offset:57344
    v_cvt_pk_bf16_f32 v166, v248, v249
    v_mfma_f32_16x16x32_bf16 a[120:123], a[216:219], v[156:159], 0
    v_exp_f32 v251, v111
    v_mfma_f32_16x16x32_bf16 a[28:31], a[220:223], v[144:147], 0
    v_cvt_pk_bf16_f32 v167, v250, v251
    v_mfma_f32_16x16x32_bf16 a[60:63], a[220:223], v[148:151], 0
    v_mfma_f32_16x16x32_bf16 a[92:95], a[220:223], v[152:155], 0
    v_mfma_f32_16x16x32_bf16 a[124:127], a[220:223], v[156:159], 0
    buffer_load_dwordx4 v217, s[16:19], s63 offen offset:3072 lds
    v_mfma_f32_16x16x32_bf16 a[240:243], v[228:231], v[144:147], 0
    s_sub_u32 s42, s42, 1
    v_mfma_f32_16x16x32_bf16 a[244:247], v[228:231], v[148:151], 0
    s_waitcnt lgkmcnt(0)
    v_mfma_f32_16x16x32_bf16 a[248:251], v[228:231], v[152:155], 0
    v_mfma_f32_16x16x32_bf16 a[252:255], v[228:231], v[156:159], 0
    .p2align 3
Lloop4:
    v_mfma_f32_16x16x32_bf16 v[104:107], a[160:163], v[0:3], v[184:187]
    ds_read_b64_tr_b16 a[192:193], v208 offset:49152
    v_mfma_f32_16x16x32_bf16 v[112:115], a[160:163], v[16:19], v[188:191]
    ds_read_b64_tr_b16 a[194:195], v208 offset:57344
    v_mfma_f32_16x16x32_bf16 v[120:123], a[160:163], v[32:35], v[192:195]
    v_exp_f32 v224, v88
    v_mfma_f32_16x16x32_bf16 v[128:131], a[160:163], v[48:51], v[196:199]
    ds_read_b64_tr_b16 a[196:197], v209 offset:49152
    v_mfma_f32_16x16x32_bf16 v[104:107], a[164:167], v[4:7], v[104:107]
    ds_read_b64_tr_b16 a[198:199], v209 offset:57344
    v_mfma_f32_16x16x32_bf16 v[112:115], a[164:167], v[20:23], v[112:115]
    v_exp_f32 v225, v89
    v_mfma_f32_16x16x32_bf16 v[120:123], a[164:167], v[36:39], v[120:123]
    ds_read_b64_tr_b16 a[200:201], v210 offset:49152
    v_cvt_pk_bf16_f32 v156, v224, v225
    v_mfma_f32_16x16x32_bf16 v[128:131], a[164:167], v[52:55], v[128:131]
    v_exp_f32 v226, v90
    v_mfma_f32_16x16x32_bf16 v[104:107], a[168:171], v[8:11], v[104:107]
    ds_read_b64_tr_b16 a[202:203], v210 offset:57344
    v_mfma_f32_16x16x32_bf16 v[112:115], a[168:171], v[24:27], v[112:115]
    ds_read_b64_tr_b16 a[204:205], v211 offset:49152
    v_mfma_f32_16x16x32_bf16 v[120:123], a[168:171], v[40:43], v[120:123]
    v_exp_f32 v227, v91
    v_mfma_f32_16x16x32_bf16 v[128:131], a[168:171], v[56:59], v[128:131]
    ds_read_b64_tr_b16 a[206:207], v211 offset:57344
    v_cvt_pk_bf16_f32 v157, v226, v227
    v_mfma_f32_16x16x32_bf16 v[104:107], a[172:175], v[12:15], v[104:107]
    v_exp_f32 v248, v92
    v_mfma_f32_16x16x32_bf16 v[112:115], a[172:175], v[28:31], v[112:115]
    ds_read_b64_tr_b16 a[208:209], v212 offset:49152
    v_mfma_f32_16x16x32_bf16 v[120:123], a[172:175], v[44:47], v[120:123]
    ds_read_b64_tr_b16 a[210:211], v212 offset:57344
    v_mfma_f32_16x16x32_bf16 v[128:131], a[172:175], v[60:63], v[128:131]
    v_exp_f32 v249, v93
    v_mfma_f32_16x16x32_bf16 v[108:111], a[176:179], v[0:3], v[184:187]
    ds_read_b64_tr_b16 a[212:213], v213 offset:49152
    v_cvt_pk_bf16_f32 v158, v248, v249
    v_mfma_f32_16x16x32_bf16 v[116:119], a[176:179], v[16:19], v[188:191]
    ds_read_b64_tr_b16 a[214:215], v213 offset:57344
    v_mfma_f32_16x16x32_bf16 v[124:127], a[176:179], v[32:35], v[192:195]
    v_exp_f32 v250, v94
    v_mfma_f32_16x16x32_bf16 v[132:135], a[176:179], v[48:51], v[196:199]
    ds_read_b64_tr_b16 a[216:217], v214 offset:49152
    v_mfma_f32_16x16x32_bf16 v[108:111], a[180:183], v[4:7], v[108:111]
    v_exp_f32 v251, v95
    v_mfma_f32_16x16x32_bf16 v[116:119], a[180:183], v[20:23], v[116:119]
    ds_read_b64_tr_b16 a[218:219], v214 offset:57344
    v_cvt_pk_bf16_f32 v159, v250, v251
    v_mfma_f32_16x16x32_bf16 v[124:127], a[180:183], v[36:39], v[124:127]
    ds_read_b64_tr_b16 a[220:221], v215 offset:49152
    v_mfma_f32_16x16x32_bf16 v[132:135], a[180:183], v[52:55], v[132:135]
    v_exp_f32 v224, v80
    v_mfma_f32_16x16x32_bf16 v[108:111], a[184:187], v[8:11], v[108:111]
    ds_read_b64_tr_b16 a[222:223], v215 offset:57344
    v_mfma_f32_16x16x32_bf16 v[116:119], a[184:187], v[24:27], v[116:119]
    v_exp_f32 v225, v81
    v_mfma_f32_16x16x32_bf16 v[124:127], a[184:187], v[40:43], v[124:127]
    v_exp_f32 v226, v82
    v_mfma_f32_16x16x32_bf16 v[132:135], a[184:187], v[56:59], v[132:135]
    s_add_u32 m0, s41, 49152
    v_exp_f32 v227, v83
    v_mfma_f32_16x16x32_bf16 v[108:111], a[188:191], v[12:15], v[108:111]
    s_add_u32 s40, s40, 131072
    v_exp_f32 v248, v84
    v_mfma_f32_16x16x32_bf16 v[116:119], a[188:191], v[28:31], v[116:119]
    s_add_u32 s63, s63, 131072
    v_exp_f32 v249, v85
    v_mfma_f32_16x16x32_bf16 v[124:127], a[188:191], v[44:47], v[124:127]
    s_waitcnt vmcnt(8) lgkmcnt(0)
    v_exp_f32 v250, v86
    v_mfma_f32_16x16x32_bf16 v[132:135], a[188:191], v[60:63], v[132:135]
    s_barrier
    v_mfma_f32_16x16x32_bf16 a[0:3], a[192:195], v[164:167], a[0:3]
    ds_read_b128 a[160:163], v204 offset:0
    v_cvt_pk_bf16_f32 v152, v224, v225
    v_mfma_f32_16x16x32_bf16 a[32:35], a[192:195], v[168:171], a[32:35]
    v_exp_f32 v251, v87
    v_mfma_f32_16x16x32_bf16 a[64:67], a[192:195], v[172:175], a[64:67]
    ds_read_b128 a[164:167], v205 offset:0
    v_cvt_pk_bf16_f32 v153, v226, v227
    v_mfma_f32_16x16x32_bf16 a[96:99], a[192:195], v[176:179], a[96:99]
    v_exp_f32 v224, v72
    v_mfma_f32_16x16x32_bf16 a[4:7], a[196:199], v[164:167], a[4:7]
    v_exp_f32 v225, v73
    v_mfma_f32_16x16x32_bf16 a[36:39], a[196:199], v[168:171], a[36:39]
    buffer_load_dwordx4 v218, s[20:23], s40 offen lds
    v_cvt_pk_bf16_f32 v154, v248, v249
    v_mfma_f32_16x16x32_bf16 a[68:71], a[196:199], v[172:175], a[68:71]
    v_exp_f32 v226, v74
    v_mfma_f32_16x16x32_bf16 a[100:103], a[196:199], v[176:179], a[100:103]
    ds_read_b128 a[168:171], v206 offset:0
    v_cvt_pk_bf16_f32 v155, v250, v251
    v_mfma_f32_16x16x32_bf16 a[8:11], a[200:203], v[164:167], a[8:11]
    v_exp_f32 v227, v75
    v_mfma_f32_16x16x32_bf16 a[40:43], a[200:203], v[168:171], a[40:43]
    v_exp_f32 v248, v76
    v_mfma_f32_16x16x32_bf16 a[72:75], a[200:203], v[172:175], a[72:75]
    ds_read_b128 a[172:175], v207 offset:0
    v_cvt_pk_bf16_f32 v148, v224, v225
    v_mfma_f32_16x16x32_bf16 a[104:107], a[200:203], v[176:179], a[104:107]
    v_exp_f32 v249, v77
    v_mfma_f32_16x16x32_bf16 a[12:15], a[204:207], v[164:167], a[12:15]
    v_exp_f32 v250, v78
    v_mfma_f32_16x16x32_bf16 a[44:47], a[204:207], v[168:171], a[44:47]
    buffer_load_dwordx4 v219, s[20:23], s40 offen offset:1024 lds
    v_cvt_pk_bf16_f32 v149, v226, v227
    v_mfma_f32_16x16x32_bf16 a[76:79], a[204:207], v[172:175], a[76:79]
    v_exp_f32 v251, v79
    v_mfma_f32_16x16x32_bf16 a[108:111], a[204:207], v[176:179], a[108:111]
    ds_read_b128 a[176:179], v204 offset:8192
    v_cvt_pk_bf16_f32 v150, v248, v249
    v_mfma_f32_16x16x32_bf16 a[16:19], a[208:211], v[164:167], a[16:19]
    v_exp_f32 v224, v64
    v_mfma_f32_16x16x32_bf16 a[48:51], a[208:211], v[168:171], a[48:51]
    v_exp_f32 v225, v65
    v_mfma_f32_16x16x32_bf16 a[80:83], a[208:211], v[172:175], a[80:83]
    ds_read_b128 a[180:183], v205 offset:8192
    v_cvt_pk_bf16_f32 v151, v250, v251
    v_mfma_f32_16x16x32_bf16 a[112:115], a[208:211], v[176:179], a[112:115]
    v_exp_f32 v226, v66
    v_mfma_f32_16x16x32_bf16 a[20:23], a[212:215], v[164:167], a[20:23]
    v_exp_f32 v227, v67
    v_mfma_f32_16x16x32_bf16 a[52:55], a[212:215], v[168:171], a[52:55]
    ds_read_b128 a[184:187], v206 offset:8192
    v_cvt_pk_bf16_f32 v144, v224, v225
    v_mfma_f32_16x16x32_bf16 a[84:87], a[212:215], v[172:175], a[84:87]
    v_exp_f32 v248, v68
    v_mfma_f32_16x16x32_bf16 a[116:119], a[212:215], v[176:179], a[116:119]
    buffer_load_dwordx4 v216, s[16:19], s63 offen offset:2048 lds
    v_cvt_pk_bf16_f32 v145, v226, v227
    v_mfma_f32_16x16x32_bf16 a[24:27], a[216:219], v[164:167], a[24:27]
    v_exp_f32 v249, v69
    v_mfma_f32_16x16x32_bf16 a[56:59], a[216:219], v[168:171], a[56:59]
    v_exp_f32 v250, v70
    v_mfma_f32_16x16x32_bf16 a[88:91], a[216:219], v[172:175], a[88:91]
    ds_read_b128 a[188:191], v207 offset:8192
    v_cvt_pk_bf16_f32 v146, v248, v249
    v_mfma_f32_16x16x32_bf16 a[120:123], a[216:219], v[176:179], a[120:123]
    v_exp_f32 v251, v71
    v_mfma_f32_16x16x32_bf16 a[28:31], a[220:223], v[164:167], a[28:31]
    v_cvt_pk_bf16_f32 v147, v250, v251
    v_mfma_f32_16x16x32_bf16 a[60:63], a[220:223], v[168:171], a[60:63]
    v_mfma_f32_16x16x32_bf16 a[92:95], a[220:223], v[172:175], a[92:95]
    v_mfma_f32_16x16x32_bf16 a[124:127], a[220:223], v[176:179], a[124:127]
    buffer_load_dwordx4 v217, s[16:19], s63 offen offset:3072 lds
    v_mfma_f32_16x16x32_bf16 a[240:243], v[228:231], v[164:167], a[240:243]
    s_sub_u32 s42, s42, 1
    v_mfma_f32_16x16x32_bf16 a[244:247], v[228:231], v[168:171], a[244:247]
    s_waitcnt lgkmcnt(0)
    v_mfma_f32_16x16x32_bf16 a[248:251], v[228:231], v[172:175], a[248:251]
    v_mfma_f32_16x16x32_bf16 a[252:255], v[228:231], v[176:179], a[252:255]
    s_cbranch_scc1 Lxt4_2
    v_mfma_f32_16x16x32_bf16 v[64:67], a[160:163], v[0:3], v[184:187]
    ds_read_b64_tr_b16 a[192:193], v208 offset:0
    v_mfma_f32_16x16x32_bf16 v[72:75], a[160:163], v[16:19], v[188:191]
    ds_read_b64_tr_b16 a[194:195], v208 offset:8192
    v_mfma_f32_16x16x32_bf16 v[80:83], a[160:163], v[32:35], v[192:195]
    v_exp_f32 v224, v128
    v_mfma_f32_16x16x32_bf16 v[88:91], a[160:163], v[48:51], v[196:199]
    ds_read_b64_tr_b16 a[196:197], v209 offset:0
    v_mfma_f32_16x16x32_bf16 v[64:67], a[164:167], v[4:7], v[64:67]
    ds_read_b64_tr_b16 a[198:199], v209 offset:8192
    v_mfma_f32_16x16x32_bf16 v[72:75], a[164:167], v[20:23], v[72:75]
    v_exp_f32 v225, v129
    v_mfma_f32_16x16x32_bf16 v[80:83], a[164:167], v[36:39], v[80:83]
    ds_read_b64_tr_b16 a[200:201], v210 offset:0
    v_cvt_pk_bf16_f32 v176, v224, v225
    v_mfma_f32_16x16x32_bf16 v[88:91], a[164:167], v[52:55], v[88:91]
    v_exp_f32 v226, v130
    v_mfma_f32_16x16x32_bf16 v[64:67], a[168:171], v[8:11], v[64:67]
    ds_read_b64_tr_b16 a[202:203], v210 offset:8192
    v_mfma_f32_16x16x32_bf16 v[72:75], a[168:171], v[24:27], v[72:75]
    ds_read_b64_tr_b16 a[204:205], v211 offset:0
    v_mfma_f32_16x16x32_bf16 v[80:83], a[168:171], v[40:43], v[80:83]
    v_exp_f32 v227, v131
    v_mfma_f32_16x16x32_bf16 v[88:91], a[168:171], v[56:59], v[88:91]
    ds_read_b64_tr_b16 a[206:207], v211 offset:8192
    v_cvt_pk_bf16_f32 v177, v226, v227
    v_mfma_f32_16x16x32_bf16 v[64:67], a[172:175], v[12:15], v[64:67]
    v_exp_f32 v248, v132
    v_mfma_f32_16x16x32_bf16 v[72:75], a[172:175], v[28:31], v[72:75]
    ds_read_b64_tr_b16 a[208:209], v212 offset:0
    v_mfma_f32_16x16x32_bf16 v[80:83], a[172:175], v[44:47], v[80:83]
    ds_read_b64_tr_b16 a[210:211], v212 offset:8192
    v_mfma_f32_16x16x32_bf16 v[88:91], a[172:175], v[60:63], v[88:91]
    v_exp_f32 v249, v133
    v_mfma_f32_16x16x32_bf16 v[68:71], a[176:179], v[0:3], v[184:187]
    ds_read_b64_tr_b16 a[212:213], v213 offset:0
    v_cvt_pk_bf16_f32 v178, v248, v249
    v_mfma_f32_16x16x32_bf16 v[76:79], a[176:179], v[16:19], v[188:191]
    ds_read_b64_tr_b16 a[214:215], v213 offset:8192
    v_mfma_f32_16x16x32_bf16 v[84:87], a[176:179], v[32:35], v[192:195]
    v_exp_f32 v250, v134
    v_mfma_f32_16x16x32_bf16 v[92:95], a[176:179], v[48:51], v[196:199]
    ds_read_b64_tr_b16 a[216:217], v214 offset:0
    v_mfma_f32_16x16x32_bf16 v[68:71], a[180:183], v[4:7], v[68:71]
    v_exp_f32 v251, v135
    v_mfma_f32_16x16x32_bf16 v[76:79], a[180:183], v[20:23], v[76:79]
    ds_read_b64_tr_b16 a[218:219], v214 offset:8192
    v_cvt_pk_bf16_f32 v179, v250, v251
    v_mfma_f32_16x16x32_bf16 v[84:87], a[180:183], v[36:39], v[84:87]
    ds_read_b64_tr_b16 a[220:221], v215 offset:0
    v_mfma_f32_16x16x32_bf16 v[92:95], a[180:183], v[52:55], v[92:95]
    v_exp_f32 v224, v120
    v_mfma_f32_16x16x32_bf16 v[68:71], a[184:187], v[8:11], v[68:71]
    ds_read_b64_tr_b16 a[222:223], v215 offset:8192
    v_mfma_f32_16x16x32_bf16 v[76:79], a[184:187], v[24:27], v[76:79]
    v_exp_f32 v225, v121
    v_mfma_f32_16x16x32_bf16 v[84:87], a[184:187], v[40:43], v[84:87]
    v_exp_f32 v226, v122
    v_mfma_f32_16x16x32_bf16 v[92:95], a[184:187], v[56:59], v[92:95]
    s_mov_b32 m0, s41
    v_exp_f32 v227, v123
    v_mfma_f32_16x16x32_bf16 v[68:71], a[188:191], v[12:15], v[68:71]
    s_add_u32 s40, s40, 131072
    v_exp_f32 v248, v124
    v_mfma_f32_16x16x32_bf16 v[76:79], a[188:191], v[28:31], v[76:79]
    s_add_u32 s63, s63, 131072
    v_exp_f32 v249, v125
    v_mfma_f32_16x16x32_bf16 v[84:87], a[188:191], v[44:47], v[84:87]
    s_waitcnt vmcnt(8) lgkmcnt(0)
    v_exp_f32 v250, v126
    v_mfma_f32_16x16x32_bf16 v[92:95], a[188:191], v[60:63], v[92:95]
    s_barrier
    v_mfma_f32_16x16x32_bf16 a[0:3], a[192:195], v[144:147], a[0:3]
    ds_read_b128 a[160:163], v204 offset:16384
    v_cvt_pk_bf16_f32 v172, v224, v225
    v_mfma_f32_16x16x32_bf16 a[32:35], a[192:195], v[148:151], a[32:35]
    v_exp_f32 v251, v127
    v_mfma_f32_16x16x32_bf16 a[64:67], a[192:195], v[152:155], a[64:67]
    ds_read_b128 a[164:167], v205 offset:16384
    v_cvt_pk_bf16_f32 v173, v226, v227
    v_mfma_f32_16x16x32_bf16 a[96:99], a[192:195], v[156:159], a[96:99]
    v_exp_f32 v224, v112
    v_mfma_f32_16x16x32_bf16 a[4:7], a[196:199], v[144:147], a[4:7]
    v_exp_f32 v225, v113
    v_mfma_f32_16x16x32_bf16 a[36:39], a[196:199], v[148:151], a[36:39]
    buffer_load_dwordx4 v218, s[20:23], s40 offen lds
    v_cvt_pk_bf16_f32 v174, v248, v249
    v_mfma_f32_16x16x32_bf16 a[68:71], a[196:199], v[152:155], a[68:71]
    v_exp_f32 v226, v114
    v_mfma_f32_16x16x32_bf16 a[100:103], a[196:199], v[156:159], a[100:103]
    ds_read_b128 a[168:171], v206 offset:16384
    v_cvt_pk_bf16_f32 v175, v250, v251
    v_mfma_f32_16x16x32_bf16 a[8:11], a[200:203], v[144:147], a[8:11]
    v_exp_f32 v227, v115
    v_mfma_f32_16x16x32_bf16 a[40:43], a[200:203], v[148:151], a[40:43]
    v_exp_f32 v248, v116
    v_mfma_f32_16x16x32_bf16 a[72:75], a[200:203], v[152:155], a[72:75]
    ds_read_b128 a[172:175], v207 offset:16384
    v_cvt_pk_bf16_f32 v168, v224, v225
    v_mfma_f32_16x16x32_bf16 a[104:107], a[200:203], v[156:159], a[104:107]
    v_exp_f32 v249, v117
    v_mfma_f32_16x16x32_bf16 a[12:15], a[204:207], v[144:147], a[12:15]
    v_exp_f32 v250, v118
    v_mfma_f32_16x16x32_bf16 a[44:47], a[204:207], v[148:151], a[44:47]
    buffer_load_dwordx4 v219, s[20:23], s40 offen offset:1024 lds
    v_cvt_pk_bf16_f32 v169, v226, v227
    v_mfma_f32_16x16x32_bf16 a[76:79], a[204:207], v[152:155], a[76:79]
    v_exp_f32 v251, v119
    v_mfma_f32_16x16x32_bf16 a[108:111], a[204:207], v[156:159], a[108:111]
    ds_read_b128 a[176:179], v204 offset:24576
    v_cvt_pk_bf16_f32 v170, v248, v249
    v_mfma_f32_16x16x32_bf16 a[16:19], a[208:211], v[144:147], a[16:19]
    v_exp_f32 v224, v104
    v_mfma_f32_16x16x32_bf16 a[48:51], a[208:211], v[148:151], a[48:51]
    v_exp_f32 v225, v105
    v_mfma_f32_16x16x32_bf16 a[80:83], a[208:211], v[152:155], a[80:83]
    ds_read_b128 a[180:183], v205 offset:24576
    v_cvt_pk_bf16_f32 v171, v250, v251
    v_mfma_f32_16x16x32_bf16 a[112:115], a[208:211], v[156:159], a[112:115]
    v_exp_f32 v226, v106
    v_mfma_f32_16x16x32_bf16 a[20:23], a[212:215], v[144:147], a[20:23]
    v_exp_f32 v227, v107
    v_mfma_f32_16x16x32_bf16 a[52:55], a[212:215], v[148:151], a[52:55]
    ds_read_b128 a[184:187], v206 offset:24576
    v_cvt_pk_bf16_f32 v164, v224, v225
    v_mfma_f32_16x16x32_bf16 a[84:87], a[212:215], v[152:155], a[84:87]
    v_exp_f32 v248, v108
    v_mfma_f32_16x16x32_bf16 a[116:119], a[212:215], v[156:159], a[116:119]
    buffer_load_dwordx4 v216, s[16:19], s63 offen offset:2048 lds
    v_cvt_pk_bf16_f32 v165, v226, v227
    v_mfma_f32_16x16x32_bf16 a[24:27], a[216:219], v[144:147], a[24:27]
    v_exp_f32 v249, v109
    v_mfma_f32_16x16x32_bf16 a[56:59], a[216:219], v[148:151], a[56:59]
    v_exp_f32 v250, v110
    v_mfma_f32_16x16x32_bf16 a[88:91], a[216:219], v[152:155], a[88:91]
    ds_read_b128 a[188:191], v207 offset:24576
    v_cvt_pk_bf16_f32 v166, v248, v249
    v_mfma_f32_16x16x32_bf16 a[120:123], a[216:219], v[156:159], a[120:123]
    v_exp_f32 v251, v111
    v_mfma_f32_16x16x32_bf16 a[28:31], a[220:223], v[144:147], a[28:31]
    v_cvt_pk_bf16_f32 v167, v250, v251
    v_mfma_f32_16x16x32_bf16 a[60:63], a[220:223], v[148:151], a[60:63]
    v_mfma_f32_16x16x32_bf16 a[92:95], a[220:223], v[152:155], a[92:95]
    v_mfma_f32_16x16x32_bf16 a[124:127], a[220:223], v[156:159], a[124:127]
    buffer_load_dwordx4 v217, s[16:19], s63 offen offset:3072 lds
    v_mfma_f32_16x16x32_bf16 a[240:243], v[228:231], v[144:147], a[240:243]
    s_sub_u32 s42, s42, 1
    v_mfma_f32_16x16x32_bf16 a[244:247], v[228:231], v[148:151], a[244:247]
    s_waitcnt lgkmcnt(0)
    v_mfma_f32_16x16x32_bf16 a[248:251], v[228:231], v[152:155], a[248:251]
    v_mfma_f32_16x16x32_bf16 a[252:255], v[228:231], v[156:159], a[252:255]
    v_mfma_f32_16x16x32_bf16 v[104:107], a[160:163], v[0:3], v[184:187]
    ds_read_b64_tr_b16 a[192:193], v208 offset:16384
    v_mfma_f32_16x16x32_bf16 v[112:115], a[160:163], v[16:19], v[188:191]
    ds_read_b64_tr_b16 a[194:195], v208 offset:24576
    v_mfma_f32_16x16x32_bf16 v[120:123], a[160:163], v[32:35], v[192:195]
    v_exp_f32 v224, v88
    v_mfma_f32_16x16x32_bf16 v[128:131], a[160:163], v[48:51], v[196:199]
    ds_read_b64_tr_b16 a[196:197], v209 offset:16384
    v_mfma_f32_16x16x32_bf16 v[104:107], a[164:167], v[4:7], v[104:107]
    ds_read_b64_tr_b16 a[198:199], v209 offset:24576
    v_mfma_f32_16x16x32_bf16 v[112:115], a[164:167], v[20:23], v[112:115]
    v_exp_f32 v225, v89
    v_mfma_f32_16x16x32_bf16 v[120:123], a[164:167], v[36:39], v[120:123]
    ds_read_b64_tr_b16 a[200:201], v210 offset:16384
    v_cvt_pk_bf16_f32 v156, v224, v225
    v_mfma_f32_16x16x32_bf16 v[128:131], a[164:167], v[52:55], v[128:131]
    v_exp_f32 v226, v90
    v_mfma_f32_16x16x32_bf16 v[104:107], a[168:171], v[8:11], v[104:107]
    ds_read_b64_tr_b16 a[202:203], v210 offset:24576
    v_mfma_f32_16x16x32_bf16 v[112:115], a[168:171], v[24:27], v[112:115]
    ds_read_b64_tr_b16 a[204:205], v211 offset:16384
    v_mfma_f32_16x16x32_bf16 v[120:123], a[168:171], v[40:43], v[120:123]
    v_exp_f32 v227, v91
    v_mfma_f32_16x16x32_bf16 v[128:131], a[168:171], v[56:59], v[128:131]
    ds_read_b64_tr_b16 a[206:207], v211 offset:24576
    v_cvt_pk_bf16_f32 v157, v226, v227
    v_mfma_f32_16x16x32_bf16 v[104:107], a[172:175], v[12:15], v[104:107]
    v_exp_f32 v248, v92
    v_mfma_f32_16x16x32_bf16 v[112:115], a[172:175], v[28:31], v[112:115]
    ds_read_b64_tr_b16 a[208:209], v212 offset:16384
    v_mfma_f32_16x16x32_bf16 v[120:123], a[172:175], v[44:47], v[120:123]
    ds_read_b64_tr_b16 a[210:211], v212 offset:24576
    v_mfma_f32_16x16x32_bf16 v[128:131], a[172:175], v[60:63], v[128:131]
    v_exp_f32 v249, v93
    v_mfma_f32_16x16x32_bf16 v[108:111], a[176:179], v[0:3], v[184:187]
    ds_read_b64_tr_b16 a[212:213], v213 offset:16384
    v_cvt_pk_bf16_f32 v158, v248, v249
    v_mfma_f32_16x16x32_bf16 v[116:119], a[176:179], v[16:19], v[188:191]
    ds_read_b64_tr_b16 a[214:215], v213 offset:24576
    v_mfma_f32_16x16x32_bf16 v[124:127], a[176:179], v[32:35], v[192:195]
    v_exp_f32 v250, v94
    v_mfma_f32_16x16x32_bf16 v[132:135], a[176:179], v[48:51], v[196:199]
    ds_read_b64_tr_b16 a[216:217], v214 offset:16384
    v_mfma_f32_16x16x32_bf16 v[108:111], a[180:183], v[4:7], v[108:111]
    v_exp_f32 v251, v95
    v_mfma_f32_16x16x32_bf16 v[116:119], a[180:183], v[20:23], v[116:119]
    ds_read_b64_tr_b16 a[218:219], v214 offset:24576
    v_cvt_pk_bf16_f32 v159, v250, v251
    v_mfma_f32_16x16x32_bf16 v[124:127], a[180:183], v[36:39], v[124:127]
    ds_read_b64_tr_b16 a[220:221], v215 offset:16384
    v_mfma_f32_16x16x32_bf16 v[132:135], a[180:183], v[52:55], v[132:135]
    v_exp_f32 v224, v80
    v_mfma_f32_16x16x32_bf16 v[108:111], a[184:187], v[8:11], v[108:111]
    ds_read_b64_tr_b16 a[222:223], v215 offset:24576
    v_mfma_f32_16x16x32_bf16 v[116:119], a[184:187], v[24:27], v[116:119]
    v_exp_f32 v225, v81
    v_mfma_f32_16x16x32_bf16 v[124:127], a[184:187], v[40:43], v[124:127]
    v_exp_f32 v226, v82
    v_mfma_f32_16x16x32_bf16 v[132:135], a[184:187], v[56:59], v[132:135]
    s_add_u32 m0, s41, 16384
    v_exp_f32 v227, v83
    v_mfma_f32_16x16x32_bf16 v[108:111], a[188:191], v[12:15], v[108:111]
    s_add_u32 s40, s40, 131072
    v_exp_f32 v248, v84
    v_mfma_f32_16x16x32_bf16 v[116:119], a[188:191], v[28:31], v[116:119]
    s_add_u32 s63, s63, 131072
    v_exp_f32 v249, v85
    v_mfma_f32_16x16x32_bf16 v[124:127], a[188:191], v[44:47], v[124:127]
    s_waitcnt vmcnt(8) lgkmcnt(0)
    v_exp_f32 v250, v86
    v_mfma_f32_16x16x32_bf16 v[132:135], a[188:191], v[60:63], v[132:135]
    s_barrier
    v_mfma_f32_16x16x32_bf16 a[0:3], a[192:195], v[164:167], a[0:3]
    ds_read_b128 a[160:163], v204 offset:32768
    v_cvt_pk_bf16_f32 v152, v224, v225
    v_mfma_f32_16x16x32_bf16 a[32:35], a[192:195], v[168:171], a[32:35]
    v_exp_f32 v251, v87
    v_mfma_f32_16x16x32_bf16 a[64:67], a[192:195], v[172:175], a[64:67]
    ds_read_b128 a[164:167], v205 offset:32768
    v_cvt_pk_bf16_f32 v153, v226, v227
    v_mfma_f32_16x16x32_bf16 a[96:99], a[192:195], v[176:179], a[96:99]
    v_exp_f32 v224, v72
    v_mfma_f32_16x16x32_bf16 a[4:7], a[196:199], v[164:167], a[4:7]
    v_exp_f32 v225, v73
    v_mfma_f32_16x16x32_bf16 a[36:39], a[196:199], v[168:171], a[36:39]
    buffer_load_dwordx4 v218, s[20:23], s40 offen lds
    v_cvt_pk_bf16_f32 v154, v248, v249
    v_mfma_f32_16x16x32_bf16 a[68:71], a[196:199], v[172:175], a[68:71]
    v_exp_f32 v226, v74
    v_mfma_f32_16x16x32_bf16 a[100:103], a[196:199], v[176:179], a[100:103]
    ds_read_b128 a[168:171], v206 offset:32768
    v_cvt_pk_bf16_f32 v155, v250, v251
    v_mfma_f32_16x16x32_bf16 a[8:11], a[200:203], v[164:167], a[8:11]
    v_exp_f32 v227, v75
    v_mfma_f32_16x16x32_bf16 a[40:43], a[200:203], v[168:171], a[40:43]
    v_exp_f32 v248, v76
    v_mfma_f32_16x16x32_bf16 a[72:75], a[200:203], v[172:175], a[72:75]
    ds_read_b128 a[172:175], v207 offset:32768
    v_cvt_pk_bf16_f32 v148, v224, v225
    v_mfma_f32_16x16x32_bf16 a[104:107], a[200:203], v[176:179], a[104:107]
    v_exp_f32 v249, v77
    v_mfma_f32_16x16x32_bf16 a[12:15], a[204:207], v[164:167], a[12:15]
    v_exp_f32 v250, v78
    v_mfma_f32_16x16x32_bf16 a[44:47], a[204:207], v[168:171], a[44:47]
    buffer_load_dwordx4 v219, s[20:23], s40 offen offset:1024 lds
    v_cvt_pk_bf16_f32 v149, v226, v227
    v_mfma_f32_16x16x32_bf16 a[76:79], a[204:207], v[172:175], a[76:79]
    v_exp_f32 v251, v79
    v_mfma_f32_16x16x32_bf16 a[108:111], a[204:207], v[176:179], a[108:111]
    ds_read_b128 a[176:179], v204 offset:40960
    v_cvt_pk_bf16_f32 v150, v248, v249
    v_mfma_f32_16x16x32_bf16 a[16:19], a[208:211], v[164:167], a[16:19]
    v_exp_f32 v224, v64
    v_mfma_f32_16x16x32_bf16 a[48:51], a[208:211], v[168:171], a[48:51]
    v_exp_f32 v225, v65
    v_mfma_f32_16x16x32_bf16 a[80:83], a[208:211], v[172:175], a[80:83]
    ds_read_b128 a[180:183], v205 offset:40960
    v_cvt_pk_bf16_f32 v151, v250, v251
    v_mfma_f32_16x16x32_bf16 a[112:115], a[208:211], v[176:179], a[112:115]
    v_exp_f32 v226, v66
    v_mfma_f32_16x16x32_bf16 a[20:23], a[212:215], v[164:167], a[20:23]
    v_exp_f32 v227, v67
    v_mfma_f32_16x16x32_bf16 a[52:55], a[212:215], v[168:171], a[52:55]
    ds_read_b128 a[184:187], v206 offset:40960
    v_cvt_pk_bf16_f32 v144, v224, v225
    v_mfma_f32_16x16x32_bf16 a[84:87], a[212:215], v[172:175], a[84:87]
    v_exp_f32 v248, v68
    v_mfma_f32_16x16x32_bf16 a[116:119], a[212:215], v[176:179], a[116:119]
    buffer_load_dwordx4 v216, s[16:19], s63 offen offset:2048 lds
    v_cvt_pk_bf16_f32 v145, v226, v227
    v_mfma_f32_16x16x32_bf16 a[24:27], a[216:219], v[164:167], a[24:27]
    v_exp_f32 v249, v69
    v_mfma_f32_16x16x32_bf16 a[56:59], a[216:219], v[168:171], a[56:59]
    v_exp_f32 v250, v70
    v_mfma_f32_16x16x32_bf16 a[88:91], a[216:219], v[172:175], a[88:91]
    ds_read_b128 a[188:191], v207 offset:40960
    v_cvt_pk_bf16_f32 v146, v248, v249
    v_mfma_f32_16x16x32_bf16 a[120:123], a[216:219], v[176:179], a[120:123]
    v_exp_f32 v251, v71
    v_mfma_f32_16x16x32_bf16 a[28:31], a[220:223], v[164:167], a[28:31]
    v_cvt_pk_bf16_f32 v147, v250, v251
    v_mfma_f32_16x16x32_bf16 a[60:63], a[220:223], v[168:171], a[60:63]
    v_mfma_f32_16x16x32_bf16 a[92:95], a[220:223], v[172:175], a[92:95]
    v_mfma_f32_16x16x32_bf16 a[124:127], a[220:223], v[176:179], a[124:127]
    buffer_load_dwordx4 v217, s[16:19], s63 offen offset:3072 lds
    v_mfma_f32_16x16x32_bf16 a[240:243], v[228:231], v[164:167], a[240:243]
    s_sub_u32 s42, s42, 1
    v_mfma_f32_16x16x32_bf16 a[244:247], v[228:231], v[168:171], a[244:247]
    s_waitcnt lgkmcnt(0)
    v_mfma_f32_16x16x32_bf16 a[248:251], v[228:231], v[172:175], a[248:251]
    v_mfma_f32_16x16x32_bf16 a[252:255], v[228:231], v[176:179], a[252:255]
    v_mfma_f32_16x16x32_bf16 v[64:67], a[160:163], v[0:3], v[184:187]
    ds_read_b64_tr_b16 a[192:193], v208 offset:32768
    v_mfma_f32_16x16x32_bf16 v[72:75], a[160:163], v[16:19], v[188:191]
    ds_read_b64_tr_b16 a[194:195], v208 offset:40960
    v_mfma_f32_16x16x32_bf16 v[80:83], a[160:163], v[32:35], v[192:195]
    v_exp_f32 v224, v128
    v_mfma_f32_16x16x32_bf16 v[88:91], a[160:163], v[48:51], v[196:199]
    ds_read_b64_tr_b16 a[196:197], v209 offset:32768
    v_mfma_f32_16x16x32_bf16 v[64:67], a[164:167], v[4:7], v[64:67]
    ds_read_b64_tr_b16 a[198:199], v209 offset:40960
    v_mfma_f32_16x16x32_bf16 v[72:75], a[164:167], v[20:23], v[72:75]
    v_exp_f32 v225, v129
    v_mfma_f32_16x16x32_bf16 v[80:83], a[164:167], v[36:39], v[80:83]
    ds_read_b64_tr_b16 a[200:201], v210 offset:32768
    v_cvt_pk_bf16_f32 v176, v224, v225
    v_mfma_f32_16x16x32_bf16 v[88:91], a[164:167], v[52:55], v[88:91]
    v_exp_f32 v226, v130
    v_mfma_f32_16x16x32_bf16 v[64:67], a[168:171], v[8:11], v[64:67]
    ds_read_b64_tr_b16 a[202:203], v210 offset:40960
    v_mfma_f32_16x16x32_bf16 v[72:75], a[168:171], v[24:27], v[72:75]
    ds_read_b64_tr_b16 a[204:205], v211 offset:32768
    v_mfma_f32_16x16x32_bf16 v[80:83], a[168:171], v[40:43], v[80:83]
    v_exp_f32 v227, v131
    v_mfma_f32_16x16x32_bf16 v[88:91], a[168:171], v[56:59], v[88:91]
    ds_read_b64_tr_b16 a[206:207], v211 offset:40960
    v_cvt_pk_bf16_f32 v177, v226, v227
    v_mfma_f32_16x16x32_bf16 v[64:67], a[172:175], v[12:15], v[64:67]
    v_exp_f32 v248, v132
    v_mfma_f32_16x16x32_bf16 v[72:75], a[172:175], v[28:31], v[72:75]
    ds_read_b64_tr_b16 a[208:209], v212 offset:32768
    v_mfma_f32_16x16x32_bf16 v[80:83], a[172:175], v[44:47], v[80:83]
    ds_read_b64_tr_b16 a[210:211], v212 offset:40960
    v_mfma_f32_16x16x32_bf16 v[88:91], a[172:175], v[60:63], v[88:91]
    v_exp_f32 v249, v133
    v_mfma_f32_16x16x32_bf16 v[68:71], a[176:179], v[0:3], v[184:187]
    ds_read_b64_tr_b16 a[212:213], v213 offset:32768
    v_cvt_pk_bf16_f32 v178, v248, v249
    v_mfma_f32_16x16x32_bf16 v[76:79], a[176:179], v[16:19], v[188:191]
    ds_read_b64_tr_b16 a[214:215], v213 offset:40960
    v_mfma_f32_16x16x32_bf16 v[84:87], a[176:179], v[32:35], v[192:195]
    v_exp_f32 v250, v134
    v_mfma_f32_16x16x32_bf16 v[92:95], a[176:179], v[48:51], v[196:199]
    ds_read_b64_tr_b16 a[216:217], v214 offset:32768
    v_mfma_f32_16x16x32_bf16 v[68:71], a[180:183], v[4:7], v[68:71]
    v_exp_f32 v251, v135
    v_mfma_f32_16x16x32_bf16 v[76:79], a[180:183], v[20:23], v[76:79]
    ds_read_b64_tr_b16 a[218:219], v214 offset:40960
    v_cvt_pk_bf16_f32 v179, v250, v251
    v_mfma_f32_16x16x32_bf16 v[84:87], a[180:183], v[36:39], v[84:87]
    ds_read_b64_tr_b16 a[220:221], v215 offset:32768
    v_mfma_f32_16x16x32_bf16 v[92:95], a[180:183], v[52:55], v[92:95]
    v_exp_f32 v224, v120
    v_mfma_f32_16x16x32_bf16 v[68:71], a[184:187], v[8:11], v[68:71]
    ds_read_b64_tr_b16 a[222:223], v215 offset:40960
    v_mfma_f32_16x16x32_bf16 v[76:79], a[184:187], v[24:27], v[76:79]
    v_exp_f32 v225, v121
    v_mfma_f32_16x16x32_bf16 v[84:87], a[184:187], v[40:43], v[84:87]
    v_exp_f32 v226, v122
    v_mfma_f32_16x16x32_bf16 v[92:95], a[184:187], v[56:59], v[92:95]
    s_add_u32 m0, s41, 32768
    v_exp_f32 v227, v123
    v_mfma_f32_16x16x32_bf16 v[68:71], a[188:191], v[12:15], v[68:71]
    s_add_u32 s40, s40, 131072
    v_exp_f32 v248, v124
    v_mfma_f32_16x16x32_bf16 v[76:79], a[188:191], v[28:31], v[76:79]
    s_add_u32 s63, s63, 131072
    v_exp_f32 v249, v125
    v_mfma_f32_16x16x32_bf16 v[84:87], a[188:191], v[44:47], v[84:87]
    s_waitcnt vmcnt(8) lgkmcnt(0)
    v_exp_f32 v250, v126
    v_mfma_f32_16x16x32_bf16 v[92:95], a[188:191], v[60:63], v[92:95]
    s_barrier
    v_mfma_f32_16x16x32_bf16 a[0:3], a[192:195], v[144:147], a[0:3]
    ds_read_b128 a[160:163], v204 offset:49152
    v_cvt_pk_bf16_f32 v172, v224, v225
    v_mfma_f32_16x16x32_bf16 a[32:35], a[192:195], v[148:151], a[32:35]
    v_exp_f32 v251, v127
    v_mfma_f32_16x16x32_bf16 a[64:67], a[192:195], v[152:155], a[64:67]
    ds_read_b128 a[164:167], v205 offset:49152
    v_cvt_pk_bf16_f32 v173, v226, v227
    v_mfma_f32_16x16x32_bf16 a[96:99], a[192:195], v[156:159], a[96:99]
    v_exp_f32 v224, v112
    v_mfma_f32_16x16x32_bf16 a[4:7], a[196:199], v[144:147], a[4:7]
    v_exp_f32 v225, v113
    v_mfma_f32_16x16x32_bf16 a[36:39], a[196:199], v[148:151], a[36:39]
    buffer_load_dwordx4 v218, s[20:23], s40 offen lds
    v_cvt_pk_bf16_f32 v174, v248, v249
    v_mfma_f32_16x16x32_bf16 a[68:71], a[196:199], v[152:155], a[68:71]
    v_exp_f32 v226, v114
    v_mfma_f32_16x16x32_bf16 a[100:103], a[196:199], v[156:159], a[100:103]
    ds_read_b128 a[168:171], v206 offset:49152
    v_cvt_pk_bf16_f32 v175, v250, v251
    v_mfma_f32_16x16x32_bf16 a[8:11], a[200:203], v[144:147], a[8:11]
    v_exp_f32 v227, v115
    v_mfma_f32_16x16x32_bf16 a[40:43], a[200:203], v[148:151], a[40:43]
    v_exp_f32 v248, v116
    v_mfma_f32_16x16x32_bf16 a[72:75], a[200:203], v[152:155], a[72:75]
    ds_read_b128 a[172:175], v207 offset:49152
    v_cvt_pk_bf16_f32 v168, v224, v225
    v_mfma_f32_16x16x32_bf16 a[104:107], a[200:203], v[156:159], a[104:107]
    v_exp_f32 v249, v117
    v_mfma_f32_16x16x32_bf16 a[12:15], a[204:207], v[144:147], a[12:15]
    v_exp_f32 v250, v118
    v_mfma_f32_16x16x32_bf16 a[44:47], a[204:207], v[148:151], a[44:47]
    buffer_load_dwordx4 v219, s[20:23], s40 offen offset:1024 lds
    v_cvt_pk_bf16_f32 v169, v226, v227
    v_mfma_f32_16x16x32_bf16 a[76:79], a[204:207], v[152:155], a[76:79]
    v_exp_f32 v251, v119
    v_mfma_f32_16x16x32_bf16 a[108:111], a[204:207], v[156:159], a[108:111]
    ds_read_b128 a[176:179], v204 offset:57344
    v_cvt_pk_bf16_f32 v170, v248, v249
    v_mfma_f32_16x16x32_bf16 a[16:19], a[208:211], v[144:147], a[16:19]
    v_exp_f32 v224, v104
    v_mfma_f32_16x16x32_bf16 a[48:51], a[208:211], v[148:151], a[48:51]
    v_exp_f32 v225, v105
    v_mfma_f32_16x16x32_bf16 a[80:83], a[208:211], v[152:155], a[80:83]
    ds_read_b128 a[180:183], v205 offset:57344
    v_cvt_pk_bf16_f32 v171, v250, v251
    v_mfma_f32_16x16x32_bf16 a[112:115], a[208:211], v[156:159], a[112:115]
    v_exp_f32 v226, v106
    v_mfma_f32_16x16x32_bf16 a[20:23], a[212:215], v[144:147], a[20:23]
    v_exp_f32 v227, v107
    v_mfma_f32_16x16x32_bf16 a[52:55], a[212:215], v[148:151], a[52:55]
    ds_read_b128 a[184:187], v206 offset:57344
    v_cvt_pk_bf16_f32 v164, v224, v225
    v_mfma_f32_16x16x32_bf16 a[84:87], a[212:215], v[152:155], a[84:87]
    v_exp_f32 v248, v108
    v_mfma_f32_16x16x32_bf16 a[116:119], a[212:215], v[156:159], a[116:119]
    buffer_load_dwordx4 v216, s[16:19], s63 offen offset:2048 lds
    v_cvt_pk_bf16_f32 v165, v226, v227
    v_mfma_f32_16x16x32_bf16 a[24:27], a[216:219], v[144:147], a[24:27]
    v_exp_f32 v249, v109
    v_mfma_f32_16x16x32_bf16 a[56:59], a[216:219], v[148:151], a[56:59]
    v_exp_f32 v250, v110
    v_mfma_f32_16x16x32_bf16 a[88:91], a[216:219], v[152:155], a[88:91]
    ds_read_b128 a[188:191], v207 offset:57344
    v_cvt_pk_bf16_f32 v166, v248, v249
    v_mfma_f32_16x16x32_bf16 a[120:123], a[216:219], v[156:159], a[120:123]
    v_exp_f32 v251, v111
    v_mfma_f32_16x16x32_bf16 a[28:31], a[220:223], v[144:147], a[28:31]
    v_cvt_pk_bf16_f32 v167, v250, v251
    v_mfma_f32_16x16x32_bf16 a[60:63], a[220:223], v[148:151], a[60:63]
    v_mfma_f32_16x16x32_bf16 a[92:95], a[220:223], v[152:155], a[92:95]
    v_mfma_f32_16x16x32_bf16 a[124:127], a[220:223], v[156:159], a[124:127]
    buffer_load_dwordx4 v217, s[16:19], s63 offen offset:3072 lds
    v_mfma_f32_16x16x32_bf16 a[240:243], v[228:231], v[144:147], a[240:243]
    s_sub_u32 s42, s42, 1
    v_mfma_f32_16x16x32_bf16 a[244:247], v[228:231], v[148:151], a[244:247]
    s_waitcnt lgkmcnt(0)
    v_mfma_f32_16x16x32_bf16 a[248:251], v[228:231], v[152:155], a[248:251]
    v_mfma_f32_16x16x32_bf16 a[252:255], v[228:231], v[156:159], a[252:255]
    s_cbranch_scc1 Lxt4_1
    s_branch Lloop4
Lxt4_1:
    s_cmp_lg_u32 s29, 0
    s_cbranch_scc1 Lft4_2_1
Lft4_2_0:
    s_waitcnt lgkmcnt(0)
    v_mfma_f32_16x16x32_bf16 a[240:243], v[228:231], v[164:167], a[240:243]
    ds_read_b64_tr_b16 a[192:193], v208 offset:49152
    v_exp_f32 v64, v64
    v_exp_f32 v65, v65
    v_exp_f32 v66, v66
    v_exp_f32 v67, v67
    v_exp_f32 v68, v68
    v_exp_f32 v69, v69
    v_exp_f32 v70, v70
    v_exp_f32 v71, v71
    v_cvt_pk_bf16_f32 v144, v64, v65
    v_cvt_pk_bf16_f32 v145, v66, v67
    v_cvt_pk_bf16_f32 v146, v68, v69
    v_cvt_pk_bf16_f32 v147, v70, v71
    v_mfma_f32_16x16x32_bf16 a[244:247], v[228:231], v[168:171], a[244:247]
    ds_read_b64_tr_b16 a[194:195], v208 offset:57344
    v_xor_b32 v184, 0, v240
    v_mfma_f32_16x16x32_bf16 a[240:243], v[228:231], v[144:147], a[240:243]
    ds_read_b64_tr_b16 a[196:197], v209 offset:49152
    s_waitcnt vmcnt(8)
    s_barrier
    ds_read_b64_tr_b16 a[198:199], v209 offset:57344
    v_xor_b32 v185, 32, v240
    v_xor_b32 v186, 64, v240
    v_xor_b32 v187, 96, v240
    v_xor_b32 v188, 128, v240
    v_accvgpr_read_b32 v252, a240
    v_rcp_f32 v192, v252
    v_xor_b32 v189, 160, v240
    v_xor_b32 v190, 192, v240
    v_xor_b32 v191, 224, v240
    s_add_u32 s68, s56, 0
    ds_read_b64_tr_b16 a[200:201], v210 offset:49152
    ds_read_b64_tr_b16 a[202:203], v210 offset:57344
    s_waitcnt lgkmcnt(4)
    v_mfma_f32_16x16x32_bf16 a[0:3], a[192:195], v[164:167], a[0:3]
    ds_read_b64_tr_b16 a[204:205], v211 offset:49152
    ds_read_b64_tr_b16 a[206:207], v211 offset:57344
    v_mfma_f32_16x16x32_bf16 a[32:35], a[192:195], v[168:171], a[32:35]
    ds_read_b64_tr_b16 a[208:209], v212 offset:49152
    ds_read_b64_tr_b16 a[210:211], v212 offset:57344
    ds_read_b64_tr_b16 a[212:213], v213 offset:49152
    ds_read_b64_tr_b16 a[214:215], v213 offset:57344
    s_waitcnt lgkmcnt(8)
    v_mfma_f32_16x16x32_bf16 a[4:7], a[196:199], v[164:167], a[4:7]
    ds_read_b64_tr_b16 a[216:217], v214 offset:49152
    ds_read_b64_tr_b16 a[218:219], v214 offset:57344
    v_mfma_f32_16x16x32_bf16 a[36:39], a[196:199], v[168:171], a[36:39]
    ds_read_b64_tr_b16 a[220:221], v215 offset:49152
    ds_read_b64_tr_b16 a[222:223], v215 offset:57344
    ds_read_b64_tr_b16 a[160:161], v208 offset:0
    ds_read_b64_tr_b16 a[162:163], v208 offset:8192
    s_waitcnt lgkmcnt(12)
    v_mfma_f32_16x16x32_bf16 a[8:11], a[200:203], v[164:167], a[8:11]
    ds_read_b64_tr_b16 a[164:165], v209 offset:0
    ds_read_b64_tr_b16 a[166:167], v209 offset:8192
    s_waitcnt lgkmcnt(12)
    v_mfma_f32_16x16x32_bf16 a[12:15], a[204:207], v[164:167], a[12:15]
    ds_read_b64_tr_b16 a[168:169], v210 offset:0
    ds_read_b64_tr_b16 a[170:171], v210 offset:8192
    s_waitcnt lgkmcnt(11)
    v_mfma_f32_16x16x32_bf16 a[16:19], a[208:211], v[164:167], a[16:19]
    ds_read_b64_tr_b16 a[172:173], v211 offset:0
    ds_read_b64_tr_b16 a[174:175], v211 offset:8192
    s_waitcnt lgkmcnt(11)
    v_mfma_f32_16x16x32_bf16 a[20:23], a[212:215], v[164:167], a[20:23]
    ds_read_b64_tr_b16 a[176:177], v212 offset:0
    ds_read_b64_tr_b16 a[178:179], v212 offset:8192
    s_waitcnt lgkmcnt(10)
    v_mfma_f32_16x16x32_bf16 a[24:27], a[216:219], v[164:167], a[24:27]
    ds_read_b64_tr_b16 a[180:181], v213 offset:0
    ds_read_b64_tr_b16 a[182:183], v213 offset:8192
    v_mfma_f32_16x16x32_bf16 a[28:31], a[220:223], v[164:167], a[28:31]
    ds_read_b64_tr_b16 a[184:185], v214 offset:0
    ds_read_b64_tr_b16 a[186:187], v214 offset:8192
    s_waitcnt lgkmcnt(10)
    v_mfma_f32_16x16x32_bf16 a[0:3], a[160:163], v[144:147], a[0:3]
    ds_read_b64_tr_b16 a[188:189], v215 offset:0
    ds_read_b64_tr_b16 a[190:191], v215 offset:8192
    v_mfma_f32_16x16x32_bf16 a[4:7], a[164:167], v[144:147], a[4:7]
    s_add_u32 s69, s56, 65536
    v_exp_f32 v72, v72
    s_waitcnt lgkmcnt(9)
    v_mfma_f32_16x16x32_bf16 a[8:11], a[168:171], v[144:147], a[8:11]
    s_nop 0
    v_accvgpr_read_b32 v0, a0
    s_waitcnt lgkmcnt(7)
    v_mfma_f32_16x16x32_bf16 a[12:15], a[172:175], v[144:147], a[12:15]
    v_accvgpr_read_b32 v1, a1
    v_accvgpr_read_b32 v4, a4
    s_waitcnt lgkmcnt(6)
    v_mfma_f32_16x16x32_bf16 a[16:19], a[176:179], v[144:147], a[16:19]
    v_accvgpr_read_b32 v5, a5
    v_accvgpr_read_b32 v8, a8
    s_waitcnt lgkmcnt(4)
    v_mfma_f32_16x16x32_bf16 a[20:23], a[180:183], v[144:147], a[20:23]
    v_accvgpr_read_b32 v9, a9
    v_accvgpr_read_b32 v12, a12
    s_waitcnt lgkmcnt(2)
    v_mfma_f32_16x16x32_bf16 a[24:27], a[184:187], v[144:147], a[24:27]
    v_accvgpr_read_b32 v13, a13
    v_accvgpr_read_b32 v16, a16
    v_accvgpr_read_b32 v17, a17
    s_waitcnt lgkmcnt(0)
    v_mfma_f32_16x16x32_bf16 a[28:31], a[188:191], v[144:147], a[28:31]
    v_accvgpr_read_b32 v20, a20
    v_accvgpr_read_b32 v21, a21
    v_accvgpr_read_b32 v2, a2
    v_accvgpr_read_b32 v24, a24
    v_accvgpr_read_b32 v25, a25
    v_accvgpr_read_b32 v3, a3
    v_pk_mul_f32 v[0:1], v[0:1], v[192:193] op_sel_hi:[1,0]
    v_accvgpr_read_b32 v6, a6
    v_accvgpr_read_b32 v28, a28
    v_accvgpr_read_b32 v29, a29
    v_accvgpr_read_b32 v7, a7
    v_pk_mul_f32 v[4:5], v[4:5], v[192:193] op_sel_hi:[1,0]
    v_accvgpr_read_b32 v10, a10
    v_accvgpr_read_b32 v11, a11
    v_pk_mul_f32 v[8:9], v[8:9], v[192:193] op_sel_hi:[1,0]
    v_accvgpr_read_b32 v14, a14
    v_accvgpr_read_b32 v15, a15
    v_pk_mul_f32 v[12:13], v[12:13], v[192:193] op_sel_hi:[1,0]
    v_accvgpr_read_b32 v18, a18
    v_accvgpr_read_b32 v19, a19
    v_pk_mul_f32 v[16:17], v[16:17], v[192:193] op_sel_hi:[1,0]
    v_accvgpr_read_b32 v22, a22
    v_accvgpr_read_b32 v23, a23
    v_pk_mul_f32 v[20:21], v[20:21], v[192:193] op_sel_hi:[1,0]
    v_accvgpr_read_b32 v26, a26
    v_accvgpr_read_b32 v27, a27
    v_pk_mul_f32 v[24:25], v[24:25], v[192:193] op_sel_hi:[1,0]
    v_accvgpr_read_b32 v30, a30
    v_accvgpr_read_b32 v31, a31
    v_pk_mul_f32 v[28:29], v[28:29], v[192:193] op_sel_hi:[1,0]
    v_pk_mul_f32 v[2:3], v[2:3], v[192:193] op_sel_hi:[1,0]
    v_cvt_pk_bf16_f32 v0, v0, v1
    v_pk_mul_f32 v[6:7], v[6:7], v[192:193] op_sel_hi:[1,0]
    v_cvt_pk_bf16_f32 v4, v4, v5
    v_pk_mul_f32 v[10:11], v[10:11], v[192:193] op_sel_hi:[1,0]
    v_cvt_pk_bf16_f32 v8, v8, v9
    v_pk_mul_f32 v[14:15], v[14:15], v[192:193] op_sel_hi:[1,0]
    v_cvt_pk_bf16_f32 v12, v12, v13
    v_pk_mul_f32 v[18:19], v[18:19], v[192:193] op_sel_hi:[1,0]
    v_cvt_pk_bf16_f32 v16, v16, v17
    v_pk_mul_f32 v[22:23], v[22:23], v[192:193] op_sel_hi:[1,0]
    v_cvt_pk_bf16_f32 v20, v20, v21
    v_pk_mul_f32 v[26:27], v[26:27], v[192:193] op_sel_hi:[1,0]
    v_cvt_pk_bf16_f32 v24, v24, v25
    v_pk_mul_f32 v[30:31], v[30:31], v[192:193] op_sel_hi:[1,0]
    v_cvt_pk_bf16_f32 v28, v28, v29
    v_mfma_f32_16x16x32_bf16 a[40:43], a[200:203], v[168:171], a[40:43]
    v_cvt_pk_bf16_f32 v1, v2, v3
    v_cvt_pk_bf16_f32 v5, v6, v7
    v_mfma_f32_16x16x32_bf16 a[44:47], a[204:207], v[168:171], a[44:47]
    ds_write_b64 v184, v[0:1]
    v_mfma_f32_16x16x32_bf16 a[48:51], a[208:211], v[168:171], a[48:51]
    v_cvt_pk_bf16_f32 v9, v10, v11
    v_cvt_pk_bf16_f32 v13, v14, v15
    v_mfma_f32_16x16x32_bf16 a[52:55], a[212:215], v[168:171], a[52:55]
    ds_write_b64 v185, v[4:5]
    v_mfma_f32_16x16x32_bf16 a[56:59], a[216:219], v[168:171], a[56:59]
    v_cvt_pk_bf16_f32 v17, v18, v19
    v_cvt_pk_bf16_f32 v21, v22, v23
    v_mfma_f32_16x16x32_bf16 a[60:63], a[220:223], v[168:171], a[60:63]
    ds_write_b64 v186, v[8:9]
    v_cvt_pk_bf16_f32 v25, v26, v27
    v_cvt_pk_bf16_f32 v29, v30, v31
    v_exp_f32 v73, v73
    v_exp_f32 v74, v74
    v_exp_f32 v75, v75
    v_exp_f32 v76, v76
    v_exp_f32 v77, v77
    v_exp_f32 v78, v78
    v_exp_f32 v79, v79
    v_cvt_pk_bf16_f32 v148, v72, v73
    v_cvt_pk_bf16_f32 v149, v74, v75
    v_cvt_pk_bf16_f32 v150, v76, v77
    v_cvt_pk_bf16_f32 v151, v78, v79
    v_mfma_f32_16x16x32_bf16 a[248:251], v[228:231], v[172:175], a[248:251]
    ds_write_b64 v187, v[12:13]
    v_mfma_f32_16x16x32_bf16 a[244:247], v[228:231], v[148:151], a[244:247]
    ds_write_b64 v188, v[16:17]
    v_mfma_f32_16x16x32_bf16 a[32:35], a[160:163], v[148:151], a[32:35]
    ds_write_b64 v189, v[20:21]
    v_mfma_f32_16x16x32_bf16 a[36:39], a[164:167], v[148:151], a[36:39]
    ds_write_b64 v190, v[24:25]
    v_mfma_f32_16x16x32_bf16 a[40:43], a[168:171], v[148:151], a[40:43]
    ds_write_b64 v191, v[28:29]
    v_mfma_f32_16x16x32_bf16 a[44:47], a[172:175], v[148:151], a[44:47]
    ds_read_b128 a[0:3], v241 offset:0
    ds_read_b128 a[4:7], v241 offset:1024
    v_mfma_f32_16x16x32_bf16 a[48:51], a[176:179], v[148:151], a[48:51]
    ds_read_b128 a[8:11], v241 offset:2048
    v_accvgpr_read_b32 v253, a244
    v_mfma_f32_16x16x32_bf16 a[52:55], a[180:183], v[148:151], a[52:55]
    ds_read_b128 a[12:15], v241 offset:3072
    v_rcp_f32 v194, v253
    v_mfma_f32_16x16x32_bf16 a[56:59], a[184:187], v[148:151], a[56:59]
    v_accvgpr_read_b32 v32, a32
    v_accvgpr_read_b32 v33, a33
    v_mfma_f32_16x16x32_bf16 a[60:63], a[188:191], v[148:151], a[60:63]
    v_accvgpr_read_b32 v36, a36
    v_accvgpr_read_b32 v37, a37
    v_accvgpr_read_b32 v40, a40
    v_accvgpr_read_b32 v41, a41
    v_accvgpr_read_b32 v44, a44
    v_accvgpr_read_b32 v45, a45
    v_accvgpr_read_b32 v48, a48
    v_accvgpr_read_b32 v49, a49
    v_accvgpr_read_b32 v52, a52
    v_accvgpr_read_b32 v53, a53
    v_accvgpr_read_b32 v56, a56
    v_accvgpr_read_b32 v57, a57
    v_accvgpr_read_b32 v60, a60
    v_accvgpr_read_b32 v61, a61
    v_accvgpr_read_b32 v34, a34
    v_accvgpr_read_b32 v35, a35
    v_pk_mul_f32 v[32:33], v[32:33], v[194:195] op_sel_hi:[1,0]
    v_accvgpr_read_b32 v38, a38
    v_accvgpr_read_b32 v39, a39
    v_pk_mul_f32 v[36:37], v[36:37], v[194:195] op_sel_hi:[1,0]
    v_accvgpr_read_b32 v42, a42
    v_accvgpr_read_b32 v43, a43
    v_pk_mul_f32 v[40:41], v[40:41], v[194:195] op_sel_hi:[1,0]
    v_accvgpr_read_b32 v46, a46
    v_accvgpr_read_b32 v47, a47
    v_pk_mul_f32 v[44:45], v[44:45], v[194:195] op_sel_hi:[1,0]
    v_accvgpr_read_b32 v50, a50
    v_accvgpr_read_b32 v51, a51
    v_pk_mul_f32 v[48:49], v[48:49], v[194:195] op_sel_hi:[1,0]
    v_accvgpr_read_b32 v54, a54
    v_accvgpr_read_b32 v55, a55
    v_pk_mul_f32 v[52:53], v[52:53], v[194:195] op_sel_hi:[1,0]
    v_accvgpr_read_b32 v58, a58
    v_accvgpr_read_b32 v59, a59
    v_pk_mul_f32 v[56:57], v[56:57], v[194:195] op_sel_hi:[1,0]
    v_accvgpr_read_b32 v62, a62
    v_accvgpr_read_b32 v63, a63
    v_pk_mul_f32 v[60:61], v[60:61], v[194:195] op_sel_hi:[1,0]
    v_pk_mul_f32 v[34:35], v[34:35], v[194:195] op_sel_hi:[1,0]
    v_cvt_pk_bf16_f32 v32, v32, v33
    v_pk_mul_f32 v[38:39], v[38:39], v[194:195] op_sel_hi:[1,0]
    v_cvt_pk_bf16_f32 v36, v36, v37
    v_pk_mul_f32 v[42:43], v[42:43], v[194:195] op_sel_hi:[1,0]
    v_cvt_pk_bf16_f32 v40, v40, v41
    v_pk_mul_f32 v[46:47], v[46:47], v[194:195] op_sel_hi:[1,0]
    v_cvt_pk_bf16_f32 v44, v44, v45
    v_pk_mul_f32 v[50:51], v[50:51], v[194:195] op_sel_hi:[1,0]
    v_cvt_pk_bf16_f32 v48, v48, v49
    v_pk_mul_f32 v[54:55], v[54:55], v[194:195] op_sel_hi:[1,0]
    v_cvt_pk_bf16_f32 v52, v52, v53
    v_pk_mul_f32 v[58:59], v[58:59], v[194:195] op_sel_hi:[1,0]
    v_cvt_pk_bf16_f32 v56, v56, v57
    v_pk_mul_f32 v[62:63], v[62:63], v[194:195] op_sel_hi:[1,0]
    v_cvt_pk_bf16_f32 v60, v60, v61
    v_mfma_f32_16x16x32_bf16 a[64:67], a[192:195], v[172:175], a[64:67]
    s_waitcnt lgkmcnt(0)
    buffer_store_dwordx4 a[0:3], v220, s[24:27], s68 offen offset:0 sc0 sc1
    v_cvt_pk_bf16_f32 v33, v34, v35
    v_mfma_f32_16x16x32_bf16 a[68:71], a[196:199], v[172:175], a[68:71]
    ds_write_b64 v184, v[32:33]
    v_mfma_f32_16x16x32_bf16 a[72:75], a[200:203], v[172:175], a[72:75]
    v_cvt_pk_bf16_f32 v37, v38, v39
    v_cvt_pk_bf16_f32 v41, v42, v43
    v_mfma_f32_16x16x32_bf16 a[76:79], a[204:207], v[172:175], a[76:79]
    ds_write_b64 v185, v[36:37]
    v_mfma_f32_16x16x32_bf16 a[80:83], a[208:211], v[172:175], a[80:83]
    v_cvt_pk_bf16_f32 v45, v46, v47
    v_cvt_pk_bf16_f32 v49, v50, v51
    v_mfma_f32_16x16x32_bf16 a[84:87], a[212:215], v[172:175], a[84:87]
    ds_write_b64 v186, v[40:41]
    v_mfma_f32_16x16x32_bf16 a[88:91], a[216:219], v[172:175], a[88:91]
    buffer_store_dwordx4 a[4:7], v221, s[24:27], s68 offen offset:1024 sc0 sc1
    v_cvt_pk_bf16_f32 v53, v54, v55
    v_mfma_f32_16x16x32_bf16 a[92:95], a[220:223], v[172:175], a[92:95]
    ds_write_b64 v187, v[44:45]
    v_cvt_pk_bf16_f32 v57, v58, v59
    v_cvt_pk_bf16_f32 v61, v62, v63
    v_exp_f32 v80, v80
    v_exp_f32 v81, v81
    v_exp_f32 v82, v82
    v_exp_f32 v83, v83
    v_exp_f32 v84, v84
    v_exp_f32 v85, v85
    v_exp_f32 v86, v86
    v_exp_f32 v87, v87
    v_cvt_pk_bf16_f32 v152, v80, v81
    v_cvt_pk_bf16_f32 v153, v82, v83
    v_cvt_pk_bf16_f32 v154, v84, v85
    v_cvt_pk_bf16_f32 v155, v86, v87
    v_mfma_f32_16x16x32_bf16 a[252:255], v[228:231], v[176:179], a[252:255]
    buffer_store_dwordx4 a[8:11], v222, s[24:27], s68 offen offset:2048 sc0 sc1
    ds_write_b64 v188, v[48:49]
    v_mfma_f32_16x16x32_bf16 a[248:251], v[228:231], v[152:155], a[248:251]
    ds_write_b64 v189, v[52:53]
    v_mfma_f32_16x16x32_bf16 a[64:67], a[160:163], v[152:155], a[64:67]
    ds_write_b64 v190, v[56:57]
    v_mfma_f32_16x16x32_bf16 a[68:71], a[164:167], v[152:155], a[68:71]
    ds_write_b64 v191, v[60:61]
    v_mfma_f32_16x16x32_bf16 a[72:75], a[168:171], v[152:155], a[72:75]
    ds_read_b128 a[32:35], v241 offset:0
    buffer_store_dwordx4 a[12:15], v223, s[24:27], s68 offen offset:3072 sc0 sc1
    v_mfma_f32_16x16x32_bf16 a[76:79], a[172:175], v[152:155], a[76:79]
    ds_read_b128 a[36:39], v241 offset:1024
    v_accvgpr_read_b32 v254, a248
    v_mfma_f32_16x16x32_bf16 a[80:83], a[176:179], v[152:155], a[80:83]
    ds_read_b128 a[40:43], v241 offset:2048
    v_rcp_f32 v196, v254
    v_mfma_f32_16x16x32_bf16 a[84:87], a[180:183], v[152:155], a[84:87]
    ds_read_b128 a[44:47], v241 offset:3072
    v_accvgpr_read_b32 v0, a64
    v_mfma_f32_16x16x32_bf16 a[88:91], a[184:187], v[152:155], a[88:91]
    s_add_u32 s70, s56, 131072
    v_accvgpr_read_b32 v1, a65
    v_accvgpr_read_b32 v4, a68
    v_mfma_f32_16x16x32_bf16 a[92:95], a[188:191], v[152:155], a[92:95]
    v_accvgpr_read_b32 v5, a69
    v_accvgpr_read_b32 v8, a72
    v_accvgpr_read_b32 v9, a73
    v_accvgpr_read_b32 v12, a76
    v_accvgpr_read_b32 v13, a77
    v_accvgpr_read_b32 v16, a80
    v_accvgpr_read_b32 v17, a81
    v_accvgpr_read_b32 v20, a84
    v_accvgpr_read_b32 v21, a85
    v_accvgpr_read_b32 v24, a88
    v_accvgpr_read_b32 v25, a89
    v_accvgpr_read_b32 v28, a92
    v_accvgpr_read_b32 v29, a93
    v_accvgpr_read_b32 v2, a66
    v_accvgpr_read_b32 v3, a67
    v_pk_mul_f32 v[0:1], v[0:1], v[196:197] op_sel_hi:[1,0]
    v_accvgpr_read_b32 v6, a70
    v_accvgpr_read_b32 v7, a71
    v_pk_mul_f32 v[4:5], v[4:5], v[196:197] op_sel_hi:[1,0]
    v_accvgpr_read_b32 v10, a74
    v_accvgpr_read_b32 v11, a75
    v_pk_mul_f32 v[8:9], v[8:9], v[196:197] op_sel_hi:[1,0]
    v_accvgpr_read_b32 v14, a78
    v_accvgpr_read_b32 v15, a79
    v_pk_mul_f32 v[12:13], v[12:13], v[196:197] op_sel_hi:[1,0]
    v_accvgpr_read_b32 v18, a82
    v_accvgpr_read_b32 v19, a83
    v_pk_mul_f32 v[16:17], v[16:17], v[196:197] op_sel_hi:[1,0]
    v_accvgpr_read_b32 v22, a86
    v_accvgpr_read_b32 v23, a87
    v_pk_mul_f32 v[20:21], v[20:21], v[196:197] op_sel_hi:[1,0]
    v_accvgpr_read_b32 v26, a90
    v_accvgpr_read_b32 v27, a91
    v_pk_mul_f32 v[24:25], v[24:25], v[196:197] op_sel_hi:[1,0]
    v_accvgpr_read_b32 v30, a94
    v_accvgpr_read_b32 v31, a95
    v_pk_mul_f32 v[28:29], v[28:29], v[196:197] op_sel_hi:[1,0]
    v_pk_mul_f32 v[2:3], v[2:3], v[196:197] op_sel_hi:[1,0]
    v_cvt_pk_bf16_f32 v0, v0, v1
    v_pk_mul_f32 v[6:7], v[6:7], v[196:197] op_sel_hi:[1,0]
    v_cvt_pk_bf16_f32 v4, v4, v5
    v_pk_mul_f32 v[10:11], v[10:11], v[196:197] op_sel_hi:[1,0]
    v_cvt_pk_bf16_f32 v8, v8, v9
    v_pk_mul_f32 v[14:15], v[14:15], v[196:197] op_sel_hi:[1,0]
    v_cvt_pk_bf16_f32 v12, v12, v13
    v_pk_mul_f32 v[18:19], v[18:19], v[196:197] op_sel_hi:[1,0]
    v_cvt_pk_bf16_f32 v16, v16, v17
    v_pk_mul_f32 v[22:23], v[22:23], v[196:197] op_sel_hi:[1,0]
    v_cvt_pk_bf16_f32 v20, v20, v21
    v_pk_mul_f32 v[26:27], v[26:27], v[196:197] op_sel_hi:[1,0]
    v_cvt_pk_bf16_f32 v24, v24, v25
    v_pk_mul_f32 v[30:31], v[30:31], v[196:197] op_sel_hi:[1,0]
    v_cvt_pk_bf16_f32 v28, v28, v29
    v_mfma_f32_16x16x32_bf16 a[96:99], a[192:195], v[176:179], a[96:99]
    s_waitcnt lgkmcnt(0)
    buffer_store_dwordx4 a[32:35], v220, s[24:27], s69 offen offset:0 sc0 sc1
    v_cvt_pk_bf16_f32 v1, v2, v3
    v_mfma_f32_16x16x32_bf16 a[100:103], a[196:199], v[176:179], a[100:103]
    ds_write_b64 v184, v[0:1]
    v_mfma_f32_16x16x32_bf16 a[104:107], a[200:203], v[176:179], a[104:107]
    v_cvt_pk_bf16_f32 v5, v6, v7
    v_cvt_pk_bf16_f32 v9, v10, v11
    v_mfma_f32_16x16x32_bf16 a[108:111], a[204:207], v[176:179], a[108:111]
    ds_write_b64 v185, v[4:5]
    v_mfma_f32_16x16x32_bf16 a[112:115], a[208:211], v[176:179], a[112:115]
    v_cvt_pk_bf16_f32 v13, v14, v15
    v_cvt_pk_bf16_f32 v17, v18, v19
    v_mfma_f32_16x16x32_bf16 a[116:119], a[212:215], v[176:179], a[116:119]
    ds_write_b64 v186, v[8:9]
    v_mfma_f32_16x16x32_bf16 a[120:123], a[216:219], v[176:179], a[120:123]
    buffer_store_dwordx4 a[36:39], v221, s[24:27], s69 offen offset:1024 sc0 sc1
    v_cvt_pk_bf16_f32 v21, v22, v23
    v_mfma_f32_16x16x32_bf16 a[124:127], a[220:223], v[176:179], a[124:127]
    ds_write_b64 v187, v[12:13]
    v_cvt_pk_bf16_f32 v25, v26, v27
    v_cvt_pk_bf16_f32 v29, v30, v31
    v_exp_f32 v88, v88
    v_exp_f32 v89, v89
    v_exp_f32 v90, v90
    v_exp_f32 v91, v91
    v_exp_f32 v92, v92
    v_exp_f32 v93, v93
    v_exp_f32 v94, v94
    v_exp_f32 v95, v95
    v_cvt_pk_bf16_f32 v156, v88, v89
    v_cvt_pk_bf16_f32 v157, v90, v91
    v_cvt_pk_bf16_f32 v158, v92, v93
    v_cvt_pk_bf16_f32 v159, v94, v95
    buffer_store_dwordx4 a[40:43], v222, s[24:27], s69 offen offset:2048 sc0 sc1
    ds_write_b64 v188, v[16:17]
    v_mfma_f32_16x16x32_bf16 a[252:255], v[228:231], v[156:159], a[252:255]
    ds_write_b64 v189, v[20:21]
    v_mfma_f32_16x16x32_bf16 a[96:99], a[160:163], v[156:159], a[96:99]
    ds_write_b64 v190, v[24:25]
    v_mfma_f32_16x16x32_bf16 a[100:103], a[164:167], v[156:159], a[100:103]
    ds_write_b64 v191, v[28:29]
    v_mfma_f32_16x16x32_bf16 a[104:107], a[168:171], v[156:159], a[104:107]
    ds_read_b128 a[64:67], v241 offset:0
    buffer_store_dwordx4 a[44:47], v223, s[24:27], s69 offen offset:3072 sc0 sc1
    v_mfma_f32_16x16x32_bf16 a[108:111], a[172:175], v[156:159], a[108:111]
    ds_read_b128 a[68:71], v241 offset:1024
    v_accvgpr_read_b32 v255, a252
    v_mfma_f32_16x16x32_bf16 a[112:115], a[176:179], v[156:159], a[112:115]
    ds_read_b128 a[72:75], v241 offset:2048
    v_rcp_f32 v198, v255
    v_mfma_f32_16x16x32_bf16 a[116:119], a[180:183], v[156:159], a[116:119]
    ds_read_b128 a[76:79], v241 offset:3072
    v_accvgpr_read_b32 v32, a96
    v_mfma_f32_16x16x32_bf16 a[120:123], a[184:187], v[156:159], a[120:123]
    s_add_u32 s71, s56, 196608
    v_accvgpr_read_b32 v33, a97
    v_accvgpr_read_b32 v36, a100
    v_mfma_f32_16x16x32_bf16 a[124:127], a[188:191], v[156:159], a[124:127]
    v_accvgpr_read_b32 v37, a101
    v_accvgpr_read_b32 v40, a104
    v_accvgpr_read_b32 v41, a105
    v_accvgpr_read_b32 v44, a108
    v_accvgpr_read_b32 v45, a109
    v_accvgpr_read_b32 v48, a112
    v_accvgpr_read_b32 v49, a113
    v_accvgpr_read_b32 v52, a116
    v_accvgpr_read_b32 v53, a117
    v_accvgpr_read_b32 v56, a120
    v_accvgpr_read_b32 v57, a121
    v_accvgpr_read_b32 v60, a124
    v_accvgpr_read_b32 v61, a125
    v_accvgpr_read_b32 v34, a98
    v_accvgpr_read_b32 v35, a99
    v_pk_mul_f32 v[32:33], v[32:33], v[198:199] op_sel_hi:[1,0]
    v_accvgpr_read_b32 v38, a102
    v_accvgpr_read_b32 v39, a103
    v_pk_mul_f32 v[36:37], v[36:37], v[198:199] op_sel_hi:[1,0]
    v_accvgpr_read_b32 v42, a106
    v_accvgpr_read_b32 v43, a107
    v_pk_mul_f32 v[40:41], v[40:41], v[198:199] op_sel_hi:[1,0]
    v_accvgpr_read_b32 v46, a110
    v_accvgpr_read_b32 v47, a111
    v_pk_mul_f32 v[44:45], v[44:45], v[198:199] op_sel_hi:[1,0]
    v_accvgpr_read_b32 v50, a114
    v_accvgpr_read_b32 v51, a115
    v_pk_mul_f32 v[48:49], v[48:49], v[198:199] op_sel_hi:[1,0]
    v_accvgpr_read_b32 v54, a118
    v_accvgpr_read_b32 v55, a119
    v_pk_mul_f32 v[52:53], v[52:53], v[198:199] op_sel_hi:[1,0]
    v_accvgpr_read_b32 v58, a122
    v_accvgpr_read_b32 v59, a123
    v_pk_mul_f32 v[56:57], v[56:57], v[198:199] op_sel_hi:[1,0]
    v_accvgpr_read_b32 v62, a126
    v_accvgpr_read_b32 v63, a127
    v_pk_mul_f32 v[60:61], v[60:61], v[198:199] op_sel_hi:[1,0]
    v_pk_mul_f32 v[34:35], v[34:35], v[198:199] op_sel_hi:[1,0]
    v_cvt_pk_bf16_f32 v32, v32, v33
    v_pk_mul_f32 v[38:39], v[38:39], v[198:199] op_sel_hi:[1,0]
    v_cvt_pk_bf16_f32 v36, v36, v37
    v_pk_mul_f32 v[42:43], v[42:43], v[198:199] op_sel_hi:[1,0]
    v_cvt_pk_bf16_f32 v40, v40, v41
    v_pk_mul_f32 v[46:47], v[46:47], v[198:199] op_sel_hi:[1,0]
    v_cvt_pk_bf16_f32 v44, v44, v45
    v_pk_mul_f32 v[50:51], v[50:51], v[198:199] op_sel_hi:[1,0]
    v_cvt_pk_bf16_f32 v48, v48, v49
    v_pk_mul_f32 v[54:55], v[54:55], v[198:199] op_sel_hi:[1,0]
    v_cvt_pk_bf16_f32 v52, v52, v53
    v_pk_mul_f32 v[58:59], v[58:59], v[198:199] op_sel_hi:[1,0]
    v_cvt_pk_bf16_f32 v56, v56, v57
    v_pk_mul_f32 v[62:63], v[62:63], v[198:199] op_sel_hi:[1,0]
    v_cvt_pk_bf16_f32 v60, v60, v61
    v_cvt_pk_bf16_f32 v33, v34, v35
    v_cvt_pk_bf16_f32 v37, v38, v39
    v_cvt_pk_bf16_f32 v41, v42, v43
    v_cvt_pk_bf16_f32 v45, v46, v47
    v_cvt_pk_bf16_f32 v49, v50, v51
    v_cvt_pk_bf16_f32 v53, v54, v55
    v_cvt_pk_bf16_f32 v57, v58, v59
    v_cvt_pk_bf16_f32 v61, v62, v63
    v_max3_f32 v237, v252, v253, v254
    v_max_f32 v237, v237, v255
    v_cmp_le_f32 vcc, s66, v237
    s_or_b32 s74, vcc_lo, vcc_hi
    s_waitcnt lgkmcnt(0)
    buffer_store_dwordx4 a[64:67], v220, s[24:27], s70 offen offset:0 sc0 sc1
    v_mov_b32 v237, s74
    ds_write_b64 v184, v[32:33]
    ds_write_b64 v185, v[36:37]
    ds_write_b64 v186, v[40:41]
    ds_write_b64 v187, v[44:45]
    buffer_store_dwordx4 a[68:71], v221, s[24:27], s70 offen offset:1024 sc0 sc1
    ds_write_b64 v188, v[48:49]
    ds_write_b64 v189, v[52:53]
    ds_write_b64 v190, v[56:57]
    ds_write_b64 v191, v[60:61]
    buffer_store_dwordx4 a[72:75], v222, s[24:27], s70 offen offset:2048 sc0 sc1
    ds_read_b128 a[96:99], v241 offset:0
    ds_read_b128 a[100:103], v241 offset:1024
    ds_write_b32 v239, v237 offset:16384
    ds_read_b128 a[104:107], v241 offset:2048
    ds_read_b128 a[108:111], v241 offset:3072
    buffer_store_dwordx4 a[76:79], v223, s[24:27], s70 offen offset:3072 sc0 sc1
    s_waitcnt lgkmcnt(1)
    s_barrier
    buffer_store_dwordx4 a[96:99], v220, s[24:27], s71 offen offset:0 sc0 sc1
    ds_read_b32 v244, v236
    buffer_store_dwordx4 a[100:103], v221, s[24:27], s71 offen offset:1024 sc0 sc1
    s_waitcnt lgkmcnt(0)
    v_cmp_ne_u32 vcc, 0, v244
    buffer_store_dwordx4 a[104:107], v222, s[24:27], s71 offen offset:2048 sc0 sc1
    buffer_store_dwordx4 a[108:111], v223, s[24:27], s71 offen offset:3072 sc0 sc1
    s_cbranch_vccnz Lrestart
    s_endpgm
Lft4_2_1:
    s_waitcnt lgkmcnt(0)
    v_mfma_f32_16x16x32_bf16 a[240:243], v[228:231], v[164:167], a[240:243]
    ds_read_b64_tr_b16 a[192:193], v208 offset:49152
    v_exp_f32 v64, v64
    v_exp_f32 v65, v65
    v_exp_f32 v66, v66
    v_exp_f32 v67, v67
    v_exp_f32 v68, v68
    v_exp_f32 v69, v69
    v_exp_f32 v70, v70
    v_exp_f32 v71, v71
    v_cvt_pk_bf16_f32 v144, v64, v65
    v_cvt_pk_bf16_f32 v145, v66, v67
    v_cvt_pk_bf16_f32 v146, v68, v69
    v_cvt_pk_bf16_f32 v147, v70, v71
    v_xor_b32 v184, 0, v240
    v_xor_b32 v185, 32, v240
    v_mfma_f32_16x16x32_bf16 a[240:243], v[228:231], v[144:147], a[240:243]
    ds_read_b64_tr_b16 a[194:195], v208 offset:57344
    s_waitcnt vmcnt(8)
    s_barrier
    s_mov_b32 m0, s41
    s_add_u32 s18, s30, 4096
    buffer_load_dwordx4 v216, s[16:19], s31 offen offset:2048 lds
    s_add_u32 s61, s55, 0
    ds_read_b64_tr_b16 a[196:197], v209 offset:49152
    v_xor_b32 v186, 64, v240
    v_xor_b32 v187, 96, v240
    v_xor_b32 v188, 128, v240
    v_xor_b32 v189, 160, v240
    v_xor_b32 v190, 192, v240
    v_xor_b32 v191, 224, v240
    v_accvgpr_read_b32 v252, a240
    v_rcp_f32 v192, v252
    v_mfma_f32_16x16x32_bf16 a[244:247], v[228:231], v[168:171], a[244:247]
    ds_read_b64_tr_b16 a[198:199], v209 offset:57344
    ds_read_b64_tr_b16 a[200:201], v210 offset:49152
    s_waitcnt lgkmcnt(3)
    v_mfma_f32_16x16x32_bf16 a[0:3], a[192:195], v[164:167], a[0:3]
    buffer_load_dwordx4 v217, s[16:19], s31 offen offset:3072 lds
    s_mov_b32 m0, s3
    ds_read_b64_tr_b16 a[202:203], v210 offset:57344
    ds_read_b64_tr_b16 a[204:205], v211 offset:49152
    ds_read_b64_tr_b16 a[206:207], v211 offset:57344
    ds_read_b64_tr_b16 a[208:209], v212 offset:49152
    ds_read_b64_tr_b16 a[210:211], v212 offset:57344
    ds_read_b64_tr_b16 a[212:213], v213 offset:49152
    ds_read_b64_tr_b16 a[214:215], v213 offset:57344
    ds_read_b64_tr_b16 a[216:217], v214 offset:49152
    buffer_load_dwordx4 v220, s[12:15], s61 offen offset:0 nt lds
    ds_read_b64_tr_b16 a[218:219], v214 offset:57344
    ds_read_b64_tr_b16 a[220:221], v215 offset:49152
    ds_read_b64_tr_b16 a[222:223], v215 offset:57344
    s_waitcnt lgkmcnt(11)
    v_mfma_f32_16x16x32_bf16 a[4:7], a[196:199], v[164:167], a[4:7]
    ds_read_b64_tr_b16 a[160:161], v208 offset:0
    ds_read_b64_tr_b16 a[162:163], v208 offset:8192
    v_mfma_f32_16x16x32_bf16 a[32:35], a[192:195], v[168:171], a[32:35]
    buffer_load_dwordx4 v221, s[12:15], s61 offen offset:1024 nt lds
    ds_read_b64_tr_b16 a[164:165], v209 offset:0
    s_waitcnt lgkmcnt(11)
    v_mfma_f32_16x16x32_bf16 a[8:11], a[200:203], v[164:167], a[8:11]
    ds_read_b64_tr_b16 a[166:167], v209 offset:8192
    ds_read_b64_tr_b16 a[168:169], v210 offset:0
    v_mfma_f32_16x16x32_bf16 a[12:15], a[204:207], v[164:167], a[12:15]
    ds_read_b64_tr_b16 a[170:171], v210 offset:8192
    ds_read_b64_tr_b16 a[172:173], v211 offset:0
    s_waitcnt lgkmcnt(10)
    v_mfma_f32_16x16x32_bf16 a[16:19], a[208:211], v[164:167], a[16:19]
    buffer_load_dwordx4 v222, s[12:15], s61 offen offset:2048 nt lds
    ds_read_b64_tr_b16 a[174:175], v211 offset:8192
    v_mfma_f32_16x16x32_bf16 a[20:23], a[212:215], v[164:167], a[20:23]
    ds_read_b64_tr_b16 a[176:177], v212 offset:0
    ds_read_b64_tr_b16 a[178:179], v212 offset:8192
    s_waitcnt lgkmcnt(9)
    v_mfma_f32_16x16x32_bf16 a[24:27], a[216:219], v[164:167], a[24:27]
    ds_read_b64_tr_b16 a[180:181], v213 offset:0
    ds_read_b64_tr_b16 a[182:183], v213 offset:8192
    v_mfma_f32_16x16x32_bf16 a[28:31], a[220:223], v[164:167], a[28:31]
    buffer_load_dwordx4 v223, s[12:15], s61 offen offset:3072 nt lds
    s_add_u32 m0, s3, 4096
    s_waitcnt lgkmcnt(8)
    v_mfma_f32_16x16x32_bf16 a[0:3], a[160:163], v[144:147], a[0:3]
    s_add_u32 s61, s55, 65536
    ds_read_b64_tr_b16 a[184:185], v214 offset:0
    ds_read_b64_tr_b16 a[186:187], v214 offset:8192
    v_mfma_f32_16x16x32_bf16 a[4:7], a[164:167], v[144:147], a[4:7]
    ds_read_b64_tr_b16 a[188:189], v215 offset:0
    ds_read_b64_tr_b16 a[190:191], v215 offset:8192
    s_waitcnt lgkmcnt(9)
    v_mfma_f32_16x16x32_bf16 a[8:11], a[168:171], v[144:147], a[8:11]
    buffer_load_dwordx4 v220, s[12:15], s61 offen offset:0 nt lds
    v_accvgpr_read_b32 v0, a0
    s_waitcnt lgkmcnt(7)
    v_mfma_f32_16x16x32_bf16 a[12:15], a[172:175], v[144:147], a[12:15]
    s_add_u32 s68, s56, 0
    v_accvgpr_read_b32 v1, a1
    v_accvgpr_read_b32 v2, a2
    s_waitcnt lgkmcnt(6)
    v_mfma_f32_16x16x32_bf16 a[16:19], a[176:179], v[144:147], a[16:19]
    v_accvgpr_read_b32 v3, a3
    v_accvgpr_read_b32 v4, a4
    s_waitcnt lgkmcnt(4)
    v_mfma_f32_16x16x32_bf16 a[20:23], a[180:183], v[144:147], a[20:23]
    buffer_load_dwordx4 v221, s[12:15], s61 offen offset:1024 nt lds
    v_accvgpr_read_b32 v5, a5
    v_accvgpr_read_b32 v6, a6
    v_accvgpr_read_b32 v7, a7
    v_pk_mul_f32 v[0:1], v[0:1], v[192:193] op_sel_hi:[1,0]
    v_pk_mul_f32 v[2:3], v[2:3], v[192:193] op_sel_hi:[1,0]
    s_waitcnt lgkmcnt(2)
    v_mfma_f32_16x16x32_bf16 a[24:27], a[184:187], v[144:147], a[24:27]
    v_cvt_pk_bf16_f32 v0, v0, v1
    v_cvt_pk_bf16_f32 v1, v2, v3
    s_waitcnt lgkmcnt(0)
    v_mfma_f32_16x16x32_bf16 a[28:31], a[188:191], v[144:147], a[28:31]
    ds_write_b64 v184, v[0:1]
    v_accvgpr_read_b32 v8, a8
    v_accvgpr_read_b32 v9, a9
    v_pk_mul_f32 v[4:5], v[4:5], v[192:193] op_sel_hi:[1,0]
    v_pk_mul_f32 v[6:7], v[6:7], v[192:193] op_sel_hi:[1,0]
    v_cvt_pk_bf16_f32 v4, v4, v5
    v_cvt_pk_bf16_f32 v5, v6, v7
    v_accvgpr_read_b32 v10, a10
    v_mfma_f32_16x16x32_bf16 a[36:39], a[196:199], v[168:171], a[36:39]
    buffer_load_dwordx4 v222, s[12:15], s61 offen offset:2048 nt lds
    v_accvgpr_read_b32 v11, a11
    v_mfma_f32_16x16x32_bf16 a[40:43], a[200:203], v[168:171], a[40:43]
    ds_write_b64 v185, v[4:5]
    v_mfma_f32_16x16x32_bf16 a[44:47], a[204:207], v[168:171], a[44:47]
    v_accvgpr_read_b32 v12, a12
    v_accvgpr_read_b32 v13, a13
    v_mfma_f32_16x16x32_bf16 a[48:51], a[208:211], v[168:171], a[48:51]
    v_accvgpr_read_b32 v14, a14
    v_accvgpr_read_b32 v15, a15
    v_mfma_f32_16x16x32_bf16 a[52:55], a[212:215], v[168:171], a[52:55]
    buffer_load_dwordx4 v223, s[12:15], s61 offen offset:3072 nt lds
    s_add_u32 m0, s41, 16384
    v_mfma_f32_16x16x32_bf16 a[56:59], a[216:219], v[168:171], a[56:59]
    v_accvgpr_read_b32 v16, a16
    v_accvgpr_read_b32 v17, a17
    v_mfma_f32_16x16x32_bf16 a[60:63], a[220:223], v[168:171], a[60:63]
    v_accvgpr_read_b32 v18, a18
    v_accvgpr_read_b32 v19, a19
    v_accvgpr_read_b32 v20, a20
    v_accvgpr_read_b32 v21, a21
    v_accvgpr_read_b32 v22, a22
    v_pk_mul_f32 v[8:9], v[8:9], v[192:193] op_sel_hi:[1,0]
    v_pk_mul_f32 v[10:11], v[10:11], v[192:193] op_sel_hi:[1,0]
    v_cvt_pk_bf16_f32 v8, v8, v9
    v_cvt_pk_bf16_f32 v9, v10, v11
    v_pk_mul_f32 v[12:13], v[12:13], v[192:193] op_sel_hi:[1,0]
    v_pk_mul_f32 v[14:15], v[14:15], v[192:193] op_sel_hi:[1,0]
    v_cvt_pk_bf16_f32 v12, v12, v13
    v_cvt_pk_bf16_f32 v13, v14, v15
    v_pk_mul_f32 v[16:17], v[16:17], v[192:193] op_sel_hi:[1,0]
    v_pk_mul_f32 v[18:19], v[18:19], v[192:193] op_sel_hi:[1,0]
    v_cvt_pk_bf16_f32 v16, v16, v17
    v_cvt_pk_bf16_f32 v17, v18, v19
    v_accvgpr_read_b32 v23, a23
    v_pk_mul_f32 v[20:21], v[20:21], v[192:193] op_sel_hi:[1,0]
    v_pk_mul_f32 v[22:23], v[22:23], v[192:193] op_sel_hi:[1,0]
    v_accvgpr_read_b32 v24, a24
    v_cvt_pk_bf16_f32 v20, v20, v21
    v_accvgpr_read_b32 v25, a25
    v_cvt_pk_bf16_f32 v21, v22, v23
    v_accvgpr_read_b32 v26, a26
    v_accvgpr_read_b32 v27, a27
    v_pk_mul_f32 v[24:25], v[24:25], v[192:193] op_sel_hi:[1,0]
    v_pk_mul_f32 v[26:27], v[26:27], v[192:193] op_sel_hi:[1,0]
    v_accvgpr_read_b32 v28, a28
    v_cvt_pk_bf16_f32 v24, v24, v25
    v_accvgpr_read_b32 v29, a29
    v_cvt_pk_bf16_f32 v25, v26, v27
    v_accvgpr_read_b32 v30, a30
    v_accvgpr_read_b32 v31, a31
    v_pk_mul_f32 v[28:29], v[28:29], v[192:193] op_sel_hi:[1,0]
    v_pk_mul_f32 v[30:31], v[30:31], v[192:193] op_sel_hi:[1,0]
    v_cvt_pk_bf16_f32 v28, v28, v29
    v_cvt_pk_bf16_f32 v29, v30, v31
    v_exp_f32 v72, v72
    v_exp_f32 v73, v73
    v_exp_f32 v74, v74
    v_exp_f32 v75, v75
    v_exp_f32 v76, v76
    v_exp_f32 v77, v77
    v_exp_f32 v78, v78
    v_exp_f32 v79, v79
    v_cvt_pk_bf16_f32 v148, v72, v73
    v_cvt_pk_bf16_f32 v149, v74, v75
    v_cvt_pk_bf16_f32 v150, v76, v77
    v_cvt_pk_bf16_f32 v151, v78, v79
    v_mfma_f32_16x16x32_bf16 a[248:251], v[228:231], v[172:175], a[248:251]
    buffer_load_dwordx4 v216, s[16:19], s28 offen offset:2048 lds
    ds_write_b64 v186, v[8:9]
    v_mfma_f32_16x16x32_bf16 a[244:247], v[228:231], v[148:151], a[244:247]
    ds_write_b64 v187, v[12:13]
    v_mfma_f32_16x16x32_bf16 a[32:35], a[160:163], v[148:151], a[32:35]
    ds_write_b64 v188, v[16:17]
    v_mfma_f32_16x16x32_bf16 a[36:39], a[164:167], v[148:151], a[36:39]
    buffer_load_dwordx4 v217, s[16:19], s28 offen offset:3072 lds
    ds_write_b64 v189, v[20:21]
    v_mfma_f32_16x16x32_bf16 a[40:43], a[168:171], v[148:151], a[40:43]
    ds_write_b64 v190, v[24:25]
    v_mfma_f32_16x16x32_bf16 a[44:47], a[172:175], v[148:151], a[44:47]
    ds_write_b64 v191, v[28:29]
    v_mfma_f32_16x16x32_bf16 a[48:51], a[176:179], v[148:151], a[48:51]
    ds_read_b128 a[0:3], v241 offset:0
    v_accvgpr_read_b32 v253, a244
    v_mfma_f32_16x16x32_bf16 a[52:55], a[180:183], v[148:151], a[52:55]
    ds_read_b128 a[4:7], v241 offset:1024
    v_rcp_f32 v194, v253
    v_mfma_f32_16x16x32_bf16 a[56:59], a[184:187], v[148:151], a[56:59]
    ds_read_b128 a[8:11], v241 offset:2048
    v_accvgpr_read_b32 v32, a32
    v_mfma_f32_16x16x32_bf16 a[60:63], a[188:191], v[148:151], a[60:63]
    ds_read_b128 a[12:15], v241 offset:3072
    v_accvgpr_read_b32 v33, a33
    v_accvgpr_read_b32 v34, a34
    v_accvgpr_read_b32 v35, a35
    v_accvgpr_read_b32 v36, a36
    v_pk_mul_f32 v[32:33], v[32:33], v[194:195] op_sel_hi:[1,0]
    v_pk_mul_f32 v[34:35], v[34:35], v[194:195] op_sel_hi:[1,0]
    v_cvt_pk_bf16_f32 v32, v32, v33
    v_accvgpr_read_b32 v37, a37
    v_cvt_pk_bf16_f32 v33, v34, v35
    v_accvgpr_read_b32 v38, a38
    v_accvgpr_read_b32 v39, a39
    v_pk_mul_f32 v[36:37], v[36:37], v[194:195] op_sel_hi:[1,0]
    v_pk_mul_f32 v[38:39], v[38:39], v[194:195] op_sel_hi:[1,0]
    v_accvgpr_read_b32 v40, a40
    v_cvt_pk_bf16_f32 v36, v36, v37
    v_accvgpr_read_b32 v41, a41
    v_mfma_f32_16x16x32_bf16 a[64:67], a[192:195], v[172:175], a[64:67]
    s_waitcnt lgkmcnt(3)
    buffer_store_dwordx4 a[0:3], v220, s[24:27], s68 offen offset:0 sc0 sc1
    v_cvt_pk_bf16_f32 v37, v38, v39
    v_accvgpr_read_b32 v42, a42
    v_mfma_f32_16x16x32_bf16 a[68:71], a[196:199], v[172:175], a[68:71]
    ds_write_b64 v184, v[32:33]
    v_accvgpr_read_b32 v43, a43
    v_mfma_f32_16x16x32_bf16 a[72:75], a[200:203], v[172:175], a[72:75]
    s_add_u32 s69, s56, 65536
    ds_write_b64 v185, v[36:37]
    v_mfma_f32_16x16x32_bf16 a[76:79], a[204:207], v[172:175], a[76:79]
    v_accvgpr_read_b32 v44, a44
    v_accvgpr_read_b32 v45, a45
    v_mfma_f32_16x16x32_bf16 a[80:83], a[208:211], v[172:175], a[80:83]
    v_accvgpr_read_b32 v46, a46
    v_accvgpr_read_b32 v47, a47
    v_mfma_f32_16x16x32_bf16 a[84:87], a[212:215], v[172:175], a[84:87]
    s_waitcnt lgkmcnt(2)
    buffer_store_dwordx4 a[4:7], v221, s[24:27], s68 offen offset:1024 sc0 sc1
    v_accvgpr_read_b32 v48, a48
    v_mfma_f32_16x16x32_bf16 a[88:91], a[216:219], v[172:175], a[88:91]
    v_accvgpr_read_b32 v49, a49
    v_accvgpr_read_b32 v50, a50
    v_mfma_f32_16x16x32_bf16 a[92:95], a[220:223], v[172:175], a[92:95]
    v_accvgpr_read_b32 v51, a51
    v_accvgpr_read_b32 v52, a52
    v_accvgpr_read_b32 v53, a53
    v_accvgpr_read_b32 v54, a54
    v_accvgpr_read_b32 v55, a55
    v_pk_mul_f32 v[40:41], v[40:41], v[194:195] op_sel_hi:[1,0]
    v_pk_mul_f32 v[42:43], v[42:43], v[194:195] op_sel_hi:[1,0]
    v_cvt_pk_bf16_f32 v40, v40, v41
    v_cvt_pk_bf16_f32 v41, v42, v43
    v_pk_mul_f32 v[44:45], v[44:45], v[194:195] op_sel_hi:[1,0]
    v_pk_mul_f32 v[46:47], v[46:47], v[194:195] op_sel_hi:[1,0]
    v_cvt_pk_bf16_f32 v44, v44, v45
    v_cvt_pk_bf16_f32 v45, v46, v47
    v_pk_mul_f32 v[48:49], v[48:49], v[194:195] op_sel_hi:[1,0]
    v_pk_mul_f32 v[50:51], v[50:51], v[194:195] op_sel_hi:[1,0]
    v_cvt_pk_bf16_f32 v48, v48, v49
    v_cvt_pk_bf16_f32 v49, v50, v51
    v_pk_mul_f32 v[52:53], v[52:53], v[194:195] op_sel_hi:[1,0]
    v_pk_mul_f32 v[54:55], v[54:55], v[194:195] op_sel_hi:[1,0]
    v_accvgpr_read_b32 v56, a56
    v_cvt_pk_bf16_f32 v52, v52, v53
    v_accvgpr_read_b32 v57, a57
    v_cvt_pk_bf16_f32 v53, v54, v55
    v_accvgpr_read_b32 v58, a58
    v_accvgpr_read_b32 v59, a59
    v_pk_mul_f32 v[56:57], v[56:57], v[194:195] op_sel_hi:[1,0]
    v_pk_mul_f32 v[58:59], v[58:59], v[194:195] op_sel_hi:[1,0]
    v_accvgpr_read_b32 v60, a60
    v_cvt_pk_bf16_f32 v56, v56, v57
    v_accvgpr_read_b32 v61, a61
    v_cvt_pk_bf16_f32 v57, v58, v59
    v_accvgpr_read_b32 v62, a62
    v_accvgpr_read_b32 v63, a63
    v_pk_mul_f32 v[60:61], v[60:61], v[194:195] op_sel_hi:[1,0]
    v_pk_mul_f32 v[62:63], v[62:63], v[194:195] op_sel_hi:[1,0]
    v_cvt_pk_bf16_f32 v60, v60, v61
    v_cvt_pk_bf16_f32 v61, v62, v63
    v_exp_f32 v80, v80
    v_exp_f32 v81, v81
    v_exp_f32 v82, v82
    v_exp_f32 v83, v83
    v_exp_f32 v84, v84
    v_exp_f32 v85, v85
    v_exp_f32 v86, v86
    v_exp_f32 v87, v87
    v_cvt_pk_bf16_f32 v152, v80, v81
    v_cvt_pk_bf16_f32 v153, v82, v83
    v_cvt_pk_bf16_f32 v154, v84, v85
    v_cvt_pk_bf16_f32 v155, v86, v87
    v_mfma_f32_16x16x32_bf16 a[252:255], v[228:231], v[176:179], a[252:255]
    buffer_store_dwordx4 a[8:11], v222, s[24:27], s68 offen offset:2048 sc0 sc1
    ds_write_b64 v186, v[40:41]
    v_mfma_f32_16x16x32_bf16 a[248:251], v[228:231], v[152:155], a[248:251]
    ds_write_b64 v187, v[44:45]
    v_mfma_f32_16x16x32_bf16 a[64:67], a[160:163], v[152:155], a[64:67]
    ds_write_b64 v188, v[48:49]
    v_mfma_f32_16x16x32_bf16 a[68:71], a[164:167], v[152:155], a[68:71]
    ds_write_b64 v189, v[52:53]
    v_mfma_f32_16x16x32_bf16 a[72:75], a[168:171], v[152:155], a[72:75]
    buffer_store_dwordx4 a[12:15], v223, s[24:27], s68 offen offset:3072 sc0 sc1
    ds_write_b64 v190, v[56:57]
    v_mfma_f32_16x16x32_bf16 a[76:79], a[172:175], v[152:155], a[76:79]
    ds_write_b64 v191, v[60:61]
    v_mfma_f32_16x16x32_bf16 a[80:83], a[176:179], v[152:155], a[80:83]
    ds_read_b128 a[32:35], v241 offset:0
    v_accvgpr_read_b32 v254, a248
    v_mfma_f32_16x16x32_bf16 a[84:87], a[180:183], v[152:155], a[84:87]
    ds_read_b128 a[36:39], v241 offset:1024
    v_rcp_f32 v196, v254
    v_mfma_f32_16x16x32_bf16 a[88:91], a[184:187], v[152:155], a[88:91]
    ds_read_b128 a[40:43], v241 offset:2048
    v_accvgpr_read_b32 v0, a64
    v_mfma_f32_16x16x32_bf16 a[92:95], a[188:191], v[152:155], a[92:95]
    ds_read_b128 a[44:47], v241 offset:3072
    v_accvgpr_read_b32 v1, a65
    v_accvgpr_read_b32 v2, a66
    v_accvgpr_read_b32 v3, a67
    v_accvgpr_read_b32 v4, a68
    v_pk_mul_f32 v[0:1], v[0:1], v[196:197] op_sel_hi:[1,0]
    v_pk_mul_f32 v[2:3], v[2:3], v[196:197] op_sel_hi:[1,0]
    v_cvt_pk_bf16_f32 v0, v0, v1
    v_accvgpr_read_b32 v5, a69
    v_cvt_pk_bf16_f32 v1, v2, v3
    v_accvgpr_read_b32 v6, a70
    v_accvgpr_read_b32 v7, a71
    v_pk_mul_f32 v[4:5], v[4:5], v[196:197] op_sel_hi:[1,0]
    v_pk_mul_f32 v[6:7], v[6:7], v[196:197] op_sel_hi:[1,0]
    v_accvgpr_read_b32 v8, a72
    v_cvt_pk_bf16_f32 v4, v4, v5
    v_accvgpr_read_b32 v9, a73
    v_mfma_f32_16x16x32_bf16 a[96:99], a[192:195], v[176:179], a[96:99]
    s_waitcnt lgkmcnt(3)
    buffer_store_dwordx4 a[32:35], v220, s[24:27], s69 offen offset:0 sc0 sc1
    v_cvt_pk_bf16_f32 v5, v6, v7
    v_accvgpr_read_b32 v10, a74
    v_mfma_f32_16x16x32_bf16 a[100:103], a[196:199], v[176:179], a[100:103]
    ds_write_b64 v184, v[0:1]
    v_accvgpr_read_b32 v11, a75
    v_mfma_f32_16x16x32_bf16 a[104:107], a[200:203], v[176:179], a[104:107]
    s_add_u32 s70, s56, 131072
    ds_write_b64 v185, v[4:5]
    v_mfma_f32_16x16x32_bf16 a[108:111], a[204:207], v[176:179], a[108:111]
    v_accvgpr_read_b32 v12, a76
    v_accvgpr_read_b32 v13, a77
    v_mfma_f32_16x16x32_bf16 a[112:115], a[208:211], v[176:179], a[112:115]
    v_accvgpr_read_b32 v14, a78
    v_accvgpr_read_b32 v15, a79
    v_mfma_f32_16x16x32_bf16 a[116:119], a[212:215], v[176:179], a[116:119]
    s_waitcnt lgkmcnt(2)
    buffer_store_dwordx4 a[36:39], v221, s[24:27], s69 offen offset:1024 sc0 sc1
    v_accvgpr_read_b32 v16, a80
    v_mfma_f32_16x16x32_bf16 a[120:123], a[216:219], v[176:179], a[120:123]
    v_accvgpr_read_b32 v17, a81
    v_accvgpr_read_b32 v18, a82
    v_mfma_f32_16x16x32_bf16 a[124:127], a[220:223], v[176:179], a[124:127]
    v_accvgpr_read_b32 v19, a83
    v_accvgpr_read_b32 v20, a84
    v_accvgpr_read_b32 v21, a85
    v_accvgpr_read_b32 v22, a86
    v_accvgpr_read_b32 v23, a87
    v_pk_mul_f32 v[8:9], v[8:9], v[196:197] op_sel_hi:[1,0]
    v_pk_mul_f32 v[10:11], v[10:11], v[196:197] op_sel_hi:[1,0]
    v_cvt_pk_bf16_f32 v8, v8, v9
    v_cvt_pk_bf16_f32 v9, v10, v11
    v_pk_mul_f32 v[12:13], v[12:13], v[196:197] op_sel_hi:[1,0]
    v_pk_mul_f32 v[14:15], v[14:15], v[196:197] op_sel_hi:[1,0]
    v_cvt_pk_bf16_f32 v12, v12, v13
    v_cvt_pk_bf16_f32 v13, v14, v15
    v_pk_mul_f32 v[16:17], v[16:17], v[196:197] op_sel_hi:[1,0]
    v_pk_mul_f32 v[18:19], v[18:19], v[196:197] op_sel_hi:[1,0]
    v_cvt_pk_bf16_f32 v16, v16, v17
    v_cvt_pk_bf16_f32 v17, v18, v19
    v_pk_mul_f32 v[20:21], v[20:21], v[196:197] op_sel_hi:[1,0]
    v_pk_mul_f32 v[22:23], v[22:23], v[196:197] op_sel_hi:[1,0]
    v_accvgpr_read_b32 v24, a88
    v_cvt_pk_bf16_f32 v20, v20, v21
    v_accvgpr_read_b32 v25, a89
    v_cvt_pk_bf16_f32 v21, v22, v23
    v_accvgpr_read_b32 v26, a90
    v_accvgpr_read_b32 v27, a91
    v_pk_mul_f32 v[24:25], v[24:25], v[196:197] op_sel_hi:[1,0]
    v_pk_mul_f32 v[26:27], v[26:27], v[196:197] op_sel_hi:[1,0]
    v_accvgpr_read_b32 v28, a92
    v_cvt_pk_bf16_f32 v24, v24, v25
    v_accvgpr_read_b32 v29, a93
    v_cvt_pk_bf16_f32 v25, v26, v27
    v_accvgpr_read_b32 v30, a94
    v_accvgpr_read_b32 v31, a95
    v_pk_mul_f32 v[28:29], v[28:29], v[196:197] op_sel_hi:[1,0]
    v_pk_mul_f32 v[30:31], v[30:31], v[196:197] op_sel_hi:[1,0]
    v_cvt_pk_bf16_f32 v28, v28, v29
    v_cvt_pk_bf16_f32 v29, v30, v31
    v_exp_f32 v88, v88
    v_exp_f32 v89, v89
    v_exp_f32 v90, v90
    v_exp_f32 v91, v91
    v_exp_f32 v92, v92
    v_exp_f32 v93, v93
    v_exp_f32 v94, v94
    v_exp_f32 v95, v95
    v_cvt_pk_bf16_f32 v156, v88, v89
    v_cvt_pk_bf16_f32 v157, v90, v91
    v_cvt_pk_bf16_f32 v158, v92, v93
    v_cvt_pk_bf16_f32 v159, v94, v95
    buffer_store_dwordx4 a[40:43], v222, s[24:27], s69 offen offset:2048 sc0 sc1
    ds_write_b64 v186, v[8:9]
    v_mfma_f32_16x16x32_bf16 a[252:255], v[228:231], v[156:159], a[252:255]
    ds_write_b64 v187, v[12:13]
    v_mfma_f32_16x16x32_bf16 a[96:99], a[160:163], v[156:159], a[96:99]
    ds_write_b64 v188, v[16:17]
    v_mfma_f32_16x16x32_bf16 a[100:103], a[164:167], v[156:159], a[100:103]
    ds_write_b64 v189, v[20:21]
    v_mfma_f32_16x16x32_bf16 a[104:107], a[168:171], v[156:159], a[104:107]
    buffer_store_dwordx4 a[44:47], v223, s[24:27], s69 offen offset:3072 sc0 sc1
    ds_write_b64 v190, v[24:25]
    v_mfma_f32_16x16x32_bf16 a[108:111], a[172:175], v[156:159], a[108:111]
    ds_write_b64 v191, v[28:29]
    v_mfma_f32_16x16x32_bf16 a[112:115], a[176:179], v[156:159], a[112:115]
    ds_read_b128 a[64:67], v241 offset:0
    v_accvgpr_read_b32 v255, a252
    v_mfma_f32_16x16x32_bf16 a[116:119], a[180:183], v[156:159], a[116:119]
    ds_read_b128 a[68:71], v241 offset:1024
    v_rcp_f32 v198, v255
    v_mfma_f32_16x16x32_bf16 a[120:123], a[184:187], v[156:159], a[120:123]
    ds_read_b128 a[72:75], v241 offset:2048
    v_accvgpr_read_b32 v32, a96
    v_mfma_f32_16x16x32_bf16 a[124:127], a[188:191], v[156:159], a[124:127]
    ds_read_b128 a[76:79], v241 offset:3072
    v_accvgpr_read_b32 v33, a97
    v_accvgpr_read_b32 v34, a98
    v_accvgpr_read_b32 v35, a99
    v_accvgpr_read_b32 v36, a100
    v_pk_mul_f32 v[32:33], v[32:33], v[198:199] op_sel_hi:[1,0]
    v_pk_mul_f32 v[34:35], v[34:35], v[198:199] op_sel_hi:[1,0]
    v_cvt_pk_bf16_f32 v32, v32, v33
    v_accvgpr_read_b32 v37, a101
    v_cvt_pk_bf16_f32 v33, v34, v35
    v_accvgpr_read_b32 v38, a102
    v_accvgpr_read_b32 v39, a103
    v_pk_mul_f32 v[36:37], v[36:37], v[198:199] op_sel_hi:[1,0]
    v_pk_mul_f32 v[38:39], v[38:39], v[198:199] op_sel_hi:[1,0]
    v_accvgpr_read_b32 v40, a104
    v_cvt_pk_bf16_f32 v36, v36, v37
    v_accvgpr_read_b32 v41, a105
    v_cvt_pk_bf16_f32 v37, v38, v39
    v_accvgpr_read_b32 v42, a106
    v_accvgpr_read_b32 v43, a107
    v_pk_mul_f32 v[40:41], v[40:41], v[198:199] op_sel_hi:[1,0]
    v_pk_mul_f32 v[42:43], v[42:43], v[198:199] op_sel_hi:[1,0]
    v_accvgpr_read_b32 v44, a108
    v_cvt_pk_bf16_f32 v40, v40, v41
    v_accvgpr_read_b32 v45, a109
    v_cvt_pk_bf16_f32 v41, v42, v43
    v_accvgpr_read_b32 v46, a110
    v_accvgpr_read_b32 v47, a111
    v_pk_mul_f32 v[44:45], v[44:45], v[198:199] op_sel_hi:[1,0]
    v_pk_mul_f32 v[46:47], v[46:47], v[198:199] op_sel_hi:[1,0]
    v_accvgpr_read_b32 v48, a112
    v_cvt_pk_bf16_f32 v44, v44, v45
    v_accvgpr_read_b32 v49, a113
    v_cvt_pk_bf16_f32 v45, v46, v47
    v_accvgpr_read_b32 v50, a114
    v_accvgpr_read_b32 v51, a115
    v_pk_mul_f32 v[48:49], v[48:49], v[198:199] op_sel_hi:[1,0]
    v_pk_mul_f32 v[50:51], v[50:51], v[198:199] op_sel_hi:[1,0]
    v_accvgpr_read_b32 v52, a116
    v_cvt_pk_bf16_f32 v48, v48, v49
    v_accvgpr_read_b32 v53, a117
    v_cvt_pk_bf16_f32 v49, v50, v51
    v_accvgpr_read_b32 v54, a118
    v_accvgpr_read_b32 v55, a119
    v_pk_mul_f32 v[52:53], v[52:53], v[198:199] op_sel_hi:[1,0]
    v_pk_mul_f32 v[54:55], v[54:55], v[198:199] op_sel_hi:[1,0]
    v_accvgpr_read_b32 v56, a120
    v_cvt_pk_bf16_f32 v52, v52, v53
    v_accvgpr_read_b32 v57, a121
    v_max3_f32 v237, v252, v253, v254
    v_cvt_pk_bf16_f32 v53, v54, v55
    v_accvgpr_read_b32 v58, a122
    v_accvgpr_read_b32 v59, a123
    v_max_f32 v237, v237, v255
    v_pk_mul_f32 v[56:57], v[56:57], v[198:199] op_sel_hi:[1,0]
    v_cmp_le_f32 vcc, s66, v237
    v_pk_mul_f32 v[58:59], v[58:59], v[198:199] op_sel_hi:[1,0]
    v_accvgpr_read_b32 v60, a124
    v_cvt_pk_bf16_f32 v56, v56, v57
    v_accvgpr_read_b32 v61, a125
    s_or_b32 s74, vcc_lo, vcc_hi
    s_waitcnt lgkmcnt(0)
    buffer_store_dwordx4 a[64:67], v220, s[24:27], s70 offen offset:0 sc0 sc1
    v_cvt_pk_bf16_f32 v57, v58, v59
    v_accvgpr_read_b32 v62, a126
    v_accvgpr_read_b32 v63, a127
    v_mov_b32 v237, s74
    v_pk_mul_f32 v[60:61], v[60:61], v[198:199] op_sel_hi:[1,0]
    v_pk_mul_f32 v[62:63], v[62:63], v[198:199] op_sel_hi:[1,0]
    v_cvt_pk_bf16_f32 v60, v60, v61
    v_cvt_pk_bf16_f32 v61, v62, v63
    s_add_u32 s71, s56, 196608
    ds_write_b64 v184, v[32:33]
    ds_write_b64 v185, v[36:37]
    buffer_store_dwordx4 a[68:71], v221, s[24:27], s70 offen offset:1024 sc0 sc1
    ds_write_b64 v186, v[40:41]
    ds_write_b64 v187, v[44:45]
    ds_write_b64 v188, v[48:49]
    ds_write_b64 v189, v[52:53]
    buffer_store_dwordx4 a[72:75], v222, s[24:27], s70 offen offset:2048 sc0 sc1
    ds_write_b64 v190, v[56:57]
    ds_write_b32 v239, v237 offset:16384
    ds_write_b64 v191, v[60:61]
    ds_read_b128 a[96:99], v241 offset:0
    ds_read_b128 a[100:103], v241 offset:1024
    buffer_store_dwordx4 a[76:79], v223, s[24:27], s70 offen offset:3072 sc0 sc1
    ds_read_b128 a[104:107], v241 offset:2048
    ds_read_b128 a[108:111], v241 offset:3072
    s_waitcnt lgkmcnt(5)
    s_barrier
    s_waitcnt lgkmcnt(2)
    buffer_store_dwordx4 a[96:99], v220, s[24:27], s71 offen offset:0 sc0 sc1
    ds_read_b32 v244, v236
    buffer_store_dwordx4 a[100:103], v221, s[24:27], s71 offen offset:1024 sc0 sc1
    s_waitcnt lgkmcnt(0)
    v_cmp_ne_u32 vcc, 0, v244
    buffer_store_dwordx4 a[104:107], v222, s[24:27], s71 offen offset:2048 sc0 sc1
    buffer_store_dwordx4 a[108:111], v223, s[24:27], s71 offen offset:3072 sc0 sc1
    s_cbranch_vccnz Lrestart
    s_mov_b32 s64, 0
    s_waitcnt vmcnt(16)
    s_branch Lstart
Lxt4_2:
Lft4_3_0:
    s_waitcnt lgkmcnt(0)
    v_mfma_f32_16x16x32_bf16 a[240:243], v[228:231], v[144:147], a[240:243]
    ds_read_b64_tr_b16 a[192:193], v208 offset:0
    v_exp_f32 v104, v104
    v_exp_f32 v105, v105
    v_exp_f32 v106, v106
    v_exp_f32 v107, v107
    v_exp_f32 v108, v108
    v_exp_f32 v109, v109
    v_exp_f32 v110, v110
    v_exp_f32 v111, v111
    v_cvt_pk_bf16_f32 v164, v104, v105
    v_cvt_pk_bf16_f32 v165, v106, v107
    v_cvt_pk_bf16_f32 v166, v108, v109
    v_cvt_pk_bf16_f32 v167, v110, v111
    v_mfma_f32_16x16x32_bf16 a[244:247], v[228:231], v[148:151], a[244:247]
    ds_read_b64_tr_b16 a[194:195], v208 offset:8192
    v_xor_b32 v184, 0, v240
    v_mfma_f32_16x16x32_bf16 a[240:243], v[228:231], v[164:167], a[240:243]
    ds_read_b64_tr_b16 a[196:197], v209 offset:0
    s_waitcnt vmcnt(8)
    s_barrier
    ds_read_b64_tr_b16 a[198:199], v209 offset:8192
    v_xor_b32 v185, 32, v240
    v_xor_b32 v186, 64, v240
    v_xor_b32 v187, 96, v240
    v_xor_b32 v188, 128, v240
    v_accvgpr_read_b32 v252, a240
    v_rcp_f32 v192, v252
    v_xor_b32 v189, 160, v240
    v_xor_b32 v190, 192, v240
    v_xor_b32 v191, 224, v240
    s_add_u32 s68, s56, 0
    ds_read_b64_tr_b16 a[200:201], v210 offset:0
    ds_read_b64_tr_b16 a[202:203], v210 offset:8192
    s_waitcnt lgkmcnt(4)
    v_mfma_f32_16x16x32_bf16 a[0:3], a[192:195], v[144:147], a[0:3]
    ds_read_b64_tr_b16 a[204:205], v211 offset:0
    ds_read_b64_tr_b16 a[206:207], v211 offset:8192
    v_mfma_f32_16x16x32_bf16 a[32:35], a[192:195], v[148:151], a[32:35]
    ds_read_b64_tr_b16 a[208:209], v212 offset:0
    ds_read_b64_tr_b16 a[210:211], v212 offset:8192
    ds_read_b64_tr_b16 a[212:213], v213 offset:0
    ds_read_b64_tr_b16 a[214:215], v213 offset:8192
    s_waitcnt lgkmcnt(8)
    v_mfma_f32_16x16x32_bf16 a[4:7], a[196:199], v[144:147], a[4:7]
    ds_read_b64_tr_b16 a[216:217], v214 offset:0
    ds_read_b64_tr_b16 a[218:219], v214 offset:8192
    v_mfma_f32_16x16x32_bf16 a[36:39], a[196:199], v[148:151], a[36:39]
    ds_read_b64_tr_b16 a[220:221], v215 offset:0
    ds_read_b64_tr_b16 a[222:223], v215 offset:8192
    ds_read_b64_tr_b16 a[160:161], v208 offset:16384
    ds_read_b64_tr_b16 a[162:163], v208 offset:24576
    s_waitcnt lgkmcnt(12)
    v_mfma_f32_16x16x32_bf16 a[8:11], a[200:203], v[144:147], a[8:11]
    ds_read_b64_tr_b16 a[164:165], v209 offset:16384
    ds_read_b64_tr_b16 a[166:167], v209 offset:24576
    s_waitcnt lgkmcnt(12)
    v_mfma_f32_16x16x32_bf16 a[12:15], a[204:207], v[144:147], a[12:15]
    ds_read_b64_tr_b16 a[168:169], v210 offset:16384
    ds_read_b64_tr_b16 a[170:171], v210 offset:24576
    s_waitcnt lgkmcnt(11)
    v_mfma_f32_16x16x32_bf16 a[16:19], a[208:211], v[144:147], a[16:19]
    ds_read_b64_tr_b16 a[172:173], v211 offset:16384
    ds_read_b64_tr_b16 a[174:175], v211 offset:24576
    s_waitcnt lgkmcnt(11)
    v_mfma_f32_16x16x32_bf16 a[20:23], a[212:215], v[144:147], a[20:23]
    ds_read_b64_tr_b16 a[176:177], v212 offset:16384
    ds_read_b64_tr_b16 a[178:179], v212 offset:24576
    s_waitcnt lgkmcnt(10)
    v_mfma_f32_16x16x32_bf16 a[24:27], a[216:219], v[144:147], a[24:27]
    ds_read_b64_tr_b16 a[180:181], v213 offset:16384
    ds_read_b64_tr_b16 a[182:183], v213 offset:24576
    v_mfma_f32_16x16x32_bf16 a[28:31], a[220:223], v[144:147], a[28:31]
    ds_read_b64_tr_b16 a[184:185], v214 offset:16384
    ds_read_b64_tr_b16 a[186:187], v214 offset:24576
    s_waitcnt lgkmcnt(10)
    v_mfma_f32_16x16x32_bf16 a[0:3], a[160:163], v[164:167], a[0:3]
    ds_read_b64_tr_b16 a[188:189], v215 offset:16384
    ds_read_b64_tr_b16 a[190:191], v215 offset:24576
    v_mfma_f32_16x16x32_bf16 a[4:7], a[164:167], v[164:167], a[4:7]
    s_add_u32 s69, s56, 65536
    v_exp_f32 v112, v112
    s_waitcnt lgkmcnt(9)
    v_mfma_f32_16x16x32_bf16 a[8:11], a[168:171], v[164:167], a[8:11]
    s_nop 0
    v_accvgpr_read_b32 v0, a0
    s_waitcnt lgkmcnt(7)
    v_mfma_f32_16x16x32_bf16 a[12:15], a[172:175], v[164:167], a[12:15]
    v_accvgpr_read_b32 v1, a1
    v_accvgpr_read_b32 v4, a4
    s_waitcnt lgkmcnt(6)
    v_mfma_f32_16x16x32_bf16 a[16:19], a[176:179], v[164:167], a[16:19]
    v_accvgpr_read_b32 v5, a5
    v_accvgpr_read_b32 v8, a8
    s_waitcnt lgkmcnt(4)
    v_mfma_f32_16x16x32_bf16 a[20:23], a[180:183], v[164:167], a[20:23]
    v_accvgpr_read_b32 v9, a9
    v_accvgpr_read_b32 v12, a12
    s_waitcnt lgkmcnt(2)
    v_mfma_f32_16x16x32_bf16 a[24:27], a[184:187], v[164:167], a[24:27]
    v_accvgpr_read_b32 v13, a13
    v_accvgpr_read_b32 v16, a16
    v_accvgpr_read_b32 v17, a17
    s_waitcnt lgkmcnt(0)
    v_mfma_f32_16x16x32_bf16 a[28:31], a[188:191], v[164:167], a[28:31]
    v_accvgpr_read_b32 v20, a20
    v_accvgpr_read_b32 v21, a21
    v_accvgpr_read_b32 v2, a2
    v_accvgpr_read_b32 v24, a24
    v_accvgpr_read_b32 v25, a25
    v_accvgpr_read_b32 v3, a3
    v_pk_mul_f32 v[0:1], v[0:1], v[192:193] op_sel_hi:[1,0]
    v_accvgpr_read_b32 v6, a6
    v_accvgpr_read_b32 v28, a28
    v_accvgpr_read_b32 v29, a29
    v_accvgpr_read_b32 v7, a7
    v_pk_mul_f32 v[4:5], v[4:5], v[192:193] op_sel_hi:[1,0]
    v_accvgpr_read_b32 v10, a10
    v_accvgpr_read_b32 v11, a11
    v_pk_mul_f32 v[8:9], v[8:9], v[192:193] op_sel_hi:[1,0]
    v_accvgpr_read_b32 v14, a14
    v_accvgpr_read_b32 v15, a15
    v_pk_mul_f32 v[12:13], v[12:13], v[192:193] op_sel_hi:[1,0]
    v_accvgpr_read_b32 v18, a18
    v_accvgpr_read_b32 v19, a19
    v_pk_mul_f32 v[16:17], v[16:17], v[192:193] op_sel_hi:[1,0]
    v_accvgpr_read_b32 v22, a22
    v_accvgpr_read_b32 v23, a23
    v_pk_mul_f32 v[20:21], v[20:21], v[192:193] op_sel_hi:[1,0]
    v_accvgpr_read_b32 v26, a26
    v_accvgpr_read_b32 v27, a27
    v_pk_mul_f32 v[24:25], v[24:25], v[192:193] op_sel_hi:[1,0]
    v_accvgpr_read_b32 v30, a30
    v_accvgpr_read_b32 v31, a31
    v_pk_mul_f32 v[28:29], v[28:29], v[192:193] op_sel_hi:[1,0]
    v_pk_mul_f32 v[2:3], v[2:3], v[192:193] op_sel_hi:[1,0]
    v_cvt_pk_bf16_f32 v0, v0, v1
    v_pk_mul_f32 v[6:7], v[6:7], v[192:193] op_sel_hi:[1,0]
    v_cvt_pk_bf16_f32 v4, v4, v5
    v_pk_mul_f32 v[10:11], v[10:11], v[192:193] op_sel_hi:[1,0]
    v_cvt_pk_bf16_f32 v8, v8, v9
    v_pk_mul_f32 v[14:15], v[14:15], v[192:193] op_sel_hi:[1,0]
    v_cvt_pk_bf16_f32 v12, v12, v13
    v_pk_mul_f32 v[18:19], v[18:19], v[192:193] op_sel_hi:[1,0]
    v_cvt_pk_bf16_f32 v16, v16, v17
    v_pk_mul_f32 v[22:23], v[22:23], v[192:193] op_sel_hi:[1,0]
    v_cvt_pk_bf16_f32 v20, v20, v21
    v_pk_mul_f32 v[26:27], v[26:27], v[192:193] op_sel_hi:[1,0]
    v_cvt_pk_bf16_f32 v24, v24, v25
    v_pk_mul_f32 v[30:31], v[30:31], v[192:193] op_sel_hi:[1,0]
    v_cvt_pk_bf16_f32 v28, v28, v29
    v_mfma_f32_16x16x32_bf16 a[40:43], a[200:203], v[148:151], a[40:43]
    v_cvt_pk_bf16_f32 v1, v2, v3
    v_cvt_pk_bf16_f32 v5, v6, v7
    v_mfma_f32_16x16x32_bf16 a[44:47], a[204:207], v[148:151], a[44:47]
    ds_write_b64 v184, v[0:1]
    v_mfma_f32_16x16x32_bf16 a[48:51], a[208:211], v[148:151], a[48:51]
    v_cvt_pk_bf16_f32 v9, v10, v11
    v_cvt_pk_bf16_f32 v13, v14, v15
    v_mfma_f32_16x16x32_bf16 a[52:55], a[212:215], v[148:151], a[52:55]
    ds_write_b64 v185, v[4:5]
    v_mfma_f32_16x16x32_bf16 a[56:59], a[216:219], v[148:151], a[56:59]
    v_cvt_pk_bf16_f32 v17, v18, v19
    v_cvt_pk_bf16_f32 v21, v22, v23
    v_mfma_f32_16x16x32_bf16 a[60:63], a[220:223], v[148:151], a[60:63]
    ds_write_b64 v186, v[8:9]
    v_cvt_pk_bf16_f32 v25, v26, v27
    v_cvt_pk_bf16_f32 v29, v30, v31
    v_exp_f32 v113, v113
    v_exp_f32 v114, v114
    v_exp_f32 v115, v115
    v_exp_f32 v116, v116
    v_exp_f32 v117, v117
    v_exp_f32 v118, v118
    v_exp_f32 v119, v119
    v_cvt_pk_bf16_f32 v168, v112, v113
    v_cvt_pk_bf16_f32 v169, v114, v115
    v_cvt_pk_bf16_f32 v170, v116, v117
    v_cvt_pk_bf16_f32 v171, v118, v119
    v_mfma_f32_16x16x32_bf16 a[248:251], v[228:231], v[152:155], a[248:251]
    ds_write_b64 v187, v[12:13]
    v_mfma_f32_16x16x32_bf16 a[244:247], v[228:231], v[168:171], a[244:247]
    ds_write_b64 v188, v[16:17]
    v_mfma_f32_16x16x32_bf16 a[32:35], a[160:163], v[168:171], a[32:35]
    ds_write_b64 v189, v[20:21]
    v_mfma_f32_16x16x32_bf16 a[36:39], a[164:167], v[168:171], a[36:39]
    ds_write_b64 v190, v[24:25]
    v_mfma_f32_16x16x32_bf16 a[40:43], a[168:171], v[168:171], a[40:43]
    ds_write_b64 v191, v[28:29]
    v_mfma_f32_16x16x32_bf16 a[44:47], a[172:175], v[168:171], a[44:47]
    ds_read_b128 a[0:3], v241 offset:0
    ds_read_b128 a[4:7], v241 offset:1024
    v_mfma_f32_16x16x32_bf16 a[48:51], a[176:179], v[168:171], a[48:51]
    ds_read_b128 a[8:11], v241 offset:2048
    v_accvgpr_read_b32 v253, a244
    v_mfma_f32_16x16x32_bf16 a[52:55], a[180:183], v[168:171], a[52:55]
    ds_read_b128 a[12:15], v241 offset:3072
    v_rcp_f32 v194, v253
    v_mfma_f32_16x16x32_bf16 a[56:59], a[184:187], v[168:171], a[56:59]
    v_accvgpr_read_b32 v32, a32
    v_accvgpr_read_b32 v33, a33
    v_mfma_f32_16x16x32_bf16 a[60:63], a[188:191], v[168:171], a[60:63]
    v_accvgpr_read_b32 v36, a36
    v_accvgpr_read_b32 v37, a37
    v_accvgpr_read_b32 v40, a40
    v_accvgpr_read_b32 v41, a41
    v_accvgpr_read_b32 v44, a44
    v_accvgpr_read_b32 v45, a45
    v_accvgpr_read_b32 v48, a48
    v_accvgpr_read_b32 v49, a49
    v_accvgpr_read_b32 v52, a52
    v_accvgpr_read_b32 v53, a53
    v_accvgpr_read_b32 v56, a56
    v_accvgpr_read_b32 v57, a57
    v_accvgpr_read_b32 v60, a60
    v_accvgpr_read_b32 v61, a61
    v_accvgpr_read_b32 v34, a34
    v_accvgpr_read_b32 v35, a35
    v_pk_mul_f32 v[32:33], v[32:33], v[194:195] op_sel_hi:[1,0]
    v_accvgpr_read_b32 v38, a38
    v_accvgpr_read_b32 v39, a39
    v_pk_mul_f32 v[36:37], v[36:37], v[194:195] op_sel_hi:[1,0]
    v_accvgpr_read_b32 v42, a42
    v_accvgpr_read_b32 v43, a43
    v_pk_mul_f32 v[40:41], v[40:41], v[194:195] op_sel_hi:[1,0]
    v_accvgpr_read_b32 v46, a46
    v_accvgpr_read_b32 v47, a47
    v_pk_mul_f32 v[44:45], v[44:45], v[194:195] op_sel_hi:[1,0]
    v_accvgpr_read_b32 v50, a50
    v_accvgpr_read_b32 v51, a51
    v_pk_mul_f32 v[48:49], v[48:49], v[194:195] op_sel_hi:[1,0]
    v_accvgpr_read_b32 v54, a54
    v_accvgpr_read_b32 v55, a55
    v_pk_mul_f32 v[52:53], v[52:53], v[194:195] op_sel_hi:[1,0]
    v_accvgpr_read_b32 v58, a58
    v_accvgpr_read_b32 v59, a59
    v_pk_mul_f32 v[56:57], v[56:57], v[194:195] op_sel_hi:[1,0]
    v_accvgpr_read_b32 v62, a62
    v_accvgpr_read_b32 v63, a63
    v_pk_mul_f32 v[60:61], v[60:61], v[194:195] op_sel_hi:[1,0]
    v_pk_mul_f32 v[34:35], v[34:35], v[194:195] op_sel_hi:[1,0]
    v_cvt_pk_bf16_f32 v32, v32, v33
    v_pk_mul_f32 v[38:39], v[38:39], v[194:195] op_sel_hi:[1,0]
    v_cvt_pk_bf16_f32 v36, v36, v37
    v_pk_mul_f32 v[42:43], v[42:43], v[194:195] op_sel_hi:[1,0]
    v_cvt_pk_bf16_f32 v40, v40, v41
    v_pk_mul_f32 v[46:47], v[46:47], v[194:195] op_sel_hi:[1,0]
    v_cvt_pk_bf16_f32 v44, v44, v45
    v_pk_mul_f32 v[50:51], v[50:51], v[194:195] op_sel_hi:[1,0]
    v_cvt_pk_bf16_f32 v48, v48, v49
    v_pk_mul_f32 v[54:55], v[54:55], v[194:195] op_sel_hi:[1,0]
    v_cvt_pk_bf16_f32 v52, v52, v53
    v_pk_mul_f32 v[58:59], v[58:59], v[194:195] op_sel_hi:[1,0]
    v_cvt_pk_bf16_f32 v56, v56, v57
    v_pk_mul_f32 v[62:63], v[62:63], v[194:195] op_sel_hi:[1,0]
    v_cvt_pk_bf16_f32 v60, v60, v61
    v_mfma_f32_16x16x32_bf16 a[64:67], a[192:195], v[152:155], a[64:67]
    s_waitcnt lgkmcnt(0)
    buffer_store_dwordx4 a[0:3], v220, s[24:27], s68 offen offset:0 sc0 sc1
    v_cvt_pk_bf16_f32 v33, v34, v35
    v_mfma_f32_16x16x32_bf16 a[68:71], a[196:199], v[152:155], a[68:71]
    ds_write_b64 v184, v[32:33]
    v_mfma_f32_16x16x32_bf16 a[72:75], a[200:203], v[152:155], a[72:75]
    v_cvt_pk_bf16_f32 v37, v38, v39
    v_cvt_pk_bf16_f32 v41, v42, v43
    v_mfma_f32_16x16x32_bf16 a[76:79], a[204:207], v[152:155], a[76:79]
    ds_write_b64 v185, v[36:37]
    v_mfma_f32_16x16x32_bf16 a[80:83], a[208:211], v[152:155], a[80:83]
    v_cvt_pk_bf16_f32 v45, v46, v47
    v_cvt_pk_bf16_f32 v49, v50, v51
    v_mfma_f32_16x16x32_bf16 a[84:87], a[212:215], v[152:155], a[84:87]
    ds_write_b64 v186, v[40:41]
    v_mfma_f32_16x16x32_bf16 a[88:91], a[216:219], v[152:155], a[88:91]
    buffer_store_dwordx4 a[4:7], v221, s[24:27], s68 offen offset:1024 sc0 sc1
    v_cvt_pk_bf16_f32 v53, v54, v55
    v_mfma_f32_16x16x32_bf16 a[92:95], a[220:223], v[152:155], a[92:95]
    ds_write_b64 v187, v[44:45]
    v_cvt_pk_bf16_f32 v57, v58, v59
    v_cvt_pk_bf16_f32 v61, v62, v63
    v_exp_f32 v120, v120
    v_exp_f32 v121, v121
    v_exp_f32 v122, v122
    v_exp_f32 v123, v123
    v_exp_f32 v124, v124
    v_exp_f32 v125, v125
    v_exp_f32 v126, v126
    v_exp_f32 v127, v127
    v_cvt_pk_bf16_f32 v172, v120, v121
    v_cvt_pk_bf16_f32 v173, v122, v123
    v_cvt_pk_bf16_f32 v174, v124, v125
    v_cvt_pk_bf16_f32 v175, v126, v127
    v_mfma_f32_16x16x32_bf16 a[252:255], v[228:231], v[156:159], a[252:255]
    buffer_store_dwordx4 a[8:11], v222, s[24:27], s68 offen offset:2048 sc0 sc1
    ds_write_b64 v188, v[48:49]
    v_mfma_f32_16x16x32_bf16 a[248:251], v[228:231], v[172:175], a[248:251]
    ds_write_b64 v189, v[52:53]
    v_mfma_f32_16x16x32_bf16 a[64:67], a[160:163], v[172:175], a[64:67]
    ds_write_b64 v190, v[56:57]
    v_mfma_f32_16x16x32_bf16 a[68:71], a[164:167], v[172:175], a[68:71]
    ds_write_b64 v191, v[60:61]
    v_mfma_f32_16x16x32_bf16 a[72:75], a[168:171], v[172:175], a[72:75]
    ds_read_b128 a[32:35], v241 offset:0
    buffer_store_dwordx4 a[12:15], v223, s[24:27], s68 offen offset:3072 sc0 sc1
    v_mfma_f32_16x16x32_bf16 a[76:79], a[172:175], v[172:175], a[76:79]
    ds_read_b128 a[36:39], v241 offset:1024
    v_accvgpr_read_b32 v254, a248
    v_mfma_f32_16x16x32_bf16 a[80:83], a[176:179], v[172:175], a[80:83]
    ds_read_b128 a[40:43], v241 offset:2048
    v_rcp_f32 v196, v254
    v_mfma_f32_16x16x32_bf16 a[84:87], a[180:183], v[172:175], a[84:87]
    ds_read_b128 a[44:47], v241 offset:3072
    v_accvgpr_read_b32 v0, a64
    v_mfma_f32_16x16x32_bf16 a[88:91], a[184:187], v[172:175], a[88:91]
    s_add_u32 s70, s56, 131072
    v_accvgpr_read_b32 v1, a65
    v_accvgpr_read_b32 v4, a68
    v_mfma_f32_16x16x32_bf16 a[92:95], a[188:191], v[172:175], a[92:95]
    v_accvgpr_read_b32 v5, a69
    v_accvgpr_read_b32 v8, a72
    v_accvgpr_read_b32 v9, a73
    v_accvgpr_read_b32 v12, a76
    v_accvgpr_read_b32 v13, a77
    v_accvgpr_read_b32 v16, a80
    v_accvgpr_read_b32 v17, a81
    v_accvgpr_read_b32 v20, a84
    v_accvgpr_read_b32 v21, a85
    v_accvgpr_read_b32 v24, a88
    v_accvgpr_read_b32 v25, a89
    v_accvgpr_read_b32 v28, a92
    v_accvgpr_read_b32 v29, a93
    v_accvgpr_read_b32 v2, a66
    v_accvgpr_read_b32 v3, a67
    v_pk_mul_f32 v[0:1], v[0:1], v[196:197] op_sel_hi:[1,0]
    v_accvgpr_read_b32 v6, a70
    v_accvgpr_read_b32 v7, a71
    v_pk_mul_f32 v[4:5], v[4:5], v[196:197] op_sel_hi:[1,0]
    v_accvgpr_read_b32 v10, a74
    v_accvgpr_read_b32 v11, a75
    v_pk_mul_f32 v[8:9], v[8:9], v[196:197] op_sel_hi:[1,0]
    v_accvgpr_read_b32 v14, a78
    v_accvgpr_read_b32 v15, a79
    v_pk_mul_f32 v[12:13], v[12:13], v[196:197] op_sel_hi:[1,0]
    v_accvgpr_read_b32 v18, a82
    v_accvgpr_read_b32 v19, a83
    v_pk_mul_f32 v[16:17], v[16:17], v[196:197] op_sel_hi:[1,0]
    v_accvgpr_read_b32 v22, a86
    v_accvgpr_read_b32 v23, a87
    v_pk_mul_f32 v[20:21], v[20:21], v[196:197] op_sel_hi:[1,0]
    v_accvgpr_read_b32 v26, a90
    v_accvgpr_read_b32 v27, a91
    v_pk_mul_f32 v[24:25], v[24:25], v[196:197] op_sel_hi:[1,0]
    v_accvgpr_read_b32 v30, a94
    v_accvgpr_read_b32 v31, a95
    v_pk_mul_f32 v[28:29], v[28:29], v[196:197] op_sel_hi:[1,0]
    v_pk_mul_f32 v[2:3], v[2:3], v[196:197] op_sel_hi:[1,0]
    v_cvt_pk_bf16_f32 v0, v0, v1
    v_pk_mul_f32 v[6:7], v[6:7], v[196:197] op_sel_hi:[1,0]
    v_cvt_pk_bf16_f32 v4, v4, v5
    v_pk_mul_f32 v[10:11], v[10:11], v[196:197] op_sel_hi:[1,0]
    v_cvt_pk_bf16_f32 v8, v8, v9
    v_pk_mul_f32 v[14:15], v[14:15], v[196:197] op_sel_hi:[1,0]
    v_cvt_pk_bf16_f32 v12, v12, v13
    v_pk_mul_f32 v[18:19], v[18:19], v[196:197] op_sel_hi:[1,0]
    v_cvt_pk_bf16_f32 v16, v16, v17
    v_pk_mul_f32 v[22:23], v[22:23], v[196:197] op_sel_hi:[1,0]
    v_cvt_pk_bf16_f32 v20, v20, v21
    v_pk_mul_f32 v[26:27], v[26:27], v[196:197] op_sel_hi:[1,0]
    v_cvt_pk_bf16_f32 v24, v24, v25
    v_pk_mul_f32 v[30:31], v[30:31], v[196:197] op_sel_hi:[1,0]
    v_cvt_pk_bf16_f32 v28, v28, v29
    v_mfma_f32_16x16x32_bf16 a[96:99], a[192:195], v[156:159], a[96:99]
    s_waitcnt lgkmcnt(0)
    buffer_store_dwordx4 a[32:35], v220, s[24:27], s69 offen offset:0 sc0 sc1
    v_cvt_pk_bf16_f32 v1, v2, v3
    v_mfma_f32_16x16x32_bf16 a[100:103], a[196:199], v[156:159], a[100:103]
    ds_write_b64 v184, v[0:1]
    v_mfma_f32_16x16x32_bf16 a[104:107], a[200:203], v[156:159], a[104:107]
    v_cvt_pk_bf16_f32 v5, v6, v7
    v_cvt_pk_bf16_f32 v9, v10, v11
    v_mfma_f32_16x16x32_bf16 a[108:111], a[204:207], v[156:159], a[108:111]
    ds_write_b64 v185, v[4:5]
    v_mfma_f32_16x16x32_bf16 a[112:115], a[208:211], v[156:159], a[112:115]
    v_cvt_pk_bf16_f32 v13, v14, v15
    v_cvt_pk_bf16_f32 v17, v18, v19
    v_mfma_f32_16x16x32_bf16 a[116:119], a[212:215], v[156:159], a[116:119]
    ds_write_b64 v186, v[8:9]
    v_mfma_f32_16x16x32_bf16 a[120:123], a[216:219], v[156:159], a[120:123]
    buffer_store_dwordx4 a[36:39], v221, s[24:27], s69 offen offset:1024 sc0 sc1
    v_cvt_pk_bf16_f32 v21, v22, v23
    v_mfma_f32_16x16x32_bf16 a[124:127], a[220:223], v[156:159], a[124:127]
    ds_write_b64 v187, v[12:13]
    v_cvt_pk_bf16_f32 v25, v26, v27
    v_cvt_pk_bf16_f32 v29, v30, v31
    v_exp_f32 v128, v128
    v_exp_f32 v129, v129
    v_exp_f32 v130, v130
    v_exp_f32 v131, v131
    v_exp_f32 v132, v132
    v_exp_f32 v133, v133
    v_exp_f32 v134, v134
    v_exp_f32 v135, v135
    v_cvt_pk_bf16_f32 v176, v128, v129
    v_cvt_pk_bf16_f32 v177, v130, v131
    v_cvt_pk_bf16_f32 v178, v132, v133
    v_cvt_pk_bf16_f32 v179, v134, v135
    buffer_store_dwordx4 a[40:43], v222, s[24:27], s69 offen offset:2048 sc0 sc1
    ds_write_b64 v188, v[16:17]
    v_mfma_f32_16x16x32_bf16 a[252:255], v[228:231], v[176:179], a[252:255]
    ds_write_b64 v189, v[20:21]
    v_mfma_f32_16x16x32_bf16 a[96:99], a[160:163], v[176:179], a[96:99]
    ds_write_b64 v190, v[24:25]
    v_mfma_f32_16x16x32_bf16 a[100:103], a[164:167], v[176:179], a[100:103]
    ds_write_b64 v191, v[28:29]
    v_mfma_f32_16x16x32_bf16 a[104:107], a[168:171], v[176:179], a[104:107]
    ds_read_b128 a[64:67], v241 offset:0
    buffer_store_dwordx4 a[44:47], v223, s[24:27], s69 offen offset:3072 sc0 sc1
    v_mfma_f32_16x16x32_bf16 a[108:111], a[172:175], v[176:179], a[108:111]
    ds_read_b128 a[68:71], v241 offset:1024
    v_accvgpr_read_b32 v255, a252
    v_mfma_f32_16x16x32_bf16 a[112:115], a[176:179], v[176:179], a[112:115]
    ds_read_b128 a[72:75], v241 offset:2048
    v_rcp_f32 v198, v255
    v_mfma_f32_16x16x32_bf16 a[116:119], a[180:183], v[176:179], a[116:119]
    ds_read_b128 a[76:79], v241 offset:3072
    v_accvgpr_read_b32 v32, a96
    v_mfma_f32_16x16x32_bf16 a[120:123], a[184:187], v[176:179], a[120:123]
    s_add_u32 s71, s56, 196608
    v_accvgpr_read_b32 v33, a97
    v_accvgpr_read_b32 v36, a100
    v_mfma_f32_16x16x32_bf16 a[124:127], a[188:191], v[176:179], a[124:127]
    v_accvgpr_read_b32 v37, a101
    v_accvgpr_read_b32 v40, a104
    v_accvgpr_read_b32 v41, a105
    v_accvgpr_read_b32 v44, a108
    v_accvgpr_read_b32 v45, a109
    v_accvgpr_read_b32 v48, a112
    v_accvgpr_read_b32 v49, a113
    v_accvgpr_read_b32 v52, a116
    v_accvgpr_read_b32 v53, a117
    v_accvgpr_read_b32 v56, a120
    v_accvgpr_read_b32 v57, a121
    v_accvgpr_read_b32 v60, a124
    v_accvgpr_read_b32 v61, a125
    v_accvgpr_read_b32 v34, a98
    v_accvgpr_read_b32 v35, a99
    v_pk_mul_f32 v[32:33], v[32:33], v[198:199] op_sel_hi:[1,0]
    v_accvgpr_read_b32 v38, a102
    v_accvgpr_read_b32 v39, a103
    v_pk_mul_f32 v[36:37], v[36:37], v[198:199] op_sel_hi:[1,0]
    v_accvgpr_read_b32 v42, a106
    v_accvgpr_read_b32 v43, a107
    v_pk_mul_f32 v[40:41], v[40:41], v[198:199] op_sel_hi:[1,0]
    v_accvgpr_read_b32 v46, a110
    v_accvgpr_read_b32 v47, a111
    v_pk_mul_f32 v[44:45], v[44:45], v[198:199] op_sel_hi:[1,0]
    v_accvgpr_read_b32 v50, a114
    v_accvgpr_read_b32 v51, a115
    v_pk_mul_f32 v[48:49], v[48:49], v[198:199] op_sel_hi:[1,0]
    v_accvgpr_read_b32 v54, a118
    v_accvgpr_read_b32 v55, a119
    v_pk_mul_f32 v[52:53], v[52:53], v[198:199] op_sel_hi:[1,0]
    v_accvgpr_read_b32 v58, a122
    v_accvgpr_read_b32 v59, a123
    v_pk_mul_f32 v[56:57], v[56:57], v[198:199] op_sel_hi:[1,0]
    v_accvgpr_read_b32 v62, a126
    v_accvgpr_read_b32 v63, a127
    v_pk_mul_f32 v[60:61], v[60:61], v[198:199] op_sel_hi:[1,0]
    v_pk_mul_f32 v[34:35], v[34:35], v[198:199] op_sel_hi:[1,0]
    v_cvt_pk_bf16_f32 v32, v32, v33
    v_pk_mul_f32 v[38:39], v[38:39], v[198:199] op_sel_hi:[1,0]
    v_cvt_pk_bf16_f32 v36, v36, v37
    v_pk_mul_f32 v[42:43], v[42:43], v[198:199] op_sel_hi:[1,0]
    v_cvt_pk_bf16_f32 v40, v40, v41
    v_pk_mul_f32 v[46:47], v[46:47], v[198:199] op_sel_hi:[1,0]
    v_cvt_pk_bf16_f32 v44, v44, v45
    v_pk_mul_f32 v[50:51], v[50:51], v[198:199] op_sel_hi:[1,0]
    v_cvt_pk_bf16_f32 v48, v48, v49
    v_pk_mul_f32 v[54:55], v[54:55], v[198:199] op_sel_hi:[1,0]
    v_cvt_pk_bf16_f32 v52, v52, v53
    v_pk_mul_f32 v[58:59], v[58:59], v[198:199] op_sel_hi:[1,0]
    v_cvt_pk_bf16_f32 v56, v56, v57
    v_pk_mul_f32 v[62:63], v[62:63], v[198:199] op_sel_hi:[1,0]
    v_cvt_pk_bf16_f32 v60, v60, v61
    v_cvt_pk_bf16_f32 v33, v34, v35
    v_cvt_pk_bf16_f32 v37, v38, v39
    v_cvt_pk_bf16_f32 v41, v42, v43
    v_cvt_pk_bf16_f32 v45, v46, v47
    v_cvt_pk_bf16_f32 v49, v50, v51
    v_cvt_pk_bf16_f32 v53, v54, v55
    v_cvt_pk_bf16_f32 v57, v58, v59
    v_cvt_pk_bf16_f32 v61, v62, v63
    v_max3_f32 v237, v252, v253, v254
    v_max_f32 v237, v237, v255
    v_cmp_le_f32 vcc, s66, v237
    s_or_b32 s74, vcc_lo, vcc_hi
    s_waitcnt lgkmcnt(0)
    buffer_store_dwordx4 a[64:67], v220, s[24:27], s70 offen offset:0 sc0 sc1
    v_mov_b32 v237, s74
    ds_write_b64 v184, v[32:33]
    ds_write_b64 v185, v[36:37]
    ds_write_b64 v186, v[40:41]
    ds_write_b64 v187, v[44:45]
    buffer_store_dwordx4 a[68:71], v221, s[24:27], s70 offen offset:1024 sc0 sc1
    ds_write_b64 v188, v[48:49]
    ds_write_b64 v189, v[52:53]
    ds_write_b64 v190, v[56:57]
    ds_write_b64 v191, v[60:61]
    buffer_store_dwordx4 a[72:75], v222, s[24:27], s70 offen offset:2048 sc0 sc1
    ds_read_b128 a[96:99], v241 offset:0
    ds_read_b128 a[100:103], v241 offset:1024
    ds_write_b32 v239, v237 offset:16384
    ds_read_b128 a[104:107], v241 offset:2048
    ds_read_b128 a[108:111], v241 offset:3072
    buffer_store_dwordx4 a[76:79], v223, s[24:27], s70 offen offset:3072 sc0 sc1
    s_waitcnt lgkmcnt(1)
    s_barrier
    buffer_store_dwordx4 a[96:99], v220, s[24:27], s71 offen offset:0 sc0 sc1
    ds_read_b32 v244, v236
    buffer_store_dwordx4 a[100:103], v221, s[24:27], s71 offen offset:1024 sc0 sc1
    s_waitcnt lgkmcnt(0)
    v_cmp_ne_u32 vcc, 0, v244
    buffer_store_dwordx4 a[104:107], v222, s[24:27], s71 offen offset:2048 sc0 sc1
    buffer_store_dwordx4 a[108:111], v223, s[24:27], s71 offen offset:3072 sc0 sc1
    s_cbranch_vccnz Lrestart
    s_endpgm
Lpro5:
    s_add_u32 m0, s3, 8192
    s_add_u32 s61, s56, 131072
    buffer_load_dwordx4 v220, s[8:11], s61 offen offset:0 nt lds
    v_xor_b32 v252, 0, v239
    v_add_u32 v176, 8, v252
    v_xor_b32 v254, 128, v239
    v_add_u32 v178, 8, v254
    v_xor_b32 v253, 64, v239
    v_add_u32 v177, 8, v253
    v_xor_b32 v255, 192, v239
    v_add_u32 v179, 8, v255
    v_mul_u32_u24 v172, 15875, v238
    v_mul_u32_u24 v173, 15875, v243
    v_mul_u32_u24 v174, 47576, v238
    v_mul_u32_u24 v175, 47576, v243
    v_sub_u32 v244, s54, v242
    v_cmp_lt_i32 s[68:69], 0, v244
    v_cmp_lt_i32 s[70:71], 1, v244
    v_cmp_lt_i32 s[72:73], 2, v244
    v_cmp_lt_i32 s[74:75], 3, v244
    v_mov_b32 v245, s46
    v_cndmask_b32 v164, v245, 0, s[68:69]
    v_cndmask_b32 v165, v245, 0, s[70:71]
    v_cndmask_b32 v166, v245, 0, s[72:73]
    v_cndmask_b32 v167, v245, 0, s[74:75]
    v_cmp_lt_i32 s[68:69], 16, v244
    v_cmp_lt_i32 s[70:71], 17, v244
    v_cmp_lt_i32 s[72:73], 18, v244
    v_cmp_lt_i32 s[74:75], 19, v244
    v_cndmask_b32 v168, v245, 0, s[68:69]
    v_cndmask_b32 v169, v245, 0, s[70:71]
    v_cndmask_b32 v170, v245, 0, s[72:73]
    v_cndmask_b32 v171, v245, 0, s[74:75]
    v_mov_b32 v233, 0
    v_mov_b32 v235, 0
    buffer_load_dwordx4 v221, s[8:11], s61 offen offset:1024 nt lds
    buffer_load_dwordx4 v222, s[8:11], s61 offen offset:2048 nt lds
    buffer_load_dwordx4 v223, s[8:11], s61 offen offset:3072 nt lds
    s_cmp_eq_u32 s64, 0
    s_cbranch_scc1 Lw3042050
    s_waitcnt vmcnt(10)
Lw3042050:
    ds_read2st64_b64 a[4:7], v176 offset0:0 offset1:0
    s_barrier
    ds_read2st64_b64 a[0:3], v252 offset0:0 offset1:0
    s_add_u32 m0, s3, 12288
    ds_read2st64_b64 a[20:23], v178 offset0:0 offset1:0
    s_add_u32 s61, s56, 196608
    ds_read2st64_b64 a[8:11], v253 offset0:0 offset1:0
    ds_read2st64_b64 a[12:15], v177 offset0:0 offset1:0
    ds_read2st64_b64 a[16:19], v254 offset0:0 offset1:0
    ds_read_b128 a[176:179], v204 offset:8192
    buffer_load_dwordx4 v220, s[8:11], s61 offen offset:0 nt lds
    ds_read2st64_b64 a[24:27], v255 offset0:0 offset1:0
    ds_read2st64_b64 a[28:31], v179 offset0:0 offset1:0
    ds_read_b128 a[180:183], v205 offset:8192
    s_waitcnt lgkmcnt(9)
    v_mfma_f32_16x16x32_bf16 v[68:71], v[172:175], a[4:7], 0
    ds_read_b128 a[184:187], v206 offset:8192
    ds_read_b128 a[188:191], v207 offset:8192
    ds_read_b128 a[160:163], v204 offset:0
    buffer_load_dwordx4 v221, s[8:11], s61 offen offset:1024 nt lds
    s_waitcnt lgkmcnt(10)
    v_mfma_f32_16x16x32_bf16 v[64:67], v[172:175], a[0:3], 0
    ds_read_b128 a[164:167], v205 offset:0
    s_nop 0
    v_cvt_pk_bf16_f32 v2, v68, v69
    s_waitcnt lgkmcnt(8)
    v_mfma_f32_16x16x32_bf16 v[104:107], v[172:175], a[8:11], 0
    ds_read_b128 a[168:171], v206 offset:0
    v_cvt_pk_bf16_f32 v3, v70, v71
    v_mfma_f32_16x16x32_bf16 v[68:71], v[172:175], a[20:23], 0
    buffer_load_dwordx4 v222, s[8:11], s61 offen offset:2048 nt lds
    v_cvt_pk_bf16_f32 v0, v64, v65
    v_mfma_f32_16x16x32_bf16 v[108:111], v[172:175], a[12:15], 0
    ds_read_b128 a[172:175], v207 offset:0
    v_cvt_pk_bf16_f32 v1, v66, v67
    v_mfma_f32_16x16x32_bf16 v[64:67], v[172:175], a[16:19], 0
    v_cvt_pk_bf16_f32 v4, v104, v105
    v_cvt_pk_bf16_f32 v5, v106, v107
    s_waitcnt lgkmcnt(4)
    v_mfma_f32_16x16x32_bf16 v[104:107], v[172:175], a[24:27], 0
    v_cvt_pk_bf16_f32 v10, v68, v69
    v_cvt_pk_bf16_f32 v11, v70, v71
    v_mfma_f32_16x16x32_bf16 v[68:71], a[176:179], v[0:3], v[168:171]
    buffer_load_dwordx4 v223, s[8:11], s61 offen offset:3072 nt lds
    v_cvt_pk_bf16_f32 v6, v108, v109
    v_cvt_pk_bf16_f32 v7, v110, v111
    v_mfma_f32_16x16x32_bf16 v[108:111], v[172:175], a[28:31], 0
    s_add_u32 m0, s3, 16384
    v_cvt_pk_bf16_f32 v8, v64, v65
    v_cvt_pk_bf16_f32 v9, v66, v67
    v_mfma_f32_16x16x32_bf16 v[68:71], a[180:183], v[4:7], v[68:71]
    s_add_u32 s61, s56, 262144
    v_cvt_pk_bf16_f32 v12, v104, v105
    v_cvt_pk_bf16_f32 v13, v106, v107
    v_mfma_f32_16x16x32_bf16 v[68:71], a[184:187], v[8:11], v[68:71]
    v_cvt_pk_bf16_f32 v14, v108, v109
    v_cvt_pk_bf16_f32 v15, v110, v111
    s_waitcnt lgkmcnt(1)
    v_mfma_f32_16x16x32_bf16 v[64:67], a[160:163], v[0:3], v[164:167]
    buffer_load_dwordx4 v220, s[8:11], s61 offen offset:0 nt lds
    v_mfma_f32_16x16x32_bf16 v[68:71], a[188:191], v[12:15], v[68:71]
    s_cmp_eq_u32 s64, 0
    s_cbranch_scc1 Lw3042123
    s_waitcnt vmcnt(9)
Lw3042123:
    ds_read2st64_b64 a[32:35], v252 offset0:8 offset1:8
    v_mfma_f32_16x16x32_bf16 v[64:67], a[164:167], v[4:7], v[64:67]
    ds_read2st64_b64 a[36:39], v176 offset0:8 offset1:8
    s_barrier
    v_mfma_f32_16x16x32_bf16 v[64:67], a[168:171], v[8:11], v[64:67]
    ds_read2st64_b64 a[48:51], v254 offset0:8 offset1:8
    ds_read2st64_b64 a[52:55], v178 offset0:8 offset1:8
    s_waitcnt lgkmcnt(4)
    v_mfma_f32_16x16x32_bf16 v[64:67], a[172:175], v[12:15], v[64:67]
    ds_read2st64_b64 a[40:43], v253 offset0:8 offset1:8
    ds_read2st64_b64 a[44:47], v177 offset0:8 offset1:8
    ds_read2st64_b64 a[56:59], v255 offset0:8 offset1:8
    ds_read2st64_b64 a[60:63], v179 offset0:8 offset1:8
    ds_read_b128 a[192:195], v204 offset:16384
    s_waitcnt lgkmcnt(8)
    v_mfma_f32_16x16x32_bf16 v[72:75], v[172:175], a[32:35], 0
    ds_read_b128 a[208:211], v204 offset:24576
    v_max3_f32 v246, v64, v65, v66
    s_waitcnt lgkmcnt(8)
    v_mfma_f32_16x16x32_bf16 v[76:79], v[172:175], a[36:39], 0
    ds_read_b128 a[196:199], v205 offset:16384
    v_max3_f32 v246, v246, v67, v68
    v_max3_f32 v246, v246, v69, v70
    v_max_f32 v246, v246, v71
    v_cvt_pk_bf16_f32 v16, v72, v73
    v_cvt_pk_bf16_f32 v17, v74, v75
    v_mov_b32 v247, v246
    s_nop 0
    v_cvt_pk_bf16_f32 v18, v76, v77
    s_waitcnt lgkmcnt(7)
    v_mfma_f32_16x16x32_bf16 v[72:75], v[172:175], a[48:51], 0
    ds_read_b128 a[212:215], v205 offset:24576
    v_cvt_pk_bf16_f32 v19, v78, v79
    v_mfma_f32_16x16x32_bf16 v[76:79], v[172:175], a[52:55], 0
    ds_read_b128 a[200:203], v206 offset:16384
    v_permlane32_swap_b32 v246, v247
    s_waitcnt lgkmcnt(5)
    v_mfma_f32_16x16x32_bf16 v[112:115], v[172:175], a[40:43], 0
    ds_read_b128 a[216:219], v206 offset:24576
    v_cvt_pk_bf16_f32 v24, v72, v73
    v_mfma_f32_16x16x32_bf16 v[116:119], v[172:175], a[44:47], 0
    buffer_load_dwordx4 v221, s[8:11], s61 offen offset:1024 nt lds
    v_cvt_pk_bf16_f32 v25, v74, v75
    v_mfma_f32_16x16x32_bf16 v[72:75], a[160:163], v[16:19], v[164:167]
    ds_read_b128 a[204:207], v207 offset:16384
    v_cvt_pk_bf16_f32 v26, v76, v77
    v_cvt_pk_bf16_f32 v27, v78, v79
    v_mfma_f32_16x16x32_bf16 v[76:79], a[176:179], v[16:19], v[168:171]
    ds_read_b128 a[220:223], v207 offset:24576
    v_cvt_pk_bf16_f32 v20, v112, v113
    v_cvt_pk_bf16_f32 v21, v114, v115
    v_mfma_f32_16x16x32_bf16 v[112:115], v[172:175], a[56:59], 0
    v_cvt_pk_bf16_f32 v22, v116, v117
    v_cvt_pk_bf16_f32 v23, v118, v119
    v_mfma_f32_16x16x32_bf16 v[116:119], v[172:175], a[60:63], 0
    buffer_load_dwordx4 v222, s[8:11], s61 offen offset:2048 nt lds
    v_max_f32 v246, v246, v247
    v_mfma_f32_16x16x32_bf16 v[72:75], a[164:167], v[20:23], v[72:75]
    v_mov_b32 v247, v246
    v_mfma_f32_16x16x32_bf16 v[76:79], a[180:183], v[20:23], v[76:79]
    v_cvt_pk_bf16_f32 v28, v112, v113
    v_cvt_pk_bf16_f32 v29, v114, v115
    v_mfma_f32_16x16x32_bf16 v[72:75], a[168:171], v[24:27], v[72:75]
    v_cvt_pk_bf16_f32 v30, v116, v117
    v_cvt_pk_bf16_f32 v31, v118, v119
    v_mfma_f32_16x16x32_bf16 v[76:79], a[184:187], v[24:27], v[76:79]
    buffer_load_dwordx4 v223, s[8:11], s61 offen offset:3072 nt lds
    v_permlane16_swap_b32 v246, v247
    v_mfma_f32_16x16x32_bf16 v[72:75], a[172:175], v[28:31], v[72:75]
    v_max_f32 v246, v246, v247
    v_add_f32 v246, s44, v246
    v_mfma_f32_16x16x32_bf16 v[76:79], a[188:191], v[28:31], v[76:79]
    v_sub_f32 v184, 0, v246
    v_sub_f32 v185, 0, v246
    v_sub_f32 v186, 0, v246
    v_sub_f32 v187, 0, v246
    v_sub_f32 v64, v64, v246
    v_max3_f32 v244, v72, v73, v74
    s_waitcnt lgkmcnt(0)
    v_mfma_f32_16x16x32_bf16 v[104:107], a[192:195], v[0:3], v[184:187]
    v_max3_f32 v244, v244, v75, v76
    v_max3_f32 v244, v244, v77, v78
    v_mfma_f32_16x16x32_bf16 v[108:111], a[208:211], v[0:3], v[184:187]
    v_max_f32 v244, v244, v79
    v_mov_b32 v245, v244
    v_mfma_f32_16x16x32_bf16 v[104:107], a[196:199], v[4:7], v[104:107]
    v_sub_f32 v65, v65, v246
    v_permlane32_swap_b32 v244, v245
    v_mfma_f32_16x16x32_bf16 v[108:111], a[212:215], v[4:7], v[108:111]
    v_sub_f32 v66, v66, v246
    v_sub_f32 v67, v67, v246
    v_mfma_f32_16x16x32_bf16 v[104:107], a[200:203], v[8:11], v[104:107]
    v_max_f32 v244, v244, v245
    v_exp_f32 v224, v64
    v_mfma_f32_16x16x32_bf16 v[108:111], a[216:219], v[8:11], v[108:111]
    v_exp_f32 v225, v65
    v_mfma_f32_16x16x32_bf16 v[104:107], a[204:207], v[12:15], v[104:107]
    v_exp_f32 v226, v66
    v_mfma_f32_16x16x32_bf16 v[108:111], a[220:223], v[12:15], v[108:111]
    v_exp_f32 v227, v67
    v_mov_b32 v245, v244
    v_sub_f32 v68, v68, v246
    v_sub_f32 v69, v69, v246
    v_sub_f32 v70, v70, v246
    v_sub_f32 v71, v71, v246
    v_cvt_pk_bf16_f32 v144, v224, v225
    v_cvt_pk_bf16_f32 v145, v226, v227
    v_permlane16_swap_b32 v244, v245
    v_exp_f32 v224, v68
    v_exp_f32 v225, v69
    v_exp_f32 v226, v70
    v_exp_f32 v227, v71
    v_max_f32 v244, v244, v245
    v_add_f32 v244, s44, v244
    v_cvt_pk_bf16_f32 v146, v224, v225
    v_cvt_pk_bf16_f32 v147, v226, v227
    v_sub_f32 v188, 0, v244
    v_sub_f32 v189, 0, v244
    v_sub_f32 v190, 0, v244
    v_sub_f32 v191, 0, v244
    s_waitcnt vmcnt(8)
    v_sub_f32 v72, v72, v244
    v_mfma_f32_16x16x32_bf16 v[112:115], a[192:195], v[16:19], v[188:191]
    s_add_u32 m0, s41, 32768
    ds_read2st64_b64 a[64:67], v252 offset0:16 offset1:16
    v_sub_f32 v73, v73, v244
    v_mfma_f32_16x16x32_bf16 v[116:119], a[208:211], v[16:19], v[188:191]
    s_add_u32 s61, s36, 131072
    ds_read2st64_b64 a[68:71], v176 offset0:16 offset1:16
    v_sub_f32 v74, v74, v244
    v_mfma_f32_16x16x32_bf16 v[112:115], a[196:199], v[20:23], v[112:115]
    ds_read2st64_b64 a[80:83], v254 offset0:16 offset1:16
    v_sub_f32 v75, v75, v244
    v_mfma_f32_16x16x32_bf16 v[116:119], a[212:215], v[20:23], v[116:119]
    ds_read2st64_b64 a[84:87], v178 offset0:16 offset1:16
    v_exp_f32 v248, v72
    v_mfma_f32_16x16x32_bf16 v[112:115], a[200:203], v[24:27], v[112:115]
    ds_read2st64_b64 a[72:75], v253 offset0:16 offset1:16
    v_exp_f32 v249, v73
    v_mfma_f32_16x16x32_bf16 v[116:119], a[216:219], v[24:27], v[116:119]
    ds_read2st64_b64 a[76:79], v177 offset0:16 offset1:16
    v_exp_f32 v250, v74
    v_mfma_f32_16x16x32_bf16 v[112:115], a[204:207], v[28:31], v[112:115]
    ds_read2st64_b64 a[88:91], v255 offset0:16 offset1:16
    v_exp_f32 v251, v75
    v_mfma_f32_16x16x32_bf16 v[116:119], a[220:223], v[28:31], v[116:119]
    ds_read2st64_b64 a[92:95], v179 offset0:16 offset1:16
    v_sub_f32 v76, v76, v244
    s_waitcnt lgkmcnt(6)
    v_mfma_f32_16x16x32_bf16 v[80:83], v[172:175], a[64:67], 0
    buffer_load_dwordx4 v216, s[16:19], s61 offen offset:2048 lds
    v_sub_f32 v77, v77, v244
    v_mfma_f32_16x16x32_bf16 v[84:87], v[172:175], a[68:71], 0
    v_sub_f32 v78, v78, v244
    v_sub_f32 v79, v79, v244
    v_cvt_pk_bf16_f32 v148, v248, v249
    v_cvt_pk_bf16_f32 v149, v250, v251
    v_exp_f32 v248, v76
    v_exp_f32 v249, v77
    s_waitcnt lgkmcnt(3)
    v_mfma_f32_16x16x32_bf16 v[120:123], v[172:175], a[72:75], 0
    buffer_load_dwordx4 v217, s[16:19], s61 offen offset:3072 lds
    s_waitcnt lgkmcnt(2)
    v_mfma_f32_16x16x32_bf16 v[124:127], v[172:175], a[76:79], 0
    s_add_u32 m0, s41, 32768
    v_exp_f32 v250, v78
    v_exp_f32 v251, v79
    v_cvt_pk_bf16_f32 v150, v248, v249
    v_cvt_pk_bf16_f32 v151, v250, v251
    s_waitcnt vmcnt(6)
    v_cvt_pk_bf16_f32 v32, v80, v81
    v_cvt_pk_bf16_f32 v33, v82, v83
    v_mfma_f32_16x16x32_bf16 v[80:83], v[172:175], a[80:83], 0
    s_add_u32 s61, s36, 262144
    ds_read2st64_b64 a[96:99], v252 offset0:24 offset1:24
    v_cvt_pk_bf16_f32 v34, v84, v85
    v_cvt_pk_bf16_f32 v35, v86, v87
    v_mfma_f32_16x16x32_bf16 v[84:87], v[172:175], a[84:87], 0
    ds_read2st64_b64 a[100:103], v176 offset0:24 offset1:24
    v_cvt_pk_bf16_f32 v36, v120, v121
    v_cvt_pk_bf16_f32 v37, v122, v123
    s_waitcnt lgkmcnt(2)
    v_mfma_f32_16x16x32_bf16 v[120:123], v[172:175], a[88:91], 0
    ds_read2st64_b64 a[112:115], v254 offset0:24 offset1:24
    v_cvt_pk_bf16_f32 v40, v80, v81
    v_cvt_pk_bf16_f32 v41, v82, v83
    v_mfma_f32_16x16x32_bf16 v[80:83], a[160:163], v[32:35], v[164:167]
    ds_read2st64_b64 a[116:119], v178 offset0:24 offset1:24
    v_cvt_pk_bf16_f32 v42, v84, v85
    v_cvt_pk_bf16_f32 v43, v86, v87
    v_mfma_f32_16x16x32_bf16 v[84:87], a[176:179], v[32:35], v[168:171]
    ds_read2st64_b64 a[104:107], v253 offset0:24 offset1:24
    v_cvt_pk_bf16_f32 v38, v124, v125
    v_cvt_pk_bf16_f32 v39, v126, v127
    v_mfma_f32_16x16x32_bf16 v[124:127], v[172:175], a[92:95], 0
    ds_read2st64_b64 a[108:111], v177 offset0:24 offset1:24
    v_cvt_pk_bf16_f32 v44, v120, v121
    v_mfma_f32_16x16x32_bf16 v[80:83], a[164:167], v[36:39], v[80:83]
    ds_read2st64_b64 a[120:123], v255 offset0:24 offset1:24
    v_cvt_pk_bf16_f32 v45, v122, v123
    s_waitcnt lgkmcnt(6)
    v_mfma_f32_16x16x32_bf16 v[88:91], v[172:175], a[96:99], 0
    ds_read2st64_b64 a[124:127], v179 offset0:24 offset1:24
    v_cvt_pk_bf16_f32 v46, v124, v125
    s_waitcnt lgkmcnt(6)
    v_mfma_f32_16x16x32_bf16 v[92:95], v[172:175], a[100:103], 0
    buffer_load_dwordx4 v218, s[20:23], s43 offen lds
    v_cvt_pk_bf16_f32 v47, v126, v127
    v_mfma_f32_16x16x32_bf16 v[84:87], a[180:183], v[36:39], v[84:87]
    s_barrier
    v_mfma_f32_16x16x32_bf16 v[80:83], a[168:171], v[40:43], v[80:83]
    s_add_u32 s40, s40, 131072
    buffer_load_dwordx4 v219, s[20:23], s43 offen offset:1024 lds
    v_cvt_pk_bf16_f32 v48, v88, v89
    v_mfma_f32_16x16x32_bf16 v[84:87], a[184:187], v[40:43], v[84:87]
    s_add_u32 m0, s41, 49152
    v_cvt_pk_bf16_f32 v49, v90, v91
    v_cvt_pk_bf16_f32 v50, v92, v93
    s_waitcnt lgkmcnt(1)
    v_mfma_f32_16x16x32_bf16 v[88:91], v[172:175], a[112:115], 0
    s_add_u32 s63, s63, 131072
    v_cvt_pk_bf16_f32 v51, v94, v95
    v_mfma_f32_16x16x32_bf16 v[92:95], v[172:175], a[116:119], 0
    buffer_load_dwordx4 v216, s[16:19], s61 offen offset:2048 lds
    v_mfma_f32_16x16x32_bf16 v[128:131], v[172:175], a[104:107], 0
    v_mfma_f32_16x16x32_bf16 v[132:135], v[172:175], a[108:111], 0
    v_mfma_f32_16x16x32_bf16 v[80:83], a[172:175], v[44:47], v[80:83]
    s_nop 0
    v_cvt_pk_bf16_f32 v56, v88, v89
    v_mfma_f32_16x16x32_bf16 v[84:87], a[188:191], v[44:47], v[84:87]
    buffer_load_dwordx4 v217, s[16:19], s61 offen offset:3072 lds
    v_cvt_pk_bf16_f32 v57, v90, v91
    v_mfma_f32_16x16x32_bf16 v[88:91], a[160:163], v[48:51], v[164:167]
    s_add_u32 m0, s41, 49152
    v_cvt_pk_bf16_f32 v58, v92, v93
    v_cvt_pk_bf16_f32 v59, v94, v95
    v_mfma_f32_16x16x32_bf16 v[92:95], a[176:179], v[48:51], v[168:171]
    v_cvt_pk_bf16_f32 v52, v128, v129
    v_cvt_pk_bf16_f32 v53, v130, v131
    v_mfma_f32_16x16x32_bf16 v[128:131], v[172:175], a[120:123], 0
    v_cvt_pk_bf16_f32 v54, v132, v133
    v_cvt_pk_bf16_f32 v55, v134, v135
    s_waitcnt lgkmcnt(0)
    v_mfma_f32_16x16x32_bf16 v[132:135], v[172:175], a[124:127], 0
    buffer_load_dwordx4 v218, s[20:23], s36 offen lds
    v_max3_f32 v246, v80, v81, v82
    v_mfma_f32_16x16x32_bf16 v[88:91], a[164:167], v[52:55], v[88:91]
    v_max3_f32 v246, v246, v83, v84
    v_max3_f32 v246, v246, v85, v86
    v_mfma_f32_16x16x32_bf16 v[92:95], a[180:183], v[52:55], v[92:95]
    v_max_f32 v246, v246, v87
    v_mov_b32 v247, v246
    v_mfma_f32_16x16x32_bf16 v[88:91], a[168:171], v[56:59], v[88:91]
    v_cvt_pk_bf16_f32 v60, v128, v129
    v_permlane32_swap_b32 v246, v247
    v_mfma_f32_16x16x32_bf16 v[92:95], a[184:187], v[56:59], v[92:95]
    buffer_load_dwordx4 v219, s[20:23], s36 offen offset:1024 lds
    v_max_f32 v246, v246, v247
    v_cvt_pk_bf16_f32 v61, v130, v131
    v_cvt_pk_bf16_f32 v62, v132, v133
    v_cvt_pk_bf16_f32 v63, v134, v135
    v_mov_b32 v247, v246
    s_mov_b32 m0, s41
    v_mfma_f32_16x16x32_bf16 v[88:91], a[172:175], v[60:63], v[88:91]
    v_permlane16_swap_b32 v246, v247
    v_mfma_f32_16x16x32_bf16 v[92:95], a[188:191], v[60:63], v[92:95]
    v_max_f32 v246, v246, v247
    v_add_f32 v246, s44, v246
    v_sub_f32 v192, 0, v246
    v_sub_f32 v193, 0, v246
    v_sub_f32 v194, 0, v246
    v_sub_f32 v195, 0, v246
    v_max3_f32 v244, v88, v89, v90
    v_sub_f32 v80, v80, v246
    v_mfma_f32_16x16x32_bf16 v[120:123], a[192:195], v[32:35], v[192:195]
    buffer_load_dwordx4 v218, s[20:23], s40 offen lds
    v_max3_f32 v244, v244, v91, v92
    v_mfma_f32_16x16x32_bf16 v[124:127], a[208:211], v[32:35], v[192:195]
    v_max3_f32 v244, v244, v93, v94
    v_max_f32 v244, v244, v95
    v_mfma_f32_16x16x32_bf16 v[120:123], a[196:199], v[36:39], v[120:123]
    v_mov_b32 v245, v244
    v_sub_f32 v81, v81, v246
    v_mfma_f32_16x16x32_bf16 v[124:127], a[212:215], v[36:39], v[124:127]
    v_permlane32_swap_b32 v244, v245
    v_mfma_f32_16x16x32_bf16 v[120:123], a[200:203], v[40:43], v[120:123]
    buffer_load_dwordx4 v219, s[20:23], s40 offen offset:1024 lds
    v_sub_f32 v82, v82, v246
    v_mfma_f32_16x16x32_bf16 v[124:127], a[216:219], v[40:43], v[124:127]
    s_add_u32 s40, s40, 131072
    v_sub_f32 v83, v83, v246
    v_max_f32 v244, v244, v245
    v_mfma_f32_16x16x32_bf16 v[120:123], a[204:207], v[44:47], v[120:123]
    v_exp_f32 v224, v80
    v_mfma_f32_16x16x32_bf16 v[124:127], a[220:223], v[44:47], v[124:127]
    v_exp_f32 v225, v81
    v_exp_f32 v226, v82
    v_exp_f32 v227, v83
    v_mov_b32 v245, v244
    v_sub_f32 v84, v84, v246
    v_sub_f32 v85, v85, v246
    v_sub_f32 v86, v86, v246
    v_sub_f32 v87, v87, v246
    v_cvt_pk_bf16_f32 v152, v224, v225
    v_cvt_pk_bf16_f32 v153, v226, v227
    v_permlane16_swap_b32 v244, v245
    v_exp_f32 v224, v84
    v_exp_f32 v225, v85
    v_exp_f32 v226, v86
    v_exp_f32 v227, v87
    v_max_f32 v244, v244, v245
    v_add_f32 v244, s44, v244
    v_cvt_pk_bf16_f32 v154, v224, v225
    v_cvt_pk_bf16_f32 v155, v226, v227
    v_sub_f32 v196, 0, v244
    v_sub_f32 v197, 0, v244
    v_sub_f32 v198, 0, v244
    v_sub_f32 v199, 0, v244
    v_sub_f32 v88, v88, v244
    v_sub_f32 v89, v89, v244
    v_mfma_f32_16x16x32_bf16 v[128:131], a[192:195], v[48:51], v[196:199]
    buffer_load_dwordx4 v216, s[16:19], s63 offen offset:2048 lds
    v_sub_f32 v90, v90, v244
    v_mfma_f32_16x16x32_bf16 v[132:135], a[208:211], v[48:51], v[196:199]
    v_sub_f32 v91, v91, v244
    v_sub_f32 v92, v92, v244
    v_mfma_f32_16x16x32_bf16 v[128:131], a[196:199], v[52:55], v[128:131]
    v_sub_f32 v93, v93, v244
    v_sub_f32 v94, v94, v244
    v_mfma_f32_16x16x32_bf16 v[132:135], a[212:215], v[52:55], v[132:135]
    v_sub_f32 v95, v95, v244
    s_waitcnt vmcnt(11)
    v_mfma_f32_16x16x32_bf16 v[128:131], a[200:203], v[56:59], v[128:131]
    ds_read2st64_b64 a[128:131], v252 offset0:32 offset1:32
    v_exp_f32 v248, v88
    v_mfma_f32_16x16x32_bf16 v[132:135], a[216:219], v[56:59], v[132:135]
    ds_read2st64_b64 a[132:135], v176 offset0:32 offset1:32
    v_exp_f32 v249, v89
    v_mfma_f32_16x16x32_bf16 v[128:131], a[204:207], v[60:63], v[128:131]
    ds_read2st64_b64 a[144:147], v254 offset0:32 offset1:32
    v_exp_f32 v250, v90
    v_mfma_f32_16x16x32_bf16 v[132:135], a[220:223], v[60:63], v[132:135]
    ds_read2st64_b64 a[148:151], v178 offset0:32 offset1:32
    v_exp_f32 v251, v91
    v_cvt_pk_bf16_f32 v156, v248, v249
    v_add_f32 v232, v248, v249
    v_exp_f32 v248, v92
    v_exp_f32 v249, v93
    v_cvt_pk_bf16_f32 v157, v250, v251
    v_add_f32 v180, v250, v251
    v_add_f32 v232, v232, v180
    v_exp_f32 v250, v94
    v_exp_f32 v251, v95
    s_waitcnt lgkmcnt(3)
    v_mfma_f32_16x16x32_bf16 v[96:99], v[172:175], a[128:131], 0
    ds_read2st64_b64 a[136:139], v253 offset0:32 offset1:32
    v_add_f32 v180, v248, v249
    s_waitcnt lgkmcnt(3)
    v_mfma_f32_16x16x32_bf16 v[100:103], v[172:175], a[132:135], 0
    ds_read2st64_b64 a[140:143], v177 offset0:32 offset1:32
    v_add_f32 v232, v232, v180
    v_add_f32 v180, v250, v251
    v_add_f32 v232, v232, v180
    v_cvt_pk_bf16_f32 v96, v96, v97
    v_cvt_pk_bf16_f32 v98, v98, v99
    v_accvgpr_write_b32 a224, v96
    v_accvgpr_write_b32 a225, v98
    s_waitcnt lgkmcnt(2)
    v_mfma_f32_16x16x32_bf16 v[96:99], v[172:175], a[144:147], 0
    ds_read2st64_b64 a[152:155], v255 offset0:32 offset1:32
    v_cvt_pk_bf16_f32 v100, v100, v101
    v_cvt_pk_bf16_f32 v102, v102, v103
    v_accvgpr_write_b32 a226, v100
    v_accvgpr_write_b32 a227, v102
    v_mfma_f32_16x16x32_bf16 v[100:103], v[172:175], a[148:151], 0
    ds_read2st64_b64 a[156:159], v179 offset0:32 offset1:32
    v_cvt_pk_bf16_f32 v158, v248, v249
    v_cvt_pk_bf16_f32 v96, v96, v97
    v_cvt_pk_bf16_f32 v98, v98, v99
    v_accvgpr_write_b32 a232, v96
    v_accvgpr_write_b32 a233, v98
    v_mfma_f32_16x16x32_bf16 v[96:99], a[160:163], a[224:227], v[164:167]
    buffer_load_dwordx4 v217, s[16:19], s63 offen offset:3072 lds
    v_cvt_pk_bf16_f32 v100, v100, v101
    s_waitcnt lgkmcnt(3)
    v_mfma_f32_16x16x32_bf16 v[136:139], v[172:175], a[136:139], 0
    s_add_u32 m0, s41, 16384
    v_cvt_pk_bf16_f32 v102, v102, v103
    v_accvgpr_write_b32 a234, v100
    s_waitcnt lgkmcnt(2)
    v_mfma_f32_16x16x32_bf16 v[140:143], v[172:175], a[140:143], 0
    s_add_u32 s63, s63, 131072
    v_accvgpr_write_b32 a235, v102
    v_cvt_pk_bf16_f32 v159, v250, v251
    v_mfma_f32_16x16x32_bf16 v[100:103], a[176:179], a[224:227], v[168:171]
    v_cvt_pk_bf16_f32 v136, v136, v137
    v_cvt_pk_bf16_f32 v138, v138, v139
    v_accvgpr_write_b32 a228, v136
    v_accvgpr_write_b32 a229, v138
    s_waitcnt lgkmcnt(1)
    v_mfma_f32_16x16x32_bf16 v[136:139], v[172:175], a[152:155], 0
    buffer_load_dwordx4 v218, s[20:23], s40 offen lds
    v_cvt_pk_bf16_f32 v140, v140, v141
    v_cvt_pk_bf16_f32 v142, v142, v143
    v_accvgpr_write_b32 a230, v140
    v_accvgpr_write_b32 a231, v142
    s_waitcnt lgkmcnt(0)
    v_mfma_f32_16x16x32_bf16 v[140:143], v[172:175], a[156:159], 0
    s_nop 0
    v_cvt_pk_bf16_f32 v136, v136, v137
    v_mfma_f32_16x16x32_bf16 v[96:99], a[164:167], a[228:231], v[96:99]
    v_cvt_pk_bf16_f32 v138, v138, v139
    v_accvgpr_write_b32 a236, v136
    v_mfma_f32_16x16x32_bf16 v[100:103], a[180:183], a[228:231], v[100:103]
    buffer_load_dwordx4 v219, s[20:23], s40 offen offset:1024 lds
    v_accvgpr_write_b32 a237, v138
    v_mfma_f32_16x16x32_bf16 v[96:99], a[168:171], a[232:235], v[96:99]
    v_cvt_pk_bf16_f32 v140, v140, v141
    v_cvt_pk_bf16_f32 v142, v142, v143
    v_mfma_f32_16x16x32_bf16 v[100:103], a[184:187], a[232:235], v[100:103]
    v_accvgpr_write_b32 a238, v140
    v_accvgpr_write_b32 a239, v142
    s_nop 1
    v_mfma_f32_16x16x32_bf16 v[96:99], a[172:175], a[236:239], v[96:99]
    buffer_load_dwordx4 v216, s[16:19], s63 offen offset:2048 lds
    v_mfma_f32_16x16x32_bf16 v[100:103], a[188:191], a[236:239], v[100:103]
    s_nop 5
    v_max3_f32 v246, v96, v97, v98
    s_nop 0
    v_max3_f32 v246, v246, v99, v100
    v_max3_f32 v246, v246, v101, v102
    v_max_f32 v246, v246, v103
    v_mov_b32 v247, v246
    s_nop 1
    v_permlane32_swap_b32 v246, v247
    v_max_f32 v246, v246, v247
    v_mov_b32 v247, v246
    s_nop 1
    v_permlane16_swap_b32 v246, v247
    v_max_f32 v246, v246, v247
    v_add_f32 v246, s44, v246
    v_sub_f32 v200, 0, v246
    v_sub_f32 v201, 0, v246
    v_sub_f32 v202, 0, v246
    v_sub_f32 v203, 0, v246
    v_sub_f32 v96, v96, v246
    v_sub_f32 v97, v97, v246
    v_mfma_f32_16x16x32_bf16 v[136:139], a[192:195], a[224:227], v[200:203]
    buffer_load_dwordx4 v217, s[16:19], s63 offen offset:3072 lds
    v_sub_f32 v98, v98, v246
    v_mfma_f32_16x16x32_bf16 v[140:143], a[208:211], a[224:227], v[200:203]
    v_sub_f32 v99, v99, v246
    v_sub_f32 v100, v100, v246
    v_mfma_f32_16x16x32_bf16 v[136:139], a[196:199], a[228:231], v[136:139]
    v_sub_f32 v101, v101, v246
    v_sub_f32 v102, v102, v246
    v_mfma_f32_16x16x32_bf16 v[140:143], a[212:215], a[228:231], v[140:143]
    v_sub_f32 v103, v103, v246
    s_waitcnt vmcnt(12)
    v_mfma_f32_16x16x32_bf16 v[136:139], a[200:203], a[232:235], v[136:139]
    s_barrier
    v_mfma_f32_16x16x32_bf16 v[140:143], a[216:219], a[232:235], v[140:143]
    ds_read_b128 a[160:163], v204 offset:32768
    v_exp_f32 v224, v96
    v_mfma_f32_16x16x32_bf16 v[136:139], a[204:207], a[236:239], v[136:139]
    ds_read_b128 a[164:167], v205 offset:32768
    v_exp_f32 v225, v97
    v_mfma_f32_16x16x32_bf16 v[140:143], a[220:223], a[236:239], v[140:143]
    ds_read_b128 a[168:171], v206 offset:32768
    v_exp_f32 v226, v98
    v_exp_f32 v227, v99
    v_cvt_pk_bf16_f32 v160, v224, v225
    v_add_f32 v234, v224, v225
    v_exp_f32 v224, v100
    v_exp_f32 v225, v101
    v_cvt_pk_bf16_f32 v161, v226, v227
    v_add_f32 v180, v226, v227
    v_add_f32 v234, v234, v180
    v_exp_f32 v226, v102
    v_exp_f32 v227, v103
    v_add_f32 v180, v224, v225
    v_add_f32 v234, v234, v180
    v_add_f32 v180, v226, v227
    v_cvt_pk_bf16_f32 v162, v224, v225
    v_cvt_pk_bf16_f32 v163, v226, v227
    v_add_f32 v234, v234, v180
    ds_read_b128 a[172:175], v207 offset:32768
    ds_read_b128 a[176:179], v204 offset:40960
    ds_read_b128 a[180:183], v205 offset:40960
    ds_read_b128 a[184:187], v206 offset:40960
    ds_read_b128 a[188:191], v207 offset:40960
    s_sub_u32 s42, s42, 1
    s_cmp_lg_u32 s65, 0
    s_cbranch_scc1 Lsafe5
    s_waitcnt lgkmcnt(0)
    v_mfma_f32_16x16x32_bf16 v[64:67], a[160:163], v[0:3], v[184:187]
    ds_read_b64_tr_b16 a[192:193], v208 offset:32768
    v_mfma_f32_16x16x32_bf16 v[72:75], a[160:163], v[16:19], v[188:191]
    v_exp_f32 v224, v136
    v_mfma_f32_16x16x32_bf16 v[80:83], a[160:163], v[32:35], v[192:195]
    ds_read_b64_tr_b16 a[194:195], v208 offset:40960
    v_mfma_f32_16x16x32_bf16 v[88:91], a[160:163], v[48:51], v[196:199]
    v_exp_f32 v225, v137
    v_mfma_f32_16x16x32_bf16 v[96:99], a[160:163], a[224:227], v[200:203]
    ds_read_b64_tr_b16 a[196:197], v209 offset:32768
    v_cvt_pk_bf16_f32 v180, v224, v225
    v_mfma_f32_16x16x32_bf16 v[64:67], a[164:167], v[4:7], v[64:67]
    v_exp_f32 v226, v138
    v_mfma_f32_16x16x32_bf16 v[72:75], a[164:167], v[20:23], v[72:75]
    ds_read_b64_tr_b16 a[198:199], v209 offset:40960
    v_add_f32 v235, v235, v234
    v_mfma_f32_16x16x32_bf16 v[80:83], a[164:167], v[36:39], v[80:83]
    v_exp_f32 v227, v139
    v_mfma_f32_16x16x32_bf16 v[88:91], a[164:167], v[52:55], v[88:91]
    ds_read_b64_tr_b16 a[200:201], v210 offset:32768
    v_add_f32 v234, v224, v225
    v_mfma_f32_16x16x32_bf16 v[96:99], a[164:167], a[228:231], v[96:99]
    v_exp_f32 v248, v140
    v_mfma_f32_16x16x32_bf16 v[64:67], a[168:171], v[8:11], v[64:67]
    ds_read_b64_tr_b16 a[202:203], v210 offset:40960
    v_cvt_pk_bf16_f32 v181, v226, v227
    v_mfma_f32_16x16x32_bf16 v[72:75], a[168:171], v[24:27], v[72:75]
    v_exp_f32 v249, v141
    v_mfma_f32_16x16x32_bf16 v[80:83], a[168:171], v[40:43], v[80:83]
    ds_read_b64_tr_b16 a[204:205], v211 offset:32768
    v_add_f32 v247, v226, v227
    v_mfma_f32_16x16x32_bf16 v[88:91], a[168:171], v[56:59], v[88:91]
    v_exp_f32 v250, v142
    v_mfma_f32_16x16x32_bf16 v[96:99], a[168:171], a[232:235], v[96:99]
    ds_read_b64_tr_b16 a[206:207], v211 offset:40960
    v_add_f32 v234, v234, v247
    v_mfma_f32_16x16x32_bf16 v[64:67], a[172:175], v[12:15], v[64:67]
    v_exp_f32 v251, v143
    v_mfma_f32_16x16x32_bf16 v[72:75], a[172:175], v[28:31], v[72:75]
    v_exp_f32 v224, v128
    v_mfma_f32_16x16x32_bf16 v[80:83], a[172:175], v[44:47], v[80:83]
    ds_read_b64_tr_b16 a[208:209], v212 offset:32768
    v_cvt_pk_bf16_f32 v182, v248, v249
    v_mfma_f32_16x16x32_bf16 v[88:91], a[172:175], v[60:63], v[88:91]
    v_exp_f32 v225, v129
    v_mfma_f32_16x16x32_bf16 v[96:99], a[172:175], a[236:239], v[96:99]
    ds_read_b64_tr_b16 a[210:211], v212 offset:40960
    v_add_f32 v247, v248, v249
    v_mfma_f32_16x16x32_bf16 v[68:71], a[176:179], v[0:3], v[184:187]
    v_exp_f32 v226, v130
    v_mfma_f32_16x16x32_bf16 v[76:79], a[176:179], v[16:19], v[188:191]
    ds_read_b64_tr_b16 a[212:213], v213 offset:32768
    v_add_f32 v234, v234, v247
    v_mfma_f32_16x16x32_bf16 v[84:87], a[176:179], v[32:35], v[192:195]
    v_exp_f32 v227, v131
    v_mfma_f32_16x16x32_bf16 v[92:95], a[176:179], v[48:51], v[196:199]
    ds_read_b64_tr_b16 a[214:215], v213 offset:40960
    v_cvt_pk_bf16_f32 v183, v250, v251
    v_mfma_f32_16x16x32_bf16 v[100:103], a[176:179], a[224:227], v[200:203]
    v_add_f32 v247, v250, v251
    v_add_f32 v234, v234, v247
    v_mfma_f32_16x16x32_bf16 v[68:71], a[180:183], v[4:7], v[68:71]
    ds_read_b64_tr_b16 a[216:217], v214 offset:32768
    v_cvt_pk_bf16_f32 v176, v224, v225
    v_mfma_f32_16x16x32_bf16 v[76:79], a[180:183], v[20:23], v[76:79]
    v_exp_f32 v248, v132
    v_mfma_f32_16x16x32_bf16 v[84:87], a[180:183], v[36:39], v[84:87]
    ds_read_b64_tr_b16 a[218:219], v214 offset:40960
    v_add_f32 v233, v233, v232
    v_mfma_f32_16x16x32_bf16 v[92:95], a[180:183], v[52:55], v[92:95]
    v_exp_f32 v249, v133
    v_mfma_f32_16x16x32_bf16 v[100:103], a[180:183], a[228:231], v[100:103]
    ds_read_b64_tr_b16 a[220:221], v215 offset:32768
    v_add_f32 v232, v224, v225
    v_mfma_f32_16x16x32_bf16 v[68:71], a[184:187], v[8:11], v[68:71]
    v_exp_f32 v250, v134
    v_mfma_f32_16x16x32_bf16 v[76:79], a[184:187], v[24:27], v[76:79]
    ds_read_b64_tr_b16 a[222:223], v215 offset:40960
    v_cvt_pk_bf16_f32 v177, v226, v227
    v_mfma_f32_16x16x32_bf16 v[84:87], a[184:187], v[40:43], v[84:87]
    v_exp_f32 v251, v135
    v_mfma_f32_16x16x32_bf16 v[92:95], a[184:187], v[56:59], v[92:95]
    v_add_f32 v247, v226, v227
    v_add_f32 v232, v232, v247
    v_mfma_f32_16x16x32_bf16 v[100:103], a[184:187], a[232:235], v[100:103]
    v_exp_f32 v224, v120
    v_mfma_f32_16x16x32_bf16 v[68:71], a[188:191], v[12:15], v[68:71]
    s_add_u32 m0, s41, 32768
    v_exp_f32 v225, v121
    v_mfma_f32_16x16x32_bf16 v[76:79], a[188:191], v[28:31], v[76:79]
    s_add_u32 s40, s40, 131072
    v_cvt_pk_bf16_f32 v178, v248, v249
    v_add_f32 v247, v248, v249
    v_mfma_f32_16x16x32_bf16 v[84:87], a[188:191], v[44:47], v[84:87]
    s_add_u32 s63, s63, 131072
    v_exp_f32 v226, v122
    v_mfma_f32_16x16x32_bf16 v[92:95], a[188:191], v[60:63], v[92:95]
    s_waitcnt vmcnt(8) lgkmcnt(0)
    v_add_f32 v232, v232, v247
    v_cvt_pk_bf16_f32 v179, v250, v251
    v_mfma_f32_16x16x32_bf16 v[100:103], a[188:191], a[236:239], v[100:103]
    s_barrier
    v_mfma_f32_16x16x32_bf16 a[0:3], a[192:195], v[144:147], 0
    ds_read_b128 a[160:163], v204 offset:49152
    v_add_f32 v247, v250, v251
    v_mfma_f32_16x16x32_bf16 a[32:35], a[192:195], v[148:151], 0
    v_exp_f32 v227, v123
    v_mfma_f32_16x16x32_bf16 a[64:67], a[192:195], v[152:155], 0
    v_exp_f32 v248, v124
    v_mfma_f32_16x16x32_bf16 a[96:99], a[192:195], v[156:159], 0
    ds_read_b128 a[164:167], v205 offset:49152
    v_add_f32 v232, v232, v247
    v_mfma_f32_16x16x32_bf16 a[128:131], a[192:195], v[160:163], 0
    v_exp_f32 v249, v125
    v_mfma_f32_16x16x32_bf16 a[4:7], a[196:199], v[144:147], 0
    v_cvt_pk_bf16_f32 v172, v224, v225
    v_cvt_pk_bf16_f32 v173, v226, v227
    v_mfma_f32_16x16x32_bf16 a[36:39], a[196:199], v[148:151], 0
    buffer_load_dwordx4 v218, s[20:23], s40 offen lds
    v_cvt_pk_bf16_f32 v174, v248, v249
    v_mfma_f32_16x16x32_bf16 a[68:71], a[196:199], v[152:155], 0
    v_exp_f32 v250, v126
    v_mfma_f32_16x16x32_bf16 a[100:103], a[196:199], v[156:159], 0
    v_exp_f32 v251, v127
    v_mfma_f32_16x16x32_bf16 a[132:135], a[196:199], v[160:163], 0
    ds_read_b128 a[168:171], v206 offset:49152
    v_cvt_pk_bf16_f32 v175, v250, v251
    v_mfma_f32_16x16x32_bf16 a[8:11], a[200:203], v[144:147], 0
    v_exp_f32 v224, v112
    v_mfma_f32_16x16x32_bf16 a[40:43], a[200:203], v[148:151], 0
    v_exp_f32 v225, v113
    v_mfma_f32_16x16x32_bf16 a[72:75], a[200:203], v[152:155], 0
    v_exp_f32 v226, v114
    v_mfma_f32_16x16x32_bf16 a[104:107], a[200:203], v[156:159], 0
    ds_read_b128 a[172:175], v207 offset:49152
    v_cvt_pk_bf16_f32 v168, v224, v225
    v_mfma_f32_16x16x32_bf16 a[136:139], a[200:203], v[160:163], 0
    v_exp_f32 v227, v115
    v_mfma_f32_16x16x32_bf16 a[12:15], a[204:207], v[144:147], 0
    v_exp_f32 v248, v116
    v_mfma_f32_16x16x32_bf16 a[44:47], a[204:207], v[148:151], 0
    buffer_load_dwordx4 v219, s[20:23], s40 offen offset:1024 lds
    v_cvt_pk_bf16_f32 v169, v226, v227
    v_mfma_f32_16x16x32_bf16 a[76:79], a[204:207], v[152:155], 0
    v_exp_f32 v249, v117
    v_mfma_f32_16x16x32_bf16 a[108:111], a[204:207], v[156:159], 0
    v_exp_f32 v250, v118
    v_mfma_f32_16x16x32_bf16 a[140:143], a[204:207], v[160:163], 0
    ds_read_b128 a[176:179], v204 offset:57344
    v_cvt_pk_bf16_f32 v170, v248, v249
    v_mfma_f32_16x16x32_bf16 a[16:19], a[208:211], v[144:147], 0
    v_exp_f32 v251, v119
    v_mfma_f32_16x16x32_bf16 a[48:51], a[208:211], v[148:151], 0
    v_exp_f32 v224, v104
    v_mfma_f32_16x16x32_bf16 a[80:83], a[208:211], v[152:155], 0
    ds_read_b128 a[180:183], v205 offset:57344
    v_cvt_pk_bf16_f32 v171, v250, v251
    v_mfma_f32_16x16x32_bf16 a[112:115], a[208:211], v[156:159], 0
    v_exp_f32 v225, v105
    v_mfma_f32_16x16x32_bf16 a[144:147], a[208:211], v[160:163], 0
    v_exp_f32 v226, v106
    v_mfma_f32_16x16x32_bf16 a[20:23], a[212:215], v[144:147], 0
    v_exp_f32 v227, v107
    v_mfma_f32_16x16x32_bf16 a[52:55], a[212:215], v[148:151], 0
    ds_read_b128 a[184:187], v206 offset:57344
    v_cvt_pk_bf16_f32 v164, v224, v225
    v_mfma_f32_16x16x32_bf16 a[84:87], a[212:215], v[152:155], 0
    v_exp_f32 v248, v108
    v_mfma_f32_16x16x32_bf16 a[116:119], a[212:215], v[156:159], 0
    v_exp_f32 v249, v109
    v_mfma_f32_16x16x32_bf16 a[148:151], a[212:215], v[160:163], 0
    buffer_load_dwordx4 v216, s[16:19], s63 offen offset:2048 lds
    v_cvt_pk_bf16_f32 v165, v226, v227
    v_mfma_f32_16x16x32_bf16 a[24:27], a[216:219], v[144:147], 0
    v_exp_f32 v250, v110
    v_mfma_f32_16x16x32_bf16 a[56:59], a[216:219], v[148:151], 0
    v_exp_f32 v251, v111
    v_mfma_f32_16x16x32_bf16 a[88:91], a[216:219], v[152:155], 0
    ds_read_b128 a[188:191], v207 offset:57344
    v_cvt_pk_bf16_f32 v166, v248, v249
    v_mfma_f32_16x16x32_bf16 a[120:123], a[216:219], v[156:159], 0
    v_cvt_pk_bf16_f32 v167, v250, v251
    v_mfma_f32_16x16x32_bf16 a[152:155], a[216:219], v[160:163], 0
    v_mfma_f32_16x16x32_bf16 a[28:31], a[220:223], v[144:147], 0
    v_mfma_f32_16x16x32_bf16 a[60:63], a[220:223], v[148:151], 0
    v_mfma_f32_16x16x32_bf16 a[92:95], a[220:223], v[152:155], 0
    v_mfma_f32_16x16x32_bf16 a[124:127], a[220:223], v[156:159], 0
    buffer_load_dwordx4 v217, s[16:19], s63 offen offset:3072 lds
    v_mfma_f32_16x16x32_bf16 a[156:159], a[220:223], v[160:163], 0
    s_sub_u32 s42, s42, 1
    v_mfma_f32_16x16x32_bf16 a[240:243], v[228:231], v[144:147], 0
    s_waitcnt lgkmcnt(0)
    v_mfma_f32_16x16x32_bf16 a[244:247], v[228:231], v[148:151], 0
    v_mfma_f32_16x16x32_bf16 a[248:251], v[228:231], v[152:155], 0
    .p2align 3
Lloop5:
    v_mfma_f32_16x16x32_bf16 v[104:107], a[160:163], v[0:3], v[184:187]
    ds_read_b64_tr_b16 a[192:193], v208 offset:49152
    v_mfma_f32_16x16x32_bf16 v[112:115], a[160:163], v[16:19], v[188:191]
    v_exp_f32 v224, v96
    v_mfma_f32_16x16x32_bf16 v[120:123], a[160:163], v[32:35], v[192:195]
    ds_read_b64_tr_b16 a[194:195], v208 offset:57344
    v_mfma_f32_16x16x32_bf16 v[128:131], a[160:163], v[48:51], v[196:199]
    v_exp_f32 v225, v97
    v_mfma_f32_16x16x32_bf16 v[136:139], a[160:163], a[224:227], v[200:203]
    ds_read_b64_tr_b16 a[196:197], v209 offset:49152
    v_cvt_pk_bf16_f32 v160, v224, v225
    v_mfma_f32_16x16x32_bf16 v[104:107], a[164:167], v[4:7], v[104:107]
    v_exp_f32 v226, v98
    v_mfma_f32_16x16x32_bf16 v[112:115], a[164:167], v[20:23], v[112:115]
    ds_read_b64_tr_b16 a[198:199], v209 offset:57344
    v_add_f32 v235, v235, v234
    v_mfma_f32_16x16x32_bf16 v[120:123], a[164:167], v[36:39], v[120:123]
    v_exp_f32 v227, v99
    v_mfma_f32_16x16x32_bf16 v[128:131], a[164:167], v[52:55], v[128:131]
    ds_read_b64_tr_b16 a[200:201], v210 offset:49152
    v_add_f32 v234, v224, v225
    v_mfma_f32_16x16x32_bf16 v[136:139], a[164:167], a[228:231], v[136:139]
    v_exp_f32 v248, v100
    v_mfma_f32_16x16x32_bf16 v[104:107], a[168:171], v[8:11], v[104:107]
    ds_read_b64_tr_b16 a[202:203], v210 offset:57344
    v_cvt_pk_bf16_f32 v161, v226, v227
    v_mfma_f32_16x16x32_bf16 v[112:115], a[168:171], v[24:27], v[112:115]
    v_exp_f32 v249, v101
    v_mfma_f32_16x16x32_bf16 v[120:123], a[168:171], v[40:43], v[120:123]
    ds_read_b64_tr_b16 a[204:205], v211 offset:49152
    v_add_f32 v247, v226, v227
    v_mfma_f32_16x16x32_bf16 v[128:131], a[168:171], v[56:59], v[128:131]
    v_exp_f32 v250, v102
    v_mfma_f32_16x16x32_bf16 v[136:139], a[168:171], a[232:235], v[136:139]
    ds_read_b64_tr_b16 a[206:207], v211 offset:57344
    v_add_f32 v234, v234, v247
    v_mfma_f32_16x16x32_bf16 v[104:107], a[172:175], v[12:15], v[104:107]
    v_exp_f32 v251, v103
    v_mfma_f32_16x16x32_bf16 v[112:115], a[172:175], v[28:31], v[112:115]
    v_exp_f32 v224, v88
    v_mfma_f32_16x16x32_bf16 v[120:123], a[172:175], v[44:47], v[120:123]
    ds_read_b64_tr_b16 a[208:209], v212 offset:49152
    v_cvt_pk_bf16_f32 v162, v248, v249
    v_mfma_f32_16x16x32_bf16 v[128:131], a[172:175], v[60:63], v[128:131]
    v_exp_f32 v225, v89
    v_mfma_f32_16x16x32_bf16 v[136:139], a[172:175], a[236:239], v[136:139]
    ds_read_b64_tr_b16 a[210:211], v212 offset:57344
    v_add_f32 v247, v248, v249
    v_mfma_f32_16x16x32_bf16 v[108:111], a[176:179], v[0:3], v[184:187]
    v_exp_f32 v226, v90
    v_mfma_f32_16x16x32_bf16 v[116:119], a[176:179], v[16:19], v[188:191]
    ds_read_b64_tr_b16 a[212:213], v213 offset:49152
    v_add_f32 v234, v234, v247
    v_mfma_f32_16x16x32_bf16 v[124:127], a[176:179], v[32:35], v[192:195]
    v_exp_f32 v227, v91
    v_mfma_f32_16x16x32_bf16 v[132:135], a[176:179], v[48:51], v[196:199]
    ds_read_b64_tr_b16 a[214:215], v213 offset:57344
    v_cvt_pk_bf16_f32 v163, v250, v251
    v_mfma_f32_16x16x32_bf16 v[140:143], a[176:179], a[224:227], v[200:203]
    v_add_f32 v247, v250, v251
    v_add_f32 v234, v234, v247
    v_mfma_f32_16x16x32_bf16 v[108:111], a[180:183], v[4:7], v[108:111]
    ds_read_b64_tr_b16 a[216:217], v214 offset:49152
    v_cvt_pk_bf16_f32 v156, v224, v225
    v_mfma_f32_16x16x32_bf16 v[116:119], a[180:183], v[20:23], v[116:119]
    v_exp_f32 v248, v92
    v_mfma_f32_16x16x32_bf16 v[124:127], a[180:183], v[36:39], v[124:127]
    ds_read_b64_tr_b16 a[218:219], v214 offset:57344
    v_add_f32 v233, v233, v232
    v_mfma_f32_16x16x32_bf16 v[132:135], a[180:183], v[52:55], v[132:135]
    v_exp_f32 v249, v93
    v_mfma_f32_16x16x32_bf16 v[140:143], a[180:183], a[228:231], v[140:143]
    ds_read_b64_tr_b16 a[220:221], v215 offset:49152
    v_add_f32 v232, v224, v225
    v_mfma_f32_16x16x32_bf16 v[108:111], a[184:187], v[8:11], v[108:111]
    v_exp_f32 v250, v94
    v_mfma_f32_16x16x32_bf16 v[116:119], a[184:187], v[24:27], v[116:119]
    ds_read_b64_tr_b16 a[222:223], v215 offset:57344
    v_cvt_pk_bf16_f32 v157, v226, v227
    v_mfma_f32_16x16x32_bf16 v[124:127], a[184:187], v[40:43], v[124:127]
    v_exp_f32 v251, v95
    v_mfma_f32_16x16x32_bf16 v[132:135], a[184:187], v[56:59], v[132:135]
    v_add_f32 v247, v226, v227
    v_add_f32 v232, v232, v247
    v_mfma_f32_16x16x32_bf16 v[140:143], a[184:187], a[232:235], v[140:143]
    v_exp_f32 v224, v80
    v_mfma_f32_16x16x32_bf16 v[108:111], a[188:191], v[12:15], v[108:111]
    s_add_u32 m0, s41, 49152
    v_exp_f32 v225, v81
    v_mfma_f32_16x16x32_bf16 v[116:119], a[188:191], v[28:31], v[116:119]
    s_add_u32 s40, s40, 131072
    v_cvt_pk_bf16_f32 v158, v248, v249
    v_add_f32 v247, v248, v249
    v_mfma_f32_16x16x32_bf16 v[124:127], a[188:191], v[44:47], v[124:127]
    s_add_u32 s63, s63, 131072
    v_exp_f32 v226, v82
    v_mfma_f32_16x16x32_bf16 v[132:135], a[188:191], v[60:63], v[132:135]
    s_waitcnt vmcnt(8) lgkmcnt(0)
    v_add_f32 v232, v232, v247
    v_cvt_pk_bf16_f32 v159, v250, v251
    v_mfma_f32_16x16x32_bf16 v[140:143], a[188:191], a[236:239], v[140:143]
    s_barrier
    v_mfma_f32_16x16x32_bf16 a[0:3], a[192:195], v[164:167], a[0:3]
    ds_read_b128 a[160:163], v204 offset:0
    v_add_f32 v247, v250, v251
    v_mfma_f32_16x16x32_bf16 a[32:35], a[192:195], v[168:171], a[32:35]
    v_exp_f32 v227, v83
    v_mfma_f32_16x16x32_bf16 a[64:67], a[192:195], v[172:175], a[64:67]
    v_exp_f32 v248, v84
    v_mfma_f32_16x16x32_bf16 a[96:99], a[192:195], v[176:179], a[96:99]
    ds_read_b128 a[164:167], v205 offset:0
    v_add_f32 v232, v232, v247
    v_mfma_f32_16x16x32_bf16 a[128:131], a[192:195], v[180:183], a[128:131]
    v_exp_f32 v249, v85
    v_mfma_f32_16x16x32_bf16 a[4:7], a[196:199], v[164:167], a[4:7]
    v_cvt_pk_bf16_f32 v152, v224, v225
    v_cvt_pk_bf16_f32 v153, v226, v227
    v_mfma_f32_16x16x32_bf16 a[36:39], a[196:199], v[168:171], a[36:39]
    buffer_load_dwordx4 v218, s[20:23], s40 offen lds
    v_cvt_pk_bf16_f32 v154, v248, v249
    v_mfma_f32_16x16x32_bf16 a[68:71], a[196:199], v[172:175], a[68:71]
    v_exp_f32 v250, v86
    v_mfma_f32_16x16x32_bf16 a[100:103], a[196:199], v[176:179], a[100:103]
    v_exp_f32 v251, v87
    v_mfma_f32_16x16x32_bf16 a[132:135], a[196:199], v[180:183], a[132:135]
    ds_read_b128 a[168:171], v206 offset:0
    v_cvt_pk_bf16_f32 v155, v250, v251
    v_mfma_f32_16x16x32_bf16 a[8:11], a[200:203], v[164:167], a[8:11]
    v_exp_f32 v224, v72
    v_mfma_f32_16x16x32_bf16 a[40:43], a[200:203], v[168:171], a[40:43]
    v_exp_f32 v225, v73
    v_mfma_f32_16x16x32_bf16 a[72:75], a[200:203], v[172:175], a[72:75]
    v_exp_f32 v226, v74
    v_mfma_f32_16x16x32_bf16 a[104:107], a[200:203], v[176:179], a[104:107]
    ds_read_b128 a[172:175], v207 offset:0
    v_cvt_pk_bf16_f32 v148, v224, v225
    v_mfma_f32_16x16x32_bf16 a[136:139], a[200:203], v[180:183], a[136:139]
    v_exp_f32 v227, v75
    v_mfma_f32_16x16x32_bf16 a[12:15], a[204:207], v[164:167], a[12:15]
    v_exp_f32 v248, v76
    v_mfma_f32_16x16x32_bf16 a[44:47], a[204:207], v[168:171], a[44:47]
    buffer_load_dwordx4 v219, s[20:23], s40 offen offset:1024 lds
    v_cvt_pk_bf16_f32 v149, v226, v227
    v_mfma_f32_16x16x32_bf16 a[76:79], a[204:207], v[172:175], a[76:79]
    v_exp_f32 v249, v77
    v_mfma_f32_16x16x32_bf16 a[108:111], a[204:207], v[176:179], a[108:111]
    v_exp_f32 v250, v78
    v_mfma_f32_16x16x32_bf16 a[140:143], a[204:207], v[180:183], a[140:143]
    ds_read_b128 a[176:179], v204 offset:8192
    v_cvt_pk_bf16_f32 v150, v248, v249
    v_mfma_f32_16x16x32_bf16 a[16:19], a[208:211], v[164:167], a[16:19]
    v_exp_f32 v251, v79
    v_mfma_f32_16x16x32_bf16 a[48:51], a[208:211], v[168:171], a[48:51]
    v_exp_f32 v224, v64
    v_mfma_f32_16x16x32_bf16 a[80:83], a[208:211], v[172:175], a[80:83]
    ds_read_b128 a[180:183], v205 offset:8192
    v_cvt_pk_bf16_f32 v151, v250, v251
    v_mfma_f32_16x16x32_bf16 a[112:115], a[208:211], v[176:179], a[112:115]
    v_exp_f32 v225, v65
    v_mfma_f32_16x16x32_bf16 a[144:147], a[208:211], v[180:183], a[144:147]
    v_exp_f32 v226, v66
    v_mfma_f32_16x16x32_bf16 a[20:23], a[212:215], v[164:167], a[20:23]
    v_exp_f32 v227, v67
    v_mfma_f32_16x16x32_bf16 a[52:55], a[212:215], v[168:171], a[52:55]
    ds_read_b128 a[184:187], v206 offset:8192
    v_cvt_pk_bf16_f32 v144, v224, v225
    v_mfma_f32_16x16x32_bf16 a[84:87], a[212:215], v[172:175], a[84:87]
    v_exp_f32 v248, v68
    v_mfma_f32_16x16x32_bf16 a[116:119], a[212:215], v[176:179], a[116:119]
    v_exp_f32 v249, v69
    v_mfma_f32_16x16x32_bf16 a[148:151], a[212:215], v[180:183], a[148:151]
    buffer_load_dwordx4 v216, s[16:19], s63 offen offset:2048 lds
    v_cvt_pk_bf16_f32 v145, v226, v227
    v_mfma_f32_16x16x32_bf16 a[24:27], a[216:219], v[164:167], a[24:27]
    v_exp_f32 v250, v70
    v_mfma_f32_16x16x32_bf16 a[56:59], a[216:219], v[168:171], a[56:59]
    v_exp_f32 v251, v71
    v_mfma_f32_16x16x32_bf16 a[88:91], a[216:219], v[172:175], a[88:91]
    ds_read_b128 a[188:191], v207 offset:8192
    v_cvt_pk_bf16_f32 v146, v248, v249
    v_mfma_f32_16x16x32_bf16 a[120:123], a[216:219], v[176:179], a[120:123]
    v_cvt_pk_bf16_f32 v147, v250, v251
    v_mfma_f32_16x16x32_bf16 a[152:155], a[216:219], v[180:183], a[152:155]
    v_mfma_f32_16x16x32_bf16 a[28:31], a[220:223], v[164:167], a[28:31]
    v_mfma_f32_16x16x32_bf16 a[60:63], a[220:223], v[168:171], a[60:63]
    v_mfma_f32_16x16x32_bf16 a[92:95], a[220:223], v[172:175], a[92:95]
    v_mfma_f32_16x16x32_bf16 a[124:127], a[220:223], v[176:179], a[124:127]
    buffer_load_dwordx4 v217, s[16:19], s63 offen offset:3072 lds
    v_mfma_f32_16x16x32_bf16 a[156:159], a[220:223], v[180:183], a[156:159]
    s_sub_u32 s42, s42, 1
    v_mfma_f32_16x16x32_bf16 a[240:243], v[228:231], v[164:167], a[240:243]
    s_waitcnt lgkmcnt(0)
    v_mfma_f32_16x16x32_bf16 a[244:247], v[228:231], v[168:171], a[244:247]
    v_mfma_f32_16x16x32_bf16 a[248:251], v[228:231], v[172:175], a[248:251]
    v_mfma_f32_16x16x32_bf16 v[64:67], a[160:163], v[0:3], v[184:187]
    ds_read_b64_tr_b16 a[192:193], v208 offset:0
    v_mfma_f32_16x16x32_bf16 v[72:75], a[160:163], v[16:19], v[188:191]
    v_exp_f32 v224, v136
    v_mfma_f32_16x16x32_bf16 v[80:83], a[160:163], v[32:35], v[192:195]
    ds_read_b64_tr_b16 a[194:195], v208 offset:8192
    v_mfma_f32_16x16x32_bf16 v[88:91], a[160:163], v[48:51], v[196:199]
    v_exp_f32 v225, v137
    v_mfma_f32_16x16x32_bf16 v[96:99], a[160:163], a[224:227], v[200:203]
    ds_read_b64_tr_b16 a[196:197], v209 offset:0
    v_cvt_pk_bf16_f32 v180, v224, v225
    v_mfma_f32_16x16x32_bf16 v[64:67], a[164:167], v[4:7], v[64:67]
    v_exp_f32 v226, v138
    v_mfma_f32_16x16x32_bf16 v[72:75], a[164:167], v[20:23], v[72:75]
    ds_read_b64_tr_b16 a[198:199], v209 offset:8192
    v_add_f32 v235, v235, v234
    v_mfma_f32_16x16x32_bf16 v[80:83], a[164:167], v[36:39], v[80:83]
    v_exp_f32 v227, v139
    v_mfma_f32_16x16x32_bf16 v[88:91], a[164:167], v[52:55], v[88:91]
    ds_read_b64_tr_b16 a[200:201], v210 offset:0
    v_add_f32 v234, v224, v225
    v_mfma_f32_16x16x32_bf16 v[96:99], a[164:167], a[228:231], v[96:99]
    v_exp_f32 v248, v140
    v_mfma_f32_16x16x32_bf16 v[64:67], a[168:171], v[8:11], v[64:67]
    ds_read_b64_tr_b16 a[202:203], v210 offset:8192
    v_cvt_pk_bf16_f32 v181, v226, v227
    v_mfma_f32_16x16x32_bf16 v[72:75], a[168:171], v[24:27], v[72:75]
    v_exp_f32 v249, v141
    v_mfma_f32_16x16x32_bf16 v[80:83], a[168:171], v[40:43], v[80:83]
    ds_read_b64_tr_b16 a[204:205], v211 offset:0
    v_add_f32 v247, v226, v227
    v_mfma_f32_16x16x32_bf16 v[88:91], a[168:171], v[56:59], v[88:91]
    v_exp_f32 v250, v142
    v_mfma_f32_16x16x32_bf16 v[96:99], a[168:171], a[232:235], v[96:99]
    ds_read_b64_tr_b16 a[206:207], v211 offset:8192
    v_add_f32 v234, v234, v247
    v_mfma_f32_16x16x32_bf16 v[64:67], a[172:175], v[12:15], v[64:67]
    v_exp_f32 v251, v143
    v_mfma_f32_16x16x32_bf16 v[72:75], a[172:175], v[28:31], v[72:75]
    v_exp_f32 v224, v128
    v_mfma_f32_16x16x32_bf16 v[80:83], a[172:175], v[44:47], v[80:83]
    ds_read_b64_tr_b16 a[208:209], v212 offset:0
    v_cvt_pk_bf16_f32 v182, v248, v249
    v_mfma_f32_16x16x32_bf16 v[88:91], a[172:175], v[60:63], v[88:91]
    v_exp_f32 v225, v129
    v_mfma_f32_16x16x32_bf16 v[96:99], a[172:175], a[236:239], v[96:99]
    ds_read_b64_tr_b16 a[210:211], v212 offset:8192
    v_add_f32 v247, v248, v249
    v_mfma_f32_16x16x32_bf16 v[68:71], a[176:179], v[0:3], v[184:187]
    v_exp_f32 v226, v130
    v_mfma_f32_16x16x32_bf16 v[76:79], a[176:179], v[16:19], v[188:191]
    ds_read_b64_tr_b16 a[212:213], v213 offset:0
    v_add_f32 v234, v234, v247
    v_mfma_f32_16x16x32_bf16 v[84:87], a[176:179], v[32:35], v[192:195]
    v_exp_f32 v227, v131
    v_mfma_f32_16x16x32_bf16 v[92:95], a[176:179], v[48:51], v[196:199]
    ds_read_b64_tr_b16 a[214:215], v213 offset:8192
    v_cvt_pk_bf16_f32 v183, v250, v251
    v_mfma_f32_16x16x32_bf16 v[100:103], a[176:179], a[224:227], v[200:203]
    v_add_f32 v247, v250, v251
    v_add_f32 v234, v234, v247
    v_mfma_f32_16x16x32_bf16 v[68:71], a[180:183], v[4:7], v[68:71]
    ds_read_b64_tr_b16 a[216:217], v214 offset:0
    v_cvt_pk_bf16_f32 v176, v224, v225
    v_mfma_f32_16x16x32_bf16 v[76:79], a[180:183], v[20:23], v[76:79]
    v_exp_f32 v248, v132
    v_mfma_f32_16x16x32_bf16 v[84:87], a[180:183], v[36:39], v[84:87]
    ds_read_b64_tr_b16 a[218:219], v214 offset:8192
    v_add_f32 v233, v233, v232
    v_mfma_f32_16x16x32_bf16 v[92:95], a[180:183], v[52:55], v[92:95]
    v_exp_f32 v249, v133
    v_mfma_f32_16x16x32_bf16 v[100:103], a[180:183], a[228:231], v[100:103]
    ds_read_b64_tr_b16 a[220:221], v215 offset:0
    v_add_f32 v232, v224, v225
    v_mfma_f32_16x16x32_bf16 v[68:71], a[184:187], v[8:11], v[68:71]
    v_exp_f32 v250, v134
    v_mfma_f32_16x16x32_bf16 v[76:79], a[184:187], v[24:27], v[76:79]
    ds_read_b64_tr_b16 a[222:223], v215 offset:8192
    v_cvt_pk_bf16_f32 v177, v226, v227
    v_mfma_f32_16x16x32_bf16 v[84:87], a[184:187], v[40:43], v[84:87]
    v_exp_f32 v251, v135
    v_mfma_f32_16x16x32_bf16 v[92:95], a[184:187], v[56:59], v[92:95]
    v_add_f32 v247, v226, v227
    v_add_f32 v232, v232, v247
    v_mfma_f32_16x16x32_bf16 v[100:103], a[184:187], a[232:235], v[100:103]
    v_exp_f32 v224, v120
    v_mfma_f32_16x16x32_bf16 v[68:71], a[188:191], v[12:15], v[68:71]
    s_mov_b32 m0, s41
    v_exp_f32 v225, v121
    v_mfma_f32_16x16x32_bf16 v[76:79], a[188:191], v[28:31], v[76:79]
    s_add_u32 s40, s40, 131072
    v_cvt_pk_bf16_f32 v178, v248, v249
    v_add_f32 v247, v248, v249
    v_mfma_f32_16x16x32_bf16 v[84:87], a[188:191], v[44:47], v[84:87]
    s_add_u32 s63, s63, 131072
    v_exp_f32 v226, v122
    v_mfma_f32_16x16x32_bf16 v[92:95], a[188:191], v[60:63], v[92:95]
    s_waitcnt vmcnt(8) lgkmcnt(0)
    v_add_f32 v232, v232, v247
    v_cvt_pk_bf16_f32 v179, v250, v251
    v_mfma_f32_16x16x32_bf16 v[100:103], a[188:191], a[236:239], v[100:103]
    s_barrier
    v_mfma_f32_16x16x32_bf16 a[0:3], a[192:195], v[144:147], a[0:3]
    ds_read_b128 a[160:163], v204 offset:16384
    v_add_f32 v247, v250, v251
    v_mfma_f32_16x16x32_bf16 a[32:35], a[192:195], v[148:151], a[32:35]
    v_exp_f32 v227, v123
    v_mfma_f32_16x16x32_bf16 a[64:67], a[192:195], v[152:155], a[64:67]
    v_exp_f32 v248, v124
    v_mfma_f32_16x16x32_bf16 a[96:99], a[192:195], v[156:159], a[96:99]
    ds_read_b128 a[164:167], v205 offset:16384
    v_add_f32 v232, v232, v247
    v_mfma_f32_16x16x32_bf16 a[128:131], a[192:195], v[160:163], a[128:131]
    v_exp_f32 v249, v125
    v_mfma_f32_16x16x32_bf16 a[4:7], a[196:199], v[144:147], a[4:7]
    v_cvt_pk_bf16_f32 v172, v224, v225
    v_cvt_pk_bf16_f32 v173, v226, v227
    v_mfma_f32_16x16x32_bf16 a[36:39], a[196:199], v[148:151], a[36:39]
    buffer_load_dwordx4 v218, s[20:23], s40 offen lds
    v_cvt_pk_bf16_f32 v174, v248, v249
    v_mfma_f32_16x16x32_bf16 a[68:71], a[196:199], v[152:155], a[68:71]
    v_exp_f32 v250, v126
    v_mfma_f32_16x16x32_bf16 a[100:103], a[196:199], v[156:159], a[100:103]
    v_exp_f32 v251, v127
    v_mfma_f32_16x16x32_bf16 a[132:135], a[196:199], v[160:163], a[132:135]
    ds_read_b128 a[168:171], v206 offset:16384
    v_cvt_pk_bf16_f32 v175, v250, v251
    v_mfma_f32_16x16x32_bf16 a[8:11], a[200:203], v[144:147], a[8:11]
    v_exp_f32 v224, v112
    v_mfma_f32_16x16x32_bf16 a[40:43], a[200:203], v[148:151], a[40:43]
    v_exp_f32 v225, v113
    v_mfma_f32_16x16x32_bf16 a[72:75], a[200:203], v[152:155], a[72:75]
    v_exp_f32 v226, v114
    v_mfma_f32_16x16x32_bf16 a[104:107], a[200:203], v[156:159], a[104:107]
    ds_read_b128 a[172:175], v207 offset:16384
    v_cvt_pk_bf16_f32 v168, v224, v225
    v_mfma_f32_16x16x32_bf16 a[136:139], a[200:203], v[160:163], a[136:139]
    v_exp_f32 v227, v115
    v_mfma_f32_16x16x32_bf16 a[12:15], a[204:207], v[144:147], a[12:15]
    v_exp_f32 v248, v116
    v_mfma_f32_16x16x32_bf16 a[44:47], a[204:207], v[148:151], a[44:47]
    buffer_load_dwordx4 v219, s[20:23], s40 offen offset:1024 lds
    v_cvt_pk_bf16_f32 v169, v226, v227
    v_mfma_f32_16x16x32_bf16 a[76:79], a[204:207], v[152:155], a[76:79]
    v_exp_f32 v249, v117
    v_mfma_f32_16x16x32_bf16 a[108:111], a[204:207], v[156:159], a[108:111]
    v_exp_f32 v250, v118
    v_mfma_f32_16x16x32_bf16 a[140:143], a[204:207], v[160:163], a[140:143]
    ds_read_b128 a[176:179], v204 offset:24576
    v_cvt_pk_bf16_f32 v170, v248, v249
    v_mfma_f32_16x16x32_bf16 a[16:19], a[208:211], v[144:147], a[16:19]
    v_exp_f32 v251, v119
    v_mfma_f32_16x16x32_bf16 a[48:51], a[208:211], v[148:151], a[48:51]
    v_exp_f32 v224, v104
    v_mfma_f32_16x16x32_bf16 a[80:83], a[208:211], v[152:155], a[80:83]
    ds_read_b128 a[180:183], v205 offset:24576
    v_cvt_pk_bf16_f32 v171, v250, v251
    v_mfma_f32_16x16x32_bf16 a[112:115], a[208:211], v[156:159], a[112:115]
    v_exp_f32 v225, v105
    v_mfma_f32_16x16x32_bf16 a[144:147], a[208:211], v[160:163], a[144:147]
    v_exp_f32 v226, v106
    v_mfma_f32_16x16x32_bf16 a[20:23], a[212:215], v[144:147], a[20:23]
    v_exp_f32 v227, v107
    v_mfma_f32_16x16x32_bf16 a[52:55], a[212:215], v[148:151], a[52:55]
    ds_read_b128 a[184:187], v206 offset:24576
    v_cvt_pk_bf16_f32 v164, v224, v225
    v_mfma_f32_16x16x32_bf16 a[84:87], a[212:215], v[152:155], a[84:87]
    v_exp_f32 v248, v108
    v_mfma_f32_16x16x32_bf16 a[116:119], a[212:215], v[156:159], a[116:119]
    v_exp_f32 v249, v109
    v_mfma_f32_16x16x32_bf16 a[148:151], a[212:215], v[160:163], a[148:151]
    buffer_load_dwordx4 v216, s[16:19], s63 offen offset:2048 lds
    v_cvt_pk_bf16_f32 v165, v226, v227
    v_mfma_f32_16x16x32_bf16 a[24:27], a[216:219], v[144:147], a[24:27]
    v_exp_f32 v250, v110
    v_mfma_f32_16x16x32_bf16 a[56:59], a[216:219], v[148:151], a[56:59]
    v_exp_f32 v251, v111
    v_mfma_f32_16x16x32_bf16 a[88:91], a[216:219], v[152:155], a[88:91]
    ds_read_b128 a[188:191], v207 offset:24576
    v_cvt_pk_bf16_f32 v166, v248, v249
    v_mfma_f32_16x16x32_bf16 a[120:123], a[216:219], v[156:159], a[120:123]
    v_cvt_pk_bf16_f32 v167, v250, v251
    v_mfma_f32_16x16x32_bf16 a[152:155], a[216:219], v[160:163], a[152:155]
    v_mfma_f32_16x16x32_bf16 a[28:31], a[220:223], v[144:147], a[28:31]
    v_mfma_f32_16x16x32_bf16 a[60:63], a[220:223], v[148:151], a[60:63]
    v_mfma_f32_16x16x32_bf16 a[92:95], a[220:223], v[152:155], a[92:95]
    v_mfma_f32_16x16x32_bf16 a[124:127], a[220:223], v[156:159], a[124:127]
    buffer_load_dwordx4 v217, s[16:19], s63 offen offset:3072 lds
    v_mfma_f32_16x16x32_bf16 a[156:159], a[220:223], v[160:163], a[156:159]
    s_sub_u32 s42, s42, 1
    v_mfma_f32_16x16x32_bf16 a[240:243], v[228:231], v[144:147], a[240:243]
    s_waitcnt lgkmcnt(0)
    v_mfma_f32_16x16x32_bf16 a[244:247], v[228:231], v[148:151], a[244:247]
    v_mfma_f32_16x16x32_bf16 a[248:251], v[228:231], v[152:155], a[248:251]
    s_cbranch_scc1 Lxt5_3
    v_mfma_f32_16x16x32_bf16 v[104:107], a[160:163], v[0:3], v[184:187]
    ds_read_b64_tr_b16 a[192:193], v208 offset:16384
    v_mfma_f32_16x16x32_bf16 v[112:115], a[160:163], v[16:19], v[188:191]
    v_exp_f32 v224, v96
    v_mfma_f32_16x16x32_bf16 v[120:123], a[160:163], v[32:35], v[192:195]
    ds_read_b64_tr_b16 a[194:195], v208 offset:24576
    v_mfma_f32_16x16x32_bf16 v[128:131], a[160:163], v[48:51], v[196:199]
    v_exp_f32 v225, v97
    v_mfma_f32_16x16x32_bf16 v[136:139], a[160:163], a[224:227], v[200:203]
    ds_read_b64_tr_b16 a[196:197], v209 offset:16384
    v_cvt_pk_bf16_f32 v160, v224, v225
    v_mfma_f32_16x16x32_bf16 v[104:107], a[164:167], v[4:7], v[104:107]
    v_exp_f32 v226, v98
    v_mfma_f32_16x16x32_bf16 v[112:115], a[164:167], v[20:23], v[112:115]
    ds_read_b64_tr_b16 a[198:199], v209 offset:24576
    v_add_f32 v235, v235, v234
    v_mfma_f32_16x16x32_bf16 v[120:123], a[164:167], v[36:39], v[120:123]
    v_exp_f32 v227, v99
    v_mfma_f32_16x16x32_bf16 v[128:131], a[164:167], v[52:55], v[128:131]
    ds_read_b64_tr_b16 a[200:201], v210 offset:16384
    v_add_f32 v234, v224, v225
    v_mfma_f32_16x16x32_bf16 v[136:139], a[164:167], a[228:231], v[136:139]
    v_exp_f32 v248, v100
    v_mfma_f32_16x16x32_bf16 v[104:107], a[168:171], v[8:11], v[104:107]
    ds_read_b64_tr_b16 a[202:203], v210 offset:24576
    v_cvt_pk_bf16_f32 v161, v226, v227
    v_mfma_f32_16x16x32_bf16 v[112:115], a[168:171], v[24:27], v[112:115]
    v_exp_f32 v249, v101
    v_mfma_f32_16x16x32_bf16 v[120:123], a[168:171], v[40:43], v[120:123]
    ds_read_b64_tr_b16 a[204:205], v211 offset:16384
    v_add_f32 v247, v226, v227
    v_mfma_f32_16x16x32_bf16 v[128:131], a[168:171], v[56:59], v[128:131]
    v_exp_f32 v250, v102
    v_mfma_f32_16x16x32_bf16 v[136:139], a[168:171], a[232:235], v[136:139]
    ds_read_b64_tr_b16 a[206:207], v211 offset:24576
    v_add_f32 v234, v234, v247
    v_mfma_f32_16x16x32_bf16 v[104:107], a[172:175], v[12:15], v[104:107]
    v_exp_f32 v251, v103
    v_mfma_f32_16x16x32_bf16 v[112:115], a[172:175], v[28:31], v[112:115]
    v_exp_f32 v224, v88
    v_mfma_f32_16x16x32_bf16 v[120:123], a[172:175], v[44:47], v[120:123]
    ds_read_b64_tr_b16 a[208:209], v212 offset:16384
    v_cvt_pk_bf16_f32 v162, v248, v249
    v_mfma_f32_16x16x32_bf16 v[128:131], a[172:175], v[60:63], v[128:131]
    v_exp_f32 v225, v89
    v_mfma_f32_16x16x32_bf16 v[136:139], a[172:175], a[236:239], v[136:139]
    ds_read_b64_tr_b16 a[210:211], v212 offset:24576
    v_add_f32 v247, v248, v249
    v_mfma_f32_16x16x32_bf16 v[108:111], a[176:179], v[0:3], v[184:187]
    v_exp_f32 v226, v90
    v_mfma_f32_16x16x32_bf16 v[116:119], a[176:179], v[16:19], v[188:191]
    ds_read_b64_tr_b16 a[212:213], v213 offset:16384
    v_add_f32 v234, v234, v247
    v_mfma_f32_16x16x32_bf16 v[124:127], a[176:179], v[32:35], v[192:195]
    v_exp_f32 v227, v91
    v_mfma_f32_16x16x32_bf16 v[132:135], a[176:179], v[48:51], v[196:199]
    ds_read_b64_tr_b16 a[214:215], v213 offset:24576
    v_cvt_pk_bf16_f32 v163, v250, v251
    v_mfma_f32_16x16x32_bf16 v[140:143], a[176:179], a[224:227], v[200:203]
    v_add_f32 v247, v250, v251
    v_add_f32 v234, v234, v247
    v_mfma_f32_16x16x32_bf16 v[108:111], a[180:183], v[4:7], v[108:111]
    ds_read_b64_tr_b16 a[216:217], v214 offset:16384
    v_cvt_pk_bf16_f32 v156, v224, v225
    v_mfma_f32_16x16x32_bf16 v[116:119], a[180:183], v[20:23], v[116:119]
    v_exp_f32 v248, v92
    v_mfma_f32_16x16x32_bf16 v[124:127], a[180:183], v[36:39], v[124:127]
    ds_read_b64_tr_b16 a[218:219], v214 offset:24576
    v_add_f32 v233, v233, v232
    v_mfma_f32_16x16x32_bf16 v[132:135], a[180:183], v[52:55], v[132:135]
    v_exp_f32 v249, v93
    v_mfma_f32_16x16x32_bf16 v[140:143], a[180:183], a[228:231], v[140:143]
    ds_read_b64_tr_b16 a[220:221], v215 offset:16384
    v_add_f32 v232, v224, v225
    v_mfma_f32_16x16x32_bf16 v[108:111], a[184:187], v[8:11], v[108:111]
    v_exp_f32 v250, v94
    v_mfma_f32_16x16x32_bf16 v[116:119], a[184:187], v[24:27], v[116:119]
    ds_read_b64_tr_b16 a[222:223], v215 offset:24576
    v_cvt_pk_bf16_f32 v157, v226, v227
    v_mfma_f32_16x16x32_bf16 v[124:127], a[184:187], v[40:43], v[124:127]
    v_exp_f32 v251, v95
    v_mfma_f32_16x16x32_bf16 v[132:135], a[184:187], v[56:59], v[132:135]
    v_add_f32 v247, v226, v227
    v_add_f32 v232, v232, v247
    v_mfma_f32_16x16x32_bf16 v[140:143], a[184:187], a[232:235], v[140:143]
    v_exp_f32 v224, v80
    v_mfma_f32_16x16x32_bf16 v[108:111], a[188:191], v[12:15], v[108:111]
    s_add_u32 m0, s41, 16384
    v_exp_f32 v225, v81
    v_mfma_f32_16x16x32_bf16 v[116:119], a[188:191], v[28:31], v[116:119]
    s_add_u32 s40, s40, 131072
    v_cvt_pk_bf16_f32 v158, v248, v249
    v_add_f32 v247, v248, v249
    v_mfma_f32_16x16x32_bf16 v[124:127], a[188:191], v[44:47], v[124:127]
    s_add_u32 s63, s63, 131072
    v_exp_f32 v226, v82
    v_mfma_f32_16x16x32_bf16 v[132:135], a[188:191], v[60:63], v[132:135]
    s_waitcnt vmcnt(8) lgkmcnt(0)
    v_add_f32 v232, v232, v247
    v_cvt_pk_bf16_f32 v159, v250, v251
    v_mfma_f32_16x16x32_bf16 v[140:143], a[188:191], a[236:239], v[140:143]
    s_barrier
    v_mfma_f32_16x16x32_bf16 a[0:3], a[192:195], v[164:167], a[0:3]
    ds_read_b128 a[160:163], v204 offset:32768
    v_add_f32 v247, v250, v251
    v_mfma_f32_16x16x32_bf16 a[32:35], a[192:195], v[168:171], a[32:35]
    v_exp_f32 v227, v83
    v_mfma_f32_16x16x32_bf16 a[64:67], a[192:195], v[172:175], a[64:67]
    v_exp_f32 v248, v84
    v_mfma_f32_16x16x32_bf16 a[96:99], a[192:195], v[176:179], a[96:99]
    ds_read_b128 a[164:167], v205 offset:32768
    v_add_f32 v232, v232, v247
    v_mfma_f32_16x16x32_bf16 a[128:131], a[192:195], v[180:183], a[128:131]
    v_exp_f32 v249, v85
    v_mfma_f32_16x16x32_bf16 a[4:7], a[196:199], v[164:167], a[4:7]
    v_cvt_pk_bf16_f32 v152, v224, v225
    v_cvt_pk_bf16_f32 v153, v226, v227
    v_mfma_f32_16x16x32_bf16 a[36:39], a[196:199], v[168:171], a[36:39]
    buffer_load_dwordx4 v218, s[20:23], s40 offen lds
    v_cvt_pk_bf16_f32 v154, v248, v249
    v_mfma_f32_16x16x32_bf16 a[68:71], a[196:199], v[172:175], a[68:71]
    v_exp_f32 v250, v86
    v_mfma_f32_16x16x32_bf16 a[100:103], a[196:199], v[176:179], a[100:103]
    v_exp_f32 v251, v87
    v_mfma_f32_16x16x32_bf16 a[132:135], a[196:199], v[180:183], a[132:135]
    ds_read_b128 a[168:171], v206 offset:32768
    v_cvt_pk_bf16_f32 v155, v250, v251
    v_mfma_f32_16x16x32_bf16 a[8:11], a[200:203], v[164:167], a[8:11]
    v_exp_f32 v224, v72
    v_mfma_f32_16x16x32_bf16 a[40:43], a[200:203], v[168:171], a[40:43]
    v_exp_f32 v225, v73
    v_mfma_f32_16x16x32_bf16 a[72:75], a[200:203], v[172:175], a[72:75]
    v_exp_f32 v226, v74
    v_mfma_f32_16x16x32_bf16 a[104:107], a[200:203], v[176:179], a[104:107]
    ds_read_b128 a[172:175], v207 offset:32768
    v_cvt_pk_bf16_f32 v148, v224, v225
    v_mfma_f32_16x16x32_bf16 a[136:139], a[200:203], v[180:183], a[136:139]
    v_exp_f32 v227, v75
    v_mfma_f32_16x16x32_bf16 a[12:15], a[204:207], v[164:167], a[12:15]
    v_exp_f32 v248, v76
    v_mfma_f32_16x16x32_bf16 a[44:47], a[204:207], v[168:171], a[44:47]
    buffer_load_dwordx4 v219, s[20:23], s40 offen offset:1024 lds
    v_cvt_pk_bf16_f32 v149, v226, v227
    v_mfma_f32_16x16x32_bf16 a[76:79], a[204:207], v[172:175], a[76:79]
    v_exp_f32 v249, v77
    v_mfma_f32_16x16x32_bf16 a[108:111], a[204:207], v[176:179], a[108:111]
    v_exp_f32 v250, v78
    v_mfma_f32_16x16x32_bf16 a[140:143], a[204:207], v[180:183], a[140:143]
    ds_read_b128 a[176:179], v204 offset:40960
    v_cvt_pk_bf16_f32 v150, v248, v249
    v_mfma_f32_16x16x32_bf16 a[16:19], a[208:211], v[164:167], a[16:19]
    v_exp_f32 v251, v79
    v_mfma_f32_16x16x32_bf16 a[48:51], a[208:211], v[168:171], a[48:51]
    v_exp_f32 v224, v64
    v_mfma_f32_16x16x32_bf16 a[80:83], a[208:211], v[172:175], a[80:83]
    ds_read_b128 a[180:183], v205 offset:40960
    v_cvt_pk_bf16_f32 v151, v250, v251
    v_mfma_f32_16x16x32_bf16 a[112:115], a[208:211], v[176:179], a[112:115]
    v_exp_f32 v225, v65
    v_mfma_f32_16x16x32_bf16 a[144:147], a[208:211], v[180:183], a[144:147]
    v_exp_f32 v226, v66
    v_mfma_f32_16x16x32_bf16 a[20:23], a[212:215], v[164:167], a[20:23]
    v_exp_f32 v227, v67
    v_mfma_f32_16x16x32_bf16 a[52:55], a[212:215], v[168:171], a[52:55]
    ds_read_b128 a[184:187], v206 offset:40960
    v_cvt_pk_bf16_f32 v144, v224, v225
    v_mfma_f32_16x16x32_bf16 a[84:87], a[212:215], v[172:175], a[84:87]
    v_exp_f32 v248, v68
    v_mfma_f32_16x16x32_bf16 a[116:119], a[212:215], v[176:179], a[116:119]
    v_exp_f32 v249, v69
    v_mfma_f32_16x16x32_bf16 a[148:151], a[212:215], v[180:183], a[148:151]
    buffer_load_dwordx4 v216, s[16:19], s63 offen offset:2048 lds
    v_cvt_pk_bf16_f32 v145, v226, v227
    v_mfma_f32_16x16x32_bf16 a[24:27], a[216:219], v[164:167], a[24:27]
    v_exp_f32 v250, v70
    v_mfma_f32_16x16x32_bf16 a[56:59], a[216:219], v[168:171], a[56:59]
    v_exp_f32 v251, v71
    v_mfma_f32_16x16x32_bf16 a[88:91], a[216:219], v[172:175], a[88:91]
    ds_read_b128 a[188:191], v207 offset:40960
    v_cvt_pk_bf16_f32 v146, v248, v249
    v_mfma_f32_16x16x32_bf16 a[120:123], a[216:219], v[176:179], a[120:123]
    v_cvt_pk_bf16_f32 v147, v250, v251
    v_mfma_f32_16x16x32_bf16 a[152:155], a[216:219], v[180:183], a[152:155]
    v_mfma_f32_16x16x32_bf16 a[28:31], a[220:223], v[164:167], a[28:31]
    v_mfma_f32_16x16x32_bf16 a[60:63], a[220:223], v[168:171], a[60:63]
    v_mfma_f32_16x16x32_bf16 a[92:95], a[220:223], v[172:175], a[92:95]
    v_mfma_f32_16x16x32_bf16 a[124:127], a[220:223], v[176:179], a[124:127]
    buffer_load_dwordx4 v217, s[16:19], s63 offen offset:3072 lds
    v_mfma_f32_16x16x32_bf16 a[156:159], a[220:223], v[180:183], a[156:159]
    s_sub_u32 s42, s42, 1
    v_mfma_f32_16x16x32_bf16 a[240:243], v[228:231], v[164:167], a[240:243]
    s_waitcnt lgkmcnt(0)
    v_mfma_f32_16x16x32_bf16 a[244:247], v[228:231], v[168:171], a[244:247]
    v_mfma_f32_16x16x32_bf16 a[248:251], v[228:231], v[172:175], a[248:251]
    v_mfma_f32_16x16x32_bf16 v[64:67], a[160:163], v[0:3], v[184:187]
    ds_read_b64_tr_b16 a[192:193], v208 offset:32768
    v_mfma_f32_16x16x32_bf16 v[72:75], a[160:163], v[16:19], v[188:191]
    v_exp_f32 v224, v136
    v_mfma_f32_16x16x32_bf16 v[80:83], a[160:163], v[32:35], v[192:195]
    ds_read_b64_tr_b16 a[194:195], v208 offset:40960
    v_mfma_f32_16x16x32_bf16 v[88:91], a[160:163], v[48:51], v[196:199]
    v_exp_f32 v225, v137
    v_mfma_f32_16x16x32_bf16 v[96:99], a[160:163], a[224:227], v[200:203]
    ds_read_b64_tr_b16 a[196:197], v209 offset:32768
    v_cvt_pk_bf16_f32 v180, v224, v225
    v_mfma_f32_16x16x32_bf16 v[64:67], a[164:167], v[4:7], v[64:67]
    v_exp_f32 v226, v138
    v_mfma_f32_16x16x32_bf16 v[72:75], a[164:167], v[20:23], v[72:75]
    ds_read_b64_tr_b16 a[198:199], v209 offset:40960
    v_add_f32 v235, v235, v234
    v_mfma_f32_16x16x32_bf16 v[80:83], a[164:167], v[36:39], v[80:83]
    v_exp_f32 v227, v139
    v_mfma_f32_16x16x32_bf16 v[88:91], a[164:167], v[52:55], v[88:91]
    ds_read_b64_tr_b16 a[200:201], v210 offset:32768
    v_add_f32 v234, v224, v225
    v_mfma_f32_16x16x32_bf16 v[96:99], a[164:167], a[228:231], v[96:99]
    v_exp_f32 v248, v140
    v_mfma_f32_16x16x32_bf16 v[64:67], a[168:171], v[8:11], v[64:67]
    ds_read_b64_tr_b16 a[202:203], v210 offset:40960
    v_cvt_pk_bf16_f32 v181, v226, v227
    v_mfma_f32_16x16x32_bf16 v[72:75], a[168:171], v[24:27], v[72:75]
    v_exp_f32 v249, v141
    v_mfma_f32_16x16x32_bf16 v[80:83], a[168:171], v[40:43], v[80:83]
    ds_read_b64_tr_b16 a[204:205], v211 offset:32768
    v_add_f32 v247, v226, v227
    v_mfma_f32_16x16x32_bf16 v[88:91], a[168:171], v[56:59], v[88:91]
    v_exp_f32 v250, v142
    v_mfma_f32_16x16x32_bf16 v[96:99], a[168:171], a[232:235], v[96:99]
    ds_read_b64_tr_b16 a[206:207], v211 offset:40960
    v_add_f32 v234, v234, v247
    v_mfma_f32_16x16x32_bf16 v[64:67], a[172:175], v[12:15], v[64:67]
    v_exp_f32 v251, v143
    v_mfma_f32_16x16x32_bf16 v[72:75], a[172:175], v[28:31], v[72:75]
    v_exp_f32 v224, v128
    v_mfma_f32_16x16x32_bf16 v[80:83], a[172:175], v[44:47], v[80:83]
    ds_read_b64_tr_b16 a[208:209], v212 offset:32768
    v_cvt_pk_bf16_f32 v182, v248, v249
    v_mfma_f32_16x16x32_bf16 v[88:91], a[172:175], v[60:63], v[88:91]
    v_exp_f32 v225, v129
    v_mfma_f32_16x16x32_bf16 v[96:99], a[172:175], a[236:239], v[96:99]
    ds_read_b64_tr_b16 a[210:211], v212 offset:40960
    v_add_f32 v247, v248, v249
    v_mfma_f32_16x16x32_bf16 v[68:71], a[176:179], v[0:3], v[184:187]
    v_exp_f32 v226, v130
    v_mfma_f32_16x16x32_bf16 v[76:79], a[176:179], v[16:19], v[188:191]
    ds_read_b64_tr_b16 a[212:213], v213 offset:32768
    v_add_f32 v234, v234, v247
    v_mfma_f32_16x16x32_bf16 v[84:87], a[176:179], v[32:35], v[192:195]
    v_exp_f32 v227, v131
    v_mfma_f32_16x16x32_bf16 v[92:95], a[176:179], v[48:51], v[196:199]
    ds_read_b64_tr_b16 a[214:215], v213 offset:40960
    v_cvt_pk_bf16_f32 v183, v250, v251
    v_mfma_f32_16x16x32_bf16 v[100:103], a[176:179], a[224:227], v[200:203]
    v_add_f32 v247, v250, v251
    v_add_f32 v234, v234, v247
    v_mfma_f32_16x16x32_bf16 v[68:71], a[180:183], v[4:7], v[68:71]
    ds_read_b64_tr_b16 a[216:217], v214 offset:32768
    v_cvt_pk_bf16_f32 v176, v224, v225
    v_mfma_f32_16x16x32_bf16 v[76:79], a[180:183], v[20:23], v[76:79]
    v_exp_f32 v248, v132
    v_mfma_f32_16x16x32_bf16 v[84:87], a[180:183], v[36:39], v[84:87]
    ds_read_b64_tr_b16 a[218:219], v214 offset:40960
    v_add_f32 v233, v233, v232
    v_mfma_f32_16x16x32_bf16 v[92:95], a[180:183], v[52:55], v[92:95]
    v_exp_f32 v249, v133
    v_mfma_f32_16x16x32_bf16 v[100:103], a[180:183], a[228:231], v[100:103]
    ds_read_b64_tr_b16 a[220:221], v215 offset:32768
    v_add_f32 v232, v224, v225
    v_mfma_f32_16x16x32_bf16 v[68:71], a[184:187], v[8:11], v[68:71]
    v_exp_f32 v250, v134
    v_mfma_f32_16x16x32_bf16 v[76:79], a[184:187], v[24:27], v[76:79]
    ds_read_b64_tr_b16 a[222:223], v215 offset:40960
    v_cvt_pk_bf16_f32 v177, v226, v227
    v_mfma_f32_16x16x32_bf16 v[84:87], a[184:187], v[40:43], v[84:87]
    v_exp_f32 v251, v135
    v_mfma_f32_16x16x32_bf16 v[92:95], a[184:187], v[56:59], v[92:95]
    v_add_f32 v247, v226, v227
    v_add_f32 v232, v232, v247
    v_mfma_f32_16x16x32_bf16 v[100:103], a[184:187], a[232:235], v[100:103]
    v_exp_f32 v224, v120
    v_mfma_f32_16x16x32_bf16 v[68:71], a[188:191], v[12:15], v[68:71]
    s_add_u32 m0, s41, 32768
    v_exp_f32 v225, v121
    v_mfma_f32_16x16x32_bf16 v[76:79], a[188:191], v[28:31], v[76:79]
    s_add_u32 s40, s40, 131072
    v_cvt_pk_bf16_f32 v178, v248, v249
    v_add_f32 v247, v248, v249
    v_mfma_f32_16x16x32_bf16 v[84:87], a[188:191], v[44:47], v[84:87]
    s_add_u32 s63, s63, 131072
    v_exp_f32 v226, v122
    v_mfma_f32_16x16x32_bf16 v[92:95], a[188:191], v[60:63], v[92:95]
    s_waitcnt vmcnt(8) lgkmcnt(0)
    v_add_f32 v232, v232, v247
    v_cvt_pk_bf16_f32 v179, v250, v251
    v_mfma_f32_16x16x32_bf16 v[100:103], a[188:191], a[236:239], v[100:103]
    s_barrier
    v_mfma_f32_16x16x32_bf16 a[0:3], a[192:195], v[144:147], a[0:3]
    ds_read_b128 a[160:163], v204 offset:49152
    v_add_f32 v247, v250, v251
    v_mfma_f32_16x16x32_bf16 a[32:35], a[192:195], v[148:151], a[32:35]
    v_exp_f32 v227, v123
    v_mfma_f32_16x16x32_bf16 a[64:67], a[192:195], v[152:155], a[64:67]
    v_exp_f32 v248, v124
    v_mfma_f32_16x16x32_bf16 a[96:99], a[192:195], v[156:159], a[96:99]
    ds_read_b128 a[164:167], v205 offset:49152
    v_add_f32 v232, v232, v247
    v_mfma_f32_16x16x32_bf16 a[128:131], a[192:195], v[160:163], a[128:131]
    v_exp_f32 v249, v125
    v_mfma_f32_16x16x32_bf16 a[4:7], a[196:199], v[144:147], a[4:7]
    v_cvt_pk_bf16_f32 v172, v224, v225
    v_cvt_pk_bf16_f32 v173, v226, v227
    v_mfma_f32_16x16x32_bf16 a[36:39], a[196:199], v[148:151], a[36:39]
    buffer_load_dwordx4 v218, s[20:23], s40 offen lds
    v_cvt_pk_bf16_f32 v174, v248, v249
    v_mfma_f32_16x16x32_bf16 a[68:71], a[196:199], v[152:155], a[68:71]
    v_exp_f32 v250, v126
    v_mfma_f32_16x16x32_bf16 a[100:103], a[196:199], v[156:159], a[100:103]
    v_exp_f32 v251, v127
    v_mfma_f32_16x16x32_bf16 a[132:135], a[196:199], v[160:163], a[132:135]
    ds_read_b128 a[168:171], v206 offset:49152
    v_cvt_pk_bf16_f32 v175, v250, v251
    v_mfma_f32_16x16x32_bf16 a[8:11], a[200:203], v[144:147], a[8:11]
    v_exp_f32 v224, v112
    v_mfma_f32_16x16x32_bf16 a[40:43], a[200:203], v[148:151], a[40:43]
    v_exp_f32 v225, v113
    v_mfma_f32_16x16x32_bf16 a[72:75], a[200:203], v[152:155], a[72:75]
    v_exp_f32 v226, v114
    v_mfma_f32_16x16x32_bf16 a[104:107], a[200:203], v[156:159], a[104:107]
    ds_read_b128 a[172:175], v207 offset:49152
    v_cvt_pk_bf16_f32 v168, v224, v225
    v_mfma_f32_16x16x32_bf16 a[136:139], a[200:203], v[160:163], a[136:139]
    v_exp_f32 v227, v115
    v_mfma_f32_16x16x32_bf16 a[12:15], a[204:207], v[144:147], a[12:15]
    v_exp_f32 v248, v116
    v_mfma_f32_16x16x32_bf16 a[44:47], a[204:207], v[148:151], a[44:47]
    buffer_load_dwordx4 v219, s[20:23], s40 offen offset:1024 lds
    v_cvt_pk_bf16_f32 v169, v226, v227
    v_mfma_f32_16x16x32_bf16 a[76:79], a[204:207], v[152:155], a[76:79]
    v_exp_f32 v249, v117
    v_mfma_f32_16x16x32_bf16 a[108:111], a[204:207], v[156:159], a[108:111]
    v_exp_f32 v250, v118
    v_mfma_f32_16x16x32_bf16 a[140:143], a[204:207], v[160:163], a[140:143]
    ds_read_b128 a[176:179], v204 offset:57344
    v_cvt_pk_bf16_f32 v170, v248, v249
    v_mfma_f32_16x16x32_bf16 a[16:19], a[208:211], v[144:147], a[16:19]
    v_exp_f32 v251, v119
    v_mfma_f32_16x16x32_bf16 a[48:51], a[208:211], v[148:151], a[48:51]
    v_exp_f32 v224, v104
    v_mfma_f32_16x16x32_bf16 a[80:83], a[208:211], v[152:155], a[80:83]
    ds_read_b128 a[180:183], v205 offset:57344
    v_cvt_pk_bf16_f32 v171, v250, v251
    v_mfma_f32_16x16x32_bf16 a[112:115], a[208:211], v[156:159], a[112:115]
    v_exp_f32 v225, v105
    v_mfma_f32_16x16x32_bf16 a[144:147], a[208:211], v[160:163], a[144:147]
    v_exp_f32 v226, v106
    v_mfma_f32_16x16x32_bf16 a[20:23], a[212:215], v[144:147], a[20:23]
    v_exp_f32 v227, v107
    v_mfma_f32_16x16x32_bf16 a[52:55], a[212:215], v[148:151], a[52:55]
    ds_read_b128 a[184:187], v206 offset:57344
    v_cvt_pk_bf16_f32 v164, v224, v225
    v_mfma_f32_16x16x32_bf16 a[84:87], a[212:215], v[152:155], a[84:87]
    v_exp_f32 v248, v108
    v_mfma_f32_16x16x32_bf16 a[116:119], a[212:215], v[156:159], a[116:119]
    v_exp_f32 v249, v109
    v_mfma_f32_16x16x32_bf16 a[148:151], a[212:215], v[160:163], a[148:151]
    buffer_load_dwordx4 v216, s[16:19], s63 offen offset:2048 lds
    v_cvt_pk_bf16_f32 v165, v226, v227
    v_mfma_f32_16x16x32_bf16 a[24:27], a[216:219], v[144:147], a[24:27]
    v_exp_f32 v250, v110
    v_mfma_f32_16x16x32_bf16 a[56:59], a[216:219], v[148:151], a[56:59]
    v_exp_f32 v251, v111
    v_mfma_f32_16x16x32_bf16 a[88:91], a[216:219], v[152:155], a[88:91]
    ds_read_b128 a[188:191], v207 offset:57344
    v_cvt_pk_bf16_f32 v166, v248, v249
    v_mfma_f32_16x16x32_bf16 a[120:123], a[216:219], v[156:159], a[120:123]
    v_cvt_pk_bf16_f32 v167, v250, v251
    v_mfma_f32_16x16x32_bf16 a[152:155], a[216:219], v[160:163], a[152:155]
    v_mfma_f32_16x16x32_bf16 a[28:31], a[220:223], v[144:147], a[28:31]
    v_mfma_f32_16x16x32_bf16 a[60:63], a[220:223], v[148:151], a[60:63]
    v_mfma_f32_16x16x32_bf16 a[92:95], a[220:223], v[152:155], a[92:95]
    v_mfma_f32_16x16x32_bf16 a[124:127], a[220:223], v[156:159], a[124:127]
    buffer_load_dwordx4 v217, s[16:19], s63 offen offset:3072 lds
    v_mfma_f32_16x16x32_bf16 a[156:159], a[220:223], v[160:163], a[156:159]
    s_sub_u32 s42, s42, 1
    v_mfma_f32_16x16x32_bf16 a[240:243], v[228:231], v[144:147], a[240:243]
    s_waitcnt lgkmcnt(0)
    v_mfma_f32_16x16x32_bf16 a[244:247], v[228:231], v[148:151], a[244:247]
    v_mfma_f32_16x16x32_bf16 a[248:251], v[228:231], v[152:155], a[248:251]
    s_branch Lloop5
Lxt5_3:
Lft5_0_0:
    s_waitcnt lgkmcnt(0)
    v_mfma_f32_16x16x32_bf16 a[240:243], v[228:231], v[164:167], a[240:243]
    ds_read_b64_tr_b16 a[192:193], v208 offset:16384
    v_exp_f32 v64, v64
    v_exp_f32 v65, v65
    v_exp_f32 v66, v66
    v_exp_f32 v67, v67
    v_exp_f32 v68, v68
    v_exp_f32 v69, v69
    v_exp_f32 v70, v70
    v_exp_f32 v71, v71
    v_cvt_pk_bf16_f32 v144, v64, v65
    v_cvt_pk_bf16_f32 v145, v66, v67
    v_cvt_pk_bf16_f32 v146, v68, v69
    v_cvt_pk_bf16_f32 v147, v70, v71
    v_mfma_f32_16x16x32_bf16 a[244:247], v[228:231], v[168:171], a[244:247]
    ds_read_b64_tr_b16 a[194:195], v208 offset:24576
    v_xor_b32 v184, 0, v240
    v_mfma_f32_16x16x32_bf16 a[240:243], v[228:231], v[144:147], a[240:243]
    ds_read_b64_tr_b16 a[196:197], v209 offset:16384
    s_waitcnt vmcnt(8)
    s_barrier
    ds_read_b64_tr_b16 a[198:199], v209 offset:24576
    v_xor_b32 v185, 32, v240
    v_xor_b32 v186, 64, v240
    v_xor_b32 v187, 96, v240
    v_xor_b32 v188, 128, v240
    v_accvgpr_read_b32 v252, a240
    v_rcp_f32 v192, v252
    v_xor_b32 v189, 160, v240
    v_xor_b32 v190, 192, v240
    v_xor_b32 v191, 224, v240
    s_add_u32 s68, s56, 0
    ds_read_b64_tr_b16 a[200:201], v210 offset:16384
    ds_read_b64_tr_b16 a[202:203], v210 offset:24576
    s_waitcnt lgkmcnt(4)
    v_mfma_f32_16x16x32_bf16 a[0:3], a[192:195], v[164:167], a[0:3]
    ds_read_b64_tr_b16 a[204:205], v211 offset:16384
    ds_read_b64_tr_b16 a[206:207], v211 offset:24576
    v_mfma_f32_16x16x32_bf16 a[32:35], a[192:195], v[168:171], a[32:35]
    ds_read_b64_tr_b16 a[208:209], v212 offset:16384
    ds_read_b64_tr_b16 a[210:211], v212 offset:24576
    ds_read_b64_tr_b16 a[212:213], v213 offset:16384
    ds_read_b64_tr_b16 a[214:215], v213 offset:24576
    s_waitcnt lgkmcnt(8)
    v_mfma_f32_16x16x32_bf16 a[4:7], a[196:199], v[164:167], a[4:7]
    ds_read_b64_tr_b16 a[216:217], v214 offset:16384
    ds_read_b64_tr_b16 a[218:219], v214 offset:24576
    v_mfma_f32_16x16x32_bf16 a[36:39], a[196:199], v[168:171], a[36:39]
    ds_read_b64_tr_b16 a[220:221], v215 offset:16384
    ds_read_b64_tr_b16 a[222:223], v215 offset:24576
    ds_read_b64_tr_b16 a[160:161], v208 offset:32768
    ds_read_b64_tr_b16 a[162:163], v208 offset:40960
    s_waitcnt lgkmcnt(12)
    v_mfma_f32_16x16x32_bf16 a[8:11], a[200:203], v[164:167], a[8:11]
    ds_read_b64_tr_b16 a[164:165], v209 offset:32768
    ds_read_b64_tr_b16 a[166:167], v209 offset:40960
    s_waitcnt lgkmcnt(12)
    v_mfma_f32_16x16x32_bf16 a[12:15], a[204:207], v[164:167], a[12:15]
    ds_read_b64_tr_b16 a[168:169], v210 offset:32768
    ds_read_b64_tr_b16 a[170:171], v210 offset:40960
    s_waitcnt lgkmcnt(11)
    v_mfma_f32_16x16x32_bf16 a[16:19], a[208:211], v[164:167], a[16:19]
    ds_read_b64_tr_b16 a[172:173], v211 offset:32768
    ds_read_b64_tr_b16 a[174:175], v211 offset:40960
    s_waitcnt lgkmcnt(11)
    v_mfma_f32_16x16x32_bf16 a[20:23], a[212:215], v[164:167], a[20:23]
    ds_read_b64_tr_b16 a[176:177], v212 offset:32768
    ds_read_b64_tr_b16 a[178:179], v212 offset:40960
    s_waitcnt lgkmcnt(10)
    v_mfma_f32_16x16x32_bf16 a[24:27], a[216:219], v[164:167], a[24:27]
    ds_read_b64_tr_b16 a[180:181], v213 offset:32768
    ds_read_b64_tr_b16 a[182:183], v213 offset:40960
    v_mfma_f32_16x16x32_bf16 a[28:31], a[220:223], v[164:167], a[28:31]
    ds_read_b64_tr_b16 a[184:185], v214 offset:32768
    ds_read_b64_tr_b16 a[186:187], v214 offset:40960
    s_waitcnt lgkmcnt(10)
    v_mfma_f32_16x16x32_bf16 a[0:3], a[160:163], v[144:147], a[0:3]
    ds_read_b64_tr_b16 a[188:189], v215 offset:32768
    ds_read_b64_tr_b16 a[190:191], v215 offset:40960
    v_mfma_f32_16x16x32_bf16 a[4:7], a[164:167], v[144:147], a[4:7]
    s_add_u32 s69, s56, 65536
    v_exp_f32 v72, v72
    s_waitcnt lgkmcnt(9)
    v_mfma_f32_16x16x32_bf16 a[8:11], a[168:171], v[144:147], a[8:11]
    s_nop 0
    v_accvgpr_read_b32 v0, a0
    s_waitcnt lgkmcnt(7)
    v_mfma_f32_16x16x32_bf16 a[12:15], a[172:175], v[144:147], a[12:15]
    v_accvgpr_read_b32 v1, a1
    v_accvgpr_read_b32 v4, a4
    s_waitcnt lgkmcnt(6)
    v_mfma_f32_16x16x32_bf16 a[16:19], a[176:179], v[144:147], a[16:19]
    v_accvgpr_read_b32 v5, a5
    v_accvgpr_read_b32 v8, a8
    s_waitcnt lgkmcnt(4)
    v_mfma_f32_16x16x32_bf16 a[20:23], a[180:183], v[144:147], a[20:23]
    v_accvgpr_read_b32 v9, a9
    v_accvgpr_read_b32 v12, a12
    s_waitcnt lgkmcnt(2)
    v_mfma_f32_16x16x32_bf16 a[24:27], a[184:187], v[144:147], a[24:27]
    v_accvgpr_read_b32 v13, a13
    v_accvgpr_read_b32 v16, a16
    v_accvgpr_read_b32 v17, a17
    s_waitcnt lgkmcnt(0)
    v_mfma_f32_16x16x32_bf16 a[28:31], a[188:191], v[144:147], a[28:31]
    v_accvgpr_read_b32 v20, a20
    v_accvgpr_read_b32 v21, a21
    v_accvgpr_read_b32 v2, a2
    v_accvgpr_read_b32 v24, a24
    v_accvgpr_read_b32 v25, a25
    v_accvgpr_read_b32 v3, a3
    v_pk_mul_f32 v[0:1], v[0:1], v[192:193] op_sel_hi:[1,0]
    v_accvgpr_read_b32 v6, a6
    v_accvgpr_read_b32 v28, a28
    v_accvgpr_read_b32 v29, a29
    v_accvgpr_read_b32 v7, a7
    v_pk_mul_f32 v[4:5], v[4:5], v[192:193] op_sel_hi:[1,0]
    v_accvgpr_read_b32 v10, a10
    v_accvgpr_read_b32 v11, a11
    v_pk_mul_f32 v[8:9], v[8:9], v[192:193] op_sel_hi:[1,0]
    v_accvgpr_read_b32 v14, a14
    v_accvgpr_read_b32 v15, a15
    v_pk_mul_f32 v[12:13], v[12:13], v[192:193] op_sel_hi:[1,0]
    v_accvgpr_read_b32 v18, a18
    v_accvgpr_read_b32 v19, a19
    v_pk_mul_f32 v[16:17], v[16:17], v[192:193] op_sel_hi:[1,0]
    v_accvgpr_read_b32 v22, a22
    v_accvgpr_read_b32 v23, a23
    v_pk_mul_f32 v[20:21], v[20:21], v[192:193] op_sel_hi:[1,0]
    v_accvgpr_read_b32 v26, a26
    v_accvgpr_read_b32 v27, a27
    v_pk_mul_f32 v[24:25], v[24:25], v[192:193] op_sel_hi:[1,0]
    v_accvgpr_read_b32 v30, a30
    v_accvgpr_read_b32 v31, a31
    v_pk_mul_f32 v[28:29], v[28:29], v[192:193] op_sel_hi:[1,0]
    v_pk_mul_f32 v[2:3], v[2:3], v[192:193] op_sel_hi:[1,0]
    v_cvt_pk_bf16_f32 v0, v0, v1
    v_pk_mul_f32 v[6:7], v[6:7], v[192:193] op_sel_hi:[1,0]
    v_cvt_pk_bf16_f32 v4, v4, v5
    v_pk_mul_f32 v[10:11], v[10:11], v[192:193] op_sel_hi:[1,0]
    v_cvt_pk_bf16_f32 v8, v8, v9
    v_pk_mul_f32 v[14:15], v[14:15], v[192:193] op_sel_hi:[1,0]
    v_cvt_pk_bf16_f32 v12, v12, v13
    v_pk_mul_f32 v[18:19], v[18:19], v[192:193] op_sel_hi:[1,0]
    v_cvt_pk_bf16_f32 v16, v16, v17
    v_pk_mul_f32 v[22:23], v[22:23], v[192:193] op_sel_hi:[1,0]
    v_cvt_pk_bf16_f32 v20, v20, v21
    v_pk_mul_f32 v[26:27], v[26:27], v[192:193] op_sel_hi:[1,0]
    v_cvt_pk_bf16_f32 v24, v24, v25
    v_pk_mul_f32 v[30:31], v[30:31], v[192:193] op_sel_hi:[1,0]
    v_cvt_pk_bf16_f32 v28, v28, v29
    v_mfma_f32_16x16x32_bf16 a[40:43], a[200:203], v[168:171], a[40:43]
    v_cvt_pk_bf16_f32 v1, v2, v3
    v_cvt_pk_bf16_f32 v5, v6, v7
    v_mfma_f32_16x16x32_bf16 a[44:47], a[204:207], v[168:171], a[44:47]
    ds_write_b64 v184, v[0:1]
    v_mfma_f32_16x16x32_bf16 a[48:51], a[208:211], v[168:171], a[48:51]
    v_cvt_pk_bf16_f32 v9, v10, v11
    v_cvt_pk_bf16_f32 v13, v14, v15
    v_mfma_f32_16x16x32_bf16 a[52:55], a[212:215], v[168:171], a[52:55]
    ds_write_b64 v185, v[4:5]
    v_mfma_f32_16x16x32_bf16 a[56:59], a[216:219], v[168:171], a[56:59]
    v_cvt_pk_bf16_f32 v17, v18, v19
    v_cvt_pk_bf16_f32 v21, v22, v23
    v_mfma_f32_16x16x32_bf16 a[60:63], a[220:223], v[168:171], a[60:63]
    ds_write_b64 v186, v[8:9]
    v_cvt_pk_bf16_f32 v25, v26, v27
    v_cvt_pk_bf16_f32 v29, v30, v31
    v_exp_f32 v73, v73
    v_exp_f32 v74, v74
    v_exp_f32 v75, v75
    v_exp_f32 v76, v76
    v_exp_f32 v77, v77
    v_exp_f32 v78, v78
    v_exp_f32 v79, v79
    v_cvt_pk_bf16_f32 v148, v72, v73
    v_cvt_pk_bf16_f32 v149, v74, v75
    v_cvt_pk_bf16_f32 v150, v76, v77
    v_cvt_pk_bf16_f32 v151, v78, v79
    v_mfma_f32_16x16x32_bf16 a[248:251], v[228:231], v[172:175], a[248:251]
    ds_write_b64 v187, v[12:13]
    v_mfma_f32_16x16x32_bf16 a[244:247], v[228:231], v[148:151], a[244:247]
    ds_write_b64 v188, v[16:17]
    v_mfma_f32_16x16x32_bf16 a[32:35], a[160:163], v[148:151], a[32:35]
    ds_write_b64 v189, v[20:21]
    v_mfma_f32_16x16x32_bf16 a[36:39], a[164:167], v[148:151], a[36:39]
    ds_write_b64 v190, v[24:25]
    v_mfma_f32_16x16x32_bf16 a[40:43], a[168:171], v[148:151], a[40:43]
    ds_write_b64 v191, v[28:29]
    v_mfma_f32_16x16x32_bf16 a[44:47], a[172:175], v[148:151], a[44:47]
    ds_read_b128 a[0:3], v241 offset:0
    ds_read_b128 a[4:7], v241 offset:1024
    v_mfma_f32_16x16x32_bf16 a[48:51], a[176:179], v[148:151], a[48:51]
    ds_read_b128 a[8:11], v241 offset:2048
    v_accvgpr_read_b32 v253, a244
    v_mfma_f32_16x16x32_bf16 a[52:55], a[180:183], v[148:151], a[52:55]
    ds_read_b128 a[12:15], v241 offset:3072
    v_rcp_f32 v194, v253
    v_mfma_f32_16x16x32_bf16 a[56:59], a[184:187], v[148:151], a[56:59]
    v_accvgpr_read_b32 v32, a32
    v_accvgpr_read_b32 v33, a33
    v_mfma_f32_16x16x32_bf16 a[60:63], a[188:191], v[148:151], a[60:63]
    v_accvgpr_read_b32 v36, a36
    v_accvgpr_read_b32 v37, a37
    v_accvgpr_read_b32 v40, a40
    v_accvgpr_read_b32 v41, a41
    v_accvgpr_read_b32 v44, a44
    v_accvgpr_read_b32 v45, a45
    v_accvgpr_read_b32 v48, a48
    v_accvgpr_read_b32 v49, a49
    v_accvgpr_read_b32 v52, a52
    v_accvgpr_read_b32 v53, a53
    v_accvgpr_read_b32 v56, a56
    v_accvgpr_read_b32 v57, a57
    v_accvgpr_read_b32 v60, a60
    v_accvgpr_read_b32 v61, a61
    v_accvgpr_read_b32 v34, a34
    v_accvgpr_read_b32 v35, a35
    v_pk_mul_f32 v[32:33], v[32:33], v[194:195] op_sel_hi:[1,0]
    v_accvgpr_read_b32 v38, a38
    v_accvgpr_read_b32 v39, a39
    v_pk_mul_f32 v[36:37], v[36:37], v[194:195] op_sel_hi:[1,0]
    v_accvgpr_read_b32 v42, a42
    v_accvgpr_read_b32 v43, a43
    v_pk_mul_f32 v[40:41], v[40:41], v[194:195] op_sel_hi:[1,0]
    v_accvgpr_read_b32 v46, a46
    v_accvgpr_read_b32 v47, a47
    v_pk_mul_f32 v[44:45], v[44:45], v[194:195] op_sel_hi:[1,0]
    v_accvgpr_read_b32 v50, a50
    v_accvgpr_read_b32 v51, a51
    v_pk_mul_f32 v[48:49], v[48:49], v[194:195] op_sel_hi:[1,0]
    v_accvgpr_read_b32 v54, a54
    v_accvgpr_read_b32 v55, a55
    v_pk_mul_f32 v[52:53], v[52:53], v[194:195] op_sel_hi:[1,0]
    v_accvgpr_read_b32 v58, a58
    v_accvgpr_read_b32 v59, a59
    v_pk_mul_f32 v[56:57], v[56:57], v[194:195] op_sel_hi:[1,0]
    v_accvgpr_read_b32 v62, a62
    v_accvgpr_read_b32 v63, a63
    v_pk_mul_f32 v[60:61], v[60:61], v[194:195] op_sel_hi:[1,0]
    v_pk_mul_f32 v[34:35], v[34:35], v[194:195] op_sel_hi:[1,0]
    v_cvt_pk_bf16_f32 v32, v32, v33
    v_pk_mul_f32 v[38:39], v[38:39], v[194:195] op_sel_hi:[1,0]
    v_cvt_pk_bf16_f32 v36, v36, v37
    v_pk_mul_f32 v[42:43], v[42:43], v[194:195] op_sel_hi:[1,0]
    v_cvt_pk_bf16_f32 v40, v40, v41
    v_pk_mul_f32 v[46:47], v[46:47], v[194:195] op_sel_hi:[1,0]
    v_cvt_pk_bf16_f32 v44, v44, v45
    v_pk_mul_f32 v[50:51], v[50:51], v[194:195] op_sel_hi:[1,0]
    v_cvt_pk_bf16_f32 v48, v48, v49
    v_pk_mul_f32 v[54:55], v[54:55], v[194:195] op_sel_hi:[1,0]
    v_cvt_pk_bf16_f32 v52, v52, v53
    v_pk_mul_f32 v[58:59], v[58:59], v[194:195] op_sel_hi:[1,0]
    v_cvt_pk_bf16_f32 v56, v56, v57
    v_pk_mul_f32 v[62:63], v[62:63], v[194:195] op_sel_hi:[1,0]
    v_cvt_pk_bf16_f32 v60, v60, v61
    v_mfma_f32_16x16x32_bf16 a[64:67], a[192:195], v[172:175], a[64:67]
    s_waitcnt lgkmcnt(0)
    buffer_store_dwordx4 a[0:3], v220, s[24:27], s68 offen offset:0 sc0 sc1
    v_cvt_pk_bf16_f32 v33, v34, v35
    v_mfma_f32_16x16x32_bf16 a[68:71], a[196:199], v[172:175], a[68:71]
    ds_write_b64 v184, v[32:33]
    v_mfma_f32_16x16x32_bf16 a[72:75], a[200:203], v[172:175], a[72:75]
    v_cvt_pk_bf16_f32 v37, v38, v39
    v_cvt_pk_bf16_f32 v41, v42, v43
    v_mfma_f32_16x16x32_bf16 a[76:79], a[204:207], v[172:175], a[76:79]
    ds_write_b64 v185, v[36:37]
    v_mfma_f32_16x16x32_bf16 a[80:83], a[208:211], v[172:175], a[80:83]
    v_cvt_pk_bf16_f32 v45, v46, v47
    v_cvt_pk_bf16_f32 v49, v50, v51
    v_mfma_f32_16x16x32_bf16 a[84:87], a[212:215], v[172:175], a[84:87]
    ds_write_b64 v186, v[40:41]
    v_mfma_f32_16x16x32_bf16 a[88:91], a[216:219], v[172:175], a[88:91]
    buffer_store_dwordx4 a[4:7], v221, s[24:27], s68 offen offset:1024 sc0 sc1
    v_cvt_pk_bf16_f32 v53, v54, v55
    v_mfma_f32_16x16x32_bf16 a[92:95], a[220:223], v[172:175], a[92:95]
    ds_write_b64 v187, v[44:45]
    v_cvt_pk_bf16_f32 v57, v58, v59
    v_cvt_pk_bf16_f32 v61, v62, v63
    v_exp_f32 v80, v80
    v_exp_f32 v81, v81
    v_exp_f32 v82, v82
    v_exp_f32 v83, v83
    v_exp_f32 v84, v84
    v_exp_f32 v85, v85
    v_exp_f32 v86, v86
    v_exp_f32 v87, v87
    v_cvt_pk_bf16_f32 v152, v80, v81
    v_cvt_pk_bf16_f32 v153, v82, v83
    v_cvt_pk_bf16_f32 v154, v84, v85
    v_cvt_pk_bf16_f32 v155, v86, v87
    v_mfma_f32_16x16x32_bf16 a[96:99], a[192:195], v[176:179], a[96:99]
    buffer_store_dwordx4 a[8:11], v222, s[24:27], s68 offen offset:2048 sc0 sc1
    ds_write_b64 v188, v[48:49]
    v_mfma_f32_16x16x32_bf16 a[248:251], v[228:231], v[152:155], a[248:251]
    ds_write_b64 v189, v[52:53]
    v_mfma_f32_16x16x32_bf16 a[64:67], a[160:163], v[152:155], a[64:67]
    ds_write_b64 v190, v[56:57]
    v_mfma_f32_16x16x32_bf16 a[68:71], a[164:167], v[152:155], a[68:71]
    ds_write_b64 v191, v[60:61]
    v_mfma_f32_16x16x32_bf16 a[72:75], a[168:171], v[152:155], a[72:75]
    ds_read_b128 a[32:35], v241 offset:0
    buffer_store_dwordx4 a[12:15], v223, s[24:27], s68 offen offset:3072 sc0 sc1
    v_mfma_f32_16x16x32_bf16 a[76:79], a[172:175], v[152:155], a[76:79]
    ds_read_b128 a[36:39], v241 offset:1024
    v_accvgpr_read_b32 v254, a248
    v_mfma_f32_16x16x32_bf16 a[80:83], a[176:179], v[152:155], a[80:83]
    ds_read_b128 a[40:43], v241 offset:2048
    v_rcp_f32 v196, v254
    v_mfma_f32_16x16x32_bf16 a[84:87], a[180:183], v[152:155], a[84:87]
    ds_read_b128 a[44:47], v241 offset:3072
    v_accvgpr_read_b32 v0, a64
    v_mfma_f32_16x16x32_bf16 a[88:91], a[184:187], v[152:155], a[88:91]
    s_add_u32 s70, s56, 131072
    v_accvgpr_read_b32 v1, a65
    v_accvgpr_read_b32 v4, a68
    v_mfma_f32_16x16x32_bf16 a[92:95], a[188:191], v[152:155], a[92:95]
    v_accvgpr_read_b32 v5, a69
    v_accvgpr_read_b32 v8, a72
    v_accvgpr_read_b32 v9, a73
    v_accvgpr_read_b32 v12, a76
    v_accvgpr_read_b32 v13, a77
    v_accvgpr_read_b32 v16, a80
    v_accvgpr_read_b32 v17, a81
    v_accvgpr_read_b32 v20, a84
    v_accvgpr_read_b32 v21, a85
    v_accvgpr_read_b32 v24, a88
    v_accvgpr_read_b32 v25, a89
    v_accvgpr_read_b32 v28, a92
    v_accvgpr_read_b32 v29, a93
    v_accvgpr_read_b32 v2, a66
    v_accvgpr_read_b32 v3, a67
    v_pk_mul_f32 v[0:1], v[0:1], v[196:197] op_sel_hi:[1,0]
    v_accvgpr_read_b32 v6, a70
    v_accvgpr_read_b32 v7, a71
    v_pk_mul_f32 v[4:5], v[4:5], v[196:197] op_sel_hi:[1,0]
    v_accvgpr_read_b32 v10, a74
    v_accvgpr_read_b32 v11, a75
    v_pk_mul_f32 v[8:9], v[8:9], v[196:197] op_sel_hi:[1,0]
    v_accvgpr_read_b32 v14, a78
    v_accvgpr_read_b32 v15, a79
    v_pk_mul_f32 v[12:13], v[12:13], v[196:197] op_sel_hi:[1,0]
    v_accvgpr_read_b32 v18, a82
    v_accvgpr_read_b32 v19, a83
    v_pk_mul_f32 v[16:17], v[16:17], v[196:197] op_sel_hi:[1,0]
    v_accvgpr_read_b32 v22, a86
    v_accvgpr_read_b32 v23, a87
    v_pk_mul_f32 v[20:21], v[20:21], v[196:197] op_sel_hi:[1,0]
    v_accvgpr_read_b32 v26, a90
    v_accvgpr_read_b32 v27, a91
    v_pk_mul_f32 v[24:25], v[24:25], v[196:197] op_sel_hi:[1,0]
    v_accvgpr_read_b32 v30, a94
    v_accvgpr_read_b32 v31, a95
    v_pk_mul_f32 v[28:29], v[28:29], v[196:197] op_sel_hi:[1,0]
    v_pk_mul_f32 v[2:3], v[2:3], v[196:197] op_sel_hi:[1,0]
    v_cvt_pk_bf16_f32 v0, v0, v1
    v_pk_mul_f32 v[6:7], v[6:7], v[196:197] op_sel_hi:[1,0]
    v_cvt_pk_bf16_f32 v4, v4, v5
    v_pk_mul_f32 v[10:11], v[10:11], v[196:197] op_sel_hi:[1,0]
    v_cvt_pk_bf16_f32 v8, v8, v9
    v_pk_mul_f32 v[14:15], v[14:15], v[196:197] op_sel_hi:[1,0]
    v_cvt_pk_bf16_f32 v12, v12, v13
    v_pk_mul_f32 v[18:19], v[18:19], v[196:197] op_sel_hi:[1,0]
    v_cvt_pk_bf16_f32 v16, v16, v17
    v_pk_mul_f32 v[22:23], v[22:23], v[196:197] op_sel_hi:[1,0]
    v_cvt_pk_bf16_f32 v20, v20, v21
    v_pk_mul_f32 v[26:27], v[26:27], v[196:197] op_sel_hi:[1,0]
    v_cvt_pk_bf16_f32 v24, v24, v25
    v_pk_mul_f32 v[30:31], v[30:31], v[196:197] op_sel_hi:[1,0]
    v_cvt_pk_bf16_f32 v28, v28, v29
    v_mfma_f32_16x16x32_bf16 a[100:103], a[196:199], v[176:179], a[100:103]
    s_waitcnt lgkmcnt(0)
    buffer_store_dwordx4 a[32:35], v220, s[24:27], s69 offen offset:0 sc0 sc1
    v_cvt_pk_bf16_f32 v1, v2, v3
    v_mfma_f32_16x16x32_bf16 a[104:107], a[200:203], v[176:179], a[104:107]
    ds_write_b64 v184, v[0:1]
    v_mfma_f32_16x16x32_bf16 a[108:111], a[204:207], v[176:179], a[108:111]
    v_cvt_pk_bf16_f32 v5, v6, v7
    v_cvt_pk_bf16_f32 v9, v10, v11
    v_mfma_f32_16x16x32_bf16 a[112:115], a[208:211], v[176:179], a[112:115]
    ds_write_b64 v185, v[4:5]
    v_mfma_f32_16x16x32_bf16 a[116:119], a[212:215], v[176:179], a[116:119]
    v_cvt_pk_bf16_f32 v13, v14, v15
    v_cvt_pk_bf16_f32 v17, v18, v19
    v_mfma_f32_16x16x32_bf16 a[120:123], a[216:219], v[176:179], a[120:123]
    ds_write_b64 v186, v[8:9]
    v_mfma_f32_16x16x32_bf16 a[124:127], a[220:223], v[176:179], a[124:127]
    buffer_store_dwordx4 a[36:39], v221, s[24:27], s69 offen offset:1024 sc0 sc1
    v_cvt_pk_bf16_f32 v21, v22, v23
    v_cvt_pk_bf16_f32 v25, v26, v27
    v_cvt_pk_bf16_f32 v29, v30, v31
    v_exp_f32 v88, v88
    v_exp_f32 v89, v89
    v_exp_f32 v90, v90
    v_exp_f32 v91, v91
    v_exp_f32 v92, v92
    v_exp_f32 v93, v93
    v_exp_f32 v94, v94
    v_exp_f32 v95, v95
    v_cvt_pk_bf16_f32 v156, v88, v89
    v_cvt_pk_bf16_f32 v157, v90, v91
    v_cvt_pk_bf16_f32 v158, v92, v93
    v_cvt_pk_bf16_f32 v159, v94, v95
    v_add_f32 v88, v88, v89
    v_add_f32 v90, v90, v91
    v_mfma_f32_16x16x32_bf16 a[96:99], a[160:163], v[156:159], a[96:99]
    buffer_store_dwordx4 a[40:43], v222, s[24:27], s69 offen offset:2048 sc0 sc1
    ds_write_b64 v187, v[12:13]
    v_mfma_f32_16x16x32_bf16 a[100:103], a[164:167], v[156:159], a[100:103]
    ds_write_b64 v188, v[16:17]
    v_mfma_f32_16x16x32_bf16 a[104:107], a[168:171], v[156:159], a[104:107]
    ds_write_b64 v189, v[20:21]
    v_mfma_f32_16x16x32_bf16 a[108:111], a[172:175], v[156:159], a[108:111]
    ds_write_b64 v190, v[24:25]
    v_mfma_f32_16x16x32_bf16 a[112:115], a[176:179], v[156:159], a[112:115]
    buffer_store_dwordx4 a[44:47], v223, s[24:27], s69 offen offset:3072 sc0 sc1
    v_add_f32 v233, v233, v232
    v_mfma_f32_16x16x32_bf16 a[116:119], a[180:183], v[156:159], a[116:119]
    ds_write_b64 v191, v[28:29]
    v_mfma_f32_16x16x32_bf16 a[120:123], a[184:187], v[156:159], a[120:123]
    ds_read_b128 a[64:67], v241 offset:0
    v_add_f32 v92, v92, v93
    v_mfma_f32_16x16x32_bf16 a[124:127], a[188:191], v[156:159], a[124:127]
    ds_read_b128 a[68:71], v241 offset:1024
    v_add_f32 v94, v94, v95
    v_add_f32 v88, v88, v90
    v_add_f32 v92, v92, v94
    v_add_f32 v233, v233, v88
    v_add_f32 v255, v233, v92
    v_mov_b32 v232, v255
    v_accvgpr_read_b32 v32, a96
    v_accvgpr_read_b32 v33, a97
    v_permlane32_swap_b32 v255, v232
    v_add_f32 v255, v255, v232
    v_mov_b32 v232, v255
    v_accvgpr_read_b32 v36, a100
    v_accvgpr_read_b32 v37, a101
    v_permlane16_swap_b32 v255, v232
    v_add_f32 v255, v255, v232
    v_rcp_f32 v198, v255
    v_accvgpr_read_b32 v40, a104
    v_accvgpr_read_b32 v41, a105
    v_accvgpr_read_b32 v44, a108
    v_accvgpr_read_b32 v45, a109
    v_accvgpr_read_b32 v48, a112
    v_accvgpr_read_b32 v49, a113
    v_accvgpr_read_b32 v52, a116
    v_accvgpr_read_b32 v53, a117
    v_accvgpr_read_b32 v56, a120
    v_accvgpr_read_b32 v57, a121
    v_accvgpr_read_b32 v60, a124
    v_accvgpr_read_b32 v61, a125
    v_accvgpr_read_b32 v34, a98
    v_accvgpr_read_b32 v35, a99
    v_pk_mul_f32 v[32:33], v[32:33], v[198:199] op_sel_hi:[1,0]
    v_accvgpr_read_b32 v38, a102
    v_accvgpr_read_b32 v39, a103
    v_pk_mul_f32 v[36:37], v[36:37], v[198:199] op_sel_hi:[1,0]
    v_accvgpr_read_b32 v42, a106
    v_accvgpr_read_b32 v43, a107
    v_pk_mul_f32 v[40:41], v[40:41], v[198:199] op_sel_hi:[1,0]
    v_accvgpr_read_b32 v46, a110
    v_accvgpr_read_b32 v47, a111
    v_pk_mul_f32 v[44:45], v[44:45], v[198:199] op_sel_hi:[1,0]
    v_accvgpr_read_b32 v50, a114
    v_accvgpr_read_b32 v51, a115
    v_pk_mul_f32 v[48:49], v[48:49], v[198:199] op_sel_hi:[1,0]
    v_accvgpr_read_b32 v54, a118
    v_accvgpr_read_b32 v55, a119
    v_pk_mul_f32 v[52:53], v[52:53], v[198:199] op_sel_hi:[1,0]
    v_accvgpr_read_b32 v58, a122
    v_accvgpr_read_b32 v59, a123
    v_pk_mul_f32 v[56:57], v[56:57], v[198:199] op_sel_hi:[1,0]
    v_accvgpr_read_b32 v62, a126
    v_accvgpr_read_b32 v63, a127
    v_pk_mul_f32 v[60:61], v[60:61], v[198:199] op_sel_hi:[1,0]
    v_pk_mul_f32 v[34:35], v[34:35], v[198:199] op_sel_hi:[1,0]
    v_cvt_pk_bf16_f32 v32, v32, v33
    v_pk_mul_f32 v[38:39], v[38:39], v[198:199] op_sel_hi:[1,0]
    v_cvt_pk_bf16_f32 v36, v36, v37
    v_pk_mul_f32 v[42:43], v[42:43], v[198:199] op_sel_hi:[1,0]
    v_cvt_pk_bf16_f32 v40, v40, v41
    v_pk_mul_f32 v[46:47], v[46:47], v[198:199] op_sel_hi:[1,0]
    v_cvt_pk_bf16_f32 v44, v44, v45
    v_pk_mul_f32 v[50:51], v[50:51], v[198:199] op_sel_hi:[1,0]
    v_cvt_pk_bf16_f32 v48, v48, v49
    v_pk_mul_f32 v[54:55], v[54:55], v[198:199] op_sel_hi:[1,0]
    v_cvt_pk_bf16_f32 v52, v52, v53
    v_pk_mul_f32 v[58:59], v[58:59], v[198:199] op_sel_hi:[1,0]
    v_cvt_pk_bf16_f32 v56, v56, v57
    v_pk_mul_f32 v[62:63], v[62:63], v[198:199] op_sel_hi:[1,0]
    v_cvt_pk_bf16_f32 v60, v60, v61
    v_mfma_f32_16x16x32_bf16 a[128:131], a[192:195], v[180:183], a[128:131]
    s_waitcnt lgkmcnt(0)
    buffer_store_dwordx4 a[64:67], v220, s[24:27], s70 offen offset:0 sc0 sc1
    v_cvt_pk_bf16_f32 v33, v34, v35
    v_mfma_f32_16x16x32_bf16 a[132:135], a[196:199], v[180:183], a[132:135]
    ds_read_b128 a[72:75], v241 offset:2048
    v_cvt_pk_bf16_f32 v37, v38, v39
    v_mfma_f32_16x16x32_bf16 a[136:139], a[200:203], v[180:183], a[136:139]
    ds_read_b128 a[76:79], v241 offset:3072
    v_cvt_pk_bf16_f32 v41, v42, v43
    v_mfma_f32_16x16x32_bf16 a[140:143], a[204:207], v[180:183], a[140:143]
    ds_write_b64 v184, v[32:33]
    v_mfma_f32_16x16x32_bf16 a[144:147], a[208:211], v[180:183], a[144:147]
    s_add_u32 s71, s56, 196608
    v_cvt_pk_bf16_f32 v45, v46, v47
    v_cvt_pk_bf16_f32 v49, v50, v51
    v_mfma_f32_16x16x32_bf16 a[148:151], a[212:215], v[180:183], a[148:151]
    ds_write_b64 v185, v[36:37]
    v_mfma_f32_16x16x32_bf16 a[152:155], a[216:219], v[180:183], a[152:155]
    buffer_store_dwordx4 a[68:71], v221, s[24:27], s70 offen offset:1024 sc0 sc1
    v_cvt_pk_bf16_f32 v53, v54, v55
    v_mfma_f32_16x16x32_bf16 a[156:159], a[220:223], v[180:183], a[156:159]
    ds_write_b64 v186, v[40:41]
    v_cvt_pk_bf16_f32 v57, v58, v59
    v_cvt_pk_bf16_f32 v61, v62, v63
    v_exp_f32 v96, v96
    v_exp_f32 v97, v97
    v_exp_f32 v98, v98
    v_exp_f32 v99, v99
    v_exp_f32 v100, v100
    v_exp_f32 v101, v101
    v_exp_f32 v102, v102
    v_exp_f32 v103, v103
    v_cvt_pk_bf16_f32 v160, v96, v97
    v_cvt_pk_bf16_f32 v161, v98, v99
    v_cvt_pk_bf16_f32 v162, v100, v101
    v_cvt_pk_bf16_f32 v163, v102, v103
    v_add_f32 v96, v96, v97
    v_add_f32 v98, v98, v99
    v_mfma_f32_16x16x32_bf16 a[128:131], a[160:163], v[160:163], a[128:131]
    s_waitcnt lgkmcnt(1)
    buffer_store_dwordx4 a[72:75], v222, s[24:27], s70 offen offset:2048 sc0 sc1
    ds_write_b64 v187, v[44:45]
    v_mfma_f32_16x16x32_bf16 a[132:135], a[164:167], v[160:163], a[132:135]
    ds_write_b64 v188, v[48:49]
    v_mfma_f32_16x16x32_bf16 a[136:139], a[168:171], v[160:163], a[136:139]
    ds_write_b64 v189, v[52:53]
    v_mfma_f32_16x16x32_bf16 a[140:143], a[172:175], v[160:163], a[140:143]
    ds_write_b64 v190, v[56:57]
    v_mfma_f32_16x16x32_bf16 a[144:147], a[176:179], v[160:163], a[144:147]
    buffer_store_dwordx4 a[76:79], v223, s[24:27], s70 offen offset:3072 sc0 sc1
    v_add_f32 v235, v235, v234
    v_mfma_f32_16x16x32_bf16 a[148:151], a[180:183], v[160:163], a[148:151]
    ds_write_b64 v191, v[60:61]
    v_mfma_f32_16x16x32_bf16 a[152:155], a[184:187], v[160:163], a[152:155]
    ds_read_b128 a[96:99], v241 offset:0
    v_add_f32 v100, v100, v101
    v_mfma_f32_16x16x32_bf16 a[156:159], a[188:191], v[160:163], a[156:159]
    ds_read_b128 a[100:103], v241 offset:1024
    v_add_f32 v102, v102, v103
    v_add_f32 v96, v96, v98
    v_add_f32 v100, v100, v102
    v_add_f32 v235, v235, v96
    v_add_f32 v246, v235, v100
    v_mov_b32 v234, v246
    v_accvgpr_read_b32 v0, a128
    v_accvgpr_read_b32 v1, a129
    v_permlane32_swap_b32 v246, v234
    v_add_f32 v246, v246, v234
    v_mov_b32 v234, v246
    v_accvgpr_read_b32 v4, a132
    v_accvgpr_read_b32 v5, a133
    v_permlane16_swap_b32 v246, v234
    v_add_f32 v246, v246, v234
    v_rcp_f32 v200, v246
    v_accvgpr_read_b32 v8, a136
    v_accvgpr_read_b32 v9, a137
    v_accvgpr_read_b32 v12, a140
    v_accvgpr_read_b32 v13, a141
    v_accvgpr_read_b32 v16, a144
    v_accvgpr_read_b32 v17, a145
    v_accvgpr_read_b32 v20, a148
    v_accvgpr_read_b32 v21, a149
    v_accvgpr_read_b32 v24, a152
    v_accvgpr_read_b32 v25, a153
    v_accvgpr_read_b32 v28, a156
    v_accvgpr_read_b32 v29, a157
    v_accvgpr_read_b32 v2, a130
    v_accvgpr_read_b32 v3, a131
    v_pk_mul_f32 v[0:1], v[0:1], v[200:201] op_sel_hi:[1,0]
    v_accvgpr_read_b32 v6, a134
    v_accvgpr_read_b32 v7, a135
    v_pk_mul_f32 v[4:5], v[4:5], v[200:201] op_sel_hi:[1,0]
    v_accvgpr_read_b32 v10, a138
    v_accvgpr_read_b32 v11, a139
    v_pk_mul_f32 v[8:9], v[8:9], v[200:201] op_sel_hi:[1,0]
    v_accvgpr_read_b32 v14, a142
    v_accvgpr_read_b32 v15, a143
    v_pk_mul_f32 v[12:13], v[12:13], v[200:201] op_sel_hi:[1,0]
    v_accvgpr_read_b32 v18, a146
    v_accvgpr_read_b32 v19, a147
    v_pk_mul_f32 v[16:17], v[16:17], v[200:201] op_sel_hi:[1,0]
    v_accvgpr_read_b32 v22, a150
    v_accvgpr_read_b32 v23, a151
    v_pk_mul_f32 v[20:21], v[20:21], v[200:201] op_sel_hi:[1,0]
    v_accvgpr_read_b32 v26, a154
    v_accvgpr_read_b32 v27, a155
    v_pk_mul_f32 v[24:25], v[24:25], v[200:201] op_sel_hi:[1,0]
    v_accvgpr_read_b32 v30, a158
    v_accvgpr_read_b32 v31, a159
    v_pk_mul_f32 v[28:29], v[28:29], v[200:201] op_sel_hi:[1,0]
    v_pk_mul_f32 v[2:3], v[2:3], v[200:201] op_sel_hi:[1,0]
    v_cvt_pk_bf16_f32 v0, v0, v1
    v_pk_mul_f32 v[6:7], v[6:7], v[200:201] op_sel_hi:[1,0]
    v_cvt_pk_bf16_f32 v4, v4, v5
    v_pk_mul_f32 v[10:11], v[10:11], v[200:201] op_sel_hi:[1,0]
    v_cvt_pk_bf16_f32 v8, v8, v9
    v_pk_mul_f32 v[14:15], v[14:15], v[200:201] op_sel_hi:[1,0]
    v_cvt_pk_bf16_f32 v12, v12, v13
    v_pk_mul_f32 v[18:19], v[18:19], v[200:201] op_sel_hi:[1,0]
    v_cvt_pk_bf16_f32 v16, v16, v17
    v_pk_mul_f32 v[22:23], v[22:23], v[200:201] op_sel_hi:[1,0]
    v_cvt_pk_bf16_f32 v20, v20, v21
    v_pk_mul_f32 v[26:27], v[26:27], v[200:201] op_sel_hi:[1,0]
    v_cvt_pk_bf16_f32 v24, v24, v25
    v_pk_mul_f32 v[30:31], v[30:31], v[200:201] op_sel_hi:[1,0]
    v_cvt_pk_bf16_f32 v28, v28, v29
    v_cvt_pk_bf16_f32 v1, v2, v3
    v_cvt_pk_bf16_f32 v5, v6, v7
    v_cvt_pk_bf16_f32 v9, v10, v11
    v_cvt_pk_bf16_f32 v13, v14, v15
    v_cvt_pk_bf16_f32 v17, v18, v19
    v_cvt_pk_bf16_f32 v21, v22, v23
    v_cvt_pk_bf16_f32 v25, v26, v27
    v_cvt_pk_bf16_f32 v29, v30, v31
    v_max3_f32 v237, v252, v253, v254
    v_max3_f32 v237, v237, v255, v246
    v_cmp_le_f32 vcc, s66, v237
    s_or_b32 s74, vcc_lo, vcc_hi
    s_waitcnt lgkmcnt(0)
    buffer_store_dwordx4 a[96:99], v220, s[24:27], s71 offen offset:0 sc0 sc1
    ds_read_b128 a[104:107], v241 offset:2048
    s_add_u32 s72, s56, 262144
    ds_read_b128 a[108:111], v241 offset:3072
    v_mov_b32 v237, s74
    ds_write_b64 v184, v[0:1]
    ds_write_b64 v185, v[4:5]
    ds_write_b64 v186, v[8:9]
    buffer_store_dwordx4 a[100:103], v221, s[24:27], s71 offen offset:1024 sc0 sc1
    ds_write_b64 v187, v[12:13]
    ds_write_b64 v188, v[16:17]
    ds_write_b64 v189, v[20:21]
    ds_write_b64 v190, v[24:25]
    s_waitcnt lgkmcnt(5)
    buffer_store_dwordx4 a[104:107], v222, s[24:27], s71 offen offset:2048 sc0 sc1
    ds_write_b64 v191, v[28:29]
    ds_read_b128 a[128:131], v241 offset:0
    ds_read_b128 a[132:135], v241 offset:1024
    ds_write_b32 v239, v237 offset:16384
    ds_read_b128 a[136:139], v241 offset:2048
    ds_read_b128 a[140:143], v241 offset:3072
    buffer_store_dwordx4 a[108:111], v223, s[24:27], s71 offen offset:3072 sc0 sc1
    s_waitcnt lgkmcnt(1)
    s_barrier
    buffer_store_dwordx4 a[128:131], v220, s[24:27], s72 offen offset:0 sc0 sc1
    ds_read_b32 v244, v236
    buffer_store_dwordx4 a[132:135], v221, s[24:27], s72 offen offset:1024 sc0 sc1
    s_waitcnt lgkmcnt(0)
    v_cmp_ne_u32 vcc, 0, v244
    buffer_store_dwordx4 a[136:139], v222, s[24:27], s72 offen offset:2048 sc0 sc1
    buffer_store_dwordx4 a[140:143], v223, s[24:27], s72 offen offset:3072 sc0 sc1
    s_cbranch_vccnz Lrestart
    s_endpgm
Lpro3:
    s_add_u32 m0, s3, 8192
    s_add_u32 s61, s56, 131072
    buffer_load_dwordx4 v220, s[8:11], s61 offen offset:0 nt lds
    v_xor_b32 v252, 0, v239
    v_add_u32 v176, 8, v252
    v_xor_b32 v254, 128, v239
    v_add_u32 v178, 8, v254
    v_xor_b32 v253, 64, v239
    v_add_u32 v177, 8, v253
    v_xor_b32 v255, 192, v239
    v_add_u32 v179, 8, v255
    v_mul_u32_u24 v172, 15875, v238
    v_mul_u32_u24 v173, 15875, v243
    v_mul_u32_u24 v174, 47576, v238
    v_mul_u32_u24 v175, 47576, v243
    v_sub_u32 v244, s54, v242
    v_cmp_lt_i32 s[68:69], 0, v244
    v_cmp_lt_i32 s[70:71], 1, v244
    v_cmp_lt_i32 s[72:73], 2, v244
    v_cmp_lt_i32 s[74:75], 3, v244
    v_mov_b32 v245, s46
    v_cndmask_b32 v164, v245, 0, s[68:69]
    v_cndmask_b32 v165, v245, 0, s[70:71]
    v_cndmask_b32 v166, v245, 0, s[72:73]
    v_cndmask_b32 v167, v245, 0, s[74:75]
    v_cmp_lt_i32 s[68:69], 16, v244
    v_cmp_lt_i32 s[70:71], 17, v244
    v_cmp_lt_i32 s[72:73], 18, v244
    v_cmp_lt_i32 s[74:75], 19, v244
    v_cndmask_b32 v168, v245, 0, s[68:69]
    v_cndmask_b32 v169, v245, 0, s[70:71]
    v_cndmask_b32 v170, v245, 0, s[72:73]
    v_cndmask_b32 v171, v245, 0, s[74:75]
    buffer_load_dwordx4 v221, s[8:11], s61 offen offset:1024 nt lds
    buffer_load_dwordx4 v222, s[8:11], s61 offen offset:2048 nt lds
    buffer_load_dwordx4 v223, s[8:11], s61 offen offset:3072 nt lds
    s_cmp_eq_u32 s64, 0
    s_cbranch_scc1 Lw5287036
    s_waitcnt vmcnt(10)
Lw5287036:
    ds_read2st64_b64 a[4:7], v176 offset0:0 offset1:0
    s_barrier
    ds_read2st64_b64 a[0:3], v252 offset0:0 offset1:0
    ds_read2st64_b64 a[20:23], v178 offset0:0 offset1:0
    ds_read2st64_b64 a[8:11], v253 offset0:0 offset1:0
    ds_read2st64_b64 a[12:15], v177 offset0:0 offset1:0
    ds_read2st64_b64 a[16:19], v254 offset0:0 offset1:0
    ds_read_b128 a[176:179], v204 offset:8192
    ds_read2st64_b64 a[24:27], v255 offset0:0 offset1:0
    ds_read2st64_b64 a[28:31], v179 offset0:0 offset1:0
    ds_read_b128 a[180:183], v205 offset:8192
    ds_read_b128 a[184:187], v206 offset:8192
    s_waitcnt lgkmcnt(10)
    v_mfma_f32_16x16x32_bf16 v[68:71], v[172:175], a[4:7], 0
    ds_read_b128 a[188:191], v207 offset:8192
    ds_read_b128 a[160:163], v204 offset:0
    ds_read_b128 a[164:167], v205 offset:0
    ds_read_b128 a[168:171], v206 offset:0
    s_waitcnt lgkmcnt(12)
    v_mfma_f32_16x16x32_bf16 v[64:67], v[172:175], a[0:3], 0
    ds_read_b128 a[172:175], v207 offset:0
    s_nop 0
    v_cvt_pk_bf16_f32 v2, v68, v69
    s_waitcnt lgkmcnt(10)
    v_mfma_f32_16x16x32_bf16 v[104:107], v[172:175], a[8:11], 0
    v_cvt_pk_bf16_f32 v3, v70, v71
    v_mfma_f32_16x16x32_bf16 v[68:71], v[172:175], a[20:23], 0
    s_nop 0
    v_cvt_pk_bf16_f32 v0, v64, v65
    v_mfma_f32_16x16x32_bf16 v[108:111], v[172:175], a[12:15], 0
    v_cvt_pk_bf16_f32 v1, v66, v67
    v_mfma_f32_16x16x32_bf16 v[64:67], v[172:175], a[16:19], 0
    s_nop 0
    v_cvt_pk_bf16_f32 v4, v104, v105
    v_cvt_pk_bf16_f32 v5, v106, v107
    s_waitcnt lgkmcnt(3)
    v_mfma_f32_16x16x32_bf16 v[104:107], v[172:175], a[24:27], 0
    v_cvt_pk_bf16_f32 v10, v68, v69
    v_cvt_pk_bf16_f32 v11, v70, v71
    v_mfma_f32_16x16x32_bf16 v[68:71], a[176:179], v[0:3], v[168:171]
    v_cvt_pk_bf16_f32 v6, v108, v109
    v_cvt_pk_bf16_f32 v7, v110, v111
    v_mfma_f32_16x16x32_bf16 v[108:111], v[172:175], a[28:31], 0
    v_cvt_pk_bf16_f32 v8, v64, v65
    v_cvt_pk_bf16_f32 v9, v66, v67
    v_mfma_f32_16x16x32_bf16 v[68:71], a[180:183], v[4:7], v[68:71]
    v_cvt_pk_bf16_f32 v12, v104, v105
    v_cvt_pk_bf16_f32 v13, v106, v107
    v_mfma_f32_16x16x32_bf16 v[68:71], a[184:187], v[8:11], v[68:71]
    s_nop 1
    v_cvt_pk_bf16_f32 v14, v108, v109
    v_mfma_f32_16x16x32_bf16 v[64:67], a[160:163], v[0:3], v[164:167]
    v_cvt_pk_bf16_f32 v15, v110, v111
    s_waitcnt lgkmcnt(0)
    v_mfma_f32_16x16x32_bf16 v[64:67], a[164:167], v[4:7], v[64:67]
    v_mfma_f32_16x16x32_bf16 v[68:71], a[188:191], v[12:15], v[68:71]
    s_cmp_eq_u32 s64, 0
    s_cbranch_scc1 Lw5287109
    s_waitcnt vmcnt(4)
Lw5287109:
    ds_read2st64_b64 a[32:35], v252 offset0:8 offset1:8
    v_mfma_f32_16x16x32_bf16 v[64:67], a[168:171], v[8:11], v[64:67]
    ds_read2st64_b64 a[36:39], v176 offset0:8 offset1:8
    s_barrier
    v_mfma_f32_16x16x32_bf16 v[64:67], a[172:175], v[12:15], v[64:67]
    s_add_u32 m0, s41, 32768
    ds_read2st64_b64 a[48:51], v254 offset0:8 offset1:8
    s_add_u32 s61, s36, 131072
    buffer_load_dwordx4 v216, s[16:19], s61 offen offset:2048 lds
    ds_read2st64_b64 a[52:55], v178 offset0:8 offset1:8
    ds_read2st64_b64 a[40:43], v253 offset0:8 offset1:8
    ds_read2st64_b64 a[44:47], v177 offset0:8 offset1:8
    ds_read2st64_b64 a[56:59], v255 offset0:8 offset1:8
    v_max3_f32 v246, v64, v65, v66
    v_max3_f32 v246, v246, v67, v68
    v_max3_f32 v246, v246, v69, v70
    v_max_f32 v246, v246, v71
    s_waitcnt lgkmcnt(6)
    v_mfma_f32_16x16x32_bf16 v[72:75], v[172:175], a[32:35], 0
    buffer_load_dwordx4 v217, s[16:19], s61 offen offset:3072 lds
    s_add_u32 m0, s41, 32768
    s_waitcnt lgkmcnt(5)
    v_mfma_f32_16x16x32_bf16 v[76:79], v[172:175], a[36:39], 0
    s_add_u32 s61, s36, 262144
    ds_read2st64_b64 a[60:63], v179 offset0:8 offset1:8
    v_mov_b32 v247, v246
    s_nop 0
    v_cvt_pk_bf16_f32 v16, v72, v73
    v_cvt_pk_bf16_f32 v17, v74, v75
    v_permlane32_swap_b32 v246, v247
    v_max_f32 v246, v246, v247
    s_waitcnt lgkmcnt(5)
    v_mfma_f32_16x16x32_bf16 v[72:75], v[172:175], a[48:51], 0
    buffer_load_dwordx4 v218, s[20:23], s43 offen lds
    v_cvt_pk_bf16_f32 v18, v76, v77
    v_cvt_pk_bf16_f32 v19, v78, v79
    s_waitcnt lgkmcnt(2)
    v_mfma_f32_16x16x32_bf16 v[76:79], v[172:175], a[52:55], 0
    ds_read_b128 a[192:195], v204 offset:16384
    v_mov_b32 v247, v246
    v_mfma_f32_16x16x32_bf16 v[112:115], v[172:175], a[40:43], 0
    ds_read_b128 a[208:211], v204 offset:24576
    v_cvt_pk_bf16_f32 v24, v72, v73
    v_mfma_f32_16x16x32_bf16 v[116:119], v[172:175], a[44:47], 0
    ds_read_b128 a[196:199], v205 offset:16384
    v_cvt_pk_bf16_f32 v25, v74, v75
    v_mfma_f32_16x16x32_bf16 v[72:75], a[160:163], v[16:19], v[164:167]
    ds_read_b128 a[212:215], v205 offset:24576
    v_cvt_pk_bf16_f32 v26, v76, v77
    v_cvt_pk_bf16_f32 v27, v78, v79
    v_mfma_f32_16x16x32_bf16 v[76:79], a[176:179], v[16:19], v[168:171]
    buffer_load_dwordx4 v219, s[20:23], s43 offen offset:1024 lds
    v_cvt_pk_bf16_f32 v20, v112, v113
    v_cvt_pk_bf16_f32 v21, v114, v115
    s_waitcnt lgkmcnt(4)
    v_mfma_f32_16x16x32_bf16 v[112:115], v[172:175], a[56:59], 0
    s_add_u32 m0, s41, 49152
    ds_read_b128 a[200:203], v206 offset:16384
    v_cvt_pk_bf16_f32 v22, v116, v117
    v_cvt_pk_bf16_f32 v23, v118, v119
    v_mfma_f32_16x16x32_bf16 v[116:119], v[172:175], a[60:63], 0
    ds_read_b128 a[216:219], v206 offset:24576
    v_permlane16_swap_b32 v246, v247
    v_mfma_f32_16x16x32_bf16 v[72:75], a[164:167], v[20:23], v[72:75]
    ds_read_b128 a[204:207], v207 offset:16384
    v_cvt_pk_bf16_f32 v28, v112, v113
    v_mfma_f32_16x16x32_bf16 v[76:79], a[180:183], v[20:23], v[76:79]
    ds_read_b128 a[220:223], v207 offset:24576
    v_cvt_pk_bf16_f32 v29, v114, v115
    v_mfma_f32_16x16x32_bf16 v[72:75], a[168:171], v[24:27], v[72:75]
    buffer_load_dwordx4 v216, s[16:19], s61 offen offset:2048 lds
    v_cvt_pk_bf16_f32 v30, v116, v117
    v_mfma_f32_16x16x32_bf16 v[76:79], a[184:187], v[24:27], v[76:79]
    v_cvt_pk_bf16_f32 v31, v118, v119
    v_max_f32 v246, v246, v247
    v_add_f32 v246, s44, v246
    v_mfma_f32_16x16x32_bf16 v[72:75], a[172:175], v[28:31], v[72:75]
    v_sub_f32 v184, 0, v246
    v_sub_f32 v185, 0, v246
    v_mfma_f32_16x16x32_bf16 v[76:79], a[188:191], v[28:31], v[76:79]
    v_sub_f32 v186, 0, v246
    v_sub_f32 v187, 0, v246
    v_sub_f32 v64, v64, v246
    v_sub_f32 v65, v65, v246
    s_waitcnt lgkmcnt(2)
    v_mfma_f32_16x16x32_bf16 v[104:107], a[192:195], v[0:3], v[184:187]
    buffer_load_dwordx4 v217, s[16:19], s61 offen offset:3072 lds
    v_max3_f32 v244, v72, v73, v74
    v_mfma_f32_16x16x32_bf16 v[108:111], a[208:211], v[0:3], v[184:187]
    s_add_u32 m0, s41, 49152
    v_max3_f32 v244, v244, v75, v76
    v_max3_f32 v244, v244, v77, v78
    v_mfma_f32_16x16x32_bf16 v[104:107], a[196:199], v[4:7], v[104:107]
    v_max_f32 v244, v244, v79
    v_mov_b32 v245, v244
    v_mfma_f32_16x16x32_bf16 v[108:111], a[212:215], v[4:7], v[108:111]
    v_sub_f32 v66, v66, v246
    v_permlane32_swap_b32 v244, v245
    v_mfma_f32_16x16x32_bf16 v[104:107], a[200:203], v[8:11], v[104:107]
    buffer_load_dwordx4 v218, s[20:23], s36 offen lds
    v_sub_f32 v67, v67, v246
    v_mfma_f32_16x16x32_bf16 v[108:111], a[216:219], v[8:11], v[108:111]
    v_max_f32 v244, v244, v245
    v_exp_f32 v224, v64
    s_waitcnt lgkmcnt(0)
    v_mfma_f32_16x16x32_bf16 v[104:107], a[204:207], v[12:15], v[104:107]
    v_exp_f32 v225, v65
    v_mfma_f32_16x16x32_bf16 v[108:111], a[220:223], v[12:15], v[108:111]
    v_exp_f32 v226, v66
    v_exp_f32 v227, v67
    v_mov_b32 v245, v244
    v_sub_f32 v68, v68, v246
    v_sub_f32 v69, v69, v246
    v_sub_f32 v70, v70, v246
    v_sub_f32 v71, v71, v246
    v_cvt_pk_bf16_f32 v144, v224, v225
    v_cvt_pk_bf16_f32 v145, v226, v227
    v_permlane16_swap_b32 v244, v245
    v_exp_f32 v224, v68
    v_exp_f32 v225, v69
    v_exp_f32 v226, v70
    v_exp_f32 v227, v71
    v_max_f32 v244, v244, v245
    v_add_f32 v244, s44, v244
    v_cvt_pk_bf16_f32 v146, v224, v225
    v_cvt_pk_bf16_f32 v147, v226, v227
    v_sub_f32 v188, 0, v244
    v_sub_f32 v189, 0, v244
    v_sub_f32 v190, 0, v244
    v_sub_f32 v191, 0, v244
    v_sub_f32 v72, v72, v244
    v_sub_f32 v73, v73, v244
    v_mfma_f32_16x16x32_bf16 v[112:115], a[192:195], v[16:19], v[188:191]
    buffer_load_dwordx4 v219, s[20:23], s36 offen offset:1024 lds
    v_sub_f32 v74, v74, v244
    v_mfma_f32_16x16x32_bf16 v[116:119], a[208:211], v[16:19], v[188:191]
    v_sub_f32 v75, v75, v244
    v_sub_f32 v76, v76, v244
    v_mfma_f32_16x16x32_bf16 v[112:115], a[196:199], v[20:23], v[112:115]
    v_sub_f32 v77, v77, v244
    v_sub_f32 v78, v78, v244
    v_mfma_f32_16x16x32_bf16 v[116:119], a[212:215], v[20:23], v[116:119]
    v_sub_f32 v79, v79, v244
    s_waitcnt vmcnt(8)
    v_mfma_f32_16x16x32_bf16 v[112:115], a[200:203], v[24:27], v[112:115]
    ds_read2st64_b64 a[64:67], v252 offset0:16 offset1:16
    s_barrier
    v_mfma_f32_16x16x32_bf16 v[116:119], a[216:219], v[24:27], v[116:119]
    s_mov_b32 m0, s41
    ds_read2st64_b64 a[68:71], v176 offset0:16 offset1:16
    s_add_u32 s40, s40, 131072
    v_mfma_f32_16x16x32_bf16 v[112:115], a[204:207], v[28:31], v[112:115]
    s_add_u32 s63, s63, 131072
    ds_read2st64_b64 a[80:83], v254 offset0:16 offset1:16
    v_exp_f32 v248, v72
    v_mfma_f32_16x16x32_bf16 v[116:119], a[220:223], v[28:31], v[116:119]
    ds_read2st64_b64 a[84:87], v178 offset0:16 offset1:16
    v_exp_f32 v249, v73
    v_exp_f32 v250, v74
    v_exp_f32 v251, v75
    v_cvt_pk_bf16_f32 v148, v248, v249
    v_cvt_pk_bf16_f32 v149, v250, v251
    s_waitcnt lgkmcnt(3)
    v_mfma_f32_16x16x32_bf16 v[80:83], v[172:175], a[64:67], 0
    ds_read2st64_b64 a[72:75], v253 offset0:16 offset1:16
    v_exp_f32 v248, v76
    v_exp_f32 v249, v77
    v_exp_f32 v250, v78
    v_exp_f32 v251, v79
    v_cvt_pk_bf16_f32 v150, v248, v249
    s_waitcnt lgkmcnt(3)
    v_mfma_f32_16x16x32_bf16 v[84:87], v[172:175], a[68:71], 0
    ds_read2st64_b64 a[76:79], v177 offset0:16 offset1:16
    v_cvt_pk_bf16_f32 v32, v80, v81
    v_cvt_pk_bf16_f32 v33, v82, v83
    s_waitcnt lgkmcnt(3)
    v_mfma_f32_16x16x32_bf16 v[80:83], v[172:175], a[80:83], 0
    ds_read2st64_b64 a[88:91], v255 offset0:16 offset1:16
    v_cvt_pk_bf16_f32 v151, v250, v251
    s_nop 0
    v_cvt_pk_bf16_f32 v34, v84, v85
    v_cvt_pk_bf16_f32 v35, v86, v87
    s_waitcnt lgkmcnt(3)
    v_mfma_f32_16x16x32_bf16 v[84:87], v[172:175], a[84:87], 0
    ds_read2st64_b64 a[92:95], v179 offset0:16 offset1:16
    v_cvt_pk_bf16_f32 v40, v80, v81
    v_cvt_pk_bf16_f32 v41, v82, v83
    v_mfma_f32_16x16x32_bf16 v[80:83], a[160:163], v[32:35], v[164:167]
    buffer_load_dwordx4 v218, s[20:23], s40 offen lds
    s_waitcnt lgkmcnt(3)
    v_mfma_f32_16x16x32_bf16 v[120:123], v[172:175], a[72:75], 0
    s_nop 0
    v_cvt_pk_bf16_f32 v42, v84, v85
    v_cvt_pk_bf16_f32 v43, v86, v87
    v_mfma_f32_16x16x32_bf16 v[84:87], a[176:179], v[32:35], v[168:171]
    s_waitcnt lgkmcnt(2)
    v_mfma_f32_16x16x32_bf16 v[124:127], v[172:175], a[76:79], 0
    buffer_load_dwordx4 v219, s[20:23], s40 offen offset:1024 lds
    s_add_u32 s40, s40, 131072
    v_cvt_pk_bf16_f32 v36, v120, v121
    v_cvt_pk_bf16_f32 v37, v122, v123
    s_waitcnt lgkmcnt(1)
    v_mfma_f32_16x16x32_bf16 v[120:123], v[172:175], a[88:91], 0
    s_nop 1
    v_cvt_pk_bf16_f32 v38, v124, v125
    v_cvt_pk_bf16_f32 v39, v126, v127
    s_waitcnt lgkmcnt(0)
    v_mfma_f32_16x16x32_bf16 v[124:127], v[172:175], a[92:95], 0
    buffer_load_dwordx4 v216, s[16:19], s63 offen offset:2048 lds
    v_mfma_f32_16x16x32_bf16 v[80:83], a[164:167], v[36:39], v[80:83]
    v_cvt_pk_bf16_f32 v44, v120, v121
    v_cvt_pk_bf16_f32 v45, v122, v123
    v_mfma_f32_16x16x32_bf16 v[84:87], a[180:183], v[36:39], v[84:87]
    v_mfma_f32_16x16x32_bf16 v[80:83], a[168:171], v[40:43], v[80:83]
    v_mfma_f32_16x16x32_bf16 v[84:87], a[184:187], v[40:43], v[84:87]
    buffer_load_dwordx4 v217, s[16:19], s63 offen offset:3072 lds
    v_cvt_pk_bf16_f32 v46, v124, v125
    v_cvt_pk_bf16_f32 v47, v126, v127
    s_add_u32 m0, s41, 16384
    s_add_u32 s63, s63, 131072
    v_mfma_f32_16x16x32_bf16 v[80:83], a[172:175], v[44:47], v[80:83]
    v_mfma_f32_16x16x32_bf16 v[84:87], a[188:191], v[44:47], v[84:87]
    buffer_load_dwordx4 v218, s[20:23], s40 offen lds
    s_nop 5
    v_max3_f32 v246, v80, v81, v82
    v_max3_f32 v246, v246, v83, v84
    v_max3_f32 v246, v246, v85, v86
    v_max_f32 v246, v246, v87
    v_mov_b32 v247, v246
    s_nop 1
    v_permlane32_swap_b32 v246, v247
    v_max_f32 v246, v246, v247
    v_mov_b32 v247, v246
    s_nop 1
    v_permlane16_swap_b32 v246, v247
    v_max_f32 v246, v246, v247
    v_add_f32 v246, s44, v246
    v_sub_f32 v192, 0, v246
    v_sub_f32 v193, 0, v246
    v_sub_f32 v194, 0, v246
    v_sub_f32 v195, 0, v246
    v_sub_f32 v80, v80, v246
    v_sub_f32 v81, v81, v246
    v_mfma_f32_16x16x32_bf16 v[120:123], a[192:195], v[32:35], v[192:195]
    buffer_load_dwordx4 v219, s[20:23], s40 offen offset:1024 lds
    v_sub_f32 v82, v82, v246
    v_mfma_f32_16x16x32_bf16 v[124:127], a[208:211], v[32:35], v[192:195]
    v_sub_f32 v83, v83, v246
    v_sub_f32 v84, v84, v246
    v_mfma_f32_16x16x32_bf16 v[120:123], a[196:199], v[36:39], v[120:123]
    v_sub_f32 v85, v85, v246
    v_sub_f32 v86, v86, v246
    v_mfma_f32_16x16x32_bf16 v[124:127], a[212:215], v[36:39], v[124:127]
    v_sub_f32 v87, v87, v246
    s_waitcnt vmcnt(10)
    v_mfma_f32_16x16x32_bf16 v[120:123], a[200:203], v[40:43], v[120:123]
    buffer_load_dwordx4 v216, s[16:19], s63 offen offset:2048 lds
    s_barrier
    v_mfma_f32_16x16x32_bf16 v[124:127], a[216:219], v[40:43], v[124:127]
    ds_read_b128 a[160:163], v204 offset:32768
    v_exp_f32 v224, v80
    v_mfma_f32_16x16x32_bf16 v[120:123], a[204:207], v[44:47], v[120:123]
    ds_read_b128 a[164:167], v205 offset:32768
    v_exp_f32 v225, v81
    v_mfma_f32_16x16x32_bf16 v[124:127], a[220:223], v[44:47], v[124:127]
    ds_read_b128 a[168:171], v206 offset:32768
    v_exp_f32 v226, v82
    v_exp_f32 v227, v83
    v_cvt_pk_bf16_f32 v152, v224, v225
    v_cvt_pk_bf16_f32 v153, v226, v227
    v_exp_f32 v224, v84
    v_exp_f32 v225, v85
    v_exp_f32 v226, v86
    v_exp_f32 v227, v87
    v_cvt_pk_bf16_f32 v154, v224, v225
    v_cvt_pk_bf16_f32 v155, v226, v227
    ds_read_b128 a[172:175], v207 offset:32768
    ds_read_b128 a[176:179], v204 offset:40960
    ds_read_b128 a[180:183], v205 offset:40960
    ds_read_b128 a[184:187], v206 offset:40960
    ds_read_b128 a[188:191], v207 offset:40960
    buffer_load_dwordx4 v217, s[16:19], s63 offen offset:3072 lds
    s_sub_u32 s42, s42, 1
    s_cmp_lg_u32 s65, 0
    s_cbranch_scc1 Lsafe3
    s_waitcnt lgkmcnt(0)
    v_mfma_f32_16x16x32_bf16 v[64:67], a[160:163], v[0:3], v[184:187]
    ds_read_b64_tr_b16 a[192:193], v208 offset:32768
    v_exp_f32 v224, v120
    v_mfma_f32_16x16x32_bf16 v[72:75], a[160:163], v[16:19], v[188:191]
    ds_read_b64_tr_b16 a[194:195], v208 offset:40960
    v_exp_f32 v225, v121
    v_mfma_f32_16x16x32_bf16 v[80:83], a[160:163], v[32:35], v[192:195]
    ds_read_b64_tr_b16 a[196:197], v209 offset:32768
    v_cvt_pk_bf16_f32 v172, v224, v225
    v_mfma_f32_16x16x32_bf16 v[64:67], a[164:167], v[4:7], v[64:67]
    ds_read_b64_tr_b16 a[198:199], v209 offset:40960
    v_exp_f32 v226, v122
    v_mfma_f32_16x16x32_bf16 v[72:75], a[164:167], v[20:23], v[72:75]
    ds_read_b64_tr_b16 a[200:201], v210 offset:32768
    v_exp_f32 v227, v123
    v_mfma_f32_16x16x32_bf16 v[80:83], a[164:167], v[36:39], v[80:83]
    ds_read_b64_tr_b16 a[202:203], v210 offset:40960
    v_cvt_pk_bf16_f32 v173, v226, v227
    v_mfma_f32_16x16x32_bf16 v[64:67], a[168:171], v[8:11], v[64:67]
    ds_read_b64_tr_b16 a[204:205], v211 offset:32768
    v_mfma_f32_16x16x32_bf16 v[72:75], a[168:171], v[24:27], v[72:75]
    ds_read_b64_tr_b16 a[206:207], v211 offset:40960
    v_mfma_f32_16x16x32_bf16 v[80:83], a[168:171], v[40:43], v[80:83]
    v_exp_f32 v248, v124
    v_mfma_f32_16x16x32_bf16 v[64:67], a[172:175], v[12:15], v[64:67]
    ds_read_b64_tr_b16 a[208:209], v212 offset:32768
    v_mfma_f32_16x16x32_bf16 v[72:75], a[172:175], v[28:31], v[72:75]
    ds_read_b64_tr_b16 a[210:211], v212 offset:40960
    v_mfma_f32_16x16x32_bf16 v[80:83], a[172:175], v[44:47], v[80:83]
    ds_read_b64_tr_b16 a[212:213], v213 offset:32768
    v_mfma_f32_16x16x32_bf16 v[68:71], a[176:179], v[0:3], v[184:187]
    ds_read_b64_tr_b16 a[214:215], v213 offset:40960
    v_mfma_f32_16x16x32_bf16 v[76:79], a[176:179], v[16:19], v[188:191]
    ds_read_b64_tr_b16 a[216:217], v214 offset:32768
    v_mfma_f32_16x16x32_bf16 v[84:87], a[176:179], v[32:35], v[192:195]
    ds_read_b64_tr_b16 a[218:219], v214 offset:40960
    v_mfma_f32_16x16x32_bf16 v[68:71], a[180:183], v[4:7], v[68:71]
    ds_read_b64_tr_b16 a[220:221], v215 offset:32768
    v_mfma_f32_16x16x32_bf16 v[76:79], a[180:183], v[20:23], v[76:79]
    ds_read_b64_tr_b16 a[222:223], v215 offset:40960
    v_mfma_f32_16x16x32_bf16 v[84:87], a[180:183], v[36:39], v[84:87]
    v_exp_f32 v249, v125
    v_mfma_f32_16x16x32_bf16 v[68:71], a[184:187], v[8:11], v[68:71]
    v_exp_f32 v250, v126
    v_mfma_f32_16x16x32_bf16 v[76:79], a[184:187], v[24:27], v[76:79]
    s_add_u32 m0, s41, 32768
    v_exp_f32 v251, v127
    v_mfma_f32_16x16x32_bf16 v[84:87], a[184:187], v[40:43], v[84:87]
    s_add_u32 s40, s40, 131072
    v_exp_f32 v224, v112
    v_mfma_f32_16x16x32_bf16 v[68:71], a[188:191], v[12:15], v[68:71]
    s_add_u32 s63, s63, 131072
    v_exp_f32 v225, v113
    v_mfma_f32_16x16x32_bf16 v[76:79], a[188:191], v[28:31], v[76:79]
    s_waitcnt vmcnt(8) lgkmcnt(0)
    v_exp_f32 v226, v114
    v_mfma_f32_16x16x32_bf16 v[84:87], a[188:191], v[44:47], v[84:87]
    s_barrier
    v_mfma_f32_16x16x32_bf16 a[0:3], a[192:195], v[144:147], 0
    ds_read_b128 a[160:163], v204 offset:49152
    v_cvt_pk_bf16_f32 v174, v248, v249
    v_mfma_f32_16x16x32_bf16 a[32:35], a[192:195], v[148:151], 0
    ds_read_b128 a[164:167], v205 offset:49152
    v_cvt_pk_bf16_f32 v175, v250, v251
    v_mfma_f32_16x16x32_bf16 a[64:67], a[192:195], v[152:155], 0
    v_exp_f32 v227, v115
    v_mfma_f32_16x16x32_bf16 a[4:7], a[196:199], v[144:147], 0
    buffer_load_dwordx4 v218, s[20:23], s40 offen lds
    v_cvt_pk_bf16_f32 v168, v224, v225
    v_mfma_f32_16x16x32_bf16 a[36:39], a[196:199], v[148:151], 0
    v_exp_f32 v248, v116
    v_mfma_f32_16x16x32_bf16 a[68:71], a[196:199], v[152:155], 0
    ds_read_b128 a[168:171], v206 offset:49152
    v_cvt_pk_bf16_f32 v169, v226, v227
    v_mfma_f32_16x16x32_bf16 a[8:11], a[200:203], v[144:147], 0
    v_exp_f32 v249, v117
    v_mfma_f32_16x16x32_bf16 a[40:43], a[200:203], v[148:151], 0
    ds_read_b128 a[172:175], v207 offset:49152
    v_cvt_pk_bf16_f32 v170, v248, v249
    v_mfma_f32_16x16x32_bf16 a[72:75], a[200:203], v[152:155], 0
    v_exp_f32 v250, v118
    v_mfma_f32_16x16x32_bf16 a[12:15], a[204:207], v[144:147], 0
    buffer_load_dwordx4 v219, s[20:23], s40 offen offset:1024 lds
    v_mfma_f32_16x16x32_bf16 a[44:47], a[204:207], v[148:151], 0
    ds_read_b128 a[176:179], v204 offset:57344
    v_mfma_f32_16x16x32_bf16 a[76:79], a[204:207], v[152:155], 0
    v_exp_f32 v251, v119
    v_mfma_f32_16x16x32_bf16 a[16:19], a[208:211], v[144:147], 0
    ds_read_b128 a[180:183], v205 offset:57344
    v_cvt_pk_bf16_f32 v171, v250, v251
    v_mfma_f32_16x16x32_bf16 a[48:51], a[208:211], v[148:151], 0
    v_exp_f32 v224, v104
    v_mfma_f32_16x16x32_bf16 a[80:83], a[208:211], v[152:155], 0
    ds_read_b128 a[184:187], v206 offset:57344
    v_mfma_f32_16x16x32_bf16 a[20:23], a[212:215], v[144:147], 0
    v_exp_f32 v225, v105
    v_mfma_f32_16x16x32_bf16 a[52:55], a[212:215], v[148:151], 0
    buffer_load_dwordx4 v216, s[16:19], s63 offen offset:2048 lds
    v_cvt_pk_bf16_f32 v164, v224, v225
    v_mfma_f32_16x16x32_bf16 a[84:87], a[212:215], v[152:155], 0
    v_exp_f32 v226, v106
    v_mfma_f32_16x16x32_bf16 a[24:27], a[216:219], v[144:147], 0
    ds_read_b128 a[188:191], v207 offset:57344
    v_mfma_f32_16x16x32_bf16 a[56:59], a[216:219], v[148:151], 0
    v_exp_f32 v227, v107
    v_mfma_f32_16x16x32_bf16 a[88:91], a[216:219], v[152:155], 0
    v_exp_f32 v248, v108
    v_mfma_f32_16x16x32_bf16 a[28:31], a[220:223], v[144:147], 0
    v_exp_f32 v249, v109
    v_mfma_f32_16x16x32_bf16 a[60:63], a[220:223], v[148:151], 0
    buffer_load_dwordx4 v217, s[16:19], s63 offen offset:3072 lds
    v_cvt_pk_bf16_f32 v165, v226, v227
    v_mfma_f32_16x16x32_bf16 a[92:95], a[220:223], v[152:155], 0
    s_sub_u32 s42, s42, 1
    v_exp_f32 v250, v110
    v_mfma_f32_16x16x32_bf16 a[240:243], v[228:231], v[144:147], 0
    s_waitcnt lgkmcnt(0)
    v_exp_f32 v251, v111
    v_mfma_f32_16x16x32_bf16 a[244:247], v[228:231], v[148:151], 0
    v_cvt_pk_bf16_f32 v166, v248, v249
    v_cvt_pk_bf16_f32 v167, v250, v251
    v_mfma_f32_16x16x32_bf16 a[248:251], v[228:231], v[152:155], 0
    .p2align 3
Lloop3:
    v_mfma_f32_16x16x32_bf16 v[104:107], a[160:163], v[0:3], v[184:187]
    ds_read_b64_tr_b16 a[192:193], v208 offset:49152
    v_exp_f32 v224, v80
    v_mfma_f32_16x16x32_bf16 v[112:115], a[160:163], v[16:19], v[188:191]
    ds_read_b64_tr_b16 a[194:195], v208 offset:57344
    v_exp_f32 v225, v81
    v_mfma_f32_16x16x32_bf16 v[120:123], a[160:163], v[32:35], v[192:195]
    ds_read_b64_tr_b16 a[196:197], v209 offset:49152
    v_cvt_pk_bf16_f32 v152, v224, v225
    v_mfma_f32_16x16x32_bf16 v[104:107], a[164:167], v[4:7], v[104:107]
    ds_read_b64_tr_b16 a[198:199], v209 offset:57344
    v_exp_f32 v226, v82
    v_mfma_f32_16x16x32_bf16 v[112:115], a[164:167], v[20:23], v[112:115]
    ds_read_b64_tr_b16 a[200:201], v210 offset:49152
    v_exp_f32 v227, v83
    v_mfma_f32_16x16x32_bf16 v[120:123], a[164:167], v[36:39], v[120:123]
    ds_read_b64_tr_b16 a[202:203], v210 offset:57344
    v_cvt_pk_bf16_f32 v153, v226, v227
    v_mfma_f32_16x16x32_bf16 v[104:107], a[168:171], v[8:11], v[104:107]
    ds_read_b64_tr_b16 a[204:205], v211 offset:49152
    v_mfma_f32_16x16x32_bf16 v[112:115], a[168:171], v[24:27], v[112:115]
    ds_read_b64_tr_b16 a[206:207], v211 offset:57344
    v_mfma_f32_16x16x32_bf16 v[120:123], a[168:171], v[40:43], v[120:123]
    v_exp_f32 v248, v84
    v_mfma_f32_16x16x32_bf16 v[104:107], a[172:175], v[12:15], v[104:107]
    ds_read_b64_tr_b16 a[208:209], v212 offset:49152
    v_mfma_f32_16x16x32_bf16 v[112:115], a[172:175], v[28:31], v[112:115]
    ds_read_b64_tr_b16 a[210:211], v212 offset:57344
    v_mfma_f32_16x16x32_bf16 v[120:123], a[172:175], v[44:47], v[120:123]
    ds_read_b64_tr_b16 a[212:213], v213 offset:49152
    v_mfma_f32_16x16x32_bf16 v[108:111], a[176:179], v[0:3], v[184:187]
    ds_read_b64_tr_b16 a[214:215], v213 offset:57344
    v_mfma_f32_16x16x32_bf16 v[116:119], a[176:179], v[16:19], v[188:191]
    ds_read_b64_tr_b16 a[216:217], v214 offset:49152
    v_mfma_f32_16x16x32_bf16 v[124:127], a[176:179], v[32:35], v[192:195]
    ds_read_b64_tr_b16 a[218:219], v214 offset:57344
    v_mfma_f32_16x16x32_bf16 v[108:111], a[180:183], v[4:7], v[108:111]
    ds_read_b64_tr_b16 a[220:221], v215 offset:49152
    v_mfma_f32_16x16x32_bf16 v[116:119], a[180:183], v[20:23], v[116:119]
    ds_read_b64_tr_b16 a[222:223], v215 offset:57344
    v_mfma_f32_16x16x32_bf16 v[124:127], a[180:183], v[36:39], v[124:127]
    v_exp_f32 v249, v85
    v_mfma_f32_16x16x32_bf16 v[108:111], a[184:187], v[8:11], v[108:111]
    v_exp_f32 v250, v86
    v_mfma_f32_16x16x32_bf16 v[116:119], a[184:187], v[24:27], v[116:119]
    s_add_u32 m0, s41, 49152
    v_exp_f32 v251, v87
    v_mfma_f32_16x16x32_bf16 v[124:127], a[184:187], v[40:43], v[124:127]
    s_add_u32 s40, s40, 131072
    v_exp_f32 v224, v72
    v_mfma_f32_16x16x32_bf16 v[108:111], a[188:191], v[12:15], v[108:111]
    s_add_u32 s63, s63, 131072
    v_exp_f32 v225, v73
    v_mfma_f32_16x16x32_bf16 v[116:119], a[188:191], v[28:31], v[116:119]
    s_waitcnt vmcnt(8) lgkmcnt(0)
    v_exp_f32 v226, v74
    v_mfma_f32_16x16x32_bf16 v[124:127], a[188:191], v[44:47], v[124:127]
    s_barrier
    v_mfma_f32_16x16x32_bf16 a[0:3], a[192:195], v[164:167], a[0:3]
    ds_read_b128 a[160:163], v204 offset:0
    v_cvt_pk_bf16_f32 v154, v248, v249
    v_mfma_f32_16x16x32_bf16 a[32:35], a[192:195], v[168:171], a[32:35]
    ds_read_b128 a[164:167], v205 offset:0
    v_cvt_pk_bf16_f32 v155, v250, v251
    v_mfma_f32_16x16x32_bf16 a[64:67], a[192:195], v[172:175], a[64:67]
    v_exp_f32 v227, v75
    v_mfma_f32_16x16x32_bf16 a[4:7], a[196:199], v[164:167], a[4:7]
    buffer_load_dwordx4 v218, s[20:23], s40 offen lds
    v_cvt_pk_bf16_f32 v148, v224, v225
    v_mfma_f32_16x16x32_bf16 a[36:39], a[196:199], v[168:171], a[36:39]
    v_exp_f32 v248, v76
    v_mfma_f32_16x16x32_bf16 a[68:71], a[196:199], v[172:175], a[68:71]
    ds_read_b128 a[168:171], v206 offset:0
    v_cvt_pk_bf16_f32 v149, v226, v227
    v_mfma_f32_16x16x32_bf16 a[8:11], a[200:203], v[164:167], a[8:11]
    v_exp_f32 v249, v77
    v_mfma_f32_16x16x32_bf16 a[40:43], a[200:203], v[168:171], a[40:43]
    ds_read_b128 a[172:175], v207 offset:0
    v_cvt_pk_bf16_f32 v150, v248, v249
    v_mfma_f32_16x16x32_bf16 a[72:75], a[200:203], v[172:175], a[72:75]
    v_exp_f32 v250, v78
    v_mfma_f32_16x16x32_bf16 a[12:15], a[204:207], v[164:167], a[12:15]
    buffer_load_dwordx4 v219, s[20:23], s40 offen offset:1024 lds
    v_mfma_f32_16x16x32_bf16 a[44:47], a[204:207], v[168:171], a[44:47]
    ds_read_b128 a[176:179], v204 offset:8192
    v_mfma_f32_16x16x32_bf16 a[76:79], a[204:207], v[172:175], a[76:79]
    v_exp_f32 v251, v79
    v_mfma_f32_16x16x32_bf16 a[16:19], a[208:211], v[164:167], a[16:19]
    ds_read_b128 a[180:183], v205 offset:8192
    v_cvt_pk_bf16_f32 v151, v250, v251
    v_mfma_f32_16x16x32_bf16 a[48:51], a[208:211], v[168:171], a[48:51]
    v_exp_f32 v224, v64
    v_mfma_f32_16x16x32_bf16 a[80:83], a[208:211], v[172:175], a[80:83]
    ds_read_b128 a[184:187], v206 offset:8192
    v_mfma_f32_16x16x32_bf16 a[20:23], a[212:215], v[164:167], a[20:23]
    v_exp_f32 v225, v65
    v_mfma_f32_16x16x32_bf16 a[52:55], a[212:215], v[168:171], a[52:55]
    buffer_load_dwordx4 v216, s[16:19], s63 offen offset:2048 lds
    v_cvt_pk_bf16_f32 v144, v224, v225
    v_mfma_f32_16x16x32_bf16 a[84:87], a[212:215], v[172:175], a[84:87]
    v_exp_f32 v226, v66
    v_mfma_f32_16x16x32_bf16 a[24:27], a[216:219], v[164:167], a[24:27]
    ds_read_b128 a[188:191], v207 offset:8192
    v_mfma_f32_16x16x32_bf16 a[56:59], a[216:219], v[168:171], a[56:59]
    v_exp_f32 v227, v67
    v_mfma_f32_16x16x32_bf16 a[88:91], a[216:219], v[172:175], a[88:91]
    v_exp_f32 v248, v68
    v_mfma_f32_16x16x32_bf16 a[28:31], a[220:223], v[164:167], a[28:31]
    v_exp_f32 v249, v69
    v_mfma_f32_16x16x32_bf16 a[60:63], a[220:223], v[168:171], a[60:63]
    buffer_load_dwordx4 v217, s[16:19], s63 offen offset:3072 lds
    v_cvt_pk_bf16_f32 v145, v226, v227
    v_mfma_f32_16x16x32_bf16 a[92:95], a[220:223], v[172:175], a[92:95]
    s_sub_u32 s42, s42, 1
    v_exp_f32 v250, v70
    v_mfma_f32_16x16x32_bf16 a[240:243], v[228:231], v[164:167], a[240:243]
    s_waitcnt lgkmcnt(0)
    v_exp_f32 v251, v71
    v_mfma_f32_16x16x32_bf16 a[244:247], v[228:231], v[168:171], a[244:247]
    v_cvt_pk_bf16_f32 v146, v248, v249
    v_cvt_pk_bf16_f32 v147, v250, v251
    v_mfma_f32_16x16x32_bf16 a[248:251], v[228:231], v[172:175], a[248:251]
    v_mfma_f32_16x16x32_bf16 v[64:67], a[160:163], v[0:3], v[184:187]
    ds_read_b64_tr_b16 a[192:193], v208 offset:0
    v_exp_f32 v224, v120
    v_mfma_f32_16x16x32_bf16 v[72:75], a[160:163], v[16:19], v[188:191]
    ds_read_b64_tr_b16 a[194:195], v208 offset:8192
    v_exp_f32 v225, v121
    v_mfma_f32_16x16x32_bf16 v[80:83], a[160:163], v[32:35], v[192:195]
    ds_read_b64_tr_b16 a[196:197], v209 offset:0
    v_cvt_pk_bf16_f32 v172, v224, v225
    v_mfma_f32_16x16x32_bf16 v[64:67], a[164:167], v[4:7], v[64:67]
    ds_read_b64_tr_b16 a[198:199], v209 offset:8192
    v_exp_f32 v226, v122
    v_mfma_f32_16x16x32_bf16 v[72:75], a[164:167], v[20:23], v[72:75]
    ds_read_b64_tr_b16 a[200:201], v210 offset:0
    v_exp_f32 v227, v123
    v_mfma_f32_16x16x32_bf16 v[80:83], a[164:167], v[36:39], v[80:83]
    ds_read_b64_tr_b16 a[202:203], v210 offset:8192
    v_cvt_pk_bf16_f32 v173, v226, v227
    v_mfma_f32_16x16x32_bf16 v[64:67], a[168:171], v[8:11], v[64:67]
    ds_read_b64_tr_b16 a[204:205], v211 offset:0
    v_mfma_f32_16x16x32_bf16 v[72:75], a[168:171], v[24:27], v[72:75]
    ds_read_b64_tr_b16 a[206:207], v211 offset:8192
    v_mfma_f32_16x16x32_bf16 v[80:83], a[168:171], v[40:43], v[80:83]
    v_exp_f32 v248, v124
    v_mfma_f32_16x16x32_bf16 v[64:67], a[172:175], v[12:15], v[64:67]
    ds_read_b64_tr_b16 a[208:209], v212 offset:0
    v_mfma_f32_16x16x32_bf16 v[72:75], a[172:175], v[28:31], v[72:75]
    ds_read_b64_tr_b16 a[210:211], v212 offset:8192
    v_mfma_f32_16x16x32_bf16 v[80:83], a[172:175], v[44:47], v[80:83]
    ds_read_b64_tr_b16 a[212:213], v213 offset:0
    v_mfma_f32_16x16x32_bf16 v[68:71], a[176:179], v[0:3], v[184:187]
    ds_read_b64_tr_b16 a[214:215], v213 offset:8192
    v_mfma_f32_16x16x32_bf16 v[76:79], a[176:179], v[16:19], v[188:191]
    ds_read_b64_tr_b16 a[216:217], v214 offset:0
    v_mfma_f32_16x16x32_bf16 v[84:87], a[176:179], v[32:35], v[192:195]
    ds_read_b64_tr_b16 a[218:219], v214 offset:8192
    v_mfma_f32_16x16x32_bf16 v[68:71], a[180:183], v[4:7], v[68:71]
    ds_read_b64_tr_b16 a[220:221], v215 offset:0
    v_mfma_f32_16x16x32_bf16 v[76:79], a[180:183], v[20:23], v[76:79]
    ds_read_b64_tr_b16 a[222:223], v215 offset:8192
    v_mfma_f32_16x16x32_bf16 v[84:87], a[180:183], v[36:39], v[84:87]
    v_exp_f32 v249, v125
    v_mfma_f32_16x16x32_bf16 v[68:71], a[184:187], v[8:11], v[68:71]
    v_exp_f32 v250, v126
    v_mfma_f32_16x16x32_bf16 v[76:79], a[184:187], v[24:27], v[76:79]
    s_mov_b32 m0, s41
    v_exp_f32 v251, v127
    v_mfma_f32_16x16x32_bf16 v[84:87], a[184:187], v[40:43], v[84:87]
    s_add_u32 s40, s40, 131072
    v_exp_f32 v224, v112
    v_mfma_f32_16x16x32_bf16 v[68:71], a[188:191], v[12:15], v[68:71]
    s_add_u32 s63, s63, 131072
    v_exp_f32 v225, v113
    v_mfma_f32_16x16x32_bf16 v[76:79], a[188:191], v[28:31], v[76:79]
    s_waitcnt vmcnt(8) lgkmcnt(0)
    v_exp_f32 v226, v114
    v_mfma_f32_16x16x32_bf16 v[84:87], a[188:191], v[44:47], v[84:87]
    s_barrier
    v_mfma_f32_16x16x32_bf16 a[0:3], a[192:195], v[144:147], a[0:3]
    ds_read_b128 a[160:163], v204 offset:16384
    v_cvt_pk_bf16_f32 v174, v248, v249
    v_mfma_f32_16x16x32_bf16 a[32:35], a[192:195], v[148:151], a[32:35]
    ds_read_b128 a[164:167], v205 offset:16384
    v_cvt_pk_bf16_f32 v175, v250, v251
    v_mfma_f32_16x16x32_bf16 a[64:67], a[192:195], v[152:155], a[64:67]
    v_exp_f32 v227, v115
    v_mfma_f32_16x16x32_bf16 a[4:7], a[196:199], v[144:147], a[4:7]
    buffer_load_dwordx4 v218, s[20:23], s40 offen lds
    v_cvt_pk_bf16_f32 v168, v224, v225
    v_mfma_f32_16x16x32_bf16 a[36:39], a[196:199], v[148:151], a[36:39]
    v_exp_f32 v248, v116
    v_mfma_f32_16x16x32_bf16 a[68:71], a[196:199], v[152:155], a[68:71]
    ds_read_b128 a[168:171], v206 offset:16384
    v_cvt_pk_bf16_f32 v169, v226, v227
    v_mfma_f32_16x16x32_bf16 a[8:11], a[200:203], v[144:147], a[8:11]
    v_exp_f32 v249, v117
    v_mfma_f32_16x16x32_bf16 a[40:43], a[200:203], v[148:151], a[40:43]
    ds_read_b128 a[172:175], v207 offset:16384
    v_cvt_pk_bf16_f32 v170, v248, v249
    v_mfma_f32_16x16x32_bf16 a[72:75], a[200:203], v[152:155], a[72:75]
    v_exp_f32 v250, v118
    v_mfma_f32_16x16x32_bf16 a[12:15], a[204:207], v[144:147], a[12:15]
    buffer_load_dwordx4 v219, s[20:23], s40 offen offset:1024 lds
    v_mfma_f32_16x16x32_bf16 a[44:47], a[204:207], v[148:151], a[44:47]
    ds_read_b128 a[176:179], v204 offset:24576
    v_mfma_f32_16x16x32_bf16 a[76:79], a[204:207], v[152:155], a[76:79]
    v_exp_f32 v251, v119
    v_mfma_f32_16x16x32_bf16 a[16:19], a[208:211], v[144:147], a[16:19]
    ds_read_b128 a[180:183], v205 offset:24576
    v_cvt_pk_bf16_f32 v171, v250, v251
    v_mfma_f32_16x16x32_bf16 a[48:51], a[208:211], v[148:151], a[48:51]
    v_exp_f32 v224, v104
    v_mfma_f32_16x16x32_bf16 a[80:83], a[208:211], v[152:155], a[80:83]
    ds_read_b128 a[184:187], v206 offset:24576
    v_mfma_f32_16x16x32_bf16 a[20:23], a[212:215], v[144:147], a[20:23]
    v_exp_f32 v225, v105
    v_mfma_f32_16x16x32_bf16 a[52:55], a[212:215], v[148:151], a[52:55]
    buffer_load_dwordx4 v216, s[16:19], s63 offen offset:2048 lds
    v_cvt_pk_bf16_f32 v164, v224, v225
    v_mfma_f32_16x16x32_bf16 a[84:87], a[212:215], v[152:155], a[84:87]
    v_exp_f32 v226, v106
    v_mfma_f32_16x16x32_bf16 a[24:27], a[216:219], v[144:147], a[24:27]
    ds_read_b128 a[188:191], v207 offset:24576
    v_mfma_f32_16x16x32_bf16 a[56:59], a[216:219], v[148:151], a[56:59]
    v_exp_f32 v227, v107
    v_mfma_f32_16x16x32_bf16 a[88:91], a[216:219], v[152:155], a[88:91]
    v_exp_f32 v248, v108
    v_mfma_f32_16x16x32_bf16 a[28:31], a[220:223], v[144:147], a[28:31]
    v_exp_f32 v249, v109
    v_mfma_f32_16x16x32_bf16 a[60:63], a[220:223], v[148:151], a[60:63]
    buffer_load_dwordx4 v217, s[16:19], s63 offen offset:3072 lds
    v_cvt_pk_bf16_f32 v165, v226, v227
    v_mfma_f32_16x16x32_bf16 a[92:95], a[220:223], v[152:155], a[92:95]
    s_sub_u32 s42, s42, 1
    v_exp_f32 v250, v110
    v_mfma_f32_16x16x32_bf16 a[240:243], v[228:231], v[144:147], a[240:243]
    s_waitcnt lgkmcnt(0)
    v_exp_f32 v251, v111
    v_mfma_f32_16x16x32_bf16 a[244:247], v[228:231], v[148:151], a[244:247]
    v_cvt_pk_bf16_f32 v166, v248, v249
    v_cvt_pk_bf16_f32 v167, v250, v251
    v_mfma_f32_16x16x32_bf16 a[248:251], v[228:231], v[152:155], a[248:251]
    s_cbranch_scc1 Lxt3_3
    v_mfma_f32_16x16x32_bf16 v[104:107], a[160:163], v[0:3], v[184:187]
    ds_read_b64_tr_b16 a[192:193], v208 offset:16384
    v_exp_f32 v224, v80
    v_mfma_f32_16x16x32_bf16 v[112:115], a[160:163], v[16:19], v[188:191]
    ds_read_b64_tr_b16 a[194:195], v208 offset:24576
    v_exp_f32 v225, v81
    v_mfma_f32_16x16x32_bf16 v[120:123], a[160:163], v[32:35], v[192:195]
    ds_read_b64_tr_b16 a[196:197], v209 offset:16384
    v_cvt_pk_bf16_f32 v152, v224, v225
    v_mfma_f32_16x16x32_bf16 v[104:107], a[164:167], v[4:7], v[104:107]
    ds_read_b64_tr_b16 a[198:199], v209 offset:24576
    v_exp_f32 v226, v82
    v_mfma_f32_16x16x32_bf16 v[112:115], a[164:167], v[20:23], v[112:115]
    ds_read_b64_tr_b16 a[200:201], v210 offset:16384
    v_exp_f32 v227, v83
    v_mfma_f32_16x16x32_bf16 v[120:123], a[164:167], v[36:39], v[120:123]
    ds_read_b64_tr_b16 a[202:203], v210 offset:24576
    v_cvt_pk_bf16_f32 v153, v226, v227
    v_mfma_f32_16x16x32_bf16 v[104:107], a[168:171], v[8:11], v[104:107]
    ds_read_b64_tr_b16 a[204:205], v211 offset:16384
    v_mfma_f32_16x16x32_bf16 v[112:115], a[168:171], v[24:27], v[112:115]
    ds_read_b64_tr_b16 a[206:207], v211 offset:24576
    v_mfma_f32_16x16x32_bf16 v[120:123], a[168:171], v[40:43], v[120:123]
    v_exp_f32 v248, v84
    v_mfma_f32_16x16x32_bf16 v[104:107], a[172:175], v[12:15], v[104:107]
    ds_read_b64_tr_b16 a[208:209], v212 offset:16384
    v_mfma_f32_16x16x32_bf16 v[112:115], a[172:175], v[28:31], v[112:115]
    ds_read_b64_tr_b16 a[210:211], v212 offset:24576
    v_mfma_f32_16x16x32_bf16 v[120:123], a[172:175], v[44:47], v[120:123]
    ds_read_b64_tr_b16 a[212:213], v213 offset:16384
    v_mfma_f32_16x16x32_bf16 v[108:111], a[176:179], v[0:3], v[184:187]
    ds_read_b64_tr_b16 a[214:215], v213 offset:24576
    v_mfma_f32_16x16x32_bf16 v[116:119], a[176:179], v[16:19], v[188:191]
    ds_read_b64_tr_b16 a[216:217], v214 offset:16384
    v_mfma_f32_16x16x32_bf16 v[124:127], a[176:179], v[32:35], v[192:195]
    ds_read_b64_tr_b16 a[218:219], v214 offset:24576
    v_mfma_f32_16x16x32_bf16 v[108:111], a[180:183], v[4:7], v[108:111]
    ds_read_b64_tr_b16 a[220:221], v215 offset:16384
    v_mfma_f32_16x16x32_bf16 v[116:119], a[180:183], v[20:23], v[116:119]
    ds_read_b64_tr_b16 a[222:223], v215 offset:24576
    v_mfma_f32_16x16x32_bf16 v[124:127], a[180:183], v[36:39], v[124:127]
    v_exp_f32 v249, v85
    v_mfma_f32_16x16x32_bf16 v[108:111], a[184:187], v[8:11], v[108:111]
    v_exp_f32 v250, v86
    v_mfma_f32_16x16x32_bf16 v[116:119], a[184:187], v[24:27], v[116:119]
    s_add_u32 m0, s41, 16384
    v_exp_f32 v251, v87
    v_mfma_f32_16x16x32_bf16 v[124:127], a[184:187], v[40:43], v[124:127]
    s_add_u32 s40, s40, 131072
    v_exp_f32 v224, v72
    v_mfma_f32_16x16x32_bf16 v[108:111], a[188:191], v[12:15], v[108:111]
    s_add_u32 s63, s63, 131072
    v_exp_f32 v225, v73
    v_mfma_f32_16x16x32_bf16 v[116:119], a[188:191], v[28:31], v[116:119]
    s_waitcnt vmcnt(8) lgkmcnt(0)
    v_exp_f32 v226, v74
    v_mfma_f32_16x16x32_bf16 v[124:127], a[188:191], v[44:47], v[124:127]
    s_barrier
    v_mfma_f32_16x16x32_bf16 a[0:3], a[192:195], v[164:167], a[0:3]
    ds_read_b128 a[160:163], v204 offset:32768
    v_cvt_pk_bf16_f32 v154, v248, v249
    v_mfma_f32_16x16x32_bf16 a[32:35], a[192:195], v[168:171], a[32:35]
    ds_read_b128 a[164:167], v205 offset:32768
    v_cvt_pk_bf16_f32 v155, v250, v251
    v_mfma_f32_16x16x32_bf16 a[64:67], a[192:195], v[172:175], a[64:67]
    v_exp_f32 v227, v75
    v_mfma_f32_16x16x32_bf16 a[4:7], a[196:199], v[164:167], a[4:7]
    buffer_load_dwordx4 v218, s[20:23], s40 offen lds
    v_cvt_pk_bf16_f32 v148, v224, v225
    v_mfma_f32_16x16x32_bf16 a[36:39], a[196:199], v[168:171], a[36:39]
    v_exp_f32 v248, v76
    v_mfma_f32_16x16x32_bf16 a[68:71], a[196:199], v[172:175], a[68:71]
    ds_read_b128 a[168:171], v206 offset:32768
    v_cvt_pk_bf16_f32 v149, v226, v227
    v_mfma_f32_16x16x32_bf16 a[8:11], a[200:203], v[164:167], a[8:11]
    v_exp_f32 v249, v77
    v_mfma_f32_16x16x32_bf16 a[40:43], a[200:203], v[168:171], a[40:43]
    ds_read_b128 a[172:175], v207 offset:32768
    v_cvt_pk_bf16_f32 v150, v248, v249
    v_mfma_f32_16x16x32_bf16 a[72:75], a[200:203], v[172:175], a[72:75]
    v_exp_f32 v250, v78
    v_mfma_f32_16x16x32_bf16 a[12:15], a[204:207], v[164:167], a[12:15]
    buffer_load_dwordx4 v219, s[20:23], s40 offen offset:1024 lds
    v_mfma_f32_16x16x32_bf16 a[44:47], a[204:207], v[168:171], a[44:47]
    ds_read_b128 a[176:179], v204 offset:40960
    v_mfma_f32_16x16x32_bf16 a[76:79], a[204:207], v[172:175], a[76:79]
    v_exp_f32 v251, v79
    v_mfma_f32_16x16x32_bf16 a[16:19], a[208:211], v[164:167], a[16:19]
    ds_read_b128 a[180:183], v205 offset:40960
    v_cvt_pk_bf16_f32 v151, v250, v251
    v_mfma_f32_16x16x32_bf16 a[48:51], a[208:211], v[168:171], a[48:51]
    v_exp_f32 v224, v64
    v_mfma_f32_16x16x32_bf16 a[80:83], a[208:211], v[172:175], a[80:83]
    ds_read_b128 a[184:187], v206 offset:40960
    v_mfma_f32_16x16x32_bf16 a[20:23], a[212:215], v[164:167], a[20:23]
    v_exp_f32 v225, v65
    v_mfma_f32_16x16x32_bf16 a[52:55], a[212:215], v[168:171], a[52:55]
    buffer_load_dwordx4 v216, s[16:19], s63 offen offset:2048 lds
    v_cvt_pk_bf16_f32 v144, v224, v225
    v_mfma_f32_16x16x32_bf16 a[84:87], a[212:215], v[172:175], a[84:87]
    v_exp_f32 v226, v66
    v_mfma_f32_16x16x32_bf16 a[24:27], a[216:219], v[164:167], a[24:27]
    ds_read_b128 a[188:191], v207 offset:40960
    v_mfma_f32_16x16x32_bf16 a[56:59], a[216:219], v[168:171], a[56:59]
    v_exp_f32 v227, v67
    v_mfma_f32_16x16x32_bf16 a[88:91], a[216:219], v[172:175], a[88:91]
    v_exp_f32 v248, v68
    v_mfma_f32_16x16x32_bf16 a[28:31], a[220:223], v[164:167], a[28:31]
    v_exp_f32 v249, v69
    v_mfma_f32_16x16x32_bf16 a[60:63], a[220:223], v[168:171], a[60:63]
    buffer_load_dwordx4 v217, s[16:19], s63 offen offset:3072 lds
    v_cvt_pk_bf16_f32 v145, v226, v227
    v_mfma_f32_16x16x32_bf16 a[92:95], a[220:223], v[172:175], a[92:95]
    s_sub_u32 s42, s42, 1
    v_exp_f32 v250, v70
    v_mfma_f32_16x16x32_bf16 a[240:243], v[228:231], v[164:167], a[240:243]
    s_waitcnt lgkmcnt(0)
    v_exp_f32 v251, v71
    v_mfma_f32_16x16x32_bf16 a[244:247], v[228:231], v[168:171], a[244:247]
    v_cvt_pk_bf16_f32 v146, v248, v249
    v_cvt_pk_bf16_f32 v147, v250, v251
    v_mfma_f32_16x16x32_bf16 a[248:251], v[228:231], v[172:175], a[248:251]
    s_cbranch_scc1 Lxt3_0
    v_mfma_f32_16x16x32_bf16 v[64:67], a[160:163], v[0:3], v[184:187]
    ds_read_b64_tr_b16 a[192:193], v208 offset:32768
    v_exp_f32 v224, v120
    v_mfma_f32_16x16x32_bf16 v[72:75], a[160:163], v[16:19], v[188:191]
    ds_read_b64_tr_b16 a[194:195], v208 offset:40960
    v_exp_f32 v225, v121
    v_mfma_f32_16x16x32_bf16 v[80:83], a[160:163], v[32:35], v[192:195]
    ds_read_b64_tr_b16 a[196:197], v209 offset:32768
    v_cvt_pk_bf16_f32 v172, v224, v225
    v_mfma_f32_16x16x32_bf16 v[64:67], a[164:167], v[4:7], v[64:67]
    ds_read_b64_tr_b16 a[198:199], v209 offset:40960
    v_exp_f32 v226, v122
    v_mfma_f32_16x16x32_bf16 v[72:75], a[164:167], v[20:23], v[72:75]
    ds_read_b64_tr_b16 a[200:201], v210 offset:32768
    v_exp_f32 v227, v123
    v_mfma_f32_16x16x32_bf16 v[80:83], a[164:167], v[36:39], v[80:83]
    ds_read_b64_tr_b16 a[202:203], v210 offset:40960
    v_cvt_pk_bf16_f32 v173, v226, v227
    v_mfma_f32_16x16x32_bf16 v[64:67], a[168:171], v[8:11], v[64:67]
    ds_read_b64_tr_b16 a[204:205], v211 offset:32768
    v_mfma_f32_16x16x32_bf16 v[72:75], a[168:171], v[24:27], v[72:75]
    ds_read_b64_tr_b16 a[206:207], v211 offset:40960
    v_mfma_f32_16x16x32_bf16 v[80:83], a[168:171], v[40:43], v[80:83]
    v_exp_f32 v248, v124
    v_mfma_f32_16x16x32_bf16 v[64:67], a[172:175], v[12:15], v[64:67]
    ds_read_b64_tr_b16 a[208:209], v212 offset:32768
    v_mfma_f32_16x16x32_bf16 v[72:75], a[172:175], v[28:31], v[72:75]
    ds_read_b64_tr_b16 a[210:211], v212 offset:40960
    v_mfma_f32_16x16x32_bf16 v[80:83], a[172:175], v[44:47], v[80:83]
    ds_read_b64_tr_b16 a[212:213], v213 offset:32768
    v_mfma_f32_16x16x32_bf16 v[68:71], a[176:179], v[0:3], v[184:187]
    ds_read_b64_tr_b16 a[214:215], v213 offset:40960
    v_mfma_f32_16x16x32_bf16 v[76:79], a[176:179], v[16:19], v[188:191]
    ds_read_b64_tr_b16 a[216:217], v214 offset:32768
    v_mfma_f32_16x16x32_bf16 v[84:87], a[176:179], v[32:35], v[192:195]
    ds_read_b64_tr_b16 a[218:219], v214 offset:40960
    v_mfma_f32_16x16x32_bf16 v[68:71], a[180:183], v[4:7], v[68:71]
    ds_read_b64_tr_b16 a[220:221], v215 offset:32768
    v_mfma_f32_16x16x32_bf16 v[76:79], a[180:183], v[20:23], v[76:79]
    ds_read_b64_tr_b16 a[222:223], v215 offset:40960
    v_mfma_f32_16x16x32_bf16 v[84:87], a[180:183], v[36:39], v[84:87]
    v_exp_f32 v249, v125
    v_mfma_f32_16x16x32_bf16 v[68:71], a[184:187], v[8:11], v[68:71]
    v_exp_f32 v250, v126
    v_mfma_f32_16x16x32_bf16 v[76:79], a[184:187], v[24:27], v[76:79]
    s_add_u32 m0, s41, 32768
    v_exp_f32 v251, v127
    v_mfma_f32_16x16x32_bf16 v[84:87], a[184:187], v[40:43], v[84:87]
    s_add_u32 s40, s40, 131072
    v_exp_f32 v224, v112
    v_mfma_f32_16x16x32_bf16 v[68:71], a[188:191], v[12:15], v[68:71]
    s_add_u32 s63, s63, 131072
    v_exp_f32 v225, v113
    v_mfma_f32_16x16x32_bf16 v[76:79], a[188:191], v[28:31], v[76:79]
    s_waitcnt vmcnt(8) lgkmcnt(0)
    v_exp_f32 v226, v114
    v_mfma_f32_16x16x32_bf16 v[84:87], a[188:191], v[44:47], v[84:87]
    s_barrier
    v_mfma_f32_16x16x32_bf16 a[0:3], a[192:195], v[144:147], a[0:3]
    ds_read_b128 a[160:163], v204 offset:49152
    v_cvt_pk_bf16_f32 v174, v248, v249
    v_mfma_f32_16x16x32_bf16 a[32:35], a[192:195], v[148:151], a[32:35]
    ds_read_b128 a[164:167], v205 offset:49152
    v_cvt_pk_bf16_f32 v175, v250, v251
    v_mfma_f32_16x16x32_bf16 a[64:67], a[192:195], v[152:155], a[64:67]
    v_exp_f32 v227, v115
    v_mfma_f32_16x16x32_bf16 a[4:7], a[196:199], v[144:147], a[4:7]
    buffer_load_dwordx4 v218, s[20:23], s40 offen lds
    v_cvt_pk_bf16_f32 v168, v224, v225
    v_mfma_f32_16x16x32_bf16 a[36:39], a[196:199], v[148:151], a[36:39]
    v_exp_f32 v248, v116
    v_mfma_f32_16x16x32_bf16 a[68:71], a[196:199], v[152:155], a[68:71]
    ds_read_b128 a[168:171], v206 offset:49152
    v_cvt_pk_bf16_f32 v169, v226, v227
    v_mfma_f32_16x16x32_bf16 a[8:11], a[200:203], v[144:147], a[8:11]
    v_exp_f32 v249, v117
    v_mfma_f32_16x16x32_bf16 a[40:43], a[200:203], v[148:151], a[40:43]
    ds_read_b128 a[172:175], v207 offset:49152
    v_cvt_pk_bf16_f32 v170, v248, v249
    v_mfma_f32_16x16x32_bf16 a[72:75], a[200:203], v[152:155], a[72:75]
    v_exp_f32 v250, v118
    v_mfma_f32_16x16x32_bf16 a[12:15], a[204:207], v[144:147], a[12:15]
    buffer_load_dwordx4 v219, s[20:23], s40 offen offset:1024 lds
    v_mfma_f32_16x16x32_bf16 a[44:47], a[204:207], v[148:151], a[44:47]
    ds_read_b128 a[176:179], v204 offset:57344
    v_mfma_f32_16x16x32_bf16 a[76:79], a[204:207], v[152:155], a[76:79]
    v_exp_f32 v251, v119
    v_mfma_f32_16x16x32_bf16 a[16:19], a[208:211], v[144:147], a[16:19]
    ds_read_b128 a[180:183], v205 offset:57344
    v_cvt_pk_bf16_f32 v171, v250, v251
    v_mfma_f32_16x16x32_bf16 a[48:51], a[208:211], v[148:151], a[48:51]
    v_exp_f32 v224, v104
    v_mfma_f32_16x16x32_bf16 a[80:83], a[208:211], v[152:155], a[80:83]
    ds_read_b128 a[184:187], v206 offset:57344
    v_mfma_f32_16x16x32_bf16 a[20:23], a[212:215], v[144:147], a[20:23]
    v_exp_f32 v225, v105
    v_mfma_f32_16x16x32_bf16 a[52:55], a[212:215], v[148:151], a[52:55]
    buffer_load_dwordx4 v216, s[16:19], s63 offen offset:2048 lds
    v_cvt_pk_bf16_f32 v164, v224, v225
    v_mfma_f32_16x16x32_bf16 a[84:87], a[212:215], v[152:155], a[84:87]
    v_exp_f32 v226, v106
    v_mfma_f32_16x16x32_bf16 a[24:27], a[216:219], v[144:147], a[24:27]
    ds_read_b128 a[188:191], v207 offset:57344
    v_mfma_f32_16x16x32_bf16 a[56:59], a[216:219], v[148:151], a[56:59]
    v_exp_f32 v227, v107
    v_mfma_f32_16x16x32_bf16 a[88:91], a[216:219], v[152:155], a[88:91]
    v_exp_f32 v248, v108
    v_mfma_f32_16x16x32_bf16 a[28:31], a[220:223], v[144:147], a[28:31]
    v_exp_f32 v249, v109
    v_mfma_f32_16x16x32_bf16 a[60:63], a[220:223], v[148:151], a[60:63]
    buffer_load_dwordx4 v217, s[16:19], s63 offen offset:3072 lds
    v_cvt_pk_bf16_f32 v165, v226, v227
    v_mfma_f32_16x16x32_bf16 a[92:95], a[220:223], v[152:155], a[92:95]
    s_sub_u32 s42, s42, 1
    v_exp_f32 v250, v110
    v_mfma_f32_16x16x32_bf16 a[240:243], v[228:231], v[144:147], a[240:243]
    s_waitcnt lgkmcnt(0)
    v_exp_f32 v251, v111
    v_mfma_f32_16x16x32_bf16 a[244:247], v[228:231], v[148:151], a[244:247]
    v_cvt_pk_bf16_f32 v166, v248, v249
    v_cvt_pk_bf16_f32 v167, v250, v251
    v_mfma_f32_16x16x32_bf16 a[248:251], v[228:231], v[152:155], a[248:251]
    s_branch Lloop3
Lxt3_0:
Lft3_1_1:
    s_waitcnt lgkmcnt(0)
    v_mfma_f32_16x16x32_bf16 a[240:243], v[228:231], v[144:147], a[240:243]
    ds_read_b64_tr_b16 a[192:193], v208 offset:32768
    v_exp_f32 v104, v104
    v_exp_f32 v105, v105
    v_exp_f32 v106, v106
    v_exp_f32 v107, v107
    v_exp_f32 v108, v108
    v_exp_f32 v109, v109
    v_exp_f32 v110, v110
    v_exp_f32 v111, v111
    v_cvt_pk_bf16_f32 v164, v104, v105
    v_cvt_pk_bf16_f32 v165, v106, v107
    v_cvt_pk_bf16_f32 v166, v108, v109
    v_cvt_pk_bf16_f32 v167, v110, v111
    v_xor_b32 v184, 0, v240
    v_xor_b32 v185, 32, v240
    v_mfma_f32_16x16x32_bf16 a[240:243], v[228:231], v[164:167], a[240:243]
    ds_read_b64_tr_b16 a[194:195], v208 offset:40960
    s_waitcnt vmcnt(8)
    s_barrier
    s_mov_b32 m0, s41
    s_add_u32 s18, s30, 4096
    buffer_load_dwordx4 v216, s[16:19], s31 offen offset:2048 lds
    s_add_u32 s61, s55, 0
    ds_read_b64_tr_b16 a[196:197], v209 offset:32768
    v_xor_b32 v186, 64, v240
    v_xor_b32 v187, 96, v240
    v_xor_b32 v188, 128, v240
    v_xor_b32 v189, 160, v240
    v_xor_b32 v190, 192, v240
    v_xor_b32 v191, 224, v240
    v_accvgpr_read_b32 v252, a240
    v_rcp_f32 v192, v252
    v_mfma_f32_16x16x32_bf16 a[244:247], v[228:231], v[148:151], a[244:247]
    ds_read_b64_tr_b16 a[198:199], v209 offset:40960
    ds_read_b64_tr_b16 a[200:201], v210 offset:32768
    s_waitcnt lgkmcnt(3)
    v_mfma_f32_16x16x32_bf16 a[0:3], a[192:195], v[144:147], a[0:3]
    buffer_load_dwordx4 v217, s[16:19], s31 offen offset:3072 lds
    s_mov_b32 m0, s3
    ds_read_b64_tr_b16 a[202:203], v210 offset:40960
    ds_read_b64_tr_b16 a[204:205], v211 offset:32768
    ds_read_b64_tr_b16 a[206:207], v211 offset:40960
    ds_read_b64_tr_b16 a[208:209], v212 offset:32768
    ds_read_b64_tr_b16 a[210:211], v212 offset:40960
    ds_read_b64_tr_b16 a[212:213], v213 offset:32768
    ds_read_b64_tr_b16 a[214:215], v213 offset:40960
    ds_read_b64_tr_b16 a[216:217], v214 offset:32768
    buffer_load_dwordx4 v220, s[12:15], s61 offen offset:0 nt lds
    ds_read_b64_tr_b16 a[218:219], v214 offset:40960
    ds_read_b64_tr_b16 a[220:221], v215 offset:32768
    ds_read_b64_tr_b16 a[222:223], v215 offset:40960
    s_waitcnt lgkmcnt(11)
    v_mfma_f32_16x16x32_bf16 a[4:7], a[196:199], v[144:147], a[4:7]
    ds_read_b64_tr_b16 a[160:161], v208 offset:49152
    ds_read_b64_tr_b16 a[162:163], v208 offset:57344
    v_mfma_f32_16x16x32_bf16 a[32:35], a[192:195], v[148:151], a[32:35]
    buffer_load_dwordx4 v221, s[12:15], s61 offen offset:1024 nt lds
    ds_read_b64_tr_b16 a[164:165], v209 offset:49152
    s_waitcnt lgkmcnt(11)
    v_mfma_f32_16x16x32_bf16 a[8:11], a[200:203], v[144:147], a[8:11]
    ds_read_b64_tr_b16 a[166:167], v209 offset:57344
    ds_read_b64_tr_b16 a[168:169], v210 offset:49152
    v_mfma_f32_16x16x32_bf16 a[12:15], a[204:207], v[144:147], a[12:15]
    ds_read_b64_tr_b16 a[170:171], v210 offset:57344
    ds_read_b64_tr_b16 a[172:173], v211 offset:49152
    s_waitcnt lgkmcnt(10)
    v_mfma_f32_16x16x32_bf16 a[16:19], a[208:211], v[144:147], a[16:19]
    buffer_load_dwordx4 v222, s[12:15], s61 offen offset:2048 nt lds
    ds_read_b64_tr_b16 a[174:175], v211 offset:57344
    v_mfma_f32_16x16x32_bf16 a[20:23], a[212:215], v[144:147], a[20:23]
    ds_read_b64_tr_b16 a[176:177], v212 offset:49152
    ds_read_b64_tr_b16 a[178:179], v212 offset:57344
    s_waitcnt lgkmcnt(9)
    v_mfma_f32_16x16x32_bf16 a[24:27], a[216:219], v[144:147], a[24:27]
    ds_read_b64_tr_b16 a[180:181], v213 offset:49152
    ds_read_b64_tr_b16 a[182:183], v213 offset:57344
    v_mfma_f32_16x16x32_bf16 a[28:31], a[220:223], v[144:147], a[28:31]
    buffer_load_dwordx4 v223, s[12:15], s61 offen offset:3072 nt lds
    s_add_u32 m0, s3, 4096
    s_waitcnt lgkmcnt(8)
    v_mfma_f32_16x16x32_bf16 a[0:3], a[160:163], v[164:167], a[0:3]
    s_add_u32 s61, s55, 65536
    ds_read_b64_tr_b16 a[184:185], v214 offset:49152
    ds_read_b64_tr_b16 a[186:187], v214 offset:57344
    v_mfma_f32_16x16x32_bf16 a[4:7], a[164:167], v[164:167], a[4:7]
    ds_read_b64_tr_b16 a[188:189], v215 offset:49152
    ds_read_b64_tr_b16 a[190:191], v215 offset:57344
    s_waitcnt lgkmcnt(9)
    v_mfma_f32_16x16x32_bf16 a[8:11], a[168:171], v[164:167], a[8:11]
    buffer_load_dwordx4 v220, s[12:15], s61 offen offset:0 nt lds
    v_accvgpr_read_b32 v0, a0
    s_waitcnt lgkmcnt(7)
    v_mfma_f32_16x16x32_bf16 a[12:15], a[172:175], v[164:167], a[12:15]
    s_add_u32 s68, s56, 0
    v_accvgpr_read_b32 v1, a1
    v_accvgpr_read_b32 v2, a2
    s_waitcnt lgkmcnt(6)
    v_mfma_f32_16x16x32_bf16 a[16:19], a[176:179], v[164:167], a[16:19]
    v_accvgpr_read_b32 v3, a3
    v_accvgpr_read_b32 v4, a4
    s_waitcnt lgkmcnt(4)
    v_mfma_f32_16x16x32_bf16 a[20:23], a[180:183], v[164:167], a[20:23]
    buffer_load_dwordx4 v221, s[12:15], s61 offen offset:1024 nt lds
    v_accvgpr_read_b32 v5, a5
    v_accvgpr_read_b32 v6, a6
    v_accvgpr_read_b32 v7, a7
    v_pk_mul_f32 v[0:1], v[0:1], v[192:193] op_sel_hi:[1,0]
    v_pk_mul_f32 v[2:3], v[2:3], v[192:193] op_sel_hi:[1,0]
    s_waitcnt lgkmcnt(2)
    v_mfma_f32_16x16x32_bf16 a[24:27], a[184:187], v[164:167], a[24:27]
    v_cvt_pk_bf16_f32 v0, v0, v1
    v_cvt_pk_bf16_f32 v1, v2, v3
    s_waitcnt lgkmcnt(0)
    v_mfma_f32_16x16x32_bf16 a[28:31], a[188:191], v[164:167], a[28:31]
    ds_write_b64 v184, v[0:1]
    v_accvgpr_read_b32 v8, a8
    v_accvgpr_read_b32 v9, a9
    v_pk_mul_f32 v[4:5], v[4:5], v[192:193] op_sel_hi:[1,0]
    v_pk_mul_f32 v[6:7], v[6:7], v[192:193] op_sel_hi:[1,0]
    v_cvt_pk_bf16_f32 v4, v4, v5
    v_cvt_pk_bf16_f32 v5, v6, v7
    v_accvgpr_read_b32 v10, a10
    v_mfma_f32_16x16x32_bf16 a[36:39], a[196:199], v[148:151], a[36:39]
    buffer_load_dwordx4 v222, s[12:15], s61 offen offset:2048 nt lds
    v_accvgpr_read_b32 v11, a11
    v_mfma_f32_16x16x32_bf16 a[40:43], a[200:203], v[148:151], a[40:43]
    ds_write_b64 v185, v[4:5]
    v_mfma_f32_16x16x32_bf16 a[44:47], a[204:207], v[148:151], a[44:47]
    v_accvgpr_read_b32 v12, a12
    v_accvgpr_read_b32 v13, a13
    v_mfma_f32_16x16x32_bf16 a[48:51], a[208:211], v[148:151], a[48:51]
    v_accvgpr_read_b32 v14, a14
    v_accvgpr_read_b32 v15, a15
    v_mfma_f32_16x16x32_bf16 a[52:55], a[212:215], v[148:151], a[52:55]
    buffer_load_dwordx4 v223, s[12:15], s61 offen offset:3072 nt lds
    s_add_u32 m0, s41, 16384
    v_mfma_f32_16x16x32_bf16 a[56:59], a[216:219], v[148:151], a[56:59]
    v_accvgpr_read_b32 v16, a16
    v_accvgpr_read_b32 v17, a17
    v_mfma_f32_16x16x32_bf16 a[60:63], a[220:223], v[148:151], a[60:63]
    v_accvgpr_read_b32 v18, a18
    v_accvgpr_read_b32 v19, a19
    v_accvgpr_read_b32 v20, a20
    v_accvgpr_read_b32 v21, a21
    v_accvgpr_read_b32 v22, a22
    v_pk_mul_f32 v[8:9], v[8:9], v[192:193] op_sel_hi:[1,0]
    v_pk_mul_f32 v[10:11], v[10:11], v[192:193] op_sel_hi:[1,0]
    v_cvt_pk_bf16_f32 v8, v8, v9
    v_cvt_pk_bf16_f32 v9, v10, v11
    v_pk_mul_f32 v[12:13], v[12:13], v[192:193] op_sel_hi:[1,0]
    v_pk_mul_f32 v[14:15], v[14:15], v[192:193] op_sel_hi:[1,0]
    v_cvt_pk_bf16_f32 v12, v12, v13
    v_cvt_pk_bf16_f32 v13, v14, v15
    v_pk_mul_f32 v[16:17], v[16:17], v[192:193] op_sel_hi:[1,0]
    v_pk_mul_f32 v[18:19], v[18:19], v[192:193] op_sel_hi:[1,0]
    v_cvt_pk_bf16_f32 v16, v16, v17
    v_cvt_pk_bf16_f32 v17, v18, v19
    v_accvgpr_read_b32 v23, a23
    v_pk_mul_f32 v[20:21], v[20:21], v[192:193] op_sel_hi:[1,0]
    v_pk_mul_f32 v[22:23], v[22:23], v[192:193] op_sel_hi:[1,0]
    v_accvgpr_read_b32 v24, a24
    v_cvt_pk_bf16_f32 v20, v20, v21
    v_accvgpr_read_b32 v25, a25
    v_cvt_pk_bf16_f32 v21, v22, v23
    v_accvgpr_read_b32 v26, a26
    v_accvgpr_read_b32 v27, a27
    v_pk_mul_f32 v[24:25], v[24:25], v[192:193] op_sel_hi:[1,0]
    v_pk_mul_f32 v[26:27], v[26:27], v[192:193] op_sel_hi:[1,0]
    v_accvgpr_read_b32 v28, a28
    v_cvt_pk_bf16_f32 v24, v24, v25
    v_accvgpr_read_b32 v29, a29
    v_cvt_pk_bf16_f32 v25, v26, v27
    v_accvgpr_read_b32 v30, a30
    v_accvgpr_read_b32 v31, a31
    v_pk_mul_f32 v[28:29], v[28:29], v[192:193] op_sel_hi:[1,0]
    v_pk_mul_f32 v[30:31], v[30:31], v[192:193] op_sel_hi:[1,0]
    v_cvt_pk_bf16_f32 v28, v28, v29
    v_cvt_pk_bf16_f32 v29, v30, v31
    v_exp_f32 v112, v112
    v_exp_f32 v113, v113
    v_exp_f32 v114, v114
    v_exp_f32 v115, v115
    v_exp_f32 v116, v116
    v_exp_f32 v117, v117
    v_exp_f32 v118, v118
    v_exp_f32 v119, v119
    v_cvt_pk_bf16_f32 v168, v112, v113
    v_cvt_pk_bf16_f32 v169, v114, v115
    v_cvt_pk_bf16_f32 v170, v116, v117
    v_cvt_pk_bf16_f32 v171, v118, v119
    v_mfma_f32_16x16x32_bf16 a[248:251], v[228:231], v[152:155], a[248:251]
    buffer_load_dwordx4 v216, s[16:19], s28 offen offset:2048 lds
    ds_write_b64 v186, v[8:9]
    v_mfma_f32_16x16x32_bf16 a[244:247], v[228:231], v[168:171], a[244:247]
    ds_write_b64 v187, v[12:13]
    v_mfma_f32_16x16x32_bf16 a[32:35], a[160:163], v[168:171], a[32:35]
    ds_write_b64 v188, v[16:17]
    v_mfma_f32_16x16x32_bf16 a[36:39], a[164:167], v[168:171], a[36:39]
    buffer_load_dwordx4 v217, s[16:19], s28 offen offset:3072 lds
    ds_write_b64 v189, v[20:21]
    v_mfma_f32_16x16x32_bf16 a[40:43], a[168:171], v[168:171], a[40:43]
    ds_write_b64 v190, v[24:25]
    v_mfma_f32_16x16x32_bf16 a[44:47], a[172:175], v[168:171], a[44:47]
    ds_write_b64 v191, v[28:29]
    v_mfma_f32_16x16x32_bf16 a[48:51], a[176:179], v[168:171], a[48:51]
    ds_read_b128 a[0:3], v241 offset:0
    v_accvgpr_read_b32 v253, a244
    v_mfma_f32_16x16x32_bf16 a[52:55], a[180:183], v[168:171], a[52:55]
    ds_read_b128 a[4:7], v241 offset:1024
    v_rcp_f32 v194, v253
    v_mfma_f32_16x16x32_bf16 a[56:59], a[184:187], v[168:171], a[56:59]
    ds_read_b128 a[8:11], v241 offset:2048
    v_accvgpr_read_b32 v32, a32
    v_mfma_f32_16x16x32_bf16 a[60:63], a[188:191], v[168:171], a[60:63]
    ds_read_b128 a[12:15], v241 offset:3072
    v_accvgpr_read_b32 v33, a33
    v_accvgpr_read_b32 v34, a34
    v_accvgpr_read_b32 v35, a35
    v_accvgpr_read_b32 v36, a36
    v_pk_mul_f32 v[32:33], v[32:33], v[194:195] op_sel_hi:[1,0]
    v_pk_mul_f32 v[34:35], v[34:35], v[194:195] op_sel_hi:[1,0]
    v_cvt_pk_bf16_f32 v32, v32, v33
    v_accvgpr_read_b32 v37, a37
    v_cvt_pk_bf16_f32 v33, v34, v35
    v_accvgpr_read_b32 v38, a38
    v_accvgpr_read_b32 v39, a39
    v_pk_mul_f32 v[36:37], v[36:37], v[194:195] op_sel_hi:[1,0]
    v_pk_mul_f32 v[38:39], v[38:39], v[194:195] op_sel_hi:[1,0]
    v_accvgpr_read_b32 v40, a40
    v_cvt_pk_bf16_f32 v36, v36, v37
    v_accvgpr_read_b32 v41, a41
    v_mfma_f32_16x16x32_bf16 a[64:67], a[192:195], v[152:155], a[64:67]
    s_waitcnt lgkmcnt(3)
    buffer_store_dwordx4 a[0:3], v220, s[24:27], s68 offen offset:0 sc0 sc1
    v_cvt_pk_bf16_f32 v37, v38, v39
    v_accvgpr_read_b32 v42, a42
    v_mfma_f32_16x16x32_bf16 a[68:71], a[196:199], v[152:155], a[68:71]
    ds_write_b64 v184, v[32:33]
    v_accvgpr_read_b32 v43, a43
    v_mfma_f32_16x16x32_bf16 a[72:75], a[200:203], v[152:155], a[72:75]
    s_add_u32 s69, s56, 65536
    ds_write_b64 v185, v[36:37]
    v_mfma_f32_16x16x32_bf16 a[76:79], a[204:207], v[152:155], a[76:79]
    v_accvgpr_read_b32 v44, a44
    v_accvgpr_read_b32 v45, a45
    v_mfma_f32_16x16x32_bf16 a[80:83], a[208:211], v[152:155], a[80:83]
    v_accvgpr_read_b32 v46, a46
    v_accvgpr_read_b32 v47, a47
    v_mfma_f32_16x16x32_bf16 a[84:87], a[212:215], v[152:155], a[84:87]
    s_waitcnt lgkmcnt(2)
    buffer_store_dwordx4 a[4:7], v221, s[24:27], s68 offen offset:1024 sc0 sc1
    v_accvgpr_read_b32 v48, a48
    v_mfma_f32_16x16x32_bf16 a[88:91], a[216:219], v[152:155], a[88:91]
    v_accvgpr_read_b32 v49, a49
    v_accvgpr_read_b32 v50, a50
    v_mfma_f32_16x16x32_bf16 a[92:95], a[220:223], v[152:155], a[92:95]
    v_accvgpr_read_b32 v51, a51
    v_accvgpr_read_b32 v52, a52
    v_accvgpr_read_b32 v53, a53
    v_accvgpr_read_b32 v54, a54
    v_accvgpr_read_b32 v55, a55
    v_pk_mul_f32 v[40:41], v[40:41], v[194:195] op_sel_hi:[1,0]
    v_pk_mul_f32 v[42:43], v[42:43], v[194:195] op_sel_hi:[1,0]
    v_cvt_pk_bf16_f32 v40, v40, v41
    v_cvt_pk_bf16_f32 v41, v42, v43
    v_pk_mul_f32 v[44:45], v[44:45], v[194:195] op_sel_hi:[1,0]
    v_pk_mul_f32 v[46:47], v[46:47], v[194:195] op_sel_hi:[1,0]
    v_cvt_pk_bf16_f32 v44, v44, v45
    v_cvt_pk_bf16_f32 v45, v46, v47
    v_pk_mul_f32 v[48:49], v[48:49], v[194:195] op_sel_hi:[1,0]
    v_pk_mul_f32 v[50:51], v[50:51], v[194:195] op_sel_hi:[1,0]
    v_cvt_pk_bf16_f32 v48, v48, v49
    v_cvt_pk_bf16_f32 v49, v50, v51
    v_pk_mul_f32 v[52:53], v[52:53], v[194:195] op_sel_hi:[1,0]
    v_pk_mul_f32 v[54:55], v[54:55], v[194:195] op_sel_hi:[1,0]
    v_accvgpr_read_b32 v56, a56
    v_cvt_pk_bf16_f32 v52, v52, v53
    v_accvgpr_read_b32 v57, a57
    v_cvt_pk_bf16_f32 v53, v54, v55
    v_accvgpr_read_b32 v58, a58
    v_accvgpr_read_b32 v59, a59
    v_pk_mul_f32 v[56:57], v[56:57], v[194:195] op_sel_hi:[1,0]
    v_pk_mul_f32 v[58:59], v[58:59], v[194:195] op_sel_hi:[1,0]
    v_accvgpr_read_b32 v60, a60
    v_cvt_pk_bf16_f32 v56, v56, v57
    v_accvgpr_read_b32 v61, a61
    v_cvt_pk_bf16_f32 v57, v58, v59
    v_accvgpr_read_b32 v62, a62
    v_accvgpr_read_b32 v63, a63
    v_pk_mul_f32 v[60:61], v[60:61], v[194:195] op_sel_hi:[1,0]
    v_pk_mul_f32 v[62:63], v[62:63], v[194:195] op_sel_hi:[1,0]
    v_cvt_pk_bf16_f32 v60, v60, v61
    v_cvt_pk_bf16_f32 v61, v62, v63
    v_exp_f32 v120, v120
    v_exp_f32 v121, v121
    v_exp_f32 v122, v122
    v_exp_f32 v123, v123
    v_exp_f32 v124, v124
    v_exp_f32 v125, v125
    v_exp_f32 v126, v126
    v_exp_f32 v127, v127
    v_cvt_pk_bf16_f32 v172, v120, v121
    v_cvt_pk_bf16_f32 v173, v122, v123
    v_cvt_pk_bf16_f32 v174, v124, v125
    v_cvt_pk_bf16_f32 v175, v126, v127
    buffer_store_dwordx4 a[8:11], v222, s[24:27], s68 offen offset:2048 sc0 sc1
    ds_write_b64 v186, v[40:41]
    v_mfma_f32_16x16x32_bf16 a[248:251], v[228:231], v[172:175], a[248:251]
    ds_write_b64 v187, v[44:45]
    v_mfma_f32_16x16x32_bf16 a[64:67], a[160:163], v[172:175], a[64:67]
    ds_write_b64 v188, v[48:49]
    v_mfma_f32_16x16x32_bf16 a[68:71], a[164:167], v[172:175], a[68:71]
    ds_write_b64 v189, v[52:53]
    v_mfma_f32_16x16x32_bf16 a[72:75], a[168:171], v[172:175], a[72:75]
    buffer_store_dwordx4 a[12:15], v223, s[24:27], s68 offen offset:3072 sc0 sc1
    ds_write_b64 v190, v[56:57]
    v_mfma_f32_16x16x32_bf16 a[76:79], a[172:175], v[172:175], a[76:79]
    ds_write_b64 v191, v[60:61]
    v_mfma_f32_16x16x32_bf16 a[80:83], a[176:179], v[172:175], a[80:83]
    ds_read_b128 a[32:35], v241 offset:0
    v_accvgpr_read_b32 v254, a248
    v_mfma_f32_16x16x32_bf16 a[84:87], a[180:183], v[172:175], a[84:87]
    ds_read_b128 a[36:39], v241 offset:1024
    v_rcp_f32 v196, v254
    v_mfma_f32_16x16x32_bf16 a[88:91], a[184:187], v[172:175], a[88:91]
    ds_read_b128 a[40:43], v241 offset:2048
    v_accvgpr_read_b32 v0, a64
    v_mfma_f32_16x16x32_bf16 a[92:95], a[188:191], v[172:175], a[92:95]
    ds_read_b128 a[44:47], v241 offset:3072
    v_accvgpr_read_b32 v1, a65
    v_accvgpr_read_b32 v2, a66
    v_accvgpr_read_b32 v3, a67
    v_accvgpr_read_b32 v4, a68
    v_pk_mul_f32 v[0:1], v[0:1], v[196:197] op_sel_hi:[1,0]
    v_pk_mul_f32 v[2:3], v[2:3], v[196:197] op_sel_hi:[1,0]
    v_cvt_pk_bf16_f32 v0, v0, v1
    v_accvgpr_read_b32 v5, a69
    v_cvt_pk_bf16_f32 v1, v2, v3
    v_accvgpr_read_b32 v6, a70
    v_accvgpr_read_b32 v7, a71
    v_pk_mul_f32 v[4:5], v[4:5], v[196:197] op_sel_hi:[1,0]
    v_pk_mul_f32 v[6:7], v[6:7], v[196:197] op_sel_hi:[1,0]
    v_accvgpr_read_b32 v8, a72
    v_cvt_pk_bf16_f32 v4, v4, v5
    v_accvgpr_read_b32 v9, a73
    v_cvt_pk_bf16_f32 v5, v6, v7
    v_accvgpr_read_b32 v10, a74
    v_accvgpr_read_b32 v11, a75
    v_pk_mul_f32 v[8:9], v[8:9], v[196:197] op_sel_hi:[1,0]
    v_pk_mul_f32 v[10:11], v[10:11], v[196:197] op_sel_hi:[1,0]
    v_accvgpr_read_b32 v12, a76
    v_cvt_pk_bf16_f32 v8, v8, v9
    v_accvgpr_read_b32 v13, a77
    v_cvt_pk_bf16_f32 v9, v10, v11
    v_accvgpr_read_b32 v14, a78
    v_accvgpr_read_b32 v15, a79
    v_pk_mul_f32 v[12:13], v[12:13], v[196:197] op_sel_hi:[1,0]
    v_pk_mul_f32 v[14:15], v[14:15], v[196:197] op_sel_hi:[1,0]
    v_accvgpr_read_b32 v16, a80
    v_cvt_pk_bf16_f32 v12, v12, v13
    v_accvgpr_read_b32 v17, a81
    v_cvt_pk_bf16_f32 v13, v14, v15
    v_accvgpr_read_b32 v18, a82
    v_accvgpr_read_b32 v19, a83
    v_pk_mul_f32 v[16:17], v[16:17], v[196:197] op_sel_hi:[1,0]
    v_pk_mul_f32 v[18:19], v[18:19], v[196:197] op_sel_hi:[1,0]
    v_accvgpr_read_b32 v20, a84
    v_cvt_pk_bf16_f32 v16, v16, v17
    v_accvgpr_read_b32 v21, a85
    v_cvt_pk_bf16_f32 v17, v18, v19
    v_accvgpr_read_b32 v22, a86
    v_accvgpr_read_b32 v23, a87
    v_pk_mul_f32 v[20:21], v[20:21], v[196:197] op_sel_hi:[1,0]
    v_pk_mul_f32 v[22:23], v[22:23], v[196:197] op_sel_hi:[1,0]
    v_accvgpr_read_b32 v24, a88
    v_cvt_pk_bf16_f32 v20, v20, v21
    v_accvgpr_read_b32 v25, a89
    v_cvt_pk_bf16_f32 v21, v22, v23
    v_accvgpr_read_b32 v26, a90
    v_accvgpr_read_b32 v27, a91
    v_max3_f32 v237, v252, v253, v254
    v_pk_mul_f32 v[24:25], v[24:25], v[196:197] op_sel_hi:[1,0]
    v_cmp_le_f32 vcc, s66, v237
    v_pk_mul_f32 v[26:27], v[26:27], v[196:197] op_sel_hi:[1,0]
    v_accvgpr_read_b32 v28, a92
    v_cvt_pk_bf16_f32 v24, v24, v25
    v_accvgpr_read_b32 v29, a93
    s_or_b32 s74, vcc_lo, vcc_hi
    s_waitcnt lgkmcnt(0)
    buffer_store_dwordx4 a[32:35], v220, s[24:27], s69 offen offset:0 sc0 sc1
    v_cvt_pk_bf16_f32 v25, v26, v27
    v_accvgpr_read_b32 v30, a94
    v_accvgpr_read_b32 v31, a95
    v_mov_b32 v237, s74
    v_pk_mul_f32 v[28:29], v[28:29], v[196:197] op_sel_hi:[1,0]
    v_pk_mul_f32 v[30:31], v[30:31], v[196:197] op_sel_hi:[1,0]
    v_cvt_pk_bf16_f32 v28, v28, v29
    v_cvt_pk_bf16_f32 v29, v30, v31
    s_add_u32 s70, s56, 131072
    ds_write_b64 v184, v[0:1]
    ds_write_b64 v185, v[4:5]
    buffer_store_dwordx4 a[36:39], v221, s[24:27], s69 offen offset:1024 sc0 sc1
    ds_write_b64 v186, v[8:9]
    ds_write_b64 v187, v[12:13]
    ds_write_b64 v188, v[16:17]
    ds_write_b64 v189, v[20:21]
    buffer_store_dwordx4 a[40:43], v222, s[24:27], s69 offen offset:2048 sc0 sc1
    ds_write_b64 v190, v[24:25]
    ds_write_b32 v239, v237 offset:16384
    ds_write_b64 v191, v[28:29]
    ds_read_b128 a[64:67], v241 offset:0
    ds_read_b128 a[68:71], v241 offset:1024
    buffer_store_dwordx4 a[44:47], v223, s[24:27], s69 offen offset:3072 sc0 sc1
    ds_read_b128 a[72:75], v241 offset:2048
    ds_read_b128 a[76:79], v241 offset:3072
    s_waitcnt lgkmcnt(5)
    s_barrier
    s_waitcnt lgkmcnt(2)
    buffer_store_dwordx4 a[64:67], v220, s[24:27], s70 offen offset:0 sc0 sc1
    ds_read_b32 v244, v236
    buffer_store_dwordx4 a[68:71], v221, s[24:27], s70 offen offset:1024 sc0 sc1
    s_waitcnt lgkmcnt(0)
    v_cmp_ne_u32 vcc, 0, v244
    buffer_store_dwordx4 a[72:75], v222, s[24:27], s70 offen offset:2048 sc0 sc1
    buffer_store_dwordx4 a[76:79], v223, s[24:27], s70 offen offset:3072 sc0 sc1
    s_cbranch_vccnz Lrestart
    s_mov_b32 s64, 0
    s_waitcnt vmcnt(12)
    s_branch Lstart
Lxt3_3:
    s_cmp_lg_u32 s29, 0
    s_cbranch_scc1 Lft3_0_1
Lft3_0_0:
    s_waitcnt lgkmcnt(0)
    v_mfma_f32_16x16x32_bf16 a[240:243], v[228:231], v[164:167], a[240:243]
    ds_read_b64_tr_b16 a[192:193], v208 offset:16384
    v_exp_f32 v64, v64
    v_exp_f32 v65, v65
    v_exp_f32 v66, v66
    v_exp_f32 v67, v67
    v_exp_f32 v68, v68
    v_exp_f32 v69, v69
    v_exp_f32 v70, v70
    v_exp_f32 v71, v71
    v_cvt_pk_bf16_f32 v144, v64, v65
    v_cvt_pk_bf16_f32 v145, v66, v67
    v_cvt_pk_bf16_f32 v146, v68, v69
    v_cvt_pk_bf16_f32 v147, v70, v71
    v_xor_b32 v184, 0, v240
    v_xor_b32 v185, 32, v240
    v_mfma_f32_16x16x32_bf16 a[240:243], v[228:231], v[144:147], a[240:243]
    ds_read_b64_tr_b16 a[194:195], v208 offset:24576
    v_xor_b32 v186, 64, v240
    v_xor_b32 v187, 96, v240
    s_waitcnt vmcnt(8)
    s_barrier
    ds_read_b64_tr_b16 a[196:197], v209 offset:16384
    v_xor_b32 v188, 128, v240
    v_xor_b32 v189, 160, v240
    v_xor_b32 v190, 192, v240
    v_xor_b32 v191, 224, v240
    v_accvgpr_read_b32 v252, a240
    v_rcp_f32 v192, v252
    v_mfma_f32_16x16x32_bf16 a[244:247], v[228:231], v[168:171], a[244:247]
    ds_read_b64_tr_b16 a[198:199], v209 offset:24576
    ds_read_b64_tr_b16 a[200:201], v210 offset:16384
    ds_read_b64_tr_b16 a[202:203], v210 offset:24576
    ds_read_b64_tr_b16 a[204:205], v211 offset:16384
    s_waitcnt lgkmcnt(5)
    v_mfma_f32_16x16x32_bf16 a[0:3], a[192:195], v[164:167], a[0:3]
    ds_read_b64_tr_b16 a[206:207], v211 offset:24576
    ds_read_b64_tr_b16 a[208:209], v212 offset:16384
    v_mfma_f32_16x16x32_bf16 a[32:35], a[192:195], v[168:171], a[32:35]
    ds_read_b64_tr_b16 a[210:211], v212 offset:24576
    ds_read_b64_tr_b16 a[212:213], v213 offset:16384
    ds_read_b64_tr_b16 a[214:215], v213 offset:24576
    ds_read_b64_tr_b16 a[216:217], v214 offset:16384
    ds_read_b64_tr_b16 a[218:219], v214 offset:24576
    ds_read_b64_tr_b16 a[220:221], v215 offset:16384
    ds_read_b64_tr_b16 a[222:223], v215 offset:24576
    ds_read_b64_tr_b16 a[160:161], v208 offset:32768
    ds_read_b64_tr_b16 a[162:163], v208 offset:40960
    s_waitcnt lgkmcnt(13)
    v_mfma_f32_16x16x32_bf16 a[4:7], a[196:199], v[164:167], a[4:7]
    ds_read_b64_tr_b16 a[164:165], v209 offset:32768
    ds_read_b64_tr_b16 a[166:167], v209 offset:40960
    s_waitcnt lgkmcnt(13)
    v_mfma_f32_16x16x32_bf16 a[8:11], a[200:203], v[164:167], a[8:11]
    ds_read_b64_tr_b16 a[168:169], v210 offset:32768
    ds_read_b64_tr_b16 a[170:171], v210 offset:40960
    s_waitcnt lgkmcnt(12)
    v_mfma_f32_16x16x32_bf16 a[12:15], a[204:207], v[164:167], a[12:15]
    ds_read_b64_tr_b16 a[172:173], v211 offset:32768
    ds_read_b64_tr_b16 a[174:175], v211 offset:40960
    v_mfma_f32_16x16x32_bf16 a[16:19], a[208:211], v[164:167], a[16:19]
    ds_read_b64_tr_b16 a[176:177], v212 offset:32768
    ds_read_b64_tr_b16 a[178:179], v212 offset:40960
    s_waitcnt lgkmcnt(11)
    v_mfma_f32_16x16x32_bf16 a[20:23], a[212:215], v[164:167], a[20:23]
    ds_read_b64_tr_b16 a[180:181], v213 offset:32768
    ds_read_b64_tr_b16 a[182:183], v213 offset:40960
    v_mfma_f32_16x16x32_bf16 a[24:27], a[216:219], v[164:167], a[24:27]
    ds_read_b64_tr_b16 a[184:185], v214 offset:32768
    ds_read_b64_tr_b16 a[186:187], v214 offset:40960
    s_waitcnt lgkmcnt(10)
    v_mfma_f32_16x16x32_bf16 a[28:31], a[220:223], v[164:167], a[28:31]
    ds_read_b64_tr_b16 a[188:189], v215 offset:32768
    ds_read_b64_tr_b16 a[190:191], v215 offset:40960
    v_mfma_f32_16x16x32_bf16 a[0:3], a[160:163], v[144:147], a[0:3]
    s_add_u32 s68, s56, 0
    v_exp_f32 v72, v72
    v_mfma_f32_16x16x32_bf16 a[4:7], a[164:167], v[144:147], a[4:7]
    s_add_u32 s69, s56, 65536
    v_exp_f32 v73, v73
    s_waitcnt lgkmcnt(8)
    v_mfma_f32_16x16x32_bf16 a[8:11], a[168:171], v[144:147], a[8:11]
    s_nop 0
    v_accvgpr_read_b32 v0, a0
    v_mfma_f32_16x16x32_bf16 a[12:15], a[172:175], v[144:147], a[12:15]
    v_accvgpr_read_b32 v1, a1
    v_accvgpr_read_b32 v2, a2
    s_waitcnt lgkmcnt(4)
    v_mfma_f32_16x16x32_bf16 a[16:19], a[176:179], v[144:147], a[16:19]
    v_accvgpr_read_b32 v3, a3
    v_accvgpr_read_b32 v4, a4
    v_mfma_f32_16x16x32_bf16 a[20:23], a[180:183], v[144:147], a[20:23]
    v_accvgpr_read_b32 v5, a5
    v_accvgpr_read_b32 v6, a6
    s_waitcnt lgkmcnt(1)
    v_mfma_f32_16x16x32_bf16 a[24:27], a[184:187], v[144:147], a[24:27]
    v_accvgpr_read_b32 v7, a7
    v_accvgpr_read_b32 v8, a8
    s_waitcnt lgkmcnt(0)
    v_mfma_f32_16x16x32_bf16 a[28:31], a[188:191], v[144:147], a[28:31]
    v_accvgpr_read_b32 v9, a9
    v_accvgpr_read_b32 v10, a10
    v_mfma_f32_16x16x32_bf16 a[36:39], a[196:199], v[168:171], a[36:39]
    v_accvgpr_read_b32 v11, a11
    v_accvgpr_read_b32 v12, a12
    v_mfma_f32_16x16x32_bf16 a[40:43], a[200:203], v[168:171], a[40:43]
    v_accvgpr_read_b32 v13, a13
    v_accvgpr_read_b32 v14, a14
    v_mfma_f32_16x16x32_bf16 a[44:47], a[204:207], v[168:171], a[44:47]
    v_accvgpr_read_b32 v15, a15
    v_accvgpr_read_b32 v16, a16
    v_mfma_f32_16x16x32_bf16 a[48:51], a[208:211], v[168:171], a[48:51]
    v_accvgpr_read_b32 v17, a17
    v_accvgpr_read_b32 v18, a18
    v_mfma_f32_16x16x32_bf16 a[52:55], a[212:215], v[168:171], a[52:55]
    v_accvgpr_read_b32 v19, a19
    v_accvgpr_read_b32 v20, a20
    v_mfma_f32_16x16x32_bf16 a[56:59], a[216:219], v[168:171], a[56:59]
    v_accvgpr_read_b32 v21, a21
    v_accvgpr_read_b32 v22, a22
    v_mfma_f32_16x16x32_bf16 a[60:63], a[220:223], v[168:171], a[60:63]
    v_accvgpr_read_b32 v23, a23
    v_accvgpr_read_b32 v24, a24
    v_accvgpr_read_b32 v25, a25
    v_accvgpr_read_b32 v26, a26
    v_accvgpr_read_b32 v27, a27
    v_pk_mul_f32 v[0:1], v[0:1], v[192:193] op_sel_hi:[1,0]
    v_pk_mul_f32 v[2:3], v[2:3], v[192:193] op_sel_hi:[1,0]
    v_cvt_pk_bf16_f32 v0, v0, v1
    v_cvt_pk_bf16_f32 v1, v2, v3
    v_pk_mul_f32 v[4:5], v[4:5], v[192:193] op_sel_hi:[1,0]
    v_pk_mul_f32 v[6:7], v[6:7], v[192:193] op_sel_hi:[1,0]
    v_cvt_pk_bf16_f32 v4, v4, v5
    v_cvt_pk_bf16_f32 v5, v6, v7
    v_pk_mul_f32 v[8:9], v[8:9], v[192:193] op_sel_hi:[1,0]
    v_pk_mul_f32 v[10:11], v[10:11], v[192:193] op_sel_hi:[1,0]
    v_cvt_pk_bf16_f32 v8, v8, v9
    v_cvt_pk_bf16_f32 v9, v10, v11
    v_pk_mul_f32 v[12:13], v[12:13], v[192:193] op_sel_hi:[1,0]
    v_pk_mul_f32 v[14:15], v[14:15], v[192:193] op_sel_hi:[1,0]
    v_cvt_pk_bf16_f32 v12, v12, v13
    v_cvt_pk_bf16_f32 v13, v14, v15
    v_pk_mul_f32 v[16:17], v[16:17], v[192:193] op_sel_hi:[1,0]
    v_pk_mul_f32 v[18:19], v[18:19], v[192:193] op_sel_hi:[1,0]
    v_cvt_pk_bf16_f32 v16, v16, v17
    v_cvt_pk_bf16_f32 v17, v18, v19
    v_pk_mul_f32 v[20:21], v[20:21], v[192:193] op_sel_hi:[1,0]
    v_pk_mul_f32 v[22:23], v[22:23], v[192:193] op_sel_hi:[1,0]
    v_cvt_pk_bf16_f32 v20, v20, v21
    v_cvt_pk_bf16_f32 v21, v22, v23
    v_pk_mul_f32 v[24:25], v[24:25], v[192:193] op_sel_hi:[1,0]
    v_pk_mul_f32 v[26:27], v[26:27], v[192:193] op_sel_hi:[1,0]
    v_accvgpr_read_b32 v28, a28
    v_cvt_pk_bf16_f32 v24, v24, v25
    v_accvgpr_read_b32 v29, a29
    v_cvt_pk_bf16_f32 v25, v26, v27
    v_accvgpr_read_b32 v30, a30
    v_accvgpr_read_b32 v31, a31
    v_pk_mul_f32 v[28:29], v[28:29], v[192:193] op_sel_hi:[1,0]
    v_pk_mul_f32 v[30:31], v[30:31], v[192:193] op_sel_hi:[1,0]
    v_cvt_pk_bf16_f32 v28, v28, v29
    v_cvt_pk_bf16_f32 v29, v30, v31
    v_exp_f32 v74, v74
    v_exp_f32 v75, v75
    v_exp_f32 v76, v76
    v_exp_f32 v77, v77
    v_exp_f32 v78, v78
    v_exp_f32 v79, v79
    v_cvt_pk_bf16_f32 v148, v72, v73
    v_cvt_pk_bf16_f32 v149, v74, v75
    v_cvt_pk_bf16_f32 v150, v76, v77
    v_cvt_pk_bf16_f32 v151, v78, v79
    v_mfma_f32_16x16x32_bf16 a[248:251], v[228:231], v[172:175], a[248:251]
    ds_write_b64 v184, v[0:1]
    v_mfma_f32_16x16x32_bf16 a[244:247], v[228:231], v[148:151], a[244:247]
    ds_write_b64 v185, v[4:5]
    v_mfma_f32_16x16x32_bf16 a[32:35], a[160:163], v[148:151], a[32:35]
    ds_write_b64 v186, v[8:9]
    v_mfma_f32_16x16x32_bf16 a[36:39], a[164:167], v[148:151], a[36:39]
    ds_write_b64 v187, v[12:13]
    v_mfma_f32_16x16x32_bf16 a[40:43], a[168:171], v[148:151], a[40:43]
    ds_write_b64 v188, v[16:17]
    v_mfma_f32_16x16x32_bf16 a[44:47], a[172:175], v[148:151], a[44:47]
    ds_write_b64 v189, v[20:21]
    v_mfma_f32_16x16x32_bf16 a[48:51], a[176:179], v[148:151], a[48:51]
    ds_write_b64 v190, v[24:25]
    v_mfma_f32_16x16x32_bf16 a[52:55], a[180:183], v[148:151], a[52:55]
    ds_write_b64 v191, v[28:29]
    v_mfma_f32_16x16x32_bf16 a[56:59], a[184:187], v[148:151], a[56:59]
    ds_read_b128 a[0:3], v241 offset:0
    v_accvgpr_read_b32 v253, a244
    v_mfma_f32_16x16x32_bf16 a[60:63], a[188:191], v[148:151], a[60:63]
    ds_read_b128 a[4:7], v241 offset:1024
    v_rcp_f32 v194, v253
    v_accvgpr_read_b32 v32, a32
    v_accvgpr_read_b32 v33, a33
    v_accvgpr_read_b32 v34, a34
    v_accvgpr_read_b32 v35, a35
    v_pk_mul_f32 v[32:33], v[32:33], v[194:195] op_sel_hi:[1,0]
    v_pk_mul_f32 v[34:35], v[34:35], v[194:195] op_sel_hi:[1,0]
    v_accvgpr_read_b32 v36, a36
    v_cvt_pk_bf16_f32 v32, v32, v33
    v_accvgpr_read_b32 v37, a37
    v_cvt_pk_bf16_f32 v33, v34, v35
    v_accvgpr_read_b32 v38, a38
    v_accvgpr_read_b32 v39, a39
    v_pk_mul_f32 v[36:37], v[36:37], v[194:195] op_sel_hi:[1,0]
    v_pk_mul_f32 v[38:39], v[38:39], v[194:195] op_sel_hi:[1,0]
    v_accvgpr_read_b32 v40, a40
    v_cvt_pk_bf16_f32 v36, v36, v37
    v_accvgpr_read_b32 v41, a41
    v_mfma_f32_16x16x32_bf16 a[64:67], a[192:195], v[172:175], a[64:67]
    ds_read_b128 a[8:11], v241 offset:2048
    v_cvt_pk_bf16_f32 v37, v38, v39
    v_accvgpr_read_b32 v42, a42
    v_mfma_f32_16x16x32_bf16 a[68:71], a[196:199], v[172:175], a[68:71]
    s_waitcnt lgkmcnt(2)
    buffer_store_dwordx4 a[0:3], v220, s[24:27], s68 offen offset:0 sc0 sc1
    v_accvgpr_read_b32 v43, a43
    v_mfma_f32_16x16x32_bf16 a[72:75], a[200:203], v[172:175], a[72:75]
    ds_read_b128 a[12:15], v241 offset:3072
    v_accvgpr_read_b32 v44, a44
    v_mfma_f32_16x16x32_bf16 a[76:79], a[204:207], v[172:175], a[76:79]
    ds_write_b64 v184, v[32:33]
    v_mfma_f32_16x16x32_bf16 a[80:83], a[208:211], v[172:175], a[80:83]
    ds_write_b64 v185, v[36:37]
    v_mfma_f32_16x16x32_bf16 a[84:87], a[212:215], v[172:175], a[84:87]
    v_accvgpr_read_b32 v45, a45
    v_accvgpr_read_b32 v46, a46
    v_mfma_f32_16x16x32_bf16 a[88:91], a[216:219], v[172:175], a[88:91]
    s_waitcnt lgkmcnt(3)
    buffer_store_dwordx4 a[4:7], v221, s[24:27], s68 offen offset:1024 sc0 sc1
    v_mfma_f32_16x16x32_bf16 a[92:95], a[220:223], v[172:175], a[92:95]
    v_accvgpr_read_b32 v47, a47
    v_accvgpr_read_b32 v48, a48
    v_accvgpr_read_b32 v49, a49
    v_accvgpr_read_b32 v50, a50
    v_accvgpr_read_b32 v51, a51
    v_pk_mul_f32 v[40:41], v[40:41], v[194:195] op_sel_hi:[1,0]
    v_pk_mul_f32 v[42:43], v[42:43], v[194:195] op_sel_hi:[1,0]
    v_cvt_pk_bf16_f32 v40, v40, v41
    v_cvt_pk_bf16_f32 v41, v42, v43
    v_pk_mul_f32 v[44:45], v[44:45], v[194:195] op_sel_hi:[1,0]
    v_pk_mul_f32 v[46:47], v[46:47], v[194:195] op_sel_hi:[1,0]
    v_cvt_pk_bf16_f32 v44, v44, v45
    v_cvt_pk_bf16_f32 v45, v46, v47
    v_pk_mul_f32 v[48:49], v[48:49], v[194:195] op_sel_hi:[1,0]
    v_pk_mul_f32 v[50:51], v[50:51], v[194:195] op_sel_hi:[1,0]
    v_accvgpr_read_b32 v52, a52
    v_cvt_pk_bf16_f32 v48, v48, v49
    v_accvgpr_read_b32 v53, a53
    v_cvt_pk_bf16_f32 v49, v50, v51
    v_accvgpr_read_b32 v54, a54
    v_accvgpr_read_b32 v55, a55
    v_pk_mul_f32 v[52:53], v[52:53], v[194:195] op_sel_hi:[1,0]
    v_pk_mul_f32 v[54:55], v[54:55], v[194:195] op_sel_hi:[1,0]
    v_accvgpr_read_b32 v56, a56
    v_cvt_pk_bf16_f32 v52, v52, v53
    v_accvgpr_read_b32 v57, a57
    v_cvt_pk_bf16_f32 v53, v54, v55
    v_accvgpr_read_b32 v58, a58
    v_accvgpr_read_b32 v59, a59
    v_pk_mul_f32 v[56:57], v[56:57], v[194:195] op_sel_hi:[1,0]
    v_pk_mul_f32 v[58:59], v[58:59], v[194:195] op_sel_hi:[1,0]
    v_accvgpr_read_b32 v60, a60
    v_cvt_pk_bf16_f32 v56, v56, v57
    v_accvgpr_read_b32 v61, a61
    v_cvt_pk_bf16_f32 v57, v58, v59
    v_accvgpr_read_b32 v62, a62
    v_accvgpr_read_b32 v63, a63
    v_pk_mul_f32 v[60:61], v[60:61], v[194:195] op_sel_hi:[1,0]
    v_pk_mul_f32 v[62:63], v[62:63], v[194:195] op_sel_hi:[1,0]
    v_cvt_pk_bf16_f32 v60, v60, v61
    v_cvt_pk_bf16_f32 v61, v62, v63
    v_exp_f32 v80, v80
    v_exp_f32 v81, v81
    v_exp_f32 v82, v82
    v_exp_f32 v83, v83
    v_exp_f32 v84, v84
    v_exp_f32 v85, v85
    v_exp_f32 v86, v86
    v_exp_f32 v87, v87
    v_cvt_pk_bf16_f32 v152, v80, v81
    v_cvt_pk_bf16_f32 v153, v82, v83
    v_cvt_pk_bf16_f32 v154, v84, v85
    v_cvt_pk_bf16_f32 v155, v86, v87
    buffer_store_dwordx4 a[8:11], v222, s[24:27], s68 offen offset:2048 sc0 sc1
    ds_write_b64 v186, v[40:41]
    v_mfma_f32_16x16x32_bf16 a[248:251], v[228:231], v[152:155], a[248:251]
    ds_write_b64 v187, v[44:45]
    v_mfma_f32_16x16x32_bf16 a[64:67], a[160:163], v[152:155], a[64:67]
    ds_write_b64 v188, v[48:49]
    v_mfma_f32_16x16x32_bf16 a[68:71], a[164:167], v[152:155], a[68:71]
    ds_write_b64 v189, v[52:53]
    v_mfma_f32_16x16x32_bf16 a[72:75], a[168:171], v[152:155], a[72:75]
    s_waitcnt lgkmcnt(4)
    buffer_store_dwordx4 a[12:15], v223, s[24:27], s68 offen offset:3072 sc0 sc1
    v_accvgpr_read_b32 v254, a248
    v_mfma_f32_16x16x32_bf16 a[76:79], a[172:175], v[152:155], a[76:79]
    ds_write_b64 v190, v[56:57]
    v_mfma_f32_16x16x32_bf16 a[80:83], a[176:179], v[152:155], a[80:83]
    ds_write_b64 v191, v[60:61]
    v_mfma_f32_16x16x32_bf16 a[84:87], a[180:183], v[152:155], a[84:87]
    ds_read_b128 a[32:35], v241 offset:0
    v_rcp_f32 v196, v254
    v_mfma_f32_16x16x32_bf16 a[88:91], a[184:187], v[152:155], a[88:91]
    ds_read_b128 a[36:39], v241 offset:1024
    v_accvgpr_read_b32 v0, a64
    v_mfma_f32_16x16x32_bf16 a[92:95], a[188:191], v[152:155], a[92:95]
    ds_read_b128 a[40:43], v241 offset:2048
    v_accvgpr_read_b32 v1, a65
    v_accvgpr_read_b32 v2, a66
    v_accvgpr_read_b32 v3, a67
    v_accvgpr_read_b32 v4, a68
    v_pk_mul_f32 v[0:1], v[0:1], v[196:197] op_sel_hi:[1,0]
    v_pk_mul_f32 v[2:3], v[2:3], v[196:197] op_sel_hi:[1,0]
    v_cvt_pk_bf16_f32 v0, v0, v1
    v_accvgpr_read_b32 v5, a69
    v_cvt_pk_bf16_f32 v1, v2, v3
    v_accvgpr_read_b32 v6, a70
    v_accvgpr_read_b32 v7, a71
    v_pk_mul_f32 v[4:5], v[4:5], v[196:197] op_sel_hi:[1,0]
    v_pk_mul_f32 v[6:7], v[6:7], v[196:197] op_sel_hi:[1,0]
    v_accvgpr_read_b32 v8, a72
    v_cvt_pk_bf16_f32 v4, v4, v5
    v_accvgpr_read_b32 v9, a73
    v_cvt_pk_bf16_f32 v5, v6, v7
    v_accvgpr_read_b32 v10, a74
    v_accvgpr_read_b32 v11, a75
    v_pk_mul_f32 v[8:9], v[8:9], v[196:197] op_sel_hi:[1,0]
    v_pk_mul_f32 v[10:11], v[10:11], v[196:197] op_sel_hi:[1,0]
    v_accvgpr_read_b32 v12, a76
    v_cvt_pk_bf16_f32 v8, v8, v9
    v_accvgpr_read_b32 v13, a77
    v_cvt_pk_bf16_f32 v9, v10, v11
    v_accvgpr_read_b32 v14, a78
    v_accvgpr_read_b32 v15, a79
    v_pk_mul_f32 v[12:13], v[12:13], v[196:197] op_sel_hi:[1,0]
    v_pk_mul_f32 v[14:15], v[14:15], v[196:197] op_sel_hi:[1,0]
    v_accvgpr_read_b32 v16, a80
    v_cvt_pk_bf16_f32 v12, v12, v13
    v_accvgpr_read_b32 v17, a81
    v_cvt_pk_bf16_f32 v13, v14, v15
    v_accvgpr_read_b32 v18, a82
    v_accvgpr_read_b32 v19, a83
    v_pk_mul_f32 v[16:17], v[16:17], v[196:197] op_sel_hi:[1,0]
    v_pk_mul_f32 v[18:19], v[18:19], v[196:197] op_sel_hi:[1,0]
    v_accvgpr_read_b32 v20, a84
    v_cvt_pk_bf16_f32 v16, v16, v17
    v_accvgpr_read_b32 v21, a85
    v_cvt_pk_bf16_f32 v17, v18, v19
    v_accvgpr_read_b32 v22, a86
    v_accvgpr_read_b32 v23, a87
    v_pk_mul_f32 v[20:21], v[20:21], v[196:197] op_sel_hi:[1,0]
    v_pk_mul_f32 v[22:23], v[22:23], v[196:197] op_sel_hi:[1,0]
    v_accvgpr_read_b32 v24, a88
    v_cvt_pk_bf16_f32 v20, v20, v21
    v_accvgpr_read_b32 v25, a89
    v_cvt_pk_bf16_f32 v21, v22, v23
    v_accvgpr_read_b32 v26, a90
    v_accvgpr_read_b32 v27, a91
    v_max3_f32 v237, v252, v253, v254
    v_pk_mul_f32 v[24:25], v[24:25], v[196:197] op_sel_hi:[1,0]
    v_cmp_le_f32 vcc, s66, v237
    v_pk_mul_f32 v[26:27], v[26:27], v[196:197] op_sel_hi:[1,0]
    v_accvgpr_read_b32 v28, a92
    v_cvt_pk_bf16_f32 v24, v24, v25
    v_accvgpr_read_b32 v29, a93
    s_or_b32 s74, vcc_lo, vcc_hi
    s_waitcnt lgkmcnt(0)
    buffer_store_dwordx4 a[32:35], v220, s[24:27], s69 offen offset:0 sc0 sc1
    v_cvt_pk_bf16_f32 v25, v26, v27
    v_accvgpr_read_b32 v30, a94
    v_accvgpr_read_b32 v31, a95
    v_mov_b32 v237, s74
    v_pk_mul_f32 v[28:29], v[28:29], v[196:197] op_sel_hi:[1,0]
    v_pk_mul_f32 v[30:31], v[30:31], v[196:197] op_sel_hi:[1,0]
    v_cvt_pk_bf16_f32 v28, v28, v29
    v_cvt_pk_bf16_f32 v29, v30, v31
    s_add_u32 s70, s56, 131072
    ds_read_b128 a[44:47], v241 offset:3072
    ds_write_b64 v184, v[0:1]
    ds_write_b64 v185, v[4:5]
    buffer_store_dwordx4 a[36:39], v221, s[24:27], s69 offen offset:1024 sc0 sc1
    ds_write_b64 v186, v[8:9]
    ds_write_b64 v187, v[12:13]
    ds_write_b64 v188, v[16:17]
    ds_write_b64 v189, v[20:21]
    buffer_store_dwordx4 a[40:43], v222, s[24:27], s69 offen offset:2048 sc0 sc1
    ds_write_b64 v190, v[24:25]
    ds_write_b32 v239, v237 offset:16384
    ds_write_b64 v191, v[28:29]
    ds_read_b128 a[64:67], v241 offset:0
    ds_read_b128 a[68:71], v241 offset:1024
    s_waitcnt lgkmcnt(6)
    buffer_store_dwordx4 a[44:47], v223, s[24:27], s69 offen offset:3072 sc0 sc1
    ds_read_b128 a[72:75], v241 offset:2048
    ds_read_b128 a[76:79], v241 offset:3072
    s_waitcnt lgkmcnt(5)
    s_barrier
    s_waitcnt lgkmcnt(2)
    buffer_store_dwordx4 a[64:67], v220, s[24:27], s70 offen offset:0 sc0 sc1
    ds_read_b32 v244, v236
    buffer_store_dwordx4 a[68:71], v221, s[24:27], s70 offen offset:1024 sc0 sc1
    s_waitcnt lgkmcnt(0)
    v_cmp_ne_u32 vcc, 0, v244
    buffer_store_dwordx4 a[72:75], v222, s[24:27], s70 offen offset:2048 sc0 sc1
    buffer_store_dwordx4 a[76:79], v223, s[24:27], s70 offen offset:3072 sc0 sc1
    s_cbranch_vccnz Lrestart
    s_endpgm
Lft3_0_1:
    s_waitcnt lgkmcnt(0)
    v_mfma_f32_16x16x32_bf16 a[240:243], v[228:231], v[164:167], a[240:243]
    ds_read_b64_tr_b16 a[192:193], v208 offset:16384
    v_exp_f32 v64, v64
    v_exp_f32 v65, v65
    v_exp_f32 v66, v66
    v_exp_f32 v67, v67
    v_exp_f32 v68, v68
    v_exp_f32 v69, v69
    v_exp_f32 v70, v70
    v_exp_f32 v71, v71
    v_cvt_pk_bf16_f32 v144, v64, v65
    v_cvt_pk_bf16_f32 v145, v66, v67
    v_cvt_pk_bf16_f32 v146, v68, v69
    v_cvt_pk_bf16_f32 v147, v70, v71
    v_xor_b32 v184, 0, v240
    v_xor_b32 v185, 32, v240
    v_mfma_f32_16x16x32_bf16 a[240:243], v[228:231], v[144:147], a[240:243]
    ds_read_b64_tr_b16 a[194:195], v208 offset:24576
    s_waitcnt vmcnt(8)
    s_barrier
    s_mov_b32 m0, s41
    s_add_u32 s18, s30, 4096
    buffer_load_dwordx4 v216, s[16:19], s31 offen offset:2048 lds
    s_add_u32 s61, s55, 0
    ds_read_b64_tr_b16 a[196:197], v209 offset:16384
    v_xor_b32 v186, 64, v240
    v_xor_b32 v187, 96, v240
    v_xor_b32 v188, 128, v240
    v_xor_b32 v189, 160, v240
    v_xor_b32 v190, 192, v240
    v_xor_b32 v191, 224, v240
    v_accvgpr_read_b32 v252, a240
    v_rcp_f32 v192, v252
    v_mfma_f32_16x16x32_bf16 a[244:247], v[228:231], v[168:171], a[244:247]
    ds_read_b64_tr_b16 a[198:199], v209 offset:24576
    ds_read_b64_tr_b16 a[200:201], v210 offset:16384
    s_waitcnt lgkmcnt(3)
    v_mfma_f32_16x16x32_bf16 a[0:3], a[192:195], v[164:167], a[0:3]
    buffer_load_dwordx4 v217, s[16:19], s31 offen offset:3072 lds
    s_mov_b32 m0, s3
    ds_read_b64_tr_b16 a[202:203], v210 offset:24576
    ds_read_b64_tr_b16 a[204:205], v211 offset:16384
    ds_read_b64_tr_b16 a[206:207], v211 offset:24576
    ds_read_b64_tr_b16 a[208:209], v212 offset:16384
    ds_read_b64_tr_b16 a[210:211], v212 offset:24576
    ds_read_b64_tr_b16 a[212:213], v213 offset:16384
    ds_read_b64_tr_b16 a[214:215], v213 offset:24576
    ds_read_b64_tr_b16 a[216:217], v214 offset:16384
    buffer_load_dwordx4 v220, s[12:15], s61 offen offset:0 nt lds
    ds_read_b64_tr_b16 a[218:219], v214 offset:24576
    ds_read_b64_tr_b16 a[220:221], v215 offset:16384
    ds_read_b64_tr_b16 a[222:223], v215 offset:24576
    s_waitcnt lgkmcnt(11)
    v_mfma_f32_16x16x32_bf16 a[4:7], a[196:199], v[164:167], a[4:7]
    ds_read_b64_tr_b16 a[160:161], v208 offset:32768
    ds_read_b64_tr_b16 a[162:163], v208 offset:40960
    v_mfma_f32_16x16x32_bf16 a[32:35], a[192:195], v[168:171], a[32:35]
    buffer_load_dwordx4 v221, s[12:15], s61 offen offset:1024 nt lds
    ds_read_b64_tr_b16 a[164:165], v209 offset:32768
    s_waitcnt lgkmcnt(11)
    v_mfma_f32_16x16x32_bf16 a[8:11], a[200:203], v[164:167], a[8:11]
    ds_read_b64_tr_b16 a[166:167], v209 offset:40960
    ds_read_b64_tr_b16 a[168:169], v210 offset:32768
    v_mfma_f32_16x16x32_bf16 a[12:15], a[204:207], v[164:167], a[12:15]
    ds_read_b64_tr_b16 a[170:171], v210 offset:40960
    ds_read_b64_tr_b16 a[172:173], v211 offset:32768
    s_waitcnt lgkmcnt(10)
    v_mfma_f32_16x16x32_bf16 a[16:19], a[208:211], v[164:167], a[16:19]
    buffer_load_dwordx4 v222, s[12:15], s61 offen offset:2048 nt lds
    ds_read_b64_tr_b16 a[174:175], v211 offset:40960
    v_mfma_f32_16x16x32_bf16 a[20:23], a[212:215], v[164:167], a[20:23]
    ds_read_b64_tr_b16 a[176:177], v212 offset:32768
    ds_read_b64_tr_b16 a[178:179], v212 offset:40960
    s_waitcnt lgkmcnt(9)
    v_mfma_f32_16x16x32_bf16 a[24:27], a[216:219], v[164:167], a[24:27]
    ds_read_b64_tr_b16 a[180:181], v213 offset:32768
    ds_read_b64_tr_b16 a[182:183], v213 offset:40960
    v_mfma_f32_16x16x32_bf16 a[28:31], a[220:223], v[164:167], a[28:31]
    buffer_load_dwordx4 v223, s[12:15], s61 offen offset:3072 nt lds
    s_add_u32 m0, s3, 4096
    s_waitcnt lgkmcnt(8)
    v_mfma_f32_16x16x32_bf16 a[0:3], a[160:163], v[144:147], a[0:3]
    s_add_u32 s61, s55, 65536
    ds_read_b64_tr_b16 a[184:185], v214 offset:32768
    ds_read_b64_tr_b16 a[186:187], v214 offset:40960
    v_mfma_f32_16x16x32_bf16 a[4:7], a[164:167], v[144:147], a[4:7]
    ds_read_b64_tr_b16 a[188:189], v215 offset:32768
    ds_read_b64_tr_b16 a[190:191], v215 offset:40960
    s_waitcnt lgkmcnt(9)
    v_mfma_f32_16x16x32_bf16 a[8:11], a[168:171], v[144:147], a[8:11]
    buffer_load_dwordx4 v220, s[12:15], s61 offen offset:0 nt lds
    v_accvgpr_read_b32 v0, a0
    s_waitcnt lgkmcnt(7)
    v_mfma_f32_16x16x32_bf16 a[12:15], a[172:175], v[144:147], a[12:15]
    s_add_u32 s68, s56, 0
    v_accvgpr_read_b32 v1, a1
    v_accvgpr_read_b32 v2, a2
    s_waitcnt lgkmcnt(6)
    v_mfma_f32_16x16x32_bf16 a[16:19], a[176:179], v[144:147], a[16:19]
    v_accvgpr_read_b32 v3, a3
    v_accvgpr_read_b32 v4, a4
    s_waitcnt lgkmcnt(4)
    v_mfma_f32_16x16x32_bf16 a[20:23], a[180:183], v[144:147], a[20:23]
    buffer_load_dwordx4 v221, s[12:15], s61 offen offset:1024 nt lds
    v_accvgpr_read_b32 v5, a5
    v_accvgpr_read_b32 v6, a6
    v_accvgpr_read_b32 v7, a7
    v_pk_mul_f32 v[0:1], v[0:1], v[192:193] op_sel_hi:[1,0]
    v_pk_mul_f32 v[2:3], v[2:3], v[192:193] op_sel_hi:[1,0]
    s_waitcnt lgkmcnt(2)
    v_mfma_f32_16x16x32_bf16 a[24:27], a[184:187], v[144:147], a[24:27]
    v_cvt_pk_bf16_f32 v0, v0, v1
    v_cvt_pk_bf16_f32 v1, v2, v3
    s_waitcnt lgkmcnt(0)
    v_mfma_f32_16x16x32_bf16 a[28:31], a[188:191], v[144:147], a[28:31]
    ds_write_b64 v184, v[0:1]
    v_accvgpr_read_b32 v8, a8
    v_accvgpr_read_b32 v9, a9
    v_pk_mul_f32 v[4:5], v[4:5], v[192:193] op_sel_hi:[1,0]
    v_pk_mul_f32 v[6:7], v[6:7], v[192:193] op_sel_hi:[1,0]
    v_cvt_pk_bf16_f32 v4, v4, v5
    v_cvt_pk_bf16_f32 v5, v6, v7
    v_accvgpr_read_b32 v10, a10
    v_mfma_f32_16x16x32_bf16 a[36:39], a[196:199], v[168:171], a[36:39]
    buffer_load_dwordx4 v222, s[12:15], s61 offen offset:2048 nt lds
    v_accvgpr_read_b32 v11, a11
    v_mfma_f32_16x16x32_bf16 a[40:43], a[200:203], v[168:171], a[40:43]
    ds_write_b64 v185, v[4:5]
    v_mfma_f32_16x16x32_bf16 a[44:47], a[204:207], v[168:171], a[44:47]
    v_accvgpr_read_b32 v12, a12
    v_accvgpr_read_b32 v13, a13
    v_mfma_f32_16x16x32_bf16 a[48:51], a[208:211], v[168:171], a[48:51]
    v_accvgpr_read_b32 v14, a14
    v_accvgpr_read_b32 v15, a15
    v_mfma_f32_16x16x32_bf16 a[52:55], a[212:215], v[168:171], a[52:55]
    buffer_load_dwordx4 v223, s[12:15], s61 offen offset:3072 nt lds
    s_add_u32 m0, s41, 16384
    v_mfma_f32_16x16x32_bf16 a[56:59], a[216:219], v[168:171], a[56:59]
    v_accvgpr_read_b32 v16, a16
    v_accvgpr_read_b32 v17, a17
    v_mfma_f32_16x16x32_bf16 a[60:63], a[220:223], v[168:171], a[60:63]
    v_accvgpr_read_b32 v18, a18
    v_accvgpr_read_b32 v19, a19
    v_accvgpr_read_b32 v20, a20
    v_accvgpr_read_b32 v21, a21
    v_accvgpr_read_b32 v22, a22
    v_pk_mul_f32 v[8:9], v[8:9], v[192:193] op_sel_hi:[1,0]
    v_pk_mul_f32 v[10:11], v[10:11], v[192:193] op_sel_hi:[1,0]
    v_cvt_pk_bf16_f32 v8, v8, v9
    v_cvt_pk_bf16_f32 v9, v10, v11
    v_pk_mul_f32 v[12:13], v[12:13], v[192:193] op_sel_hi:[1,0]
    v_pk_mul_f32 v[14:15], v[14:15], v[192:193] op_sel_hi:[1,0]
    v_cvt_pk_bf16_f32 v12, v12, v13
    v_cvt_pk_bf16_f32 v13, v14, v15
    v_pk_mul_f32 v[16:17], v[16:17], v[192:193] op_sel_hi:[1,0]
    v_pk_mul_f32 v[18:19], v[18:19], v[192:193] op_sel_hi:[1,0]
    v_cvt_pk_bf16_f32 v16, v16, v17
    v_cvt_pk_bf16_f32 v17, v18, v19
    v_accvgpr_read_b32 v23, a23
    v_pk_mul_f32 v[20:21], v[20:21], v[192:193] op_sel_hi:[1,0]
    v_pk_mul_f32 v[22:23], v[22:23], v[192:193] op_sel_hi:[1,0]
    v_accvgpr_read_b32 v24, a24
    v_cvt_pk_bf16_f32 v20, v20, v21
    v_accvgpr_read_b32 v25, a25
    v_cvt_pk_bf16_f32 v21, v22, v23
    v_accvgpr_read_b32 v26, a26
    v_accvgpr_read_b32 v27, a27
    v_pk_mul_f32 v[24:25], v[24:25], v[192:193] op_sel_hi:[1,0]
    v_pk_mul_f32 v[26:27], v[26:27], v[192:193] op_sel_hi:[1,0]
    v_accvgpr_read_b32 v28, a28
    v_cvt_pk_bf16_f32 v24, v24, v25
    v_accvgpr_read_b32 v29, a29
    v_cvt_pk_bf16_f32 v25, v26, v27
    v_accvgpr_read_b32 v30, a30
    v_accvgpr_read_b32 v31, a31
    v_pk_mul_f32 v[28:29], v[28:29], v[192:193] op_sel_hi:[1,0]
    v_pk_mul_f32 v[30:31], v[30:31], v[192:193] op_sel_hi:[1,0]
    v_cvt_pk_bf16_f32 v28, v28, v29
    v_cvt_pk_bf16_f32 v29, v30, v31
    v_exp_f32 v72, v72
    v_exp_f32 v73, v73
    v_exp_f32 v74, v74
    v_exp_f32 v75, v75
    v_exp_f32 v76, v76
    v_exp_f32 v77, v77
    v_exp_f32 v78, v78
    v_exp_f32 v79, v79
    v_cvt_pk_bf16_f32 v148, v72, v73
    v_cvt_pk_bf16_f32 v149, v74, v75
    v_cvt_pk_bf16_f32 v150, v76, v77
    v_cvt_pk_bf16_f32 v151, v78, v79
    v_mfma_f32_16x16x32_bf16 a[248:251], v[228:231], v[172:175], a[248:251]
    buffer_load_dwordx4 v216, s[16:19], s28 offen offset:2048 lds
    ds_write_b64 v186, v[8:9]
    v_mfma_f32_16x16x32_bf16 a[244:247], v[228:231], v[148:151], a[244:247]
    ds_write_b64 v187, v[12:13]
    v_mfma_f32_16x16x32_bf16 a[32:35], a[160:163], v[148:151], a[32:35]
    ds_write_b64 v188, v[16:17]
    v_mfma_f32_16x16x32_bf16 a[36:39], a[164:167], v[148:151], a[36:39]
    buffer_load_dwordx4 v217, s[16:19], s28 offen offset:3072 lds
    ds_write_b64 v189, v[20:21]
    v_mfma_f32_16x16x32_bf16 a[40:43], a[168:171], v[148:151], a[40:43]
    ds_write_b64 v190, v[24:25]
    v_mfma_f32_16x16x32_bf16 a[44:47], a[172:175], v[148:151], a[44:47]
    ds_write_b64 v191, v[28:29]
    v_mfma_f32_16x16x32_bf16 a[48:51], a[176:179], v[148:151], a[48:51]
    ds_read_b128 a[0:3], v241 offset:0
    v_accvgpr_read_b32 v253, a244
    v_mfma_f32_16x16x32_bf16 a[52:55], a[180:183], v[148:151], a[52:55]
    ds_read_b128 a[4:7], v241 offset:1024
    v_rcp_f32 v194, v253
    v_mfma_f32_16x16x32_bf16 a[56:59], a[184:187], v[148:151], a[56:59]
    ds_read_b128 a[8:11], v241 offset:2048
    v_accvgpr_read_b32 v32, a32
    v_mfma_f32_16x16x32_bf16 a[60:63], a[188:191], v[148:151], a[60:63]
    ds_read_b128 a[12:15], v241 offset:3072
    v_accvgpr_read_b32 v33, a33
    v_accvgpr_read_b32 v34, a34
    v_accvgpr_read_b32 v35, a35
    v_accvgpr_read_b32 v36, a36
    v_pk_mul_f32 v[32:33], v[32:33], v[194:195] op_sel_hi:[1,0]
    v_pk_mul_f32 v[34:35], v[34:35], v[194:195] op_sel_hi:[1,0]
    v_cvt_pk_bf16_f32 v32, v32, v33
    v_accvgpr_read_b32 v37, a37
    v_cvt_pk_bf16_f32 v33, v34, v35
    v_accvgpr_read_b32 v38, a38
    v_accvgpr_read_b32 v39, a39
    v_pk_mul_f32 v[36:37], v[36:37], v[194:195] op_sel_hi:[1,0]
    v_pk_mul_f32 v[38:39], v[38:39], v[194:195] op_sel_hi:[1,0]
    v_accvgpr_read_b32 v40, a40
    v_cvt_pk_bf16_f32 v36, v36, v37
    v_accvgpr_read_b32 v41, a41
    v_mfma_f32_16x16x32_bf16 a[64:67], a[192:195], v[172:175], a[64:67]
    s_waitcnt lgkmcnt(3)
    buffer_store_dwordx4 a[0:3], v220, s[24:27], s68 offen offset:0 sc0 sc1
    v_cvt_pk_bf16_f32 v37, v38, v39
    v_accvgpr_read_b32 v42, a42
    v_mfma_f32_16x16x32_bf16 a[68:71], a[196:199], v[172:175], a[68:71]
    ds_write_b64 v184, v[32:33]
    v_accvgpr_read_b32 v43, a43
    v_mfma_f32_16x16x32_bf16 a[72:75], a[200:203], v[172:175], a[72:75]
    s_add_u32 s69, s56, 65536
    ds_write_b64 v185, v[36:37]
    v_mfma_f32_16x16x32_bf16 a[76:79], a[204:207], v[172:175], a[76:79]
    v_accvgpr_read_b32 v44, a44
    v_accvgpr_read_b32 v45, a45
    v_mfma_f32_16x16x32_bf16 a[80:83], a[208:211], v[172:175], a[80:83]
    v_accvgpr_read_b32 v46, a46
    v_accvgpr_read_b32 v47, a47
    v_mfma_f32_16x16x32_bf16 a[84:87], a[212:215], v[172:175], a[84:87]
    s_waitcnt lgkmcnt(2)
    buffer_store_dwordx4 a[4:7], v221, s[24:27], s68 offen offset:1024 sc0 sc1
    v_accvgpr_read_b32 v48, a48
    v_mfma_f32_16x16x32_bf16 a[88:91], a[216:219], v[172:175], a[88:91]
    v_accvgpr_read_b32 v49, a49
    v_accvgpr_read_b32 v50, a50
    v_mfma_f32_16x16x32_bf16 a[92:95], a[220:223], v[172:175], a[92:95]
    v_accvgpr_read_b32 v51, a51
    v_accvgpr_read_b32 v52, a52
    v_accvgpr_read_b32 v53, a53
    v_accvgpr_read_b32 v54, a54
    v_accvgpr_read_b32 v55, a55
    v_pk_mul_f32 v[40:41], v[40:41], v[194:195] op_sel_hi:[1,0]
    v_pk_mul_f32 v[42:43], v[42:43], v[194:195] op_sel_hi:[1,0]
    v_cvt_pk_bf16_f32 v40, v40, v41
    v_cvt_pk_bf16_f32 v41, v42, v43
    v_pk_mul_f32 v[44:45], v[44:45], v[194:195] op_sel_hi:[1,0]
    v_pk_mul_f32 v[46:47], v[46:47], v[194:195] op_sel_hi:[1,0]
    v_cvt_pk_bf16_f32 v44, v44, v45
    v_cvt_pk_bf16_f32 v45, v46, v47
    v_pk_mul_f32 v[48:49], v[48:49], v[194:195] op_sel_hi:[1,0]
    v_pk_mul_f32 v[50:51], v[50:51], v[194:195] op_sel_hi:[1,0]
    v_cvt_pk_bf16_f32 v48, v48, v49
    v_cvt_pk_bf16_f32 v49, v50, v51
    v_pk_mul_f32 v[52:53], v[52:53], v[194:195] op_sel_hi:[1,0]
    v_pk_mul_f32 v[54:55], v[54:55], v[194:195] op_sel_hi:[1,0]
    v_accvgpr_read_b32 v56, a56
    v_cvt_pk_bf16_f32 v52, v52, v53
    v_accvgpr_read_b32 v57, a57
    v_cvt_pk_bf16_f32 v53, v54, v55
    v_accvgpr_read_b32 v58, a58
    v_accvgpr_read_b32 v59, a59
    v_pk_mul_f32 v[56:57], v[56:57], v[194:195] op_sel_hi:[1,0]
    v_pk_mul_f32 v[58:59], v[58:59], v[194:195] op_sel_hi:[1,0]
    v_accvgpr_read_b32 v60, a60
    v_cvt_pk_bf16_f32 v56, v56, v57
    v_accvgpr_read_b32 v61, a61
    v_cvt_pk_bf16_f32 v57, v58, v59
    v_accvgpr_read_b32 v62, a62
    v_accvgpr_read_b32 v63, a63
    v_pk_mul_f32 v[60:61], v[60:61], v[194:195] op_sel_hi:[1,0]
    v_pk_mul_f32 v[62:63], v[62:63], v[194:195] op_sel_hi:[1,0]
    v_cvt_pk_bf16_f32 v60, v60, v61
    v_cvt_pk_bf16_f32 v61, v62, v63
    v_exp_f32 v80, v80
    v_exp_f32 v81, v81
    v_exp_f32 v82, v82
    v_exp_f32 v83, v83
    v_exp_f32 v84, v84
    v_exp_f32 v85, v85
    v_exp_f32 v86, v86
    v_exp_f32 v87, v87
    v_cvt_pk_bf16_f32 v152, v80, v81
    v_cvt_pk_bf16_f32 v153, v82, v83
    v_cvt_pk_bf16_f32 v154, v84, v85
    v_cvt_pk_bf16_f32 v155, v86, v87
    buffer_store_dwordx4 a[8:11], v222, s[24:27], s68 offen offset:2048 sc0 sc1
    ds_write_b64 v186, v[40:41]
    v_mfma_f32_16x16x32_bf16 a[248:251], v[228:231], v[152:155], a[248:251]
    ds_write_b64 v187, v[44:45]
    v_mfma_f32_16x16x32_bf16 a[64:67], a[160:163], v[152:155], a[64:67]
    ds_write_b64 v188, v[48:49]
    v_mfma_f32_16x16x32_bf16 a[68:71], a[164:167], v[152:155], a[68:71]
    ds_write_b64 v189, v[52:53]
    v_mfma_f32_16x16x32_bf16 a[72:75], a[168:171], v[152:155], a[72:75]
    buffer_store_dwordx4 a[12:15], v223, s[24:27], s68 offen offset:3072 sc0 sc1
    ds_write_b64 v190, v[56:57]
    v_mfma_f32_16x16x32_bf16 a[76:79], a[172:175], v[152:155], a[76:79]
    ds_write_b64 v191, v[60:61]
    v_mfma_f32_16x16x32_bf16 a[80:83], a[176:179], v[152:155], a[80:83]
    ds_read_b128 a[32:35], v241 offset:0
    v_accvgpr_read_b32 v254, a248
    v_mfma_f32_16x16x32_bf16 a[84:87], a[180:183], v[152:155], a[84:87]
    ds_read_b128 a[36:39], v241 offset:1024
    v_rcp_f32 v196, v254
    v_mfma_f32_16x16x32_bf16 a[88:91], a[184:187], v[152:155], a[88:91]
    ds_read_b128 a[40:43], v241 offset:2048
    v_accvgpr_read_b32 v0, a64
    v_mfma_f32_16x16x32_bf16 a[92:95], a[188:191], v[152:155], a[92:95]
    ds_read_b128 a[44:47], v241 offset:3072
    v_accvgpr_read_b32 v1, a65
    v_accvgpr_read_b32 v2, a66
    v_accvgpr_read_b32 v3, a67
    v_accvgpr_read_b32 v4, a68
    v_pk_mul_f32 v[0:1], v[0:1], v[196:197] op_sel_hi:[1,0]
    v_pk_mul_f32 v[2:3], v[2:3], v[196:197] op_sel_hi:[1,0]
    v_cvt_pk_bf16_f32 v0, v0, v1
    v_accvgpr_read_b32 v5, a69
    v_cvt_pk_bf16_f32 v1, v2, v3
    v_accvgpr_read_b32 v6, a70
    v_accvgpr_read_b32 v7, a71
    v_pk_mul_f32 v[4:5], v[4:5], v[196:197] op_sel_hi:[1,0]
    v_pk_mul_f32 v[6:7], v[6:7], v[196:197] op_sel_hi:[1,0]
    v_accvgpr_read_b32 v8, a72
    v_cvt_pk_bf16_f32 v4, v4, v5
    v_accvgpr_read_b32 v9, a73
    v_cvt_pk_bf16_f32 v5, v6, v7
    v_accvgpr_read_b32 v10, a74
    v_accvgpr_read_b32 v11, a75
    v_pk_mul_f32 v[8:9], v[8:9], v[196:197] op_sel_hi:[1,0]
    v_pk_mul_f32 v[10:11], v[10:11], v[196:197] op_sel_hi:[1,0]
    v_accvgpr_read_b32 v12, a76
    v_cvt_pk_bf16_f32 v8, v8, v9
    v_accvgpr_read_b32 v13, a77
    v_cvt_pk_bf16_f32 v9, v10, v11
    v_accvgpr_read_b32 v14, a78
    v_accvgpr_read_b32 v15, a79
    v_pk_mul_f32 v[12:13], v[12:13], v[196:197] op_sel_hi:[1,0]
    v_pk_mul_f32 v[14:15], v[14:15], v[196:197] op_sel_hi:[1,0]
    v_accvgpr_read_b32 v16, a80
    v_cvt_pk_bf16_f32 v12, v12, v13
    v_accvgpr_read_b32 v17, a81
    v_cvt_pk_bf16_f32 v13, v14, v15
    v_accvgpr_read_b32 v18, a82
    v_accvgpr_read_b32 v19, a83
    v_pk_mul_f32 v[16:17], v[16:17], v[196:197] op_sel_hi:[1,0]
    v_pk_mul_f32 v[18:19], v[18:19], v[196:197] op_sel_hi:[1,0]
    v_accvgpr_read_b32 v20, a84
    v_cvt_pk_bf16_f32 v16, v16, v17
    v_accvgpr_read_b32 v21, a85
    v_cvt_pk_bf16_f32 v17, v18, v19
    v_accvgpr_read_b32 v22, a86
    v_accvgpr_read_b32 v23, a87
    v_pk_mul_f32 v[20:21], v[20:21], v[196:197] op_sel_hi:[1,0]
    v_pk_mul_f32 v[22:23], v[22:23], v[196:197] op_sel_hi:[1,0]
    v_accvgpr_read_b32 v24, a88
    v_cvt_pk_bf16_f32 v20, v20, v21
    v_accvgpr_read_b32 v25, a89
    v_cvt_pk_bf16_f32 v21, v22, v23
    v_accvgpr_read_b32 v26, a90
    v_accvgpr_read_b32 v27, a91
    v_max3_f32 v237, v252, v253, v254
    v_pk_mul_f32 v[24:25], v[24:25], v[196:197] op_sel_hi:[1,0]
    v_cmp_le_f32 vcc, s66, v237
    v_pk_mul_f32 v[26:27], v[26:27], v[196:197] op_sel_hi:[1,0]
    v_accvgpr_read_b32 v28, a92
    v_cvt_pk_bf16_f32 v24, v24, v25
    v_accvgpr_read_b32 v29, a93
    s_or_b32 s74, vcc_lo, vcc_hi
    s_waitcnt lgkmcnt(0)
    buffer_store_dwordx4 a[32:35], v220, s[24:27], s69 offen offset:0 sc0 sc1
    v_cvt_pk_bf16_f32 v25, v26, v27
    v_accvgpr_read_b32 v30, a94
    v_accvgpr_read_b32 v31, a95
    v_mov_b32 v237, s74
    v_pk_mul_f32 v[28:29], v[28:29], v[196:197] op_sel_hi:[1,0]
    v_pk_mul_f32 v[30:31], v[30:31], v[196:197] op_sel_hi:[1,0]
    v_cvt_pk_bf16_f32 v28, v28, v29
    v_cvt_pk_bf16_f32 v29, v30, v31
    s_add_u32 s70, s56, 131072
    ds_write_b64 v184, v[0:1]
    ds_write_b64 v185, v[4:5]
    buffer_store_dwordx4 a[36:39], v221, s[24:27], s69 offen offset:1024 sc0 sc1
    ds_write_b64 v186, v[8:9]
    ds_write_b64 v187, v[12:13]
    ds_write_b64 v188, v[16:17]
    ds_write_b64 v189, v[20:21]
    buffer_store_dwordx4 a[40:43], v222, s[24:27], s69 offen offset:2048 sc0 sc1
    ds_write_b64 v190, v[24:25]
    ds_write_b32 v239, v237 offset:16384
    ds_write_b64 v191, v[28:29]
    ds_read_b128 a[64:67], v241 offset:0
    ds_read_b128 a[68:71], v241 offset:1024
    buffer_store_dwordx4 a[44:47], v223, s[24:27], s69 offen offset:3072 sc0 sc1
    ds_read_b128 a[72:75], v241 offset:2048
    ds_read_b128 a[76:79], v241 offset:3072
    s_waitcnt lgkmcnt(5)
    s_barrier
    s_waitcnt lgkmcnt(2)
    buffer_store_dwordx4 a[64:67], v220, s[24:27], s70 offen offset:0 sc0 sc1
    ds_read_b32 v244, v236
    buffer_store_dwordx4 a[68:71], v221, s[24:27], s70 offen offset:1024 sc0 sc1
    s_waitcnt lgkmcnt(0)
    v_cmp_ne_u32 vcc, 0, v244
    buffer_store_dwordx4 a[72:75], v222, s[24:27], s70 offen offset:2048 sc0 sc1
    buffer_store_dwordx4 a[76:79], v223, s[24:27], s70 offen offset:3072 sc0 sc1
    s_cbranch_vccnz Lrestart
    s_mov_b32 s64, 0
    s_waitcnt vmcnt(12)
    s_branch Lstart
Lpro2:
    v_xor_b32 v252, 0, v239
    v_add_u32 v176, 8, v252
    v_xor_b32 v254, 128, v239
    v_add_u32 v178, 8, v254
    v_xor_b32 v253, 64, v239
    v_add_u32 v177, 8, v253
    v_xor_b32 v255, 192, v239
    v_add_u32 v179, 8, v255
    v_mul_u32_u24 v172, 15875, v238
    v_mul_u32_u24 v173, 15875, v243
    v_mul_u32_u24 v174, 47576, v238
    v_mul_u32_u24 v175, 47576, v243
    v_sub_u32 v244, s54, v242
    v_cmp_lt_i32 s[68:69], 0, v244
    v_cmp_lt_i32 s[70:71], 1, v244
    v_cmp_lt_i32 s[72:73], 2, v244
    v_cmp_lt_i32 s[74:75], 3, v244
    v_mov_b32 v245, s46
    v_cndmask_b32 v164, v245, 0, s[68:69]
    v_cndmask_b32 v165, v245, 0, s[70:71]
    v_cndmask_b32 v166, v245, 0, s[72:73]
    v_cndmask_b32 v167, v245, 0, s[74:75]
    v_cmp_lt_i32 s[68:69], 16, v244
    v_cmp_lt_i32 s[70:71], 17, v244
    v_cmp_lt_i32 s[72:73], 18, v244
    s_cmp_eq_u32 s64, 0
    s_cbranch_scc1 Lw7569030
    s_waitcnt vmcnt(6)
Lw7569030:
    ds_read2st64_b64 a[4:7], v176 offset0:0 offset1:0
    s_barrier
    ds_read2st64_b64 a[0:3], v252 offset0:0 offset1:0
    v_cmp_lt_i32 s[74:75], 19, v244
    v_cndmask_b32 v168, v245, 0, s[68:69]
    v_cndmask_b32 v169, v245, 0, s[70:71]
    v_cndmask_b32 v170, v245, 0, s[72:73]
    v_cndmask_b32 v171, v245, 0, s[74:75]
    ds_read2st64_b64 a[20:23], v178 offset0:0 offset1:0
    ds_read2st64_b64 a[8:11], v253 offset0:0 offset1:0
    ds_read2st64_b64 a[12:15], v177 offset0:0 offset1:0
    ds_read2st64_b64 a[16:19], v254 offset0:0 offset1:0
    ds_read_b128 a[176:179], v204 offset:8192
    ds_read2st64_b64 a[24:27], v255 offset0:0 offset1:0
    ds_read2st64_b64 a[28:31], v179 offset0:0 offset1:0
    s_waitcnt lgkmcnt(8)
    v_mfma_f32_16x16x32_bf16 v[68:71], v[172:175], a[4:7], 0
    ds_read_b128 a[180:183], v205 offset:8192
    ds_read_b128 a[184:187], v206 offset:8192
    ds_read_b128 a[188:191], v207 offset:8192
    ds_read_b128 a[160:163], v204 offset:0
    s_waitcnt lgkmcnt(11)
    v_mfma_f32_16x16x32_bf16 v[64:67], v[172:175], a[0:3], 0
    ds_read_b128 a[164:167], v205 offset:0
    s_nop 0
    v_cvt_pk_bf16_f32 v2, v68, v69
    v_cvt_pk_bf16_f32 v3, v70, v71
    s_waitcnt lgkmcnt(10)
    v_mfma_f32_16x16x32_bf16 v[68:71], v[172:175], a[20:23], 0
    ds_read_b128 a[168:171], v206 offset:0
    v_mfma_f32_16x16x32_bf16 v[104:107], v[172:175], a[8:11], 0
    ds_read_b128 a[172:175], v207 offset:0
    v_cvt_pk_bf16_f32 v0, v64, v65
    s_waitcnt lgkmcnt(8)
    v_mfma_f32_16x16x32_bf16 v[108:111], v[172:175], a[12:15], 0
    v_cvt_pk_bf16_f32 v1, v66, v67
    v_mfma_f32_16x16x32_bf16 v[64:67], v[172:175], a[16:19], 0
    v_cvt_pk_bf16_f32 v10, v68, v69
    v_cvt_pk_bf16_f32 v11, v70, v71
    v_mfma_f32_16x16x32_bf16 v[68:71], a[176:179], v[0:3], v[168:171]
    v_cvt_pk_bf16_f32 v4, v104, v105
    v_cvt_pk_bf16_f32 v5, v106, v107
    v_mfma_f32_16x16x32_bf16 v[104:107], v[172:175], a[24:27], 0
    v_cvt_pk_bf16_f32 v6, v108, v109
    v_cvt_pk_bf16_f32 v7, v110, v111
    s_waitcnt lgkmcnt(2)
    v_mfma_f32_16x16x32_bf16 v[108:111], v[172:175], a[28:31], 0
    v_cvt_pk_bf16_f32 v8, v64, v65
    v_cvt_pk_bf16_f32 v9, v66, v67
    v_mfma_f32_16x16x32_bf16 v[68:71], a[180:183], v[4:7], v[68:71]
    s_nop 0
    v_cvt_pk_bf16_f32 v12, v104, v105
    v_mfma_f32_16x16x32_bf16 v[68:71], a[184:187], v[8:11], v[68:71]
    v_cvt_pk_bf16_f32 v13, v106, v107
    s_nop 0
    v_cvt_pk_bf16_f32 v14, v108, v109
    v_mfma_f32_16x16x32_bf16 v[64:67], a[160:163], v[0:3], v[164:167]
    v_cvt_pk_bf16_f32 v15, v110, v111
    v_mfma_f32_16x16x32_bf16 v[64:67], a[164:167], v[4:7], v[64:67]
    s_nop 0
    v_mfma_f32_16x16x32_bf16 v[68:71], a[188:191], v[12:15], v[68:71]
    s_cmp_eq_u32 s64, 0
    s_cbranch_scc1 Lw7569103
    s_waitcnt vmcnt(0)
Lw7569103:
    ds_read2st64_b64 a[32:35], v252 offset0:8 offset1:8
    s_waitcnt lgkmcnt(1)
    v_mfma_f32_16x16x32_bf16 v[64:67], a[168:171], v[8:11], v[64:67]
    ds_read2st64_b64 a[36:39], v176 offset0:8 offset1:8
    s_barrier
    v_mfma_f32_16x16x32_bf16 v[64:67], a[172:175], v[12:15], v[64:67]
    s_add_u32 m0, s41, 32768
    ds_read_b128 a[192:195], v204 offset:16384
    s_add_u32 s61, s36, 131072
    buffer_load_dwordx4 v216, s[16:19], s61 offen offset:2048 lds
    ds_read_b128 a[196:199], v205 offset:16384
    ds_read_b128 a[200:203], v206 offset:16384
    ds_read_b128 a[204:207], v207 offset:16384
    ds_read_b128 a[208:211], v204 offset:24576
    v_max3_f32 v246, v64, v65, v66
    v_max3_f32 v246, v246, v67, v68
    v_max3_f32 v246, v246, v69, v70
    s_waitcnt lgkmcnt(6)
    v_mfma_f32_16x16x32_bf16 v[72:75], v[172:175], a[32:35], 0
    ds_read_b128 a[212:215], v205 offset:24576
    v_max_f32 v246, v246, v71
    s_waitcnt lgkmcnt(6)
    v_mfma_f32_16x16x32_bf16 v[76:79], v[172:175], a[36:39], 0
    buffer_load_dwordx4 v217, s[16:19], s61 offen offset:3072 lds
    s_add_u32 m0, s41, 32768
    s_add_u32 s61, s36, 262144
    ds_read_b128 a[216:219], v206 offset:24576
    v_cvt_pk_bf16_f32 v16, v72, v73
    v_cvt_pk_bf16_f32 v17, v74, v75
    v_mov_b32 v247, v246
    s_nop 0
    v_cvt_pk_bf16_f32 v18, v76, v77
    v_cvt_pk_bf16_f32 v19, v78, v79
    v_permlane32_swap_b32 v246, v247
    v_max_f32 v246, v246, v247
    v_mov_b32 v247, v246
    buffer_load_dwordx4 v218, s[20:23], s43 offen lds
    ds_read_b128 a[220:223], v207 offset:24576
    v_permlane16_swap_b32 v246, v247
    v_max_f32 v246, v246, v247
    v_add_f32 v246, s44, v246
    v_sub_f32 v184, 0, v246
    v_sub_f32 v185, 0, v246
    v_sub_f32 v186, 0, v246
    v_sub_f32 v187, 0, v246
    v_sub_f32 v64, v64, v246
    v_sub_f32 v65, v65, v246
    s_waitcnt lgkmcnt(2)
    v_mfma_f32_16x16x32_bf16 v[104:107], a[192:195], v[0:3], v[184:187]
    buffer_load_dwordx4 v219, s[20:23], s43 offen offset:1024 lds
    s_add_u32 m0, s41, 49152
    v_mfma_f32_16x16x32_bf16 v[108:111], a[208:211], v[0:3], v[184:187]
    ds_read2st64_b64 a[48:51], v254 offset0:8 offset1:8
    v_sub_f32 v66, v66, v246
    v_mfma_f32_16x16x32_bf16 v[104:107], a[196:199], v[4:7], v[104:107]
    ds_read2st64_b64 a[52:55], v178 offset0:8 offset1:8
    v_sub_f32 v67, v67, v246
    v_mfma_f32_16x16x32_bf16 v[108:111], a[212:215], v[4:7], v[108:111]
    ds_read2st64_b64 a[40:43], v253 offset0:8 offset1:8
    v_exp_f32 v224, v64
    v_mfma_f32_16x16x32_bf16 v[104:107], a[200:203], v[8:11], v[104:107]
    buffer_load_dwordx4 v216, s[16:19], s61 offen offset:2048 lds
    s_waitcnt lgkmcnt(3)
    s_barrier
    v_mfma_f32_16x16x32_bf16 v[108:111], a[216:219], v[8:11], v[108:111]
    s_add_u32 s40, s40, 131072
    ds_read2st64_b64 a[44:47], v177 offset0:8 offset1:8
    s_add_u32 s63, s63, 131072
    v_mfma_f32_16x16x32_bf16 v[104:107], a[204:207], v[12:15], v[104:107]
    buffer_load_dwordx4 v217, s[16:19], s61 offen offset:3072 lds
    s_add_u32 m0, s41, 49152
    s_waitcnt lgkmcnt(2)
    v_mfma_f32_16x16x32_bf16 v[72:75], v[172:175], a[48:51], 0
    ds_read2st64_b64 a[56:59], v255 offset0:8 offset1:8
    v_exp_f32 v225, v65
    v_mfma_f32_16x16x32_bf16 v[76:79], v[172:175], a[52:55], 0
    ds_read2st64_b64 a[60:63], v179 offset0:8 offset1:8
    v_exp_f32 v226, v66
    s_waitcnt lgkmcnt(3)
    v_mfma_f32_16x16x32_bf16 v[112:115], v[172:175], a[40:43], 0
    buffer_load_dwordx4 v218, s[20:23], s36 offen lds
    v_cvt_pk_bf16_f32 v24, v72, v73
    v_mfma_f32_16x16x32_bf16 v[108:111], a[220:223], v[12:15], v[108:111]
    v_cvt_pk_bf16_f32 v25, v74, v75
    v_cvt_pk_bf16_f32 v26, v76, v77
    v_mfma_f32_16x16x32_bf16 v[72:75], a[160:163], v[16:19], v[164:167]
    v_cvt_pk_bf16_f32 v27, v78, v79
    v_exp_f32 v227, v67
    s_waitcnt lgkmcnt(2)
    v_mfma_f32_16x16x32_bf16 v[116:119], v[172:175], a[44:47], 0
    v_cvt_pk_bf16_f32 v20, v112, v113
    v_cvt_pk_bf16_f32 v21, v114, v115
    v_mfma_f32_16x16x32_bf16 v[76:79], a[176:179], v[16:19], v[168:171]
    buffer_load_dwordx4 v219, s[20:23], s36 offen offset:1024 lds
    s_mov_b32 m0, s41
    s_waitcnt lgkmcnt(1)
    v_mfma_f32_16x16x32_bf16 v[112:115], v[172:175], a[56:59], 0
    v_sub_f32 v68, v68, v246
    v_cvt_pk_bf16_f32 v22, v116, v117
    v_cvt_pk_bf16_f32 v23, v118, v119
    s_waitcnt lgkmcnt(0)
    v_mfma_f32_16x16x32_bf16 v[116:119], v[172:175], a[60:63], 0
    v_sub_f32 v69, v69, v246
    v_sub_f32 v70, v70, v246
    v_mfma_f32_16x16x32_bf16 v[72:75], a[164:167], v[20:23], v[72:75]
    buffer_load_dwordx4 v218, s[20:23], s40 offen lds
    v_mfma_f32_16x16x32_bf16 v[76:79], a[180:183], v[20:23], v[76:79]
    v_cvt_pk_bf16_f32 v28, v112, v113
    v_cvt_pk_bf16_f32 v29, v114, v115
    v_mfma_f32_16x16x32_bf16 v[72:75], a[168:171], v[24:27], v[72:75]
    v_cvt_pk_bf16_f32 v30, v116, v117
    v_cvt_pk_bf16_f32 v31, v118, v119
    v_mfma_f32_16x16x32_bf16 v[76:79], a[184:187], v[24:27], v[76:79]
    v_sub_f32 v71, v71, v246
    v_cvt_pk_bf16_f32 v144, v224, v225
    v_mfma_f32_16x16x32_bf16 v[72:75], a[172:175], v[28:31], v[72:75]
    buffer_load_dwordx4 v219, s[20:23], s40 offen offset:1024 lds
    v_mfma_f32_16x16x32_bf16 v[76:79], a[188:191], v[28:31], v[76:79]
    s_add_u32 s40, s40, 131072
    v_cvt_pk_bf16_f32 v145, v226, v227
    v_exp_f32 v224, v68
    v_exp_f32 v225, v69
    v_exp_f32 v226, v70
    v_exp_f32 v227, v71
    v_max3_f32 v244, v72, v73, v74
    v_cvt_pk_bf16_f32 v146, v224, v225
    v_max3_f32 v244, v244, v75, v76
    v_max3_f32 v244, v244, v77, v78
    v_max_f32 v244, v244, v79
    v_mov_b32 v245, v244
    v_cvt_pk_bf16_f32 v147, v226, v227
    s_nop 0
    v_permlane32_swap_b32 v244, v245
    v_max_f32 v244, v244, v245
    v_mov_b32 v245, v244
    buffer_load_dwordx4 v216, s[16:19], s63 offen offset:2048 lds
    s_nop 0
    v_permlane16_swap_b32 v244, v245
    v_max_f32 v244, v244, v245
    v_add_f32 v244, s44, v244
    v_sub_f32 v188, 0, v244
    v_sub_f32 v189, 0, v244
    v_sub_f32 v190, 0, v244
    v_sub_f32 v191, 0, v244
    v_sub_f32 v72, v72, v244
    v_sub_f32 v73, v73, v244
    v_mfma_f32_16x16x32_bf16 v[112:115], a[192:195], v[16:19], v[188:191]
    v_sub_f32 v74, v74, v244
    v_sub_f32 v75, v75, v244
    v_mfma_f32_16x16x32_bf16 v[116:119], a[208:211], v[16:19], v[188:191]
    buffer_load_dwordx4 v217, s[16:19], s63 offen offset:3072 lds
    s_add_u32 m0, s41, 16384
    v_mfma_f32_16x16x32_bf16 v[112:115], a[196:199], v[20:23], v[112:115]
    s_add_u32 s63, s63, 131072
    v_sub_f32 v76, v76, v244
    v_sub_f32 v77, v77, v244
    v_mfma_f32_16x16x32_bf16 v[116:119], a[212:215], v[20:23], v[116:119]
    v_sub_f32 v78, v78, v244
    v_sub_f32 v79, v79, v244
    v_mfma_f32_16x16x32_bf16 v[112:115], a[200:203], v[24:27], v[112:115]
    s_waitcnt vmcnt(8)
    s_barrier
    v_mfma_f32_16x16x32_bf16 v[116:119], a[216:219], v[24:27], v[116:119]
    buffer_load_dwordx4 v218, s[20:23], s40 offen lds
    v_exp_f32 v248, v72
    v_mfma_f32_16x16x32_bf16 v[112:115], a[204:207], v[28:31], v[112:115]
    ds_read_b128 a[160:163], v204 offset:32768
    v_exp_f32 v249, v73
    v_mfma_f32_16x16x32_bf16 v[116:119], a[220:223], v[28:31], v[116:119]
    ds_read_b128 a[164:167], v205 offset:32768
    v_exp_f32 v250, v74
    v_exp_f32 v251, v75
    v_cvt_pk_bf16_f32 v148, v248, v249
    v_cvt_pk_bf16_f32 v149, v250, v251
    v_exp_f32 v248, v76
    v_exp_f32 v249, v77
    v_exp_f32 v250, v78
    v_exp_f32 v251, v79
    v_cvt_pk_bf16_f32 v150, v248, v249
    v_cvt_pk_bf16_f32 v151, v250, v251
    ds_read_b128 a[168:171], v206 offset:32768
    ds_read_b128 a[172:175], v207 offset:32768
    ds_read_b128 a[176:179], v204 offset:40960
    ds_read_b128 a[180:183], v205 offset:40960
    ds_read_b128 a[184:187], v206 offset:40960
    ds_read_b128 a[188:191], v207 offset:40960
    buffer_load_dwordx4 v219, s[20:23], s40 offen offset:1024 lds
    buffer_load_dwordx4 v216, s[16:19], s63 offen offset:2048 lds
    buffer_load_dwordx4 v217, s[16:19], s63 offen offset:3072 lds
    s_sub_u32 s42, s42, 1
    s_cmp_lg_u32 s65, 0
    s_cbranch_scc1 Lsafe2
    s_waitcnt lgkmcnt(0)
    v_mfma_f32_16x16x32_bf16 v[64:67], a[160:163], v[0:3], v[184:187]
    ds_read_b64_tr_b16 a[192:193], v208 offset:32768
    ds_read_b64_tr_b16 a[194:195], v208 offset:40960
    v_mfma_f32_16x16x32_bf16 v[72:75], a[160:163], v[16:19], v[188:191]
    ds_read_b64_tr_b16 a[196:197], v209 offset:32768
    v_exp_f32 v224, v112
    v_mfma_f32_16x16x32_bf16 v[64:67], a[164:167], v[4:7], v[64:67]
    ds_read_b64_tr_b16 a[198:199], v209 offset:40960
    v_exp_f32 v225, v113
    v_mfma_f32_16x16x32_bf16 v[72:75], a[164:167], v[20:23], v[72:75]
    ds_read_b64_tr_b16 a[200:201], v210 offset:32768
    ds_read_b64_tr_b16 a[202:203], v210 offset:40960
    v_mfma_f32_16x16x32_bf16 v[64:67], a[168:171], v[8:11], v[64:67]
    ds_read_b64_tr_b16 a[204:205], v211 offset:32768
    v_cvt_pk_bf16_f32 v168, v224, v225
    v_mfma_f32_16x16x32_bf16 v[72:75], a[168:171], v[24:27], v[72:75]
    ds_read_b64_tr_b16 a[206:207], v211 offset:40960
    v_exp_f32 v226, v114
    v_mfma_f32_16x16x32_bf16 v[64:67], a[172:175], v[12:15], v[64:67]
    ds_read_b64_tr_b16 a[208:209], v212 offset:32768
    ds_read_b64_tr_b16 a[210:211], v212 offset:40960
    v_mfma_f32_16x16x32_bf16 v[72:75], a[172:175], v[28:31], v[72:75]
    ds_read_b64_tr_b16 a[212:213], v213 offset:32768
    v_exp_f32 v227, v115
    v_mfma_f32_16x16x32_bf16 v[68:71], a[176:179], v[0:3], v[184:187]
    ds_read_b64_tr_b16 a[214:215], v213 offset:40960
    v_cvt_pk_bf16_f32 v169, v226, v227
    v_mfma_f32_16x16x32_bf16 v[76:79], a[176:179], v[16:19], v[188:191]
    ds_read_b64_tr_b16 a[216:217], v214 offset:32768
    ds_read_b64_tr_b16 a[218:219], v214 offset:40960
    v_mfma_f32_16x16x32_bf16 v[68:71], a[180:183], v[4:7], v[68:71]
    ds_read_b64_tr_b16 a[220:221], v215 offset:32768
    v_exp_f32 v248, v116
    v_mfma_f32_16x16x32_bf16 v[76:79], a[180:183], v[20:23], v[76:79]
    ds_read_b64_tr_b16 a[222:223], v215 offset:40960
    v_exp_f32 v249, v117
    v_mfma_f32_16x16x32_bf16 v[68:71], a[184:187], v[8:11], v[68:71]
    s_add_u32 m0, s41, 32768
    v_exp_f32 v250, v118
    v_mfma_f32_16x16x32_bf16 v[76:79], a[184:187], v[24:27], v[76:79]
    s_add_u32 s40, s40, 131072
    v_exp_f32 v251, v119
    v_mfma_f32_16x16x32_bf16 v[68:71], a[188:191], v[12:15], v[68:71]
    s_add_u32 s63, s63, 131072
    v_exp_f32 v224, v104
    v_mfma_f32_16x16x32_bf16 v[76:79], a[188:191], v[28:31], v[76:79]
    s_waitcnt vmcnt(8) lgkmcnt(0)
    s_barrier
    v_mfma_f32_16x16x32_bf16 a[0:3], a[192:195], v[144:147], 0
    ds_read_b128 a[160:163], v204 offset:49152
    v_cvt_pk_bf16_f32 v170, v248, v249
    v_mfma_f32_16x16x32_bf16 a[32:35], a[192:195], v[148:151], 0
    ds_read_b128 a[164:167], v205 offset:49152
    v_cvt_pk_bf16_f32 v171, v250, v251
    v_mfma_f32_16x16x32_bf16 a[4:7], a[196:199], v[144:147], 0
    buffer_load_dwordx4 v218, s[20:23], s40 offen lds
    v_exp_f32 v225, v105
    v_mfma_f32_16x16x32_bf16 a[36:39], a[196:199], v[148:151], 0
    ds_read_b128 a[168:171], v206 offset:49152
    v_cvt_pk_bf16_f32 v164, v224, v225
    v_mfma_f32_16x16x32_bf16 a[8:11], a[200:203], v[144:147], 0
    ds_read_b128 a[172:175], v207 offset:49152
    v_exp_f32 v226, v106
    v_mfma_f32_16x16x32_bf16 a[40:43], a[200:203], v[148:151], 0
    ds_read_b128 a[176:179], v204 offset:57344
    v_exp_f32 v227, v107
    v_mfma_f32_16x16x32_bf16 a[12:15], a[204:207], v[144:147], 0
    v_exp_f32 v248, v108
    v_mfma_f32_16x16x32_bf16 a[44:47], a[204:207], v[148:151], 0
    buffer_load_dwordx4 v219, s[20:23], s40 offen offset:1024 lds
    v_cvt_pk_bf16_f32 v165, v226, v227
    v_mfma_f32_16x16x32_bf16 a[16:19], a[208:211], v[144:147], 0
    ds_read_b128 a[180:183], v205 offset:57344
    v_mfma_f32_16x16x32_bf16 a[48:51], a[208:211], v[148:151], 0
    ds_read_b128 a[184:187], v206 offset:57344
    v_mfma_f32_16x16x32_bf16 a[20:23], a[212:215], v[144:147], 0
    ds_read_b128 a[188:191], v207 offset:57344
    v_mfma_f32_16x16x32_bf16 a[52:55], a[212:215], v[148:151], 0
    buffer_load_dwordx4 v216, s[16:19], s63 offen offset:2048 lds
    v_mfma_f32_16x16x32_bf16 a[24:27], a[216:219], v[144:147], 0
    v_exp_f32 v249, v109
    v_mfma_f32_16x16x32_bf16 a[56:59], a[216:219], v[148:151], 0
    v_exp_f32 v250, v110
    v_mfma_f32_16x16x32_bf16 a[28:31], a[220:223], v[144:147], 0
    v_exp_f32 v251, v111
    v_mfma_f32_16x16x32_bf16 a[60:63], a[220:223], v[148:151], 0
    v_cvt_pk_bf16_f32 v166, v248, v249
    v_cvt_pk_bf16_f32 v167, v250, v251
    v_mfma_f32_16x16x32_bf16 a[240:243], v[228:231], v[144:147], 0
    s_sub_u32 s42, s42, 1
    buffer_load_dwordx4 v217, s[16:19], s63 offen offset:3072 lds
    v_mfma_f32_16x16x32_bf16 a[244:247], v[228:231], v[148:151], 0
    .p2align 3
Lloop2:
    s_waitcnt lgkmcnt(0)
    v_mfma_f32_16x16x32_bf16 v[104:107], a[160:163], v[0:3], v[184:187]
    ds_read_b64_tr_b16 a[192:193], v208 offset:49152
    ds_read_b64_tr_b16 a[194:195], v208 offset:57344
    v_mfma_f32_16x16x32_bf16 v[112:115], a[160:163], v[16:19], v[188:191]
    ds_read_b64_tr_b16 a[196:197], v209 offset:49152
    v_exp_f32 v224, v72
    v_mfma_f32_16x16x32_bf16 v[104:107], a[164:167], v[4:7], v[104:107]
    ds_read_b64_tr_b16 a[198:199], v209 offset:57344
    v_exp_f32 v225, v73
    v_mfma_f32_16x16x32_bf16 v[112:115], a[164:167], v[20:23], v[112:115]
    ds_read_b64_tr_b16 a[200:201], v210 offset:49152
    ds_read_b64_tr_b16 a[202:203], v210 offset:57344
    v_mfma_f32_16x16x32_bf16 v[104:107], a[168:171], v[8:11], v[104:107]
    ds_read_b64_tr_b16 a[204:205], v211 offset:49152
    v_cvt_pk_bf16_f32 v148, v224, v225
    v_mfma_f32_16x16x32_bf16 v[112:115], a[168:171], v[24:27], v[112:115]
    ds_read_b64_tr_b16 a[206:207], v211 offset:57344
    v_exp_f32 v226, v74
    v_mfma_f32_16x16x32_bf16 v[104:107], a[172:175], v[12:15], v[104:107]
    ds_read_b64_tr_b16 a[208:209], v212 offset:49152
    ds_read_b64_tr_b16 a[210:211], v212 offset:57344
    v_mfma_f32_16x16x32_bf16 v[112:115], a[172:175], v[28:31], v[112:115]
    ds_read_b64_tr_b16 a[212:213], v213 offset:49152
    v_exp_f32 v227, v75
    v_mfma_f32_16x16x32_bf16 v[108:111], a[176:179], v[0:3], v[184:187]
    ds_read_b64_tr_b16 a[214:215], v213 offset:57344
    v_cvt_pk_bf16_f32 v149, v226, v227
    v_mfma_f32_16x16x32_bf16 v[116:119], a[176:179], v[16:19], v[188:191]
    ds_read_b64_tr_b16 a[216:217], v214 offset:49152
    ds_read_b64_tr_b16 a[218:219], v214 offset:57344
    v_mfma_f32_16x16x32_bf16 v[108:111], a[180:183], v[4:7], v[108:111]
    ds_read_b64_tr_b16 a[220:221], v215 offset:49152
    v_exp_f32 v248, v76
    v_mfma_f32_16x16x32_bf16 v[116:119], a[180:183], v[20:23], v[116:119]
    ds_read_b64_tr_b16 a[222:223], v215 offset:57344
    v_exp_f32 v249, v77
    v_mfma_f32_16x16x32_bf16 v[108:111], a[184:187], v[8:11], v[108:111]
    s_add_u32 m0, s41, 49152
    v_exp_f32 v250, v78
    v_mfma_f32_16x16x32_bf16 v[116:119], a[184:187], v[24:27], v[116:119]
    s_add_u32 s40, s40, 131072
    v_exp_f32 v251, v79
    v_mfma_f32_16x16x32_bf16 v[108:111], a[188:191], v[12:15], v[108:111]
    s_add_u32 s63, s63, 131072
    v_exp_f32 v224, v64
    v_mfma_f32_16x16x32_bf16 v[116:119], a[188:191], v[28:31], v[116:119]
    s_waitcnt vmcnt(8) lgkmcnt(0)
    s_barrier
    v_mfma_f32_16x16x32_bf16 a[0:3], a[192:195], v[164:167], a[0:3]
    ds_read_b128 a[160:163], v204 offset:0
    v_cvt_pk_bf16_f32 v150, v248, v249
    v_mfma_f32_16x16x32_bf16 a[32:35], a[192:195], v[168:171], a[32:35]
    ds_read_b128 a[164:167], v205 offset:0
    v_cvt_pk_bf16_f32 v151, v250, v251
    v_mfma_f32_16x16x32_bf16 a[4:7], a[196:199], v[164:167], a[4:7]
    buffer_load_dwordx4 v218, s[20:23], s40 offen lds
    v_exp_f32 v225, v65
    v_mfma_f32_16x16x32_bf16 a[36:39], a[196:199], v[168:171], a[36:39]
    ds_read_b128 a[168:171], v206 offset:0
    v_cvt_pk_bf16_f32 v144, v224, v225
    v_mfma_f32_16x16x32_bf16 a[8:11], a[200:203], v[164:167], a[8:11]
    ds_read_b128 a[172:175], v207 offset:0
    v_exp_f32 v226, v66
    v_mfma_f32_16x16x32_bf16 a[40:43], a[200:203], v[168:171], a[40:43]
    ds_read_b128 a[176:179], v204 offset:8192
    v_exp_f32 v227, v67
    v_mfma_f32_16x16x32_bf16 a[12:15], a[204:207], v[164:167], a[12:15]
    v_exp_f32 v248, v68
    v_mfma_f32_16x16x32_bf16 a[44:47], a[204:207], v[168:171], a[44:47]
    buffer_load_dwordx4 v219, s[20:23], s40 offen offset:1024 lds
    v_cvt_pk_bf16_f32 v145, v226, v227
    v_mfma_f32_16x16x32_bf16 a[16:19], a[208:211], v[164:167], a[16:19]
    ds_read_b128 a[180:183], v205 offset:8192
    v_mfma_f32_16x16x32_bf16 a[48:51], a[208:211], v[168:171], a[48:51]
    ds_read_b128 a[184:187], v206 offset:8192
    v_mfma_f32_16x16x32_bf16 a[20:23], a[212:215], v[164:167], a[20:23]
    ds_read_b128 a[188:191], v207 offset:8192
    v_mfma_f32_16x16x32_bf16 a[52:55], a[212:215], v[168:171], a[52:55]
    buffer_load_dwordx4 v216, s[16:19], s63 offen offset:2048 lds
    v_mfma_f32_16x16x32_bf16 a[24:27], a[216:219], v[164:167], a[24:27]
    v_exp_f32 v249, v69
    v_mfma_f32_16x16x32_bf16 a[56:59], a[216:219], v[168:171], a[56:59]
    v_exp_f32 v250, v70
    v_mfma_f32_16x16x32_bf16 a[28:31], a[220:223], v[164:167], a[28:31]
    v_exp_f32 v251, v71
    v_mfma_f32_16x16x32_bf16 a[60:63], a[220:223], v[168:171], a[60:63]
    v_cvt_pk_bf16_f32 v146, v248, v249
    v_cvt_pk_bf16_f32 v147, v250, v251
    v_mfma_f32_16x16x32_bf16 a[240:243], v[228:231], v[164:167], a[240:243]
    s_sub_u32 s42, s42, 1
    buffer_load_dwordx4 v217, s[16:19], s63 offen offset:3072 lds
    v_mfma_f32_16x16x32_bf16 a[244:247], v[228:231], v[168:171], a[244:247]
    s_cbranch_scc1 Lxt2_2
    s_waitcnt lgkmcnt(0)
    v_mfma_f32_16x16x32_bf16 v[64:67], a[160:163], v[0:3], v[184:187]
    ds_read_b64_tr_b16 a[192:193], v208 offset:0
    ds_read_b64_tr_b16 a[194:195], v208 offset:8192
    v_mfma_f32_16x16x32_bf16 v[72:75], a[160:163], v[16:19], v[188:191]
    ds_read_b64_tr_b16 a[196:197], v209 offset:0
    v_exp_f32 v224, v112
    v_mfma_f32_16x16x32_bf16 v[64:67], a[164:167], v[4:7], v[64:67]
    ds_read_b64_tr_b16 a[198:199], v209 offset:8192
    v_exp_f32 v225, v113
    v_mfma_f32_16x16x32_bf16 v[72:75], a[164:167], v[20:23], v[72:75]
    ds_read_b64_tr_b16 a[200:201], v210 offset:0
    ds_read_b64_tr_b16 a[202:203], v210 offset:8192
    v_mfma_f32_16x16x32_bf16 v[64:67], a[168:171], v[8:11], v[64:67]
    ds_read_b64_tr_b16 a[204:205], v211 offset:0
    v_cvt_pk_bf16_f32 v168, v224, v225
    v_mfma_f32_16x16x32_bf16 v[72:75], a[168:171], v[24:27], v[72:75]
    ds_read_b64_tr_b16 a[206:207], v211 offset:8192
    v_exp_f32 v226, v114
    v_mfma_f32_16x16x32_bf16 v[64:67], a[172:175], v[12:15], v[64:67]
    ds_read_b64_tr_b16 a[208:209], v212 offset:0
    ds_read_b64_tr_b16 a[210:211], v212 offset:8192
    v_mfma_f32_16x16x32_bf16 v[72:75], a[172:175], v[28:31], v[72:75]
    ds_read_b64_tr_b16 a[212:213], v213 offset:0
    v_exp_f32 v227, v115
    v_mfma_f32_16x16x32_bf16 v[68:71], a[176:179], v[0:3], v[184:187]
    ds_read_b64_tr_b16 a[214:215], v213 offset:8192
    v_cvt_pk_bf16_f32 v169, v226, v227
    v_mfma_f32_16x16x32_bf16 v[76:79], a[176:179], v[16:19], v[188:191]
    ds_read_b64_tr_b16 a[216:217], v214 offset:0
    ds_read_b64_tr_b16 a[218:219], v214 offset:8192
    v_mfma_f32_16x16x32_bf16 v[68:71], a[180:183], v[4:7], v[68:71]
    ds_read_b64_tr_b16 a[220:221], v215 offset:0
    v_exp_f32 v248, v116
    v_mfma_f32_16x16x32_bf16 v[76:79], a[180:183], v[20:23], v[76:79]
    ds_read_b64_tr_b16 a[222:223], v215 offset:8192
    v_exp_f32 v249, v117
    v_mfma_f32_16x16x32_bf16 v[68:71], a[184:187], v[8:11], v[68:71]
    s_mov_b32 m0, s41
    v_exp_f32 v250, v118
    v_mfma_f32_16x16x32_bf16 v[76:79], a[184:187], v[24:27], v[76:79]
    s_add_u32 s40, s40, 131072
    v_exp_f32 v251, v119
    v_mfma_f32_16x16x32_bf16 v[68:71], a[188:191], v[12:15], v[68:71]
    s_add_u32 s63, s63, 131072
    v_exp_f32 v224, v104
    v_mfma_f32_16x16x32_bf16 v[76:79], a[188:191], v[28:31], v[76:79]
    s_waitcnt vmcnt(8) lgkmcnt(0)
    s_barrier
    v_mfma_f32_16x16x32_bf16 a[0:3], a[192:195], v[144:147], a[0:3]
    ds_read_b128 a[160:163], v204 offset:16384
    v_cvt_pk_bf16_f32 v170, v248, v249
    v_mfma_f32_16x16x32_bf16 a[32:35], a[192:195], v[148:151], a[32:35]
    ds_read_b128 a[164:167], v205 offset:16384
    v_cvt_pk_bf16_f32 v171, v250, v251
    v_mfma_f32_16x16x32_bf16 a[4:7], a[196:199], v[144:147], a[4:7]
    buffer_load_dwordx4 v218, s[20:23], s40 offen lds
    v_exp_f32 v225, v105
    v_mfma_f32_16x16x32_bf16 a[36:39], a[196:199], v[148:151], a[36:39]
    ds_read_b128 a[168:171], v206 offset:16384
    v_cvt_pk_bf16_f32 v164, v224, v225
    v_mfma_f32_16x16x32_bf16 a[8:11], a[200:203], v[144:147], a[8:11]
    ds_read_b128 a[172:175], v207 offset:16384
    v_exp_f32 v226, v106
    v_mfma_f32_16x16x32_bf16 a[40:43], a[200:203], v[148:151], a[40:43]
    ds_read_b128 a[176:179], v204 offset:24576
    v_exp_f32 v227, v107
    v_mfma_f32_16x16x32_bf16 a[12:15], a[204:207], v[144:147], a[12:15]
    v_exp_f32 v248, v108
    v_mfma_f32_16x16x32_bf16 a[44:47], a[204:207], v[148:151], a[44:47]
    buffer_load_dwordx4 v219, s[20:23], s40 offen offset:1024 lds
    v_cvt_pk_bf16_f32 v165, v226, v227
    v_mfma_f32_16x16x32_bf16 a[16:19], a[208:211], v[144:147], a[16:19]
    ds_read_b128 a[180:183], v205 offset:24576
    v_mfma_f32_16x16x32_bf16 a[48:51], a[208:211], v[148:151], a[48:51]
    ds_read_b128 a[184:187], v206 offset:24576
    v_mfma_f32_16x16x32_bf16 a[20:23], a[212:215], v[144:147], a[20:23]
    ds_read_b128 a[188:191], v207 offset:24576
    v_mfma_f32_16x16x32_bf16 a[52:55], a[212:215], v[148:151], a[52:55]
    buffer_load_dwordx4 v216, s[16:19], s63 offen offset:2048 lds
    v_mfma_f32_16x16x32_bf16 a[24:27], a[216:219], v[144:147], a[24:27]
    v_exp_f32 v249, v109
    v_mfma_f32_16x16x32_bf16 a[56:59], a[216:219], v[148:151], a[56:59]
    v_exp_f32 v250, v110
    v_mfma_f32_16x16x32_bf16 a[28:31], a[220:223], v[144:147], a[28:31]
    v_exp_f32 v251, v111
    v_mfma_f32_16x16x32_bf16 a[60:63], a[220:223], v[148:151], a[60:63]
    v_cvt_pk_bf16_f32 v166, v248, v249
    v_cvt_pk_bf16_f32 v167, v250, v251
    v_mfma_f32_16x16x32_bf16 a[240:243], v[228:231], v[144:147], a[240:243]
    s_sub_u32 s42, s42, 1
    buffer_load_dwordx4 v217, s[16:19], s63 offen offset:3072 lds
    v_mfma_f32_16x16x32_bf16 a[244:247], v[228:231], v[148:151], a[244:247]
    s_cbranch_scc1 Lxt2_3
    s_waitcnt lgkmcnt(0)
    v_mfma_f32_16x16x32_bf16 v[104:107], a[160:163], v[0:3], v[184:187]
    ds_read_b64_tr_b16 a[192:193], v208 offset:16384
    ds_read_b64_tr_b16 a[194:195], v208 offset:24576
    v_mfma_f32_16x16x32_bf16 v[112:115], a[160:163], v[16:19], v[188:191]
    ds_read_b64_tr_b16 a[196:197], v209 offset:16384
    v_exp_f32 v224, v72
    v_mfma_f32_16x16x32_bf16 v[104:107], a[164:167], v[4:7], v[104:107]
    ds_read_b64_tr_b16 a[198:199], v209 offset:24576
    v_exp_f32 v225, v73
    v_mfma_f32_16x16x32_bf16 v[112:115], a[164:167], v[20:23], v[112:115]
    ds_read_b64_tr_b16 a[200:201], v210 offset:16384
    ds_read_b64_tr_b16 a[202:203], v210 offset:24576
    v_mfma_f32_16x16x32_bf16 v[104:107], a[168:171], v[8:11], v[104:107]
    ds_read_b64_tr_b16 a[204:205], v211 offset:16384
    v_cvt_pk_bf16_f32 v148, v224, v225
    v_mfma_f32_16x16x32_bf16 v[112:115], a[168:171], v[24:27], v[112:115]
    ds_read_b64_tr_b16 a[206:207], v211 offset:24576
    v_exp_f32 v226, v74
    v_mfma_f32_16x16x32_bf16 v[104:107], a[172:175], v[12:15], v[104:107]
    ds_read_b64_tr_b16 a[208:209], v212 offset:16384
    ds_read_b64_tr_b16 a[210:211], v212 offset:24576
    v_mfma_f32_16x16x32_bf16 v[112:115], a[172:175], v[28:31], v[112:115]
    ds_read_b64_tr_b16 a[212:213], v213 offset:16384
    v_exp_f32 v227, v75
    v_mfma_f32_16x16x32_bf16 v[108:111], a[176:179], v[0:3], v[184:187]
    ds_read_b64_tr_b16 a[214:215], v213 offset:24576
    v_cvt_pk_bf16_f32 v149, v226, v227
    v_mfma_f32_16x16x32_bf16 v[116:119], a[176:179], v[16:19], v[188:191]
    ds_read_b64_tr_b16 a[216:217], v214 offset:16384
    ds_read_b64_tr_b16 a[218:219], v214 offset:24576
    v_mfma_f32_16x16x32_bf16 v[108:111], a[180:183], v[4:7], v[108:111]
    ds_read_b64_tr_b16 a[220:221], v215 offset:16384
    v_exp_f32 v248, v76
    v_mfma_f32_16x16x32_bf16 v[116:119], a[180:183], v[20:23], v[116:119]
    ds_read_b64_tr_b16 a[222:223], v215 offset:24576
    v_exp_f32 v249, v77
    v_mfma_f32_16x16x32_bf16 v[108:111], a[184:187], v[8:11], v[108:111]
    s_add_u32 m0, s41, 16384
    v_exp_f32 v250, v78
    v_mfma_f32_16x16x32_bf16 v[116:119], a[184:187], v[24:27], v[116:119]
    s_add_u32 s40, s40, 131072
    v_exp_f32 v251, v79
    v_mfma_f32_16x16x32_bf16 v[108:111], a[188:191], v[12:15], v[108:111]
    s_add_u32 s63, s63, 131072
    v_exp_f32 v224, v64
    v_mfma_f32_16x16x32_bf16 v[116:119], a[188:191], v[28:31], v[116:119]
    s_waitcnt vmcnt(8) lgkmcnt(0)
    s_barrier
    v_mfma_f32_16x16x32_bf16 a[0:3], a[192:195], v[164:167], a[0:3]
    ds_read_b128 a[160:163], v204 offset:32768
    v_cvt_pk_bf16_f32 v150, v248, v249
    v_mfma_f32_16x16x32_bf16 a[32:35], a[192:195], v[168:171], a[32:35]
    ds_read_b128 a[164:167], v205 offset:32768
    v_cvt_pk_bf16_f32 v151, v250, v251
    v_mfma_f32_16x16x32_bf16 a[4:7], a[196:199], v[164:167], a[4:7]
    buffer_load_dwordx4 v218, s[20:23], s40 offen lds
    v_exp_f32 v225, v65
    v_mfma_f32_16x16x32_bf16 a[36:39], a[196:199], v[168:171], a[36:39]
    ds_read_b128 a[168:171], v206 offset:32768
    v_cvt_pk_bf16_f32 v144, v224, v225
    v_mfma_f32_16x16x32_bf16 a[8:11], a[200:203], v[164:167], a[8:11]
    ds_read_b128 a[172:175], v207 offset:32768
    v_exp_f32 v226, v66
    v_mfma_f32_16x16x32_bf16 a[40:43], a[200:203], v[168:171], a[40:43]
    ds_read_b128 a[176:179], v204 offset:40960
    v_exp_f32 v227, v67
    v_mfma_f32_16x16x32_bf16 a[12:15], a[204:207], v[164:167], a[12:15]
    v_exp_f32 v248, v68
    v_mfma_f32_16x16x32_bf16 a[44:47], a[204:207], v[168:171], a[44:47]
    buffer_load_dwordx4 v219, s[20:23], s40 offen offset:1024 lds
    v_cvt_pk_bf16_f32 v145, v226, v227
    v_mfma_f32_16x16x32_bf16 a[16:19], a[208:211], v[164:167], a[16:19]
    ds_read_b128 a[180:183], v205 offset:40960
    v_mfma_f32_16x16x32_bf16 a[48:51], a[208:211], v[168:171], a[48:51]
    ds_read_b128 a[184:187], v206 offset:40960
    v_mfma_f32_16x16x32_bf16 a[20:23], a[212:215], v[164:167], a[20:23]
    ds_read_b128 a[188:191], v207 offset:40960
    v_mfma_f32_16x16x32_bf16 a[52:55], a[212:215], v[168:171], a[52:55]
    buffer_load_dwordx4 v216, s[16:19], s63 offen offset:2048 lds
    v_mfma_f32_16x16x32_bf16 a[24:27], a[216:219], v[164:167], a[24:27]
    v_exp_f32 v249, v69
    v_mfma_f32_16x16x32_bf16 a[56:59], a[216:219], v[168:171], a[56:59]
    v_exp_f32 v250, v70
    v_mfma_f32_16x16x32_bf16 a[28:31], a[220:223], v[164:167], a[28:31]
    v_exp_f32 v251, v71
    v_mfma_f32_16x16x32_bf16 a[60:63], a[220:223], v[168:171], a[60:63]
    v_cvt_pk_bf16_f32 v146, v248, v249
    v_cvt_pk_bf16_f32 v147, v250, v251
    v_mfma_f32_16x16x32_bf16 a[240:243], v[228:231], v[164:167], a[240:243]
    s_sub_u32 s42, s42, 1
    buffer_load_dwordx4 v217, s[16:19], s63 offen offset:3072 lds
    v_mfma_f32_16x16x32_bf16 a[244:247], v[228:231], v[168:171], a[244:247]
    s_waitcnt lgkmcnt(0)
    v_mfma_f32_16x16x32_bf16 v[64:67], a[160:163], v[0:3], v[184:187]
    ds_read_b64_tr_b16 a[192:193], v208 offset:32768
    ds_read_b64_tr_b16 a[194:195], v208 offset:40960
    v_mfma_f32_16x16x32_bf16 v[72:75], a[160:163], v[16:19], v[188:191]
    ds_read_b64_tr_b16 a[196:197], v209 offset:32768
    v_exp_f32 v224, v112
    v_mfma_f32_16x16x32_bf16 v[64:67], a[164:167], v[4:7], v[64:67]
    ds_read_b64_tr_b16 a[198:199], v209 offset:40960
    v_exp_f32 v225, v113
    v_mfma_f32_16x16x32_bf16 v[72:75], a[164:167], v[20:23], v[72:75]
    ds_read_b64_tr_b16 a[200:201], v210 offset:32768
    ds_read_b64_tr_b16 a[202:203], v210 offset:40960
    v_mfma_f32_16x16x32_bf16 v[64:67], a[168:171], v[8:11], v[64:67]
    ds_read_b64_tr_b16 a[204:205], v211 offset:32768
    v_cvt_pk_bf16_f32 v168, v224, v225
    v_mfma_f32_16x16x32_bf16 v[72:75], a[168:171], v[24:27], v[72:75]
    ds_read_b64_tr_b16 a[206:207], v211 offset:40960
    v_exp_f32 v226, v114
    v_mfma_f32_16x16x32_bf16 v[64:67], a[172:175], v[12:15], v[64:67]
    ds_read_b64_tr_b16 a[208:209], v212 offset:32768
    ds_read_b64_tr_b16 a[210:211], v212 offset:40960
    v_mfma_f32_16x16x32_bf16 v[72:75], a[172:175], v[28:31], v[72:75]
    ds_read_b64_tr_b16 a[212:213], v213 offset:32768
    v_exp_f32 v227, v115
    v_mfma_f32_16x16x32_bf16 v[68:71], a[176:179], v[0:3], v[184:187]
    ds_read_b64_tr_b16 a[214:215], v213 offset:40960
    v_cvt_pk_bf16_f32 v169, v226, v227
    v_mfma_f32_16x16x32_bf16 v[76:79], a[176:179], v[16:19], v[188:191]
    ds_read_b64_tr_b16 a[216:217], v214 offset:32768
    ds_read_b64_tr_b16 a[218:219], v214 offset:40960
    v_mfma_f32_16x16x32_bf16 v[68:71], a[180:183], v[4:7], v[68:71]
    ds_read_b64_tr_b16 a[220:221], v215 offset:32768
    v_exp_f32 v248, v116
    v_mfma_f32_16x16x32_bf16 v[76:79], a[180:183], v[20:23], v[76:79]
    ds_read_b64_tr_b16 a[222:223], v215 offset:40960
    v_exp_f32 v249, v117
    v_mfma_f32_16x16x32_bf16 v[68:71], a[184:187], v[8:11], v[68:71]
    s_add_u32 m0, s41, 32768
    v_exp_f32 v250, v118
    v_mfma_f32_16x16x32_bf16 v[76:79], a[184:187], v[24:27], v[76:79]
    s_add_u32 s40, s40, 131072
    v_exp_f32 v251, v119
    v_mfma_f32_16x16x32_bf16 v[68:71], a[188:191], v[12:15], v[68:71]
    s_add_u32 s63, s63, 131072
    v_exp_f32 v224, v104
    v_mfma_f32_16x16x32_bf16 v[76:79], a[188:191], v[28:31], v[76:79]
    s_waitcnt vmcnt(8) lgkmcnt(0)
    s_barrier
    v_mfma_f32_16x16x32_bf16 a[0:3], a[192:195], v[144:147], a[0:3]
    ds_read_b128 a[160:163], v204 offset:49152
    v_cvt_pk_bf16_f32 v170, v248, v249
    v_mfma_f32_16x16x32_bf16 a[32:35], a[192:195], v[148:151], a[32:35]
    ds_read_b128 a[164:167], v205 offset:49152
    v_cvt_pk_bf16_f32 v171, v250, v251
    v_mfma_f32_16x16x32_bf16 a[4:7], a[196:199], v[144:147], a[4:7]
    buffer_load_dwordx4 v218, s[20:23], s40 offen lds
    v_exp_f32 v225, v105
    v_mfma_f32_16x16x32_bf16 a[36:39], a[196:199], v[148:151], a[36:39]
    ds_read_b128 a[168:171], v206 offset:49152
    v_cvt_pk_bf16_f32 v164, v224, v225
    v_mfma_f32_16x16x32_bf16 a[8:11], a[200:203], v[144:147], a[8:11]
    ds_read_b128 a[172:175], v207 offset:49152
    v_exp_f32 v226, v106
    v_mfma_f32_16x16x32_bf16 a[40:43], a[200:203], v[148:151], a[40:43]
    ds_read_b128 a[176:179], v204 offset:57344
    v_exp_f32 v227, v107
    v_mfma_f32_16x16x32_bf16 a[12:15], a[204:207], v[144:147], a[12:15]
    v_exp_f32 v248, v108
    v_mfma_f32_16x16x32_bf16 a[44:47], a[204:207], v[148:151], a[44:47]
    buffer_load_dwordx4 v219, s[20:23], s40 offen offset:1024 lds
    v_cvt_pk_bf16_f32 v165, v226, v227
    v_mfma_f32_16x16x32_bf16 a[16:19], a[208:211], v[144:147], a[16:19]
    ds_read_b128 a[180:183], v205 offset:57344
    v_mfma_f32_16x16x32_bf16 a[48:51], a[208:211], v[148:151], a[48:51]
    ds_read_b128 a[184:187], v206 offset:57344
    v_mfma_f32_16x16x32_bf16 a[20:23], a[212:215], v[144:147], a[20:23]
    ds_read_b128 a[188:191], v207 offset:57344
    v_mfma_f32_16x16x32_bf16 a[52:55], a[212:215], v[148:151], a[52:55]
    buffer_load_dwordx4 v216, s[16:19], s63 offen offset:2048 lds
    v_mfma_f32_16x16x32_bf16 a[24:27], a[216:219], v[144:147], a[24:27]
    v_exp_f32 v249, v109
    v_mfma_f32_16x16x32_bf16 a[56:59], a[216:219], v[148:151], a[56:59]
    v_exp_f32 v250, v110
    v_mfma_f32_16x16x32_bf16 a[28:31], a[220:223], v[144:147], a[28:31]
    v_exp_f32 v251, v111
    v_mfma_f32_16x16x32_bf16 a[60:63], a[220:223], v[148:151], a[60:63]
    v_cvt_pk_bf16_f32 v166, v248, v249
    v_cvt_pk_bf16_f32 v167, v250, v251
    v_mfma_f32_16x16x32_bf16 a[240:243], v[228:231], v[144:147], a[240:243]
    s_sub_u32 s42, s42, 1
    buffer_load_dwordx4 v217, s[16:19], s63 offen offset:3072 lds
    v_mfma_f32_16x16x32_bf16 a[244:247], v[228:231], v[148:151], a[244:247]
    s_cbranch_scc1 Lxt2_1
    s_branch Lloop2
Lxt2_1:
Lft2_2_0:
    s_waitcnt lgkmcnt(0)
    v_mfma_f32_16x16x32_bf16 a[240:243], v[228:231], v[164:167], a[240:243]
    ds_read_b64_tr_b16 a[192:193], v208 offset:49152
    v_exp_f32 v64, v64
    v_exp_f32 v65, v65
    v_exp_f32 v66, v66
    v_exp_f32 v67, v67
    v_exp_f32 v68, v68
    v_exp_f32 v69, v69
    v_exp_f32 v70, v70
    v_exp_f32 v71, v71
    v_cvt_pk_bf16_f32 v144, v64, v65
    v_cvt_pk_bf16_f32 v145, v66, v67
    v_cvt_pk_bf16_f32 v146, v68, v69
    v_cvt_pk_bf16_f32 v147, v70, v71
    v_xor_b32 v184, 0, v240
    v_xor_b32 v185, 32, v240
    v_mfma_f32_16x16x32_bf16 a[240:243], v[228:231], v[144:147], a[240:243]
    ds_read_b64_tr_b16 a[194:195], v208 offset:57344
    v_xor_b32 v186, 64, v240
    v_xor_b32 v187, 96, v240
    s_waitcnt vmcnt(8)
    s_barrier
    ds_read_b64_tr_b16 a[196:197], v209 offset:49152
    v_xor_b32 v188, 128, v240
    v_xor_b32 v189, 160, v240
    v_xor_b32 v190, 192, v240
    v_xor_b32 v191, 224, v240
    v_accvgpr_read_b32 v252, a240
    v_rcp_f32 v192, v252
    v_mfma_f32_16x16x32_bf16 a[244:247], v[228:231], v[168:171], a[244:247]
    ds_read_b64_tr_b16 a[198:199], v209 offset:57344
    ds_read_b64_tr_b16 a[200:201], v210 offset:49152
    ds_read_b64_tr_b16 a[202:203], v210 offset:57344
    ds_read_b64_tr_b16 a[204:205], v211 offset:49152
    s_waitcnt lgkmcnt(5)
    v_mfma_f32_16x16x32_bf16 a[0:3], a[192:195], v[164:167], a[0:3]
    ds_read_b64_tr_b16 a[206:207], v211 offset:57344
    ds_read_b64_tr_b16 a[208:209], v212 offset:49152
    v_mfma_f32_16x16x32_bf16 a[32:35], a[192:195], v[168:171], a[32:35]
    ds_read_b64_tr_b16 a[210:211], v212 offset:57344
    ds_read_b64_tr_b16 a[212:213], v213 offset:49152
    ds_read_b64_tr_b16 a[214:215], v213 offset:57344
    ds_read_b64_tr_b16 a[216:217], v214 offset:49152
    ds_read_b64_tr_b16 a[218:219], v214 offset:57344
    ds_read_b64_tr_b16 a[220:221], v215 offset:49152
    ds_read_b64_tr_b16 a[222:223], v215 offset:57344
    ds_read_b64_tr_b16 a[160:161], v208 offset:0
    ds_read_b64_tr_b16 a[162:163], v208 offset:8192
    s_waitcnt lgkmcnt(13)
    v_mfma_f32_16x16x32_bf16 a[4:7], a[196:199], v[164:167], a[4:7]
    ds_read_b64_tr_b16 a[164:165], v209 offset:0
    ds_read_b64_tr_b16 a[166:167], v209 offset:8192
    s_waitcnt lgkmcnt(13)
    v_mfma_f32_16x16x32_bf16 a[8:11], a[200:203], v[164:167], a[8:11]
    ds_read_b64_tr_b16 a[168:169], v210 offset:0
    ds_read_b64_tr_b16 a[170:171], v210 offset:8192
    s_waitcnt lgkmcnt(12)
    v_mfma_f32_16x16x32_bf16 a[12:15], a[204:207], v[164:167], a[12:15]
    ds_read_b64_tr_b16 a[172:173], v211 offset:0
    ds_read_b64_tr_b16 a[174:175], v211 offset:8192
    v_mfma_f32_16x16x32_bf16 a[16:19], a[208:211], v[164:167], a[16:19]
    ds_read_b64_tr_b16 a[176:177], v212 offset:0
    ds_read_b64_tr_b16 a[178:179], v212 offset:8192
    s_waitcnt lgkmcnt(11)
    v_mfma_f32_16x16x32_bf16 a[20:23], a[212:215], v[164:167], a[20:23]
    ds_read_b64_tr_b16 a[180:181], v213 offset:0
    ds_read_b64_tr_b16 a[182:183], v213 offset:8192
    v_mfma_f32_16x16x32_bf16 a[24:27], a[216:219], v[164:167], a[24:27]
    ds_read_b64_tr_b16 a[184:185], v214 offset:0
    ds_read_b64_tr_b16 a[186:187], v214 offset:8192
    s_waitcnt lgkmcnt(10)
    v_mfma_f32_16x16x32_bf16 a[28:31], a[220:223], v[164:167], a[28:31]
    ds_read_b64_tr_b16 a[188:189], v215 offset:0
    ds_read_b64_tr_b16 a[190:191], v215 offset:8192
    v_mfma_f32_16x16x32_bf16 a[0:3], a[160:163], v[144:147], a[0:3]
    s_add_u32 s68, s56, 0
    v_exp_f32 v72, v72
    v_mfma_f32_16x16x32_bf16 a[4:7], a[164:167], v[144:147], a[4:7]
    s_add_u32 s69, s56, 65536
    v_exp_f32 v73, v73
    s_waitcnt lgkmcnt(8)
    v_mfma_f32_16x16x32_bf16 a[8:11], a[168:171], v[144:147], a[8:11]
    s_nop 0
    v_accvgpr_read_b32 v0, a0
    v_mfma_f32_16x16x32_bf16 a[12:15], a[172:175], v[144:147], a[12:15]
    v_accvgpr_read_b32 v1, a1
    v_accvgpr_read_b32 v2, a2
    s_waitcnt lgkmcnt(4)
    v_mfma_f32_16x16x32_bf16 a[16:19], a[176:179], v[144:147], a[16:19]
    v_accvgpr_read_b32 v3, a3
    v_accvgpr_read_b32 v4, a4
    v_mfma_f32_16x16x32_bf16 a[20:23], a[180:183], v[144:147], a[20:23]
    v_accvgpr_read_b32 v5, a5
    v_accvgpr_read_b32 v6, a6
    s_waitcnt lgkmcnt(1)
    v_mfma_f32_16x16x32_bf16 a[24:27], a[184:187], v[144:147], a[24:27]
    v_accvgpr_read_b32 v7, a7
    v_accvgpr_read_b32 v8, a8
    s_waitcnt lgkmcnt(0)
    v_mfma_f32_16x16x32_bf16 a[28:31], a[188:191], v[144:147], a[28:31]
    v_accvgpr_read_b32 v9, a9
    v_accvgpr_read_b32 v10, a10
    v_mfma_f32_16x16x32_bf16 a[36:39], a[196:199], v[168:171], a[36:39]
    v_accvgpr_read_b32 v11, a11
    v_accvgpr_read_b32 v12, a12
    v_mfma_f32_16x16x32_bf16 a[40:43], a[200:203], v[168:171], a[40:43]
    v_accvgpr_read_b32 v13, a13
    v_accvgpr_read_b32 v14, a14
    v_mfma_f32_16x16x32_bf16 a[44:47], a[204:207], v[168:171], a[44:47]
    v_accvgpr_read_b32 v15, a15
    v_accvgpr_read_b32 v16, a16
    v_mfma_f32_16x16x32_bf16 a[48:51], a[208:211], v[168:171], a[48:51]
    v_accvgpr_read_b32 v17, a17
    v_accvgpr_read_b32 v18, a18
    v_mfma_f32_16x16x32_bf16 a[52:55], a[212:215], v[168:171], a[52:55]
    v_accvgpr_read_b32 v19, a19
    v_accvgpr_read_b32 v20, a20
    v_mfma_f32_16x16x32_bf16 a[56:59], a[216:219], v[168:171], a[56:59]
    v_accvgpr_read_b32 v21, a21
    v_accvgpr_read_b32 v22, a22
    v_mfma_f32_16x16x32_bf16 a[60:63], a[220:223], v[168:171], a[60:63]
    v_accvgpr_read_b32 v23, a23
    v_accvgpr_read_b32 v24, a24
    v_accvgpr_read_b32 v25, a25
    v_accvgpr_read_b32 v26, a26
    v_accvgpr_read_b32 v27, a27
    v_pk_mul_f32 v[0:1], v[0:1], v[192:193] op_sel_hi:[1,0]
    v_pk_mul_f32 v[2:3], v[2:3], v[192:193] op_sel_hi:[1,0]
    v_cvt_pk_bf16_f32 v0, v0, v1
    v_cvt_pk_bf16_f32 v1, v2, v3
    v_pk_mul_f32 v[4:5], v[4:5], v[192:193] op_sel_hi:[1,0]
    v_pk_mul_f32 v[6:7], v[6:7], v[192:193] op_sel_hi:[1,0]
    v_cvt_pk_bf16_f32 v4, v4, v5
    v_cvt_pk_bf16_f32 v5, v6, v7
    v_pk_mul_f32 v[8:9], v[8:9], v[192:193] op_sel_hi:[1,0]
    v_pk_mul_f32 v[10:11], v[10:11], v[192:193] op_sel_hi:[1,0]
    v_cvt_pk_bf16_f32 v8, v8, v9
    v_cvt_pk_bf16_f32 v9, v10, v11
    v_pk_mul_f32 v[12:13], v[12:13], v[192:193] op_sel_hi:[1,0]
    v_pk_mul_f32 v[14:15], v[14:15], v[192:193] op_sel_hi:[1,0]
    v_cvt_pk_bf16_f32 v12, v12, v13
    v_cvt_pk_bf16_f32 v13, v14, v15
    v_pk_mul_f32 v[16:17], v[16:17], v[192:193] op_sel_hi:[1,0]
    v_pk_mul_f32 v[18:19], v[18:19], v[192:193] op_sel_hi:[1,0]
    v_cvt_pk_bf16_f32 v16, v16, v17
    v_cvt_pk_bf16_f32 v17, v18, v19
    v_pk_mul_f32 v[20:21], v[20:21], v[192:193] op_sel_hi:[1,0]
    v_pk_mul_f32 v[22:23], v[22:23], v[192:193] op_sel_hi:[1,0]
    v_cvt_pk_bf16_f32 v20, v20, v21
    v_cvt_pk_bf16_f32 v21, v22, v23
    v_pk_mul_f32 v[24:25], v[24:25], v[192:193] op_sel_hi:[1,0]
    v_pk_mul_f32 v[26:27], v[26:27], v[192:193] op_sel_hi:[1,0]
    v_accvgpr_read_b32 v28, a28
    v_cvt_pk_bf16_f32 v24, v24, v25
    v_accvgpr_read_b32 v29, a29
    v_cvt_pk_bf16_f32 v25, v26, v27
    v_accvgpr_read_b32 v30, a30
    v_accvgpr_read_b32 v31, a31
    v_pk_mul_f32 v[28:29], v[28:29], v[192:193] op_sel_hi:[1,0]
    v_pk_mul_f32 v[30:31], v[30:31], v[192:193] op_sel_hi:[1,0]
    v_cvt_pk_bf16_f32 v28, v28, v29
    v_cvt_pk_bf16_f32 v29, v30, v31
    v_exp_f32 v74, v74
    v_exp_f32 v75, v75
    v_exp_f32 v76, v76
    v_exp_f32 v77, v77
    v_exp_f32 v78, v78
    v_exp_f32 v79, v79
    v_cvt_pk_bf16_f32 v148, v72, v73
    v_cvt_pk_bf16_f32 v149, v74, v75
    v_cvt_pk_bf16_f32 v150, v76, v77
    v_cvt_pk_bf16_f32 v151, v78, v79
    ds_write_b64 v184, v[0:1]
    s_nop 0
    v_mfma_f32_16x16x32_bf16 a[244:247], v[228:231], v[148:151], a[244:247]
    ds_write_b64 v185, v[4:5]
    v_mfma_f32_16x16x32_bf16 a[32:35], a[160:163], v[148:151], a[32:35]
    ds_write_b64 v186, v[8:9]
    v_mfma_f32_16x16x32_bf16 a[36:39], a[164:167], v[148:151], a[36:39]
    ds_write_b64 v187, v[12:13]
    v_mfma_f32_16x16x32_bf16 a[40:43], a[168:171], v[148:151], a[40:43]
    ds_write_b64 v188, v[16:17]
    v_mfma_f32_16x16x32_bf16 a[44:47], a[172:175], v[148:151], a[44:47]
    ds_write_b64 v189, v[20:21]
    v_mfma_f32_16x16x32_bf16 a[48:51], a[176:179], v[148:151], a[48:51]
    ds_write_b64 v190, v[24:25]
    v_mfma_f32_16x16x32_bf16 a[52:55], a[180:183], v[148:151], a[52:55]
    ds_write_b64 v191, v[28:29]
    v_mfma_f32_16x16x32_bf16 a[56:59], a[184:187], v[148:151], a[56:59]
    ds_read_b128 a[0:3], v241 offset:0
    v_accvgpr_read_b32 v253, a244
    v_mfma_f32_16x16x32_bf16 a[60:63], a[188:191], v[148:151], a[60:63]
    ds_read_b128 a[4:7], v241 offset:1024
    v_rcp_f32 v194, v253
    v_accvgpr_read_b32 v32, a32
    v_accvgpr_read_b32 v33, a33
    v_accvgpr_read_b32 v34, a34
    v_accvgpr_read_b32 v35, a35
    v_pk_mul_f32 v[32:33], v[32:33], v[194:195] op_sel_hi:[1,0]
    v_pk_mul_f32 v[34:35], v[34:35], v[194:195] op_sel_hi:[1,0]
    v_accvgpr_read_b32 v36, a36
    v_cvt_pk_bf16_f32 v32, v32, v33
    v_accvgpr_read_b32 v37, a37
    v_cvt_pk_bf16_f32 v33, v34, v35
    v_accvgpr_read_b32 v38, a38
    v_accvgpr_read_b32 v39, a39
    v_pk_mul_f32 v[36:37], v[36:37], v[194:195] op_sel_hi:[1,0]
    v_pk_mul_f32 v[38:39], v[38:39], v[194:195] op_sel_hi:[1,0]
    v_accvgpr_read_b32 v40, a40
    v_cvt_pk_bf16_f32 v36, v36, v37
    v_accvgpr_read_b32 v41, a41
    v_cvt_pk_bf16_f32 v37, v38, v39
    v_accvgpr_read_b32 v42, a42
    v_accvgpr_read_b32 v43, a43
    v_pk_mul_f32 v[40:41], v[40:41], v[194:195] op_sel_hi:[1,0]
    v_pk_mul_f32 v[42:43], v[42:43], v[194:195] op_sel_hi:[1,0]
    v_accvgpr_read_b32 v44, a44
    v_cvt_pk_bf16_f32 v40, v40, v41
    v_accvgpr_read_b32 v45, a45
    v_cvt_pk_bf16_f32 v41, v42, v43
    v_accvgpr_read_b32 v46, a46
    v_accvgpr_read_b32 v47, a47
    v_pk_mul_f32 v[44:45], v[44:45], v[194:195] op_sel_hi:[1,0]
    v_pk_mul_f32 v[46:47], v[46:47], v[194:195] op_sel_hi:[1,0]
    v_accvgpr_read_b32 v48, a48
    v_cvt_pk_bf16_f32 v44, v44, v45
    v_accvgpr_read_b32 v49, a49
    v_cvt_pk_bf16_f32 v45, v46, v47
    v_accvgpr_read_b32 v50, a50
    v_accvgpr_read_b32 v51, a51
    v_pk_mul_f32 v[48:49], v[48:49], v[194:195] op_sel_hi:[1,0]
    v_pk_mul_f32 v[50:51], v[50:51], v[194:195] op_sel_hi:[1,0]
    v_accvgpr_read_b32 v52, a52
    v_cvt_pk_bf16_f32 v48, v48, v49
    v_accvgpr_read_b32 v53, a53
    v_cvt_pk_bf16_f32 v49, v50, v51
    v_accvgpr_read_b32 v54, a54
    v_accvgpr_read_b32 v55, a55
    v_pk_mul_f32 v[52:53], v[52:53], v[194:195] op_sel_hi:[1,0]
    v_pk_mul_f32 v[54:55], v[54:55], v[194:195] op_sel_hi:[1,0]
    v_accvgpr_read_b32 v56, a56
    v_cvt_pk_bf16_f32 v52, v52, v53
    v_accvgpr_read_b32 v57, a57
    v_cvt_pk_bf16_f32 v53, v54, v55
    v_accvgpr_read_b32 v58, a58
    v_accvgpr_read_b32 v59, a59
    v_max_f32 v237, v252, v253
    v_pk_mul_f32 v[56:57], v[56:57], v[194:195] op_sel_hi:[1,0]
    v_cmp_le_f32 vcc, s66, v237
    v_pk_mul_f32 v[58:59], v[58:59], v[194:195] op_sel_hi:[1,0]
    v_accvgpr_read_b32 v60, a60
    v_cvt_pk_bf16_f32 v56, v56, v57
    v_accvgpr_read_b32 v61, a61
    s_or_b32 s74, vcc_lo, vcc_hi
    s_waitcnt lgkmcnt(0)
    buffer_store_dwordx4 a[0:3], v220, s[24:27], s68 offen offset:0 sc0 sc1
    ds_read_b128 a[8:11], v241 offset:2048
    v_cvt_pk_bf16_f32 v57, v58, v59
    v_accvgpr_read_b32 v62, a62
    v_accvgpr_read_b32 v63, a63
    v_mov_b32 v237, s74
    v_pk_mul_f32 v[60:61], v[60:61], v[194:195] op_sel_hi:[1,0]
    v_pk_mul_f32 v[62:63], v[62:63], v[194:195] op_sel_hi:[1,0]
    v_cvt_pk_bf16_f32 v60, v60, v61
    v_cvt_pk_bf16_f32 v61, v62, v63
    ds_read_b128 a[12:15], v241 offset:3072
    ds_write_b64 v184, v[32:33]
    ds_write_b64 v185, v[36:37]
    buffer_store_dwordx4 a[4:7], v221, s[24:27], s68 offen offset:1024 sc0 sc1
    ds_write_b64 v186, v[40:41]
    ds_write_b64 v187, v[44:45]
    ds_write_b64 v188, v[48:49]
    ds_write_b64 v189, v[52:53]
    s_waitcnt lgkmcnt(5)
    buffer_store_dwordx4 a[8:11], v222, s[24:27], s68 offen offset:2048 sc0 sc1
    ds_write_b64 v190, v[56:57]
    ds_write_b32 v239, v237 offset:16384
    ds_write_b64 v191, v[60:61]
    ds_read_b128 a[32:35], v241 offset:0
    ds_read_b128 a[36:39], v241 offset:1024
    ds_read_b128 a[40:43], v241 offset:2048
    buffer_store_dwordx4 a[12:15], v223, s[24:27], s68 offen offset:3072 sc0 sc1
    ds_read_b128 a[44:47], v241 offset:3072
    s_waitcnt lgkmcnt(5)
    s_barrier
    s_waitcnt lgkmcnt(1)
    buffer_store_dwordx4 a[32:35], v220, s[24:27], s69 offen offset:0 sc0 sc1
    ds_read_b32 v244, v236
    buffer_store_dwordx4 a[36:39], v221, s[24:27], s69 offen offset:1024 sc0 sc1
    s_waitcnt lgkmcnt(0)
    v_cmp_ne_u32 vcc, 0, v244
    buffer_store_dwordx4 a[40:43], v222, s[24:27], s69 offen offset:2048 sc0 sc1
    buffer_store_dwordx4 a[44:47], v223, s[24:27], s69 offen offset:3072 sc0 sc1
    s_cbranch_vccnz Lrestart
    s_endpgm
Lxt2_2:
Lft2_3_1:
    s_waitcnt lgkmcnt(0)
    v_mfma_f32_16x16x32_bf16 a[240:243], v[228:231], v[144:147], a[240:243]
    ds_read_b64_tr_b16 a[192:193], v208 offset:0
    v_exp_f32 v104, v104
    v_exp_f32 v105, v105
    v_exp_f32 v106, v106
    v_exp_f32 v107, v107
    v_exp_f32 v108, v108
    v_exp_f32 v109, v109
    v_exp_f32 v110, v110
    v_exp_f32 v111, v111
    v_cvt_pk_bf16_f32 v164, v104, v105
    v_cvt_pk_bf16_f32 v165, v106, v107
    v_cvt_pk_bf16_f32 v166, v108, v109
    v_cvt_pk_bf16_f32 v167, v110, v111
    v_xor_b32 v184, 0, v240
    v_xor_b32 v185, 32, v240
    v_mfma_f32_16x16x32_bf16 a[240:243], v[228:231], v[164:167], a[240:243]
    ds_read_b64_tr_b16 a[194:195], v208 offset:8192
    s_waitcnt vmcnt(8)
    s_barrier
    s_mov_b32 m0, s41
    s_add_u32 s18, s30, 4096
    buffer_load_dwordx4 v216, s[16:19], s31 offen offset:2048 lds
    s_add_u32 s61, s55, 0
    ds_read_b64_tr_b16 a[196:197], v209 offset:0
    v_xor_b32 v186, 64, v240
    v_xor_b32 v187, 96, v240
    v_xor_b32 v188, 128, v240
    v_xor_b32 v189, 160, v240
    v_xor_b32 v190, 192, v240
    v_xor_b32 v191, 224, v240
    v_accvgpr_read_b32 v252, a240
    v_rcp_f32 v192, v252
    v_mfma_f32_16x16x32_bf16 a[244:247], v[228:231], v[148:151], a[244:247]
    ds_read_b64_tr_b16 a[198:199], v209 offset:8192
    ds_read_b64_tr_b16 a[200:201], v210 offset:0
    s_waitcnt lgkmcnt(3)
    v_mfma_f32_16x16x32_bf16 a[0:3], a[192:195], v[144:147], a[0:3]
    buffer_load_dwordx4 v217, s[16:19], s31 offen offset:3072 lds
    s_mov_b32 m0, s3
    ds_read_b64_tr_b16 a[202:203], v210 offset:8192
    ds_read_b64_tr_b16 a[204:205], v211 offset:0
    ds_read_b64_tr_b16 a[206:207], v211 offset:8192
    ds_read_b64_tr_b16 a[208:209], v212 offset:0
    ds_read_b64_tr_b16 a[210:211], v212 offset:8192
    ds_read_b64_tr_b16 a[212:213], v213 offset:0
    ds_read_b64_tr_b16 a[214:215], v213 offset:8192
    ds_read_b64_tr_b16 a[216:217], v214 offset:0
    buffer_load_dwordx4 v220, s[12:15], s61 offen offset:0 nt lds
    ds_read_b64_tr_b16 a[218:219], v214 offset:8192
    ds_read_b64_tr_b16 a[220:221], v215 offset:0
    ds_read_b64_tr_b16 a[222:223], v215 offset:8192
    s_waitcnt lgkmcnt(11)
    v_mfma_f32_16x16x32_bf16 a[4:7], a[196:199], v[144:147], a[4:7]
    ds_read_b64_tr_b16 a[160:161], v208 offset:16384
    ds_read_b64_tr_b16 a[162:163], v208 offset:24576
    v_mfma_f32_16x16x32_bf16 a[32:35], a[192:195], v[148:151], a[32:35]
    buffer_load_dwordx4 v221, s[12:15], s61 offen offset:1024 nt lds
    ds_read_b64_tr_b16 a[164:165], v209 offset:16384
    s_waitcnt lgkmcnt(11)
    v_mfma_f32_16x16x32_bf16 a[8:11], a[200:203], v[144:147], a[8:11]
    ds_read_b64_tr_b16 a[166:167], v209 offset:24576
    ds_read_b64_tr_b16 a[168:169], v210 offset:16384
    v_mfma_f32_16x16x32_bf16 a[12:15], a[204:207], v[144:147], a[12:15]
    ds_read_b64_tr_b16 a[170:171], v210 offset:24576
    ds_read_b64_tr_b16 a[172:173], v211 offset:16384
    s_waitcnt lgkmcnt(10)
    v_mfma_f32_16x16x32_bf16 a[16:19], a[208:211], v[144:147], a[16:19]
    buffer_load_dwordx4 v222, s[12:15], s61 offen offset:2048 nt lds
    ds_read_b64_tr_b16 a[174:175], v211 offset:24576
    v_mfma_f32_16x16x32_bf16 a[20:23], a[212:215], v[144:147], a[20:23]
    ds_read_b64_tr_b16 a[176:177], v212 offset:16384
    ds_read_b64_tr_b16 a[178:179], v212 offset:24576
    s_waitcnt lgkmcnt(9)
    v_mfma_f32_16x16x32_bf16 a[24:27], a[216:219], v[144:147], a[24:27]
    ds_read_b64_tr_b16 a[180:181], v213 offset:16384
    ds_read_b64_tr_b16 a[182:183], v213 offset:24576
    v_mfma_f32_16x16x32_bf16 a[28:31], a[220:223], v[144:147], a[28:31]
    buffer_load_dwordx4 v223, s[12:15], s61 offen offset:3072 nt lds
    s_add_u32 m0, s3, 4096
    s_waitcnt lgkmcnt(8)
    v_mfma_f32_16x16x32_bf16 a[0:3], a[160:163], v[164:167], a[0:3]
    s_add_u32 s61, s55, 65536
    ds_read_b64_tr_b16 a[184:185], v214 offset:16384
    ds_read_b64_tr_b16 a[186:187], v214 offset:24576
    v_mfma_f32_16x16x32_bf16 a[4:7], a[164:167], v[164:167], a[4:7]
    ds_read_b64_tr_b16 a[188:189], v215 offset:16384
    ds_read_b64_tr_b16 a[190:191], v215 offset:24576
    s_waitcnt lgkmcnt(9)
    v_mfma_f32_16x16x32_bf16 a[8:11], a[168:171], v[164:167], a[8:11]
    buffer_load_dwordx4 v220, s[12:15], s61 offen offset:0 nt lds
    v_accvgpr_read_b32 v0, a0
    s_waitcnt lgkmcnt(7)
    v_mfma_f32_16x16x32_bf16 a[12:15], a[172:175], v[164:167], a[12:15]
    s_add_u32 s68, s56, 0
    v_accvgpr_read_b32 v1, a1
    v_accvgpr_read_b32 v2, a2
    s_waitcnt lgkmcnt(6)
    v_mfma_f32_16x16x32_bf16 a[16:19], a[176:179], v[164:167], a[16:19]
    v_accvgpr_read_b32 v3, a3
    v_accvgpr_read_b32 v4, a4
    s_waitcnt lgkmcnt(4)
    v_mfma_f32_16x16x32_bf16 a[20:23], a[180:183], v[164:167], a[20:23]
    buffer_load_dwordx4 v221, s[12:15], s61 offen offset:1024 nt lds
    v_accvgpr_read_b32 v5, a5
    v_accvgpr_read_b32 v6, a6
    v_accvgpr_read_b32 v7, a7
    v_pk_mul_f32 v[0:1], v[0:1], v[192:193] op_sel_hi:[1,0]
    v_pk_mul_f32 v[2:3], v[2:3], v[192:193] op_sel_hi:[1,0]
    s_waitcnt lgkmcnt(2)
    v_mfma_f32_16x16x32_bf16 a[24:27], a[184:187], v[164:167], a[24:27]
    v_cvt_pk_bf16_f32 v0, v0, v1
    v_cvt_pk_bf16_f32 v1, v2, v3
    s_waitcnt lgkmcnt(0)
    v_mfma_f32_16x16x32_bf16 a[28:31], a[188:191], v[164:167], a[28:31]
    ds_write_b64 v184, v[0:1]
    v_accvgpr_read_b32 v8, a8
    v_accvgpr_read_b32 v9, a9
    v_pk_mul_f32 v[4:5], v[4:5], v[192:193] op_sel_hi:[1,0]
    v_pk_mul_f32 v[6:7], v[6:7], v[192:193] op_sel_hi:[1,0]
    v_cvt_pk_bf16_f32 v4, v4, v5
    v_cvt_pk_bf16_f32 v5, v6, v7
    v_accvgpr_read_b32 v10, a10
    v_mfma_f32_16x16x32_bf16 a[36:39], a[196:199], v[148:151], a[36:39]
    buffer_load_dwordx4 v222, s[12:15], s61 offen offset:2048 nt lds
    v_accvgpr_read_b32 v11, a11
    v_mfma_f32_16x16x32_bf16 a[40:43], a[200:203], v[148:151], a[40:43]
    ds_write_b64 v185, v[4:5]
    v_mfma_f32_16x16x32_bf16 a[44:47], a[204:207], v[148:151], a[44:47]
    v_accvgpr_read_b32 v12, a12
    v_accvgpr_read_b32 v13, a13
    v_mfma_f32_16x16x32_bf16 a[48:51], a[208:211], v[148:151], a[48:51]
    v_accvgpr_read_b32 v14, a14
    v_accvgpr_read_b32 v15, a15
    v_mfma_f32_16x16x32_bf16 a[52:55], a[212:215], v[148:151], a[52:55]
    buffer_load_dwordx4 v223, s[12:15], s61 offen offset:3072 nt lds
    s_add_u32 m0, s41, 16384
    v_mfma_f32_16x16x32_bf16 a[56:59], a[216:219], v[148:151], a[56:59]
    v_accvgpr_read_b32 v16, a16
    v_accvgpr_read_b32 v17, a17
    v_mfma_f32_16x16x32_bf16 a[60:63], a[220:223], v[148:151], a[60:63]
    v_accvgpr_read_b32 v18, a18
    v_accvgpr_read_b32 v19, a19
    v_accvgpr_read_b32 v20, a20
    v_accvgpr_read_b32 v21, a21
    v_accvgpr_read_b32 v22, a22
    v_pk_mul_f32 v[8:9], v[8:9], v[192:193] op_sel_hi:[1,0]
    v_pk_mul_f32 v[10:11], v[10:11], v[192:193] op_sel_hi:[1,0]
    v_cvt_pk_bf16_f32 v8, v8, v9
    v_cvt_pk_bf16_f32 v9, v10, v11
    v_pk_mul_f32 v[12:13], v[12:13], v[192:193] op_sel_hi:[1,0]
    v_pk_mul_f32 v[14:15], v[14:15], v[192:193] op_sel_hi:[1,0]
    v_cvt_pk_bf16_f32 v12, v12, v13
    v_cvt_pk_bf16_f32 v13, v14, v15
    v_pk_mul_f32 v[16:17], v[16:17], v[192:193] op_sel_hi:[1,0]
    v_pk_mul_f32 v[18:19], v[18:19], v[192:193] op_sel_hi:[1,0]
    v_cvt_pk_bf16_f32 v16, v16, v17
    v_cvt_pk_bf16_f32 v17, v18, v19
    v_accvgpr_read_b32 v23, a23
    v_pk_mul_f32 v[20:21], v[20:21], v[192:193] op_sel_hi:[1,0]
    v_pk_mul_f32 v[22:23], v[22:23], v[192:193] op_sel_hi:[1,0]
    v_accvgpr_read_b32 v24, a24
    v_cvt_pk_bf16_f32 v20, v20, v21
    v_accvgpr_read_b32 v25, a25
    v_cvt_pk_bf16_f32 v21, v22, v23
    v_accvgpr_read_b32 v26, a26
    v_accvgpr_read_b32 v27, a27
    v_pk_mul_f32 v[24:25], v[24:25], v[192:193] op_sel_hi:[1,0]
    v_pk_mul_f32 v[26:27], v[26:27], v[192:193] op_sel_hi:[1,0]
    v_accvgpr_read_b32 v28, a28
    v_cvt_pk_bf16_f32 v24, v24, v25
    v_accvgpr_read_b32 v29, a29
    v_cvt_pk_bf16_f32 v25, v26, v27
    v_accvgpr_read_b32 v30, a30
    v_accvgpr_read_b32 v31, a31
    v_pk_mul_f32 v[28:29], v[28:29], v[192:193] op_sel_hi:[1,0]
    v_pk_mul_f32 v[30:31], v[30:31], v[192:193] op_sel_hi:[1,0]
    v_cvt_pk_bf16_f32 v28, v28, v29
    v_cvt_pk_bf16_f32 v29, v30, v31
    v_exp_f32 v112, v112
    v_exp_f32 v113, v113
    v_exp_f32 v114, v114
    v_exp_f32 v115, v115
    v_exp_f32 v116, v116
    v_exp_f32 v117, v117
    v_exp_f32 v118, v118
    v_exp_f32 v119, v119
    v_cvt_pk_bf16_f32 v168, v112, v113
    v_cvt_pk_bf16_f32 v169, v114, v115
    v_cvt_pk_bf16_f32 v170, v116, v117
    v_cvt_pk_bf16_f32 v171, v118, v119
    buffer_load_dwordx4 v216, s[16:19], s28 offen offset:2048 lds
    ds_write_b64 v186, v[8:9]
    v_mfma_f32_16x16x32_bf16 a[244:247], v[228:231], v[168:171], a[244:247]
    ds_write_b64 v187, v[12:13]
    v_mfma_f32_16x16x32_bf16 a[32:35], a[160:163], v[168:171], a[32:35]
    ds_write_b64 v188, v[16:17]
    v_mfma_f32_16x16x32_bf16 a[36:39], a[164:167], v[168:171], a[36:39]
    buffer_load_dwordx4 v217, s[16:19], s28 offen offset:3072 lds
    ds_write_b64 v189, v[20:21]
    v_mfma_f32_16x16x32_bf16 a[40:43], a[168:171], v[168:171], a[40:43]
    ds_write_b64 v190, v[24:25]
    v_mfma_f32_16x16x32_bf16 a[44:47], a[172:175], v[168:171], a[44:47]
    ds_write_b64 v191, v[28:29]
    v_mfma_f32_16x16x32_bf16 a[48:51], a[176:179], v[168:171], a[48:51]
    ds_read_b128 a[0:3], v241 offset:0
    v_accvgpr_read_b32 v253, a244
    v_mfma_f32_16x16x32_bf16 a[52:55], a[180:183], v[168:171], a[52:55]
    ds_read_b128 a[4:7], v241 offset:1024
    v_rcp_f32 v194, v253
    v_mfma_f32_16x16x32_bf16 a[56:59], a[184:187], v[168:171], a[56:59]
    ds_read_b128 a[8:11], v241 offset:2048
    v_accvgpr_read_b32 v32, a32
    v_mfma_f32_16x16x32_bf16 a[60:63], a[188:191], v[168:171], a[60:63]
    ds_read_b128 a[12:15], v241 offset:3072
    v_accvgpr_read_b32 v33, a33
    v_accvgpr_read_b32 v34, a34
    v_accvgpr_read_b32 v35, a35
    v_accvgpr_read_b32 v36, a36
    v_pk_mul_f32 v[32:33], v[32:33], v[194:195] op_sel_hi:[1,0]
    v_pk_mul_f32 v[34:35], v[34:35], v[194:195] op_sel_hi:[1,0]
    v_cvt_pk_bf16_f32 v32, v32, v33
    v_accvgpr_read_b32 v37, a37
    v_cvt_pk_bf16_f32 v33, v34, v35
    v_accvgpr_read_b32 v38, a38
    v_accvgpr_read_b32 v39, a39
    v_pk_mul_f32 v[36:37], v[36:37], v[194:195] op_sel_hi:[1,0]
    v_pk_mul_f32 v[38:39], v[38:39], v[194:195] op_sel_hi:[1,0]
    v_accvgpr_read_b32 v40, a40
    v_cvt_pk_bf16_f32 v36, v36, v37
    v_accvgpr_read_b32 v41, a41
    v_cvt_pk_bf16_f32 v37, v38, v39
    v_accvgpr_read_b32 v42, a42
    v_accvgpr_read_b32 v43, a43
    v_pk_mul_f32 v[40:41], v[40:41], v[194:195] op_sel_hi:[1,0]
    v_pk_mul_f32 v[42:43], v[42:43], v[194:195] op_sel_hi:[1,0]
    v_accvgpr_read_b32 v44, a44
    v_cvt_pk_bf16_f32 v40, v40, v41
    v_accvgpr_read_b32 v45, a45
    v_cvt_pk_bf16_f32 v41, v42, v43
    v_accvgpr_read_b32 v46, a46
    v_accvgpr_read_b32 v47, a47
    v_pk_mul_f32 v[44:45], v[44:45], v[194:195] op_sel_hi:[1,0]
    v_pk_mul_f32 v[46:47], v[46:47], v[194:195] op_sel_hi:[1,0]
    v_accvgpr_read_b32 v48, a48
    v_cvt_pk_bf16_f32 v44, v44, v45
    v_accvgpr_read_b32 v49, a49
    v_cvt_pk_bf16_f32 v45, v46, v47
    v_accvgpr_read_b32 v50, a50
    v_accvgpr_read_b32 v51, a51
    v_pk_mul_f32 v[48:49], v[48:49], v[194:195] op_sel_hi:[1,0]
    v_pk_mul_f32 v[50:51], v[50:51], v[194:195] op_sel_hi:[1,0]
    v_accvgpr_read_b32 v52, a52
    v_cvt_pk_bf16_f32 v48, v48, v49
    v_accvgpr_read_b32 v53, a53
    v_cvt_pk_bf16_f32 v49, v50, v51
    v_accvgpr_read_b32 v54, a54
    v_accvgpr_read_b32 v55, a55
    v_pk_mul_f32 v[52:53], v[52:53], v[194:195] op_sel_hi:[1,0]
    v_pk_mul_f32 v[54:55], v[54:55], v[194:195] op_sel_hi:[1,0]
    v_accvgpr_read_b32 v56, a56
    v_cvt_pk_bf16_f32 v52, v52, v53
    v_accvgpr_read_b32 v57, a57
    v_cvt_pk_bf16_f32 v53, v54, v55
    v_accvgpr_read_b32 v58, a58
    v_accvgpr_read_b32 v59, a59
    v_max_f32 v237, v252, v253
    v_pk_mul_f32 v[56:57], v[56:57], v[194:195] op_sel_hi:[1,0]
    v_cmp_le_f32 vcc, s66, v237
    v_pk_mul_f32 v[58:59], v[58:59], v[194:195] op_sel_hi:[1,0]
    v_accvgpr_read_b32 v60, a60
    v_cvt_pk_bf16_f32 v56, v56, v57
    v_accvgpr_read_b32 v61, a61
    s_or_b32 s74, vcc_lo, vcc_hi
    s_waitcnt lgkmcnt(0)
    buffer_store_dwordx4 a[0:3], v220, s[24:27], s68 offen offset:0 sc0 sc1
    v_cvt_pk_bf16_f32 v57, v58, v59
    v_accvgpr_read_b32 v62, a62
    v_accvgpr_read_b32 v63, a63
    v_mov_b32 v237, s74
    v_pk_mul_f32 v[60:61], v[60:61], v[194:195] op_sel_hi:[1,0]
    v_pk_mul_f32 v[62:63], v[62:63], v[194:195] op_sel_hi:[1,0]
    v_cvt_pk_bf16_f32 v60, v60, v61
    v_cvt_pk_bf16_f32 v61, v62, v63
    s_add_u32 s69, s56, 65536
    ds_write_b64 v184, v[32:33]
    ds_write_b64 v185, v[36:37]
    buffer_store_dwordx4 a[4:7], v221, s[24:27], s68 offen offset:1024 sc0 sc1
    ds_write_b64 v186, v[40:41]
    ds_write_b64 v187, v[44:45]
    ds_write_b64 v188, v[48:49]
    ds_write_b64 v189, v[52:53]
    buffer_store_dwordx4 a[8:11], v222, s[24:27], s68 offen offset:2048 sc0 sc1
    ds_write_b64 v190, v[56:57]
    ds_write_b32 v239, v237 offset:16384
    ds_write_b64 v191, v[60:61]
    ds_read_b128 a[32:35], v241 offset:0
    ds_read_b128 a[36:39], v241 offset:1024
    buffer_store_dwordx4 a[12:15], v223, s[24:27], s68 offen offset:3072 sc0 sc1
    ds_read_b128 a[40:43], v241 offset:2048
    ds_read_b128 a[44:47], v241 offset:3072
    s_waitcnt lgkmcnt(5)
    s_barrier
    s_waitcnt lgkmcnt(2)
    buffer_store_dwordx4 a[32:35], v220, s[24:27], s69 offen offset:0 sc0 sc1
    ds_read_b32 v244, v236
    buffer_store_dwordx4 a[36:39], v221, s[24:27], s69 offen offset:1024 sc0 sc1
    s_waitcnt lgkmcnt(0)
    v_cmp_ne_u32 vcc, 0, v244
    buffer_store_dwordx4 a[40:43], v222, s[24:27], s69 offen offset:2048 sc0 sc1
    buffer_store_dwordx4 a[44:47], v223, s[24:27], s69 offen offset:3072 sc0 sc1
    s_cbranch_vccnz Lrestart
    s_mov_b32 s64, 0
    s_waitcnt vmcnt(8)
    s_branch Lstart
Lxt2_3:
Lft2_0_0:
    s_waitcnt lgkmcnt(0)
    v_mfma_f32_16x16x32_bf16 a[240:243], v[228:231], v[164:167], a[240:243]
    ds_read_b64_tr_b16 a[192:193], v208 offset:16384
    v_exp_f32 v64, v64
    v_exp_f32 v65, v65
    v_exp_f32 v66, v66
    v_exp_f32 v67, v67
    v_exp_f32 v68, v68
    v_exp_f32 v69, v69
    v_exp_f32 v70, v70
    v_exp_f32 v71, v71
    v_cvt_pk_bf16_f32 v144, v64, v65
    v_cvt_pk_bf16_f32 v145, v66, v67
    v_cvt_pk_bf16_f32 v146, v68, v69
    v_cvt_pk_bf16_f32 v147, v70, v71
    v_xor_b32 v184, 0, v240
    v_xor_b32 v185, 32, v240
    v_mfma_f32_16x16x32_bf16 a[240:243], v[228:231], v[144:147], a[240:243]
    ds_read_b64_tr_b16 a[194:195], v208 offset:24576
    v_xor_b32 v186, 64, v240
    v_xor_b32 v187, 96, v240
    s_waitcnt vmcnt(8)
    s_barrier
    ds_read_b64_tr_b16 a[196:197], v209 offset:16384
    v_xor_b32 v188, 128, v240
    v_xor_b32 v189, 160, v240
    v_xor_b32 v190, 192, v240
    v_xor_b32 v191, 224, v240
    v_accvgpr_read_b32 v252, a240
    v_rcp_f32 v192, v252
    v_mfma_f32_16x16x32_bf16 a[244:247], v[228:231], v[168:171], a[244:247]
    ds_read_b64_tr_b16 a[198:199], v209 offset:24576
    ds_read_b64_tr_b16 a[200:201], v210 offset:16384
    ds_read_b64_tr_b16 a[202:203], v210 offset:24576
    ds_read_b64_tr_b16 a[204:205], v211 offset:16384
    s_waitcnt lgkmcnt(5)
    v_mfma_f32_16x16x32_bf16 a[0:3], a[192:195], v[164:167], a[0:3]
    ds_read_b64_tr_b16 a[206:207], v211 offset:24576
    ds_read_b64_tr_b16 a[208:209], v212 offset:16384
    v_mfma_f32_16x16x32_bf16 a[32:35], a[192:195], v[168:171], a[32:35]
    ds_read_b64_tr_b16 a[210:211], v212 offset:24576
    ds_read_b64_tr_b16 a[212:213], v213 offset:16384
    ds_read_b64_tr_b16 a[214:215], v213 offset:24576
    ds_read_b64_tr_b16 a[216:217], v214 offset:16384
    ds_read_b64_tr_b16 a[218:219], v214 offset:24576
    ds_read_b64_tr_b16 a[220:221], v215 offset:16384
    ds_read_b64_tr_b16 a[222:223], v215 offset:24576
    ds_read_b64_tr_b16 a[160:161], v208 offset:32768
    ds_read_b64_tr_b16 a[162:163], v208 offset:40960
    s_waitcnt lgkmcnt(13)
    v_mfma_f32_16x16x32_bf16 a[4:7], a[196:199], v[164:167], a[4:7]
    ds_read_b64_tr_b16 a[164:165], v209 offset:32768
    ds_read_b64_tr_b16 a[166:167], v209 offset:40960
    s_waitcnt lgkmcnt(13)
    v_mfma_f32_16x16x32_bf16 a[8:11], a[200:203], v[164:167], a[8:11]
    ds_read_b64_tr_b16 a[168:169], v210 offset:32768
    ds_read_b64_tr_b16 a[170:171], v210 offset:40960
    s_waitcnt lgkmcnt(12)
    v_mfma_f32_16x16x32_bf16 a[12:15], a[204:207], v[164:167], a[12:15]
    ds_read_b64_tr_b16 a[172:173], v211 offset:32768
    ds_read_b64_tr_b16 a[174:175], v211 offset:40960
    v_mfma_f32_16x16x32_bf16 a[16:19], a[208:211], v[164:167], a[16:19]
    ds_read_b64_tr_b16 a[176:177], v212 offset:32768
    ds_read_b64_tr_b16 a[178:179], v212 offset:40960
    s_waitcnt lgkmcnt(11)
    v_mfma_f32_16x16x32_bf16 a[20:23], a[212:215], v[164:167], a[20:23]
    ds_read_b64_tr_b16 a[180:181], v213 offset:32768
    ds_read_b64_tr_b16 a[182:183], v213 offset:40960
    v_mfma_f32_16x16x32_bf16 a[24:27], a[216:219], v[164:167], a[24:27]
    ds_read_b64_tr_b16 a[184:185], v214 offset:32768
    ds_read_b64_tr_b16 a[186:187], v214 offset:40960
    s_waitcnt lgkmcnt(10)
    v_mfma_f32_16x16x32_bf16 a[28:31], a[220:223], v[164:167], a[28:31]
    ds_read_b64_tr_b16 a[188:189], v215 offset:32768
    ds_read_b64_tr_b16 a[190:191], v215 offset:40960
    v_mfma_f32_16x16x32_bf16 a[0:3], a[160:163], v[144:147], a[0:3]
    s_add_u32 s68, s56, 0
    v_exp_f32 v72, v72
    v_mfma_f32_16x16x32_bf16 a[4:7], a[164:167], v[144:147], a[4:7]
    s_add_u32 s69, s56, 65536
    v_exp_f32 v73, v73
    s_waitcnt lgkmcnt(8)
    v_mfma_f32_16x16x32_bf16 a[8:11], a[168:171], v[144:147], a[8:11]
    s_nop 0
    v_accvgpr_read_b32 v0, a0
    v_mfma_f32_16x16x32_bf16 a[12:15], a[172:175], v[144:147], a[12:15]
    v_accvgpr_read_b32 v1, a1
    v_accvgpr_read_b32 v2, a2
    s_waitcnt lgkmcnt(4)
    v_mfma_f32_16x16x32_bf16 a[16:19], a[176:179], v[144:147], a[16:19]
    v_accvgpr_read_b32 v3, a3
    v_accvgpr_read_b32 v4, a4
    v_mfma_f32_16x16x32_bf16 a[20:23], a[180:183], v[144:147], a[20:23]
    v_accvgpr_read_b32 v5, a5
    v_accvgpr_read_b32 v6, a6
    s_waitcnt lgkmcnt(1)
    v_mfma_f32_16x16x32_bf16 a[24:27], a[184:187], v[144:147], a[24:27]
    v_accvgpr_read_b32 v7, a7
    v_accvgpr_read_b32 v8, a8
    s_waitcnt lgkmcnt(0)
    v_mfma_f32_16x16x32_bf16 a[28:31], a[188:191], v[144:147], a[28:31]
    v_accvgpr_read_b32 v9, a9
    v_accvgpr_read_b32 v10, a10
    v_mfma_f32_16x16x32_bf16 a[36:39], a[196:199], v[168:171], a[36:39]
    v_accvgpr_read_b32 v11, a11
    v_accvgpr_read_b32 v12, a12
    v_mfma_f32_16x16x32_bf16 a[40:43], a[200:203], v[168:171], a[40:43]
    v_accvgpr_read_b32 v13, a13
    v_accvgpr_read_b32 v14, a14
    v_mfma_f32_16x16x32_bf16 a[44:47], a[204:207], v[168:171], a[44:47]
    v_accvgpr_read_b32 v15, a15
    v_accvgpr_read_b32 v16, a16
    v_mfma_f32_16x16x32_bf16 a[48:51], a[208:211], v[168:171], a[48:51]
    v_accvgpr_read_b32 v17, a17
    v_accvgpr_read_b32 v18, a18
    v_mfma_f32_16x16x32_bf16 a[52:55], a[212:215], v[168:171], a[52:55]
    v_accvgpr_read_b32 v19, a19
    v_accvgpr_read_b32 v20, a20
    v_mfma_f32_16x16x32_bf16 a[56:59], a[216:219], v[168:171], a[56:59]
    v_accvgpr_read_b32 v21, a21
    v_accvgpr_read_b32 v22, a22
    v_mfma_f32_16x16x32_bf16 a[60:63], a[220:223], v[168:171], a[60:63]
    v_accvgpr_read_b32 v23, a23
    v_accvgpr_read_b32 v24, a24
    v_accvgpr_read_b32 v25, a25
    v_accvgpr_read_b32 v26, a26
    v_accvgpr_read_b32 v27, a27
    v_pk_mul_f32 v[0:1], v[0:1], v[192:193] op_sel_hi:[1,0]
    v_pk_mul_f32 v[2:3], v[2:3], v[192:193] op_sel_hi:[1,0]
    v_cvt_pk_bf16_f32 v0, v0, v1
    v_cvt_pk_bf16_f32 v1, v2, v3
    v_pk_mul_f32 v[4:5], v[4:5], v[192:193] op_sel_hi:[1,0]
    v_pk_mul_f32 v[6:7], v[6:7], v[192:193] op_sel_hi:[1,0]
    v_cvt_pk_bf16_f32 v4, v4, v5
    v_cvt_pk_bf16_f32 v5, v6, v7
    v_pk_mul_f32 v[8:9], v[8:9], v[192:193] op_sel_hi:[1,0]
    v_pk_mul_f32 v[10:11], v[10:11], v[192:193] op_sel_hi:[1,0]
    v_cvt_pk_bf16_f32 v8, v8, v9
    v_cvt_pk_bf16_f32 v9, v10, v11
    v_pk_mul_f32 v[12:13], v[12:13], v[192:193] op_sel_hi:[1,0]
    v_pk_mul_f32 v[14:15], v[14:15], v[192:193] op_sel_hi:[1,0]
    v_cvt_pk_bf16_f32 v12, v12, v13
    v_cvt_pk_bf16_f32 v13, v14, v15
    v_pk_mul_f32 v[16:17], v[16:17], v[192:193] op_sel_hi:[1,0]
    v_pk_mul_f32 v[18:19], v[18:19], v[192:193] op_sel_hi:[1,0]
    v_cvt_pk_bf16_f32 v16, v16, v17
    v_cvt_pk_bf16_f32 v17, v18, v19
    v_pk_mul_f32 v[20:21], v[20:21], v[192:193] op_sel_hi:[1,0]
    v_pk_mul_f32 v[22:23], v[22:23], v[192:193] op_sel_hi:[1,0]
    v_cvt_pk_bf16_f32 v20, v20, v21
    v_cvt_pk_bf16_f32 v21, v22, v23
    v_pk_mul_f32 v[24:25], v[24:25], v[192:193] op_sel_hi:[1,0]
    v_pk_mul_f32 v[26:27], v[26:27], v[192:193] op_sel_hi:[1,0]
    v_accvgpr_read_b32 v28, a28
    v_cvt_pk_bf16_f32 v24, v24, v25
    v_accvgpr_read_b32 v29, a29
    v_cvt_pk_bf16_f32 v25, v26, v27
    v_accvgpr_read_b32 v30, a30
    v_accvgpr_read_b32 v31, a31
    v_pk_mul_f32 v[28:29], v[28:29], v[192:193] op_sel_hi:[1,0]
    v_pk_mul_f32 v[30:31], v[30:31], v[192:193] op_sel_hi:[1,0]
    v_cvt_pk_bf16_f32 v28, v28, v29
    v_cvt_pk_bf16_f32 v29, v30, v31
    v_exp_f32 v74, v74
    v_exp_f32 v75, v75
    v_exp_f32 v76, v76
    v_exp_f32 v77, v77
    v_exp_f32 v78, v78
    v_exp_f32 v79, v79
    v_cvt_pk_bf16_f32 v148, v72, v73
    v_cvt_pk_bf16_f32 v149, v74, v75
    v_cvt_pk_bf16_f32 v150, v76, v77
    v_cvt_pk_bf16_f32 v151, v78, v79
    ds_write_b64 v184, v[0:1]
    s_nop 0
    v_mfma_f32_16x16x32_bf16 a[244:247], v[228:231], v[148:151], a[244:247]
    ds_write_b64 v185, v[4:5]
    v_mfma_f32_16x16x32_bf16 a[32:35], a[160:163], v[148:151], a[32:35]
    ds_write_b64 v186, v[8:9]
    v_mfma_f32_16x16x32_bf16 a[36:39], a[164:167], v[148:151], a[36:39]
    ds_write_b64 v187, v[12:13]
    v_mfma_f32_16x16x32_bf16 a[40:43], a[168:171], v[148:151], a[40:43]
    ds_write_b64 v188, v[16:17]
    v_mfma_f32_16x16x32_bf16 a[44:47], a[172:175], v[148:151], a[44:47]
    ds_write_b64 v189, v[20:21]
    v_mfma_f32_16x16x32_bf16 a[48:51], a[176:179], v[148:151], a[48:51]
    ds_write_b64 v190, v[24:25]
    v_mfma_f32_16x16x32_bf16 a[52:55], a[180:183], v[148:151], a[52:55]
    ds_write_b64 v191, v[28:29]
    v_mfma_f32_16x16x32_bf16 a[56:59], a[184:187], v[148:151], a[56:59]
    ds_read_b128 a[0:3], v241 offset:0
    v_accvgpr_read_b32 v253, a244
    v_mfma_f32_16x16x32_bf16 a[60:63], a[188:191], v[148:151], a[60:63]
    ds_read_b128 a[4:7], v241 offset:1024
    v_rcp_f32 v194, v253
    v_accvgpr_read_b32 v32, a32
    v_accvgpr_read_b32 v33, a33
    v_accvgpr_read_b32 v34, a34
    v_accvgpr_read_b32 v35, a35
    v_pk_mul_f32 v[32:33], v[32:33], v[194:195] op_sel_hi:[1,0]
    v_pk_mul_f32 v[34:35], v[34:35], v[194:195] op_sel_hi:[1,0]
    v_accvgpr_read_b32 v36, a36
    v_cvt_pk_bf16_f32 v32, v32, v33
    v_accvgpr_read_b32 v37, a37
    v_cvt_pk_bf16_f32 v33, v34, v35
    v_accvgpr_read_b32 v38, a38
    v_accvgpr_read_b32 v39, a39
    v_pk_mul_f32 v[36:37], v[36:37], v[194:195] op_sel_hi:[1,0]
    v_pk_mul_f32 v[38:39], v[38:39], v[194:195] op_sel_hi:[1,0]
    v_accvgpr_read_b32 v40, a40
    v_cvt_pk_bf16_f32 v36, v36, v37
    v_accvgpr_read_b32 v41, a41
    v_cvt_pk_bf16_f32 v37, v38, v39
    v_accvgpr_read_b32 v42, a42
    v_accvgpr_read_b32 v43, a43
    v_pk_mul_f32 v[40:41], v[40:41], v[194:195] op_sel_hi:[1,0]
    v_pk_mul_f32 v[42:43], v[42:43], v[194:195] op_sel_hi:[1,0]
    v_accvgpr_read_b32 v44, a44
    v_cvt_pk_bf16_f32 v40, v40, v41
    v_accvgpr_read_b32 v45, a45
    v_cvt_pk_bf16_f32 v41, v42, v43
    v_accvgpr_read_b32 v46, a46
    v_accvgpr_read_b32 v47, a47
    v_pk_mul_f32 v[44:45], v[44:45], v[194:195] op_sel_hi:[1,0]
    v_pk_mul_f32 v[46:47], v[46:47], v[194:195] op_sel_hi:[1,0]
    v_accvgpr_read_b32 v48, a48
    v_cvt_pk_bf16_f32 v44, v44, v45
    v_accvgpr_read_b32 v49, a49
    v_cvt_pk_bf16_f32 v45, v46, v47
    v_accvgpr_read_b32 v50, a50
    v_accvgpr_read_b32 v51, a51
    v_pk_mul_f32 v[48:49], v[48:49], v[194:195] op_sel_hi:[1,0]
    v_pk_mul_f32 v[50:51], v[50:51], v[194:195] op_sel_hi:[1,0]
    v_accvgpr_read_b32 v52, a52
    v_cvt_pk_bf16_f32 v48, v48, v49
    v_accvgpr_read_b32 v53, a53
    v_cvt_pk_bf16_f32 v49, v50, v51
    v_accvgpr_read_b32 v54, a54
    v_accvgpr_read_b32 v55, a55
    v_pk_mul_f32 v[52:53], v[52:53], v[194:195] op_sel_hi:[1,0]
    v_pk_mul_f32 v[54:55], v[54:55], v[194:195] op_sel_hi:[1,0]
    v_accvgpr_read_b32 v56, a56
    v_cvt_pk_bf16_f32 v52, v52, v53
    v_accvgpr_read_b32 v57, a57
    v_cvt_pk_bf16_f32 v53, v54, v55
    v_accvgpr_read_b32 v58, a58
    v_accvgpr_read_b32 v59, a59
    v_max_f32 v237, v252, v253
    v_pk_mul_f32 v[56:57], v[56:57], v[194:195] op_sel_hi:[1,0]
    v_cmp_le_f32 vcc, s66, v237
    v_pk_mul_f32 v[58:59], v[58:59], v[194:195] op_sel_hi:[1,0]
    v_accvgpr_read_b32 v60, a60
    v_cvt_pk_bf16_f32 v56, v56, v57
    v_accvgpr_read_b32 v61, a61
    s_or_b32 s74, vcc_lo, vcc_hi
    s_waitcnt lgkmcnt(0)
    buffer_store_dwordx4 a[0:3], v220, s[24:27], s68 offen offset:0 sc0 sc1
    ds_read_b128 a[8:11], v241 offset:2048
    v_cvt_pk_bf16_f32 v57, v58, v59
    v_accvgpr_read_b32 v62, a62
    v_accvgpr_read_b32 v63, a63
    v_mov_b32 v237, s74
    v_pk_mul_f32 v[60:61], v[60:61], v[194:195] op_sel_hi:[1,0]
    v_pk_mul_f32 v[62:63], v[62:63], v[194:195] op_sel_hi:[1,0]
    v_cvt_pk_bf16_f32 v60, v60, v61
    v_cvt_pk_bf16_f32 v61, v62, v63
    ds_read_b128 a[12:15], v241 offset:3072
    ds_write_b64 v184, v[32:33]
    ds_write_b64 v185, v[36:37]
    buffer_store_dwordx4 a[4:7], v221, s[24:27], s68 offen offset:1024 sc0 sc1
    ds_write_b64 v186, v[40:41]
    ds_write_b64 v187, v[44:45]
    ds_write_b64 v188, v[48:49]
    ds_write_b64 v189, v[52:53]
    s_waitcnt lgkmcnt(5)
    buffer_store_dwordx4 a[8:11], v222, s[24:27], s68 offen offset:2048 sc0 sc1
    ds_write_b64 v190, v[56:57]
    ds_write_b32 v239, v237 offset:16384
    ds_write_b64 v191, v[60:61]
    ds_read_b128 a[32:35], v241 offset:0
    ds_read_b128 a[36:39], v241 offset:1024
    ds_read_b128 a[40:43], v241 offset:2048
    buffer_store_dwordx4 a[12:15], v223, s[24:27], s68 offen offset:3072 sc0 sc1
    ds_read_b128 a[44:47], v241 offset:3072
    s_waitcnt lgkmcnt(5)
    s_barrier
    s_waitcnt lgkmcnt(1)
    buffer_store_dwordx4 a[32:35], v220, s[24:27], s69 offen offset:0 sc0 sc1
    ds_read_b32 v244, v236
    buffer_store_dwordx4 a[36:39], v221, s[24:27], s69 offen offset:1024 sc0 sc1
    s_waitcnt lgkmcnt(0)
    v_cmp_ne_u32 vcc, 0, v244
    buffer_store_dwordx4 a[40:43], v222, s[24:27], s69 offen offset:2048 sc0 sc1
    buffer_store_dwordx4 a[44:47], v223, s[24:27], s69 offen offset:3072 sc0 sc1
    s_cbranch_vccnz Lrestart
    s_endpgm
Ldone:
Lend:
    s_endpgm
Lcold:
Lrestart:
    s_waitcnt vmcnt(0) lgkmcnt(0)
    s_barrier
    s_mov_b64 s[32:33], s[28:29]
    s_mov_b64 s[34:35], s[30:31]
    s_mov_b64 s[28:29], s[36:37]
    s_mov_b32 s30, s26
    s_mov_b32 s31, s43
    s_mov_b32 s65, 1
    s_mov_b32 s64, 1
    s_mov_b32 s14, s30
    s_bfe_u32 s50, s29, 0x30018
    s_mul_i32 s61, s50, s47
    s_lshl_b32 s61, s61, 16
    s_and_b32 s55, s29, 0xfff000
    s_add_u32 s55, s55, s28
    s_add_u32 s55, s55, s61
    s_mov_b32 m0, s41
    s_add_u32 s18, s30, 4096
    buffer_load_dwordx4 v216, s[16:19], s31 offen offset:2048 lds
    buffer_load_dwordx4 v217, s[16:19], s31 offen offset:3072 lds
    s_mov_b32 m0, s3
    s_add_u32 s61, s55, 0
    buffer_load_dwordx4 v220, s[12:15], s61 offen offset:0 nt lds
    buffer_load_dwordx4 v221, s[12:15], s61 offen offset:1024 nt lds
    buffer_load_dwordx4 v222, s[12:15], s61 offen offset:2048 nt lds
    buffer_load_dwordx4 v223, s[12:15], s61 offen offset:3072 nt lds
    s_add_u32 m0, s3, 4096
    s_add_u32 s61, s55, 65536
    buffer_load_dwordx4 v220, s[12:15], s61 offen offset:0 nt lds
    buffer_load_dwordx4 v221, s[12:15], s61 offen offset:1024 nt lds
    buffer_load_dwordx4 v222, s[12:15], s61 offen offset:2048 nt lds
    buffer_load_dwordx4 v223, s[12:15], s61 offen offset:3072 nt lds
    s_add_u32 m0, s41, 16384
    s_nop 0
    buffer_load_dwordx4 v216, s[16:19], s28 offen offset:2048 lds
    buffer_load_dwordx4 v217, s[16:19], s28 offen offset:3072 lds
    s_branch Lstart
Lsafe4:
    s_waitcnt lgkmcnt(0)
    v_mfma_f32_16x16x32_bf16 v[64:67], a[160:163], v[0:3], v[184:187]
    ds_read_b64_tr_b16 a[192:193], v208 offset:32768
    v_mfma_f32_16x16x32_bf16 v[72:75], a[160:163], v[16:19], v[188:191]
    ds_read_b64_tr_b16 a[194:195], v208 offset:40960
    v_mfma_f32_16x16x32_bf16 v[80:83], a[160:163], v[32:35], v[192:195]
    v_exp_f32 v224, v128
    v_mfma_f32_16x16x32_bf16 v[88:91], a[160:163], v[48:51], v[196:199]
    ds_read_b64_tr_b16 a[196:197], v209 offset:32768
    v_mfma_f32_16x16x32_bf16 v[64:67], a[164:167], v[4:7], v[64:67]
    ds_read_b64_tr_b16 a[198:199], v209 offset:40960
    v_mfma_f32_16x16x32_bf16 v[72:75], a[164:167], v[20:23], v[72:75]
    v_exp_f32 v225, v129
    v_mfma_f32_16x16x32_bf16 v[80:83], a[164:167], v[36:39], v[80:83]
    ds_read_b64_tr_b16 a[200:201], v210 offset:32768
    v_cvt_pk_bf16_f32 v176, v224, v225
    v_mfma_f32_16x16x32_bf16 v[88:91], a[164:167], v[52:55], v[88:91]
    v_exp_f32 v226, v130
    v_mfma_f32_16x16x32_bf16 v[64:67], a[168:171], v[8:11], v[64:67]
    ds_read_b64_tr_b16 a[202:203], v210 offset:40960
    v_mfma_f32_16x16x32_bf16 v[72:75], a[168:171], v[24:27], v[72:75]
    ds_read_b64_tr_b16 a[204:205], v211 offset:32768
    v_mfma_f32_16x16x32_bf16 v[80:83], a[168:171], v[40:43], v[80:83]
    v_exp_f32 v227, v131
    v_mfma_f32_16x16x32_bf16 v[88:91], a[168:171], v[56:59], v[88:91]
    ds_read_b64_tr_b16 a[206:207], v211 offset:40960
    v_cvt_pk_bf16_f32 v177, v226, v227
    v_mfma_f32_16x16x32_bf16 v[64:67], a[172:175], v[12:15], v[64:67]
    v_exp_f32 v248, v132
    v_mfma_f32_16x16x32_bf16 v[72:75], a[172:175], v[28:31], v[72:75]
    ds_read_b64_tr_b16 a[208:209], v212 offset:32768
    v_or_b32 v245, v176, v177
    v_mfma_f32_16x16x32_bf16 v[80:83], a[172:175], v[44:47], v[80:83]
    ds_read_b64_tr_b16 a[210:211], v212 offset:40960
    v_mfma_f32_16x16x32_bf16 v[88:91], a[172:175], v[60:63], v[88:91]
    v_exp_f32 v249, v133
    v_mfma_f32_16x16x32_bf16 v[68:71], a[176:179], v[0:3], v[184:187]
    ds_read_b64_tr_b16 a[212:213], v213 offset:32768
    v_cvt_pk_bf16_f32 v178, v248, v249
    v_mfma_f32_16x16x32_bf16 v[76:79], a[176:179], v[16:19], v[188:191]
    ds_read_b64_tr_b16 a[214:215], v213 offset:40960
    v_mfma_f32_16x16x32_bf16 v[84:87], a[176:179], v[32:35], v[192:195]
    v_exp_f32 v250, v134
    v_mfma_f32_16x16x32_bf16 v[92:95], a[176:179], v[48:51], v[196:199]
    ds_read_b64_tr_b16 a[216:217], v214 offset:32768
    v_mfma_f32_16x16x32_bf16 v[68:71], a[180:183], v[4:7], v[68:71]
    v_exp_f32 v251, v135
    v_mfma_f32_16x16x32_bf16 v[76:79], a[180:183], v[20:23], v[76:79]
    ds_read_b64_tr_b16 a[218:219], v214 offset:40960
    v_cvt_pk_bf16_f32 v179, v250, v251
    v_mfma_f32_16x16x32_bf16 v[84:87], a[180:183], v[36:39], v[84:87]
    ds_read_b64_tr_b16 a[220:221], v215 offset:32768
    v_or3_b32 v245, v245, v178, v179
    v_mfma_f32_16x16x32_bf16 v[92:95], a[180:183], v[52:55], v[92:95]
    v_exp_f32 v224, v120
    v_mfma_f32_16x16x32_bf16 v[68:71], a[184:187], v[8:11], v[68:71]
    ds_read_b64_tr_b16 a[222:223], v215 offset:40960
    v_mfma_f32_16x16x32_bf16 v[76:79], a[184:187], v[24:27], v[76:79]
    v_exp_f32 v225, v121
    v_mfma_f32_16x16x32_bf16 v[84:87], a[184:187], v[40:43], v[84:87]
    v_exp_f32 v226, v122
    v_mfma_f32_16x16x32_bf16 v[92:95], a[184:187], v[56:59], v[92:95]
    s_add_u32 m0, s41, 32768
    v_exp_f32 v227, v123
    v_mfma_f32_16x16x32_bf16 v[68:71], a[188:191], v[12:15], v[68:71]
    s_add_u32 s40, s40, 131072
    v_exp_f32 v248, v124
    v_mfma_f32_16x16x32_bf16 v[76:79], a[188:191], v[28:31], v[76:79]
    s_add_u32 s63, s63, 131072
    v_exp_f32 v249, v125
    v_mfma_f32_16x16x32_bf16 v[84:87], a[188:191], v[44:47], v[84:87]
    s_waitcnt vmcnt(8) lgkmcnt(0)
    v_exp_f32 v250, v126
    v_mfma_f32_16x16x32_bf16 v[92:95], a[188:191], v[60:63], v[92:95]
    s_barrier
    v_mfma_f32_16x16x32_bf16 a[0:3], a[192:195], v[144:147], 0
    ds_read_b128 a[160:163], v204 offset:49152
    v_cvt_pk_bf16_f32 v172, v224, v225
    v_mfma_f32_16x16x32_bf16 a[32:35], a[192:195], v[148:151], 0
    v_exp_f32 v251, v127
    v_mfma_f32_16x16x32_bf16 a[64:67], a[192:195], v[152:155], 0
    ds_read_b128 a[164:167], v205 offset:49152
    v_cvt_pk_bf16_f32 v173, v226, v227
    v_mfma_f32_16x16x32_bf16 a[96:99], a[192:195], v[156:159], 0
    v_exp_f32 v224, v112
    v_mfma_f32_16x16x32_bf16 a[4:7], a[196:199], v[144:147], 0
    v_exp_f32 v225, v113
    v_mfma_f32_16x16x32_bf16 a[36:39], a[196:199], v[148:151], 0
    buffer_load_dwordx4 v218, s[20:23], s40 offen lds
    v_or3_b32 v245, v245, v172, v173
    v_mfma_f32_16x16x32_bf16 a[68:71], a[196:199], v[152:155], 0
    v_exp_f32 v226, v114
    v_mfma_f32_16x16x32_bf16 a[100:103], a[196:199], v[156:159], 0
    ds_read_b128 a[168:171], v206 offset:49152
    v_cvt_pk_bf16_f32 v174, v248, v249
    v_mfma_f32_16x16x32_bf16 a[8:11], a[200:203], v[144:147], 0
    v_exp_f32 v227, v115
    v_mfma_f32_16x16x32_bf16 a[40:43], a[200:203], v[148:151], 0
    v_exp_f32 v248, v116
    v_mfma_f32_16x16x32_bf16 a[72:75], a[200:203], v[152:155], 0
    ds_read_b128 a[172:175], v207 offset:49152
    v_cvt_pk_bf16_f32 v175, v250, v251
    v_mfma_f32_16x16x32_bf16 a[104:107], a[200:203], v[156:159], 0
    v_exp_f32 v249, v117
    v_mfma_f32_16x16x32_bf16 a[12:15], a[204:207], v[144:147], 0
    v_exp_f32 v250, v118
    v_mfma_f32_16x16x32_bf16 a[44:47], a[204:207], v[148:151], 0
    buffer_load_dwordx4 v219, s[20:23], s40 offen offset:1024 lds
    v_or3_b32 v245, v245, v174, v175
    v_mfma_f32_16x16x32_bf16 a[76:79], a[204:207], v[152:155], 0
    v_cvt_pk_bf16_f32 v168, v224, v225
    v_cvt_pk_bf16_f32 v169, v226, v227
    v_mfma_f32_16x16x32_bf16 a[108:111], a[204:207], v[156:159], 0
    ds_read_b128 a[176:179], v204 offset:57344
    v_or3_b32 v245, v245, v168, v169
    v_mfma_f32_16x16x32_bf16 a[16:19], a[208:211], v[144:147], 0
    v_exp_f32 v251, v119
    v_mfma_f32_16x16x32_bf16 a[48:51], a[208:211], v[148:151], 0
    v_exp_f32 v224, v104
    v_mfma_f32_16x16x32_bf16 a[80:83], a[208:211], v[152:155], 0
    ds_read_b128 a[180:183], v205 offset:57344
    v_cvt_pk_bf16_f32 v170, v248, v249
    v_mfma_f32_16x16x32_bf16 a[112:115], a[208:211], v[156:159], 0
    v_exp_f32 v225, v105
    v_mfma_f32_16x16x32_bf16 a[20:23], a[212:215], v[144:147], 0
    v_exp_f32 v226, v106
    v_mfma_f32_16x16x32_bf16 a[52:55], a[212:215], v[148:151], 0
    ds_read_b128 a[184:187], v206 offset:57344
    v_cvt_pk_bf16_f32 v171, v250, v251
    v_mfma_f32_16x16x32_bf16 a[84:87], a[212:215], v[152:155], 0
    v_exp_f32 v227, v107
    v_mfma_f32_16x16x32_bf16 a[116:119], a[212:215], v[156:159], 0
    buffer_load_dwordx4 v216, s[16:19], s63 offen offset:2048 lds
    v_or3_b32 v245, v245, v170, v171
    v_mfma_f32_16x16x32_bf16 a[24:27], a[216:219], v[144:147], 0
    v_exp_f32 v248, v108
    v_mfma_f32_16x16x32_bf16 a[56:59], a[216:219], v[148:151], 0
    v_exp_f32 v249, v109
    v_mfma_f32_16x16x32_bf16 a[88:91], a[216:219], v[152:155], 0
    ds_read_b128 a[188:191], v207 offset:57344
    v_cvt_pk_bf16_f32 v164, v224, v225
    v_mfma_f32_16x16x32_bf16 a[120:123], a[216:219], v[156:159], 0
    v_exp_f32 v250, v110
    v_mfma_f32_16x16x32_bf16 a[28:31], a[220:223], v[144:147], 0
    v_exp_f32 v251, v111
    v_mfma_f32_16x16x32_bf16 a[60:63], a[220:223], v[148:151], 0
    v_cvt_pk_bf16_f32 v165, v226, v227
    v_or3_b32 v245, v245, v164, v165
    v_mfma_f32_16x16x32_bf16 a[92:95], a[220:223], v[152:155], 0
    v_cvt_pk_bf16_f32 v166, v248, v249
    v_cvt_pk_bf16_f32 v167, v250, v251
    v_mfma_f32_16x16x32_bf16 a[124:127], a[220:223], v[156:159], 0
    buffer_load_dwordx4 v217, s[16:19], s63 offen offset:3072 lds
    v_or3_b32 v245, v245, v166, v167
    v_mfma_f32_16x16x32_bf16 a[240:243], v[228:231], v[144:147], 0
    s_sub_u32 s42, s42, 1
    v_and_b32 v244, 0x40004000, v245
    v_cmp_ne_u32 vcc, 0, v244
    v_mfma_f32_16x16x32_bf16 a[244:247], v[228:231], v[148:151], 0
    s_waitcnt lgkmcnt(0)
    v_mfma_f32_16x16x32_bf16 a[248:251], v[228:231], v[152:155], 0
    v_mfma_f32_16x16x32_bf16 a[252:255], v[228:231], v[156:159], 0
    s_cbranch_vccnz Lrare_t4p1
Lback_t4p1:
Lsloop4:
    v_mfma_f32_16x16x32_bf16 v[104:107], a[160:163], v[0:3], v[184:187]
    ds_read_b64_tr_b16 a[192:193], v208 offset:49152
    v_mfma_f32_16x16x32_bf16 v[112:115], a[160:163], v[16:19], v[188:191]
    ds_read_b64_tr_b16 a[194:195], v208 offset:57344
    v_mfma_f32_16x16x32_bf16 v[120:123], a[160:163], v[32:35], v[192:195]
    v_exp_f32 v224, v88
    v_mfma_f32_16x16x32_bf16 v[128:131], a[160:163], v[48:51], v[196:199]
    ds_read_b64_tr_b16 a[196:197], v209 offset:49152
    v_mfma_f32_16x16x32_bf16 v[104:107], a[164:167], v[4:7], v[104:107]
    ds_read_b64_tr_b16 a[198:199], v209 offset:57344
    v_mfma_f32_16x16x32_bf16 v[112:115], a[164:167], v[20:23], v[112:115]
    v_exp_f32 v225, v89
    v_mfma_f32_16x16x32_bf16 v[120:123], a[164:167], v[36:39], v[120:123]
    ds_read_b64_tr_b16 a[200:201], v210 offset:49152
    v_cvt_pk_bf16_f32 v156, v224, v225
    v_mfma_f32_16x16x32_bf16 v[128:131], a[164:167], v[52:55], v[128:131]
    v_exp_f32 v226, v90
    v_mfma_f32_16x16x32_bf16 v[104:107], a[168:171], v[8:11], v[104:107]
    ds_read_b64_tr_b16 a[202:203], v210 offset:57344
    v_mfma_f32_16x16x32_bf16 v[112:115], a[168:171], v[24:27], v[112:115]
    ds_read_b64_tr_b16 a[204:205], v211 offset:49152
    v_mfma_f32_16x16x32_bf16 v[120:123], a[168:171], v[40:43], v[120:123]
    v_exp_f32 v227, v91
    v_mfma_f32_16x16x32_bf16 v[128:131], a[168:171], v[56:59], v[128:131]
    ds_read_b64_tr_b16 a[206:207], v211 offset:57344
    v_cvt_pk_bf16_f32 v157, v226, v227
    v_mfma_f32_16x16x32_bf16 v[104:107], a[172:175], v[12:15], v[104:107]
    v_exp_f32 v248, v92
    v_mfma_f32_16x16x32_bf16 v[112:115], a[172:175], v[28:31], v[112:115]
    ds_read_b64_tr_b16 a[208:209], v212 offset:49152
    v_or_b32 v245, v156, v157
    v_mfma_f32_16x16x32_bf16 v[120:123], a[172:175], v[44:47], v[120:123]
    ds_read_b64_tr_b16 a[210:211], v212 offset:57344
    v_mfma_f32_16x16x32_bf16 v[128:131], a[172:175], v[60:63], v[128:131]
    v_exp_f32 v249, v93
    v_mfma_f32_16x16x32_bf16 v[108:111], a[176:179], v[0:3], v[184:187]
    ds_read_b64_tr_b16 a[212:213], v213 offset:49152
    v_cvt_pk_bf16_f32 v158, v248, v249
    v_mfma_f32_16x16x32_bf16 v[116:119], a[176:179], v[16:19], v[188:191]
    ds_read_b64_tr_b16 a[214:215], v213 offset:57344
    v_mfma_f32_16x16x32_bf16 v[124:127], a[176:179], v[32:35], v[192:195]
    v_exp_f32 v250, v94
    v_mfma_f32_16x16x32_bf16 v[132:135], a[176:179], v[48:51], v[196:199]
    ds_read_b64_tr_b16 a[216:217], v214 offset:49152
    v_mfma_f32_16x16x32_bf16 v[108:111], a[180:183], v[4:7], v[108:111]
    v_exp_f32 v251, v95
    v_mfma_f32_16x16x32_bf16 v[116:119], a[180:183], v[20:23], v[116:119]
    ds_read_b64_tr_b16 a[218:219], v214 offset:57344
    v_cvt_pk_bf16_f32 v159, v250, v251
    v_mfma_f32_16x16x32_bf16 v[124:127], a[180:183], v[36:39], v[124:127]
    ds_read_b64_tr_b16 a[220:221], v215 offset:49152
    v_or3_b32 v245, v245, v158, v159
    v_mfma_f32_16x16x32_bf16 v[132:135], a[180:183], v[52:55], v[132:135]
    v_exp_f32 v224, v80
    v_mfma_f32_16x16x32_bf16 v[108:111], a[184:187], v[8:11], v[108:111]
    ds_read_b64_tr_b16 a[222:223], v215 offset:57344
    v_mfma_f32_16x16x32_bf16 v[116:119], a[184:187], v[24:27], v[116:119]
    v_exp_f32 v225, v81
    v_mfma_f32_16x16x32_bf16 v[124:127], a[184:187], v[40:43], v[124:127]
    v_exp_f32 v226, v82
    v_mfma_f32_16x16x32_bf16 v[132:135], a[184:187], v[56:59], v[132:135]
    s_add_u32 m0, s41, 49152
    v_exp_f32 v227, v83
    v_mfma_f32_16x16x32_bf16 v[108:111], a[188:191], v[12:15], v[108:111]
    s_add_u32 s40, s40, 131072
    v_exp_f32 v248, v84
    v_mfma_f32_16x16x32_bf16 v[116:119], a[188:191], v[28:31], v[116:119]
    s_add_u32 s63, s63, 131072
    v_exp_f32 v249, v85
    v_mfma_f32_16x16x32_bf16 v[124:127], a[188:191], v[44:47], v[124:127]
    s_waitcnt vmcnt(8) lgkmcnt(0)
    v_exp_f32 v250, v86
    v_mfma_f32_16x16x32_bf16 v[132:135], a[188:191], v[60:63], v[132:135]
    s_barrier
    v_mfma_f32_16x16x32_bf16 a[0:3], a[192:195], v[164:167], a[0:3]
    ds_read_b128 a[160:163], v204 offset:0
    v_cvt_pk_bf16_f32 v152, v224, v225
    v_mfma_f32_16x16x32_bf16 a[32:35], a[192:195], v[168:171], a[32:35]
    v_exp_f32 v251, v87
    v_mfma_f32_16x16x32_bf16 a[64:67], a[192:195], v[172:175], a[64:67]
    ds_read_b128 a[164:167], v205 offset:0
    v_cvt_pk_bf16_f32 v153, v226, v227
    v_mfma_f32_16x16x32_bf16 a[96:99], a[192:195], v[176:179], a[96:99]
    v_exp_f32 v224, v72
    v_mfma_f32_16x16x32_bf16 a[4:7], a[196:199], v[164:167], a[4:7]
    v_exp_f32 v225, v73
    v_mfma_f32_16x16x32_bf16 a[36:39], a[196:199], v[168:171], a[36:39]
    buffer_load_dwordx4 v218, s[20:23], s40 offen lds
    v_or3_b32 v245, v245, v152, v153
    v_mfma_f32_16x16x32_bf16 a[68:71], a[196:199], v[172:175], a[68:71]
    v_exp_f32 v226, v74
    v_mfma_f32_16x16x32_bf16 a[100:103], a[196:199], v[176:179], a[100:103]
    ds_read_b128 a[168:171], v206 offset:0
    v_cvt_pk_bf16_f32 v154, v248, v249
    v_mfma_f32_16x16x32_bf16 a[8:11], a[200:203], v[164:167], a[8:11]
    v_exp_f32 v227, v75
    v_mfma_f32_16x16x32_bf16 a[40:43], a[200:203], v[168:171], a[40:43]
    v_exp_f32 v248, v76
    v_mfma_f32_16x16x32_bf16 a[72:75], a[200:203], v[172:175], a[72:75]
    ds_read_b128 a[172:175], v207 offset:0
    v_cvt_pk_bf16_f32 v155, v250, v251
    v_mfma_f32_16x16x32_bf16 a[104:107], a[200:203], v[176:179], a[104:107]
    v_exp_f32 v249, v77
    v_mfma_f32_16x16x32_bf16 a[12:15], a[204:207], v[164:167], a[12:15]
    v_exp_f32 v250, v78
    v_mfma_f32_16x16x32_bf16 a[44:47], a[204:207], v[168:171], a[44:47]
    buffer_load_dwordx4 v219, s[20:23], s40 offen offset:1024 lds
    v_or3_b32 v245, v245, v154, v155
    v_mfma_f32_16x16x32_bf16 a[76:79], a[204:207], v[172:175], a[76:79]
    v_cvt_pk_bf16_f32 v148, v224, v225
    v_cvt_pk_bf16_f32 v149, v226, v227
    v_mfma_f32_16x16x32_bf16 a[108:111], a[204:207], v[176:179], a[108:111]
    ds_read_b128 a[176:179], v204 offset:8192
    v_or3_b32 v245, v245, v148, v149
    v_mfma_f32_16x16x32_bf16 a[16:19], a[208:211], v[164:167], a[16:19]
    v_exp_f32 v251, v79
    v_mfma_f32_16x16x32_bf16 a[48:51], a[208:211], v[168:171], a[48:51]
    v_exp_f32 v224, v64
    v_mfma_f32_16x16x32_bf16 a[80:83], a[208:211], v[172:175], a[80:83]
    ds_read_b128 a[180:183], v205 offset:8192
    v_cvt_pk_bf16_f32 v150, v248, v249
    v_mfma_f32_16x16x32_bf16 a[112:115], a[208:211], v[176:179], a[112:115]
    v_exp_f32 v225, v65
    v_mfma_f32_16x16x32_bf16 a[20:23], a[212:215], v[164:167], a[20:23]
    v_exp_f32 v226, v66
    v_mfma_f32_16x16x32_bf16 a[52:55], a[212:215], v[168:171], a[52:55]
    ds_read_b128 a[184:187], v206 offset:8192
    v_cvt_pk_bf16_f32 v151, v250, v251
    v_mfma_f32_16x16x32_bf16 a[84:87], a[212:215], v[172:175], a[84:87]
    v_exp_f32 v227, v67
    v_mfma_f32_16x16x32_bf16 a[116:119], a[212:215], v[176:179], a[116:119]
    buffer_load_dwordx4 v216, s[16:19], s63 offen offset:2048 lds
    v_or3_b32 v245, v245, v150, v151
    v_mfma_f32_16x16x32_bf16 a[24:27], a[216:219], v[164:167], a[24:27]
    v_exp_f32 v248, v68
    v_mfma_f32_16x16x32_bf16 a[56:59], a[216:219], v[168:171], a[56:59]
    v_exp_f32 v249, v69
    v_mfma_f32_16x16x32_bf16 a[88:91], a[216:219], v[172:175], a[88:91]
    ds_read_b128 a[188:191], v207 offset:8192
    v_cvt_pk_bf16_f32 v144, v224, v225
    v_mfma_f32_16x16x32_bf16 a[120:123], a[216:219], v[176:179], a[120:123]
    v_exp_f32 v250, v70
    v_mfma_f32_16x16x32_bf16 a[28:31], a[220:223], v[164:167], a[28:31]
    v_exp_f32 v251, v71
    v_mfma_f32_16x16x32_bf16 a[60:63], a[220:223], v[168:171], a[60:63]
    v_cvt_pk_bf16_f32 v145, v226, v227
    v_or3_b32 v245, v245, v144, v145
    v_mfma_f32_16x16x32_bf16 a[92:95], a[220:223], v[172:175], a[92:95]
    v_cvt_pk_bf16_f32 v146, v248, v249
    v_cvt_pk_bf16_f32 v147, v250, v251
    v_mfma_f32_16x16x32_bf16 a[124:127], a[220:223], v[176:179], a[124:127]
    buffer_load_dwordx4 v217, s[16:19], s63 offen offset:3072 lds
    v_or3_b32 v245, v245, v146, v147
    v_mfma_f32_16x16x32_bf16 a[240:243], v[228:231], v[164:167], a[240:243]
    s_sub_u32 s42, s42, 1
    v_and_b32 v244, 0x40004000, v245
    v_cmp_ne_u32 vcc, 0, v244
    v_mfma_f32_16x16x32_bf16 a[244:247], v[228:231], v[168:171], a[244:247]
    s_waitcnt lgkmcnt(0)
    v_mfma_f32_16x16x32_bf16 a[248:251], v[228:231], v[172:175], a[248:251]
    s_cselect_b64 vcc, -1, vcc
    v_mfma_f32_16x16x32_bf16 a[252:255], v[228:231], v[176:179], a[252:255]
    s_cbranch_vccnz Lx4_2
Lxb4_2:
    v_mfma_f32_16x16x32_bf16 v[64:67], a[160:163], v[0:3], v[184:187]
    ds_read_b64_tr_b16 a[192:193], v208 offset:0
    v_mfma_f32_16x16x32_bf16 v[72:75], a[160:163], v[16:19], v[188:191]
    ds_read_b64_tr_b16 a[194:195], v208 offset:8192
    v_mfma_f32_16x16x32_bf16 v[80:83], a[160:163], v[32:35], v[192:195]
    v_exp_f32 v224, v128
    v_mfma_f32_16x16x32_bf16 v[88:91], a[160:163], v[48:51], v[196:199]
    ds_read_b64_tr_b16 a[196:197], v209 offset:0
    v_mfma_f32_16x16x32_bf16 v[64:67], a[164:167], v[4:7], v[64:67]
    ds_read_b64_tr_b16 a[198:199], v209 offset:8192
    v_mfma_f32_16x16x32_bf16 v[72:75], a[164:167], v[20:23], v[72:75]
    v_exp_f32 v225, v129
    v_mfma_f32_16x16x32_bf16 v[80:83], a[164:167], v[36:39], v[80:83]
    ds_read_b64_tr_b16 a[200:201], v210 offset:0
    v_cvt_pk_bf16_f32 v176, v224, v225
    v_mfma_f32_16x16x32_bf16 v[88:91], a[164:167], v[52:55], v[88:91]
    v_exp_f32 v226, v130
    v_mfma_f32_16x16x32_bf16 v[64:67], a[168:171], v[8:11], v[64:67]
    ds_read_b64_tr_b16 a[202:203], v210 offset:8192
    v_mfma_f32_16x16x32_bf16 v[72:75], a[168:171], v[24:27], v[72:75]
    ds_read_b64_tr_b16 a[204:205], v211 offset:0
    v_mfma_f32_16x16x32_bf16 v[80:83], a[168:171], v[40:43], v[80:83]
    v_exp_f32 v227, v131
    v_mfma_f32_16x16x32_bf16 v[88:91], a[168:171], v[56:59], v[88:91]
    ds_read_b64_tr_b16 a[206:207], v211 offset:8192
    v_cvt_pk_bf16_f32 v177, v226, v227
    v_mfma_f32_16x16x32_bf16 v[64:67], a[172:175], v[12:15], v[64:67]
    v_exp_f32 v248, v132
    v_mfma_f32_16x16x32_bf16 v[72:75], a[172:175], v[28:31], v[72:75]
    ds_read_b64_tr_b16 a[208:209], v212 offset:0
    v_or_b32 v245, v176, v177
    v_mfma_f32_16x16x32_bf16 v[80:83], a[172:175], v[44:47], v[80:83]
    ds_read_b64_tr_b16 a[210:211], v212 offset:8192
    v_mfma_f32_16x16x32_bf16 v[88:91], a[172:175], v[60:63], v[88:91]
    v_exp_f32 v249, v133
    v_mfma_f32_16x16x32_bf16 v[68:71], a[176:179], v[0:3], v[184:187]
    ds_read_b64_tr_b16 a[212:213], v213 offset:0
    v_cvt_pk_bf16_f32 v178, v248, v249
    v_mfma_f32_16x16x32_bf16 v[76:79], a[176:179], v[16:19], v[188:191]
    ds_read_b64_tr_b16 a[214:215], v213 offset:8192
    v_mfma_f32_16x16x32_bf16 v[84:87], a[176:179], v[32:35], v[192:195]
    v_exp_f32 v250, v134
    v_mfma_f32_16x16x32_bf16 v[92:95], a[176:179], v[48:51], v[196:199]
    ds_read_b64_tr_b16 a[216:217], v214 offset:0
    v_mfma_f32_16x16x32_bf16 v[68:71], a[180:183], v[4:7], v[68:71]
    v_exp_f32 v251, v135
    v_mfma_f32_16x16x32_bf16 v[76:79], a[180:183], v[20:23], v[76:79]
    ds_read_b64_tr_b16 a[218:219], v214 offset:8192
    v_cvt_pk_bf16_f32 v179, v250, v251
    v_mfma_f32_16x16x32_bf16 v[84:87], a[180:183], v[36:39], v[84:87]
    ds_read_b64_tr_b16 a[220:221], v215 offset:0
    v_or3_b32 v245, v245, v178, v179
    v_mfma_f32_16x16x32_bf16 v[92:95], a[180:183], v[52:55], v[92:95]
    v_exp_f32 v224, v120
    v_mfma_f32_16x16x32_bf16 v[68:71], a[184:187], v[8:11], v[68:71]
    ds_read_b64_tr_b16 a[222:223], v215 offset:8192
    v_mfma_f32_16x16x32_bf16 v[76:79], a[184:187], v[24:27], v[76:79]
    v_exp_f32 v225, v121
    v_mfma_f32_16x16x32_bf16 v[84:87], a[184:187], v[40:43], v[84:87]
    v_exp_f32 v226, v122
    v_mfma_f32_16x16x32_bf16 v[92:95], a[184:187], v[56:59], v[92:95]
    s_mov_b32 m0, s41
    v_exp_f32 v227, v123
    v_mfma_f32_16x16x32_bf16 v[68:71], a[188:191], v[12:15], v[68:71]
    s_add_u32 s40, s40, 131072
    v_exp_f32 v248, v124
    v_mfma_f32_16x16x32_bf16 v[76:79], a[188:191], v[28:31], v[76:79]
    s_add_u32 s63, s63, 131072
    v_exp_f32 v249, v125
    v_mfma_f32_16x16x32_bf16 v[84:87], a[188:191], v[44:47], v[84:87]
    s_waitcnt vmcnt(8) lgkmcnt(0)
    v_exp_f32 v250, v126
    v_mfma_f32_16x16x32_bf16 v[92:95], a[188:191], v[60:63], v[92:95]
    s_barrier
    v_mfma_f32_16x16x32_bf16 a[0:3], a[192:195], v[144:147], a[0:3]
    ds_read_b128 a[160:163], v204 offset:16384
    v_cvt_pk_bf16_f32 v172, v224, v225
    v_mfma_f32_16x16x32_bf16 a[32:35], a[192:195], v[148:151], a[32:35]
    v_exp_f32 v251, v127
    v_mfma_f32_16x16x32_bf16 a[64:67], a[192:195], v[152:155], a[64:67]
    ds_read_b128 a[164:167], v205 offset:16384
    v_cvt_pk_bf16_f32 v173, v226, v227
    v_mfma_f32_16x16x32_bf16 a[96:99], a[192:195], v[156:159], a[96:99]
    v_exp_f32 v224, v112
    v_mfma_f32_16x16x32_bf16 a[4:7], a[196:199], v[144:147], a[4:7]
    v_exp_f32 v225, v113
    v_mfma_f32_16x16x32_bf16 a[36:39], a[196:199], v[148:151], a[36:39]
    buffer_load_dwordx4 v218, s[20:23], s40 offen lds
    v_or3_b32 v245, v245, v172, v173
    v_mfma_f32_16x16x32_bf16 a[68:71], a[196:199], v[152:155], a[68:71]
    v_exp_f32 v226, v114
    v_mfma_f32_16x16x32_bf16 a[100:103], a[196:199], v[156:159], a[100:103]
    ds_read_b128 a[168:171], v206 offset:16384
    v_cvt_pk_bf16_f32 v174, v248, v249
    v_mfma_f32_16x16x32_bf16 a[8:11], a[200:203], v[144:147], a[8:11]
    v_exp_f32 v227, v115
    v_mfma_f32_16x16x32_bf16 a[40:43], a[200:203], v[148:151], a[40:43]
    v_exp_f32 v248, v116
    v_mfma_f32_16x16x32_bf16 a[72:75], a[200:203], v[152:155], a[72:75]
    ds_read_b128 a[172:175], v207 offset:16384
    v_cvt_pk_bf16_f32 v175, v250, v251
    v_mfma_f32_16x16x32_bf16 a[104:107], a[200:203], v[156:159], a[104:107]
    v_exp_f32 v249, v117
    v_mfma_f32_16x16x32_bf16 a[12:15], a[204:207], v[144:147], a[12:15]
    v_exp_f32 v250, v118
    v_mfma_f32_16x16x32_bf16 a[44:47], a[204:207], v[148:151], a[44:47]
    buffer_load_dwordx4 v219, s[20:23], s40 offen offset:1024 lds
    v_or3_b32 v245, v245, v174, v175
    v_mfma_f32_16x16x32_bf16 a[76:79], a[204:207], v[152:155], a[76:79]
    v_cvt_pk_bf16_f32 v168, v224, v225
    v_cvt_pk_bf16_f32 v169, v226, v227
    v_mfma_f32_16x16x32_bf16 a[108:111], a[204:207], v[156:159], a[108:111]
    ds_read_b128 a[176:179], v204 offset:24576
    v_or3_b32 v245, v245, v168, v169
    v_mfma_f32_16x16x32_bf16 a[16:19], a[208:211], v[144:147], a[16:19]
    v_exp_f32 v251, v119
    v_mfma_f32_16x16x32_bf16 a[48:51], a[208:211], v[148:151], a[48:51]
    v_exp_f32 v224, v104
    v_mfma_f32_16x16x32_bf16 a[80:83], a[208:211], v[152:155], a[80:83]
    ds_read_b128 a[180:183], v205 offset:24576
    v_cvt_pk_bf16_f32 v170, v248, v249
    v_mfma_f32_16x16x32_bf16 a[112:115], a[208:211], v[156:159], a[112:115]
    v_exp_f32 v225, v105
    v_mfma_f32_16x16x32_bf16 a[20:23], a[212:215], v[144:147], a[20:23]
    v_exp_f32 v226, v106
    v_mfma_f32_16x16x32_bf16 a[52:55], a[212:215], v[148:151], a[52:55]
    ds_read_b128 a[184:187], v206 offset:24576
    v_cvt_pk_bf16_f32 v171, v250, v251
    v_mfma_f32_16x16x32_bf16 a[84:87], a[212:215], v[152:155], a[84:87]
    v_exp_f32 v227, v107
    v_mfma_f32_16x16x32_bf16 a[116:119], a[212:215], v[156:159], a[116:119]
    buffer_load_dwordx4 v216, s[16:19], s63 offen offset:2048 lds
    v_or3_b32 v245, v245, v170, v171
    v_mfma_f32_16x16x32_bf16 a[24:27], a[216:219], v[144:147], a[24:27]
    v_exp_f32 v248, v108
    v_mfma_f32_16x16x32_bf16 a[56:59], a[216:219], v[148:151], a[56:59]
    v_exp_f32 v249, v109
    v_mfma_f32_16x16x32_bf16 a[88:91], a[216:219], v[152:155], a[88:91]
    ds_read_b128 a[188:191], v207 offset:24576
    v_cvt_pk_bf16_f32 v164, v224, v225
    v_mfma_f32_16x16x32_bf16 a[120:123], a[216:219], v[156:159], a[120:123]
    v_exp_f32 v250, v110
    v_mfma_f32_16x16x32_bf16 a[28:31], a[220:223], v[144:147], a[28:31]
    v_exp_f32 v251, v111
    v_mfma_f32_16x16x32_bf16 a[60:63], a[220:223], v[148:151], a[60:63]
    v_cvt_pk_bf16_f32 v165, v226, v227
    v_or3_b32 v245, v245, v164, v165
    v_mfma_f32_16x16x32_bf16 a[92:95], a[220:223], v[152:155], a[92:95]
    v_cvt_pk_bf16_f32 v166, v248, v249
    v_cvt_pk_bf16_f32 v167, v250, v251
    v_mfma_f32_16x16x32_bf16 a[124:127], a[220:223], v[156:159], a[124:127]
    buffer_load_dwordx4 v217, s[16:19], s63 offen offset:3072 lds
    v_or3_b32 v245, v245, v166, v167
    v_mfma_f32_16x16x32_bf16 a[240:243], v[228:231], v[144:147], a[240:243]
    s_sub_u32 s42, s42, 1
    v_and_b32 v244, 0x40004000, v245
    v_cmp_ne_u32 vcc, 0, v244
    v_mfma_f32_16x16x32_bf16 a[244:247], v[228:231], v[148:151], a[244:247]
    s_waitcnt lgkmcnt(0)
    v_mfma_f32_16x16x32_bf16 a[248:251], v[228:231], v[152:155], a[248:251]
    s_cselect_b64 vcc, -1, vcc
    v_mfma_f32_16x16x32_bf16 a[252:255], v[228:231], v[156:159], a[252:255]
    s_cbranch_vccnz Lx4_3
Lxb4_3:
    v_mfma_f32_16x16x32_bf16 v[104:107], a[160:163], v[0:3], v[184:187]
    ds_read_b64_tr_b16 a[192:193], v208 offset:16384
    v_mfma_f32_16x16x32_bf16 v[112:115], a[160:163], v[16:19], v[188:191]
    ds_read_b64_tr_b16 a[194:195], v208 offset:24576
    v_mfma_f32_16x16x32_bf16 v[120:123], a[160:163], v[32:35], v[192:195]
    v_exp_f32 v224, v88
    v_mfma_f32_16x16x32_bf16 v[128:131], a[160:163], v[48:51], v[196:199]
    ds_read_b64_tr_b16 a[196:197], v209 offset:16384
    v_mfma_f32_16x16x32_bf16 v[104:107], a[164:167], v[4:7], v[104:107]
    ds_read_b64_tr_b16 a[198:199], v209 offset:24576
    v_mfma_f32_16x16x32_bf16 v[112:115], a[164:167], v[20:23], v[112:115]
    v_exp_f32 v225, v89
    v_mfma_f32_16x16x32_bf16 v[120:123], a[164:167], v[36:39], v[120:123]
    ds_read_b64_tr_b16 a[200:201], v210 offset:16384
    v_cvt_pk_bf16_f32 v156, v224, v225
    v_mfma_f32_16x16x32_bf16 v[128:131], a[164:167], v[52:55], v[128:131]
    v_exp_f32 v226, v90
    v_mfma_f32_16x16x32_bf16 v[104:107], a[168:171], v[8:11], v[104:107]
    ds_read_b64_tr_b16 a[202:203], v210 offset:24576
    v_mfma_f32_16x16x32_bf16 v[112:115], a[168:171], v[24:27], v[112:115]
    ds_read_b64_tr_b16 a[204:205], v211 offset:16384
    v_mfma_f32_16x16x32_bf16 v[120:123], a[168:171], v[40:43], v[120:123]
    v_exp_f32 v227, v91
    v_mfma_f32_16x16x32_bf16 v[128:131], a[168:171], v[56:59], v[128:131]
    ds_read_b64_tr_b16 a[206:207], v211 offset:24576
    v_cvt_pk_bf16_f32 v157, v226, v227
    v_mfma_f32_16x16x32_bf16 v[104:107], a[172:175], v[12:15], v[104:107]
    v_exp_f32 v248, v92
    v_mfma_f32_16x16x32_bf16 v[112:115], a[172:175], v[28:31], v[112:115]
    ds_read_b64_tr_b16 a[208:209], v212 offset:16384
    v_or_b32 v245, v156, v157
    v_mfma_f32_16x16x32_bf16 v[120:123], a[172:175], v[44:47], v[120:123]
    ds_read_b64_tr_b16 a[210:211], v212 offset:24576
    v_mfma_f32_16x16x32_bf16 v[128:131], a[172:175], v[60:63], v[128:131]
    v_exp_f32 v249, v93
    v_mfma_f32_16x16x32_bf16 v[108:111], a[176:179], v[0:3], v[184:187]
    ds_read_b64_tr_b16 a[212:213], v213 offset:16384
    v_cvt_pk_bf16_f32 v158, v248, v249
    v_mfma_f32_16x16x32_bf16 v[116:119], a[176:179], v[16:19], v[188:191]
    ds_read_b64_tr_b16 a[214:215], v213 offset:24576
    v_mfma_f32_16x16x32_bf16 v[124:127], a[176:179], v[32:35], v[192:195]
    v_exp_f32 v250, v94
    v_mfma_f32_16x16x32_bf16 v[132:135], a[176:179], v[48:51], v[196:199]
    ds_read_b64_tr_b16 a[216:217], v214 offset:16384
    v_mfma_f32_16x16x32_bf16 v[108:111], a[180:183], v[4:7], v[108:111]
    v_exp_f32 v251, v95
    v_mfma_f32_16x16x32_bf16 v[116:119], a[180:183], v[20:23], v[116:119]
    ds_read_b64_tr_b16 a[218:219], v214 offset:24576
    v_cvt_pk_bf16_f32 v159, v250, v251
    v_mfma_f32_16x16x32_bf16 v[124:127], a[180:183], v[36:39], v[124:127]
    ds_read_b64_tr_b16 a[220:221], v215 offset:16384
    v_or3_b32 v245, v245, v158, v159
    v_mfma_f32_16x16x32_bf16 v[132:135], a[180:183], v[52:55], v[132:135]
    v_exp_f32 v224, v80
    v_mfma_f32_16x16x32_bf16 v[108:111], a[184:187], v[8:11], v[108:111]
    ds_read_b64_tr_b16 a[222:223], v215 offset:24576
    v_mfma_f32_16x16x32_bf16 v[116:119], a[184:187], v[24:27], v[116:119]
    v_exp_f32 v225, v81
    v_mfma_f32_16x16x32_bf16 v[124:127], a[184:187], v[40:43], v[124:127]
    v_exp_f32 v226, v82
    v_mfma_f32_16x16x32_bf16 v[132:135], a[184:187], v[56:59], v[132:135]
    s_add_u32 m0, s41, 16384
    v_exp_f32 v227, v83
    v_mfma_f32_16x16x32_bf16 v[108:111], a[188:191], v[12:15], v[108:111]
    s_add_u32 s40, s40, 131072
    v_exp_f32 v248, v84
    v_mfma_f32_16x16x32_bf16 v[116:119], a[188:191], v[28:31], v[116:119]
    s_add_u32 s63, s63, 131072
    v_exp_f32 v249, v85
    v_mfma_f32_16x16x32_bf16 v[124:127], a[188:191], v[44:47], v[124:127]
    s_waitcnt vmcnt(8) lgkmcnt(0)
    v_exp_f32 v250, v86
    v_mfma_f32_16x16x32_bf16 v[132:135], a[188:191], v[60:63], v[132:135]
    s_barrier
    v_mfma_f32_16x16x32_bf16 a[0:3], a[192:195], v[164:167], a[0:3]
    ds_read_b128 a[160:163], v204 offset:32768
    v_cvt_pk_bf16_f32 v152, v224, v225
    v_mfma_f32_16x16x32_bf16 a[32:35], a[192:195], v[168:171], a[32:35]
    v_exp_f32 v251, v87
    v_mfma_f32_16x16x32_bf16 a[64:67], a[192:195], v[172:175], a[64:67]
    ds_read_b128 a[164:167], v205 offset:32768
    v_cvt_pk_bf16_f32 v153, v226, v227
    v_mfma_f32_16x16x32_bf16 a[96:99], a[192:195], v[176:179], a[96:99]
    v_exp_f32 v224, v72
    v_mfma_f32_16x16x32_bf16 a[4:7], a[196:199], v[164:167], a[4:7]
    v_exp_f32 v225, v73
    v_mfma_f32_16x16x32_bf16 a[36:39], a[196:199], v[168:171], a[36:39]
    buffer_load_dwordx4 v218, s[20:23], s40 offen lds
    v_or3_b32 v245, v245, v152, v153
    v_mfma_f32_16x16x32_bf16 a[68:71], a[196:199], v[172:175], a[68:71]
    v_exp_f32 v226, v74
    v_mfma_f32_16x16x32_bf16 a[100:103], a[196:199], v[176:179], a[100:103]
    ds_read_b128 a[168:171], v206 offset:32768
    v_cvt_pk_bf16_f32 v154, v248, v249
    v_mfma_f32_16x16x32_bf16 a[8:11], a[200:203], v[164:167], a[8:11]
    v_exp_f32 v227, v75
    v_mfma_f32_16x16x32_bf16 a[40:43], a[200:203], v[168:171], a[40:43]
    v_exp_f32 v248, v76
    v_mfma_f32_16x16x32_bf16 a[72:75], a[200:203], v[172:175], a[72:75]
    ds_read_b128 a[172:175], v207 offset:32768
    v_cvt_pk_bf16_f32 v155, v250, v251
    v_mfma_f32_16x16x32_bf16 a[104:107], a[200:203], v[176:179], a[104:107]
    v_exp_f32 v249, v77
    v_mfma_f32_16x16x32_bf16 a[12:15], a[204:207], v[164:167], a[12:15]
    v_exp_f32 v250, v78
    v_mfma_f32_16x16x32_bf16 a[44:47], a[204:207], v[168:171], a[44:47]
    buffer_load_dwordx4 v219, s[20:23], s40 offen offset:1024 lds
    v_or3_b32 v245, v245, v154, v155
    v_mfma_f32_16x16x32_bf16 a[76:79], a[204:207], v[172:175], a[76:79]
    v_cvt_pk_bf16_f32 v148, v224, v225
    v_cvt_pk_bf16_f32 v149, v226, v227
    v_mfma_f32_16x16x32_bf16 a[108:111], a[204:207], v[176:179], a[108:111]
    ds_read_b128 a[176:179], v204 offset:40960
    v_or3_b32 v245, v245, v148, v149
    v_mfma_f32_16x16x32_bf16 a[16:19], a[208:211], v[164:167], a[16:19]
    v_exp_f32 v251, v79
    v_mfma_f32_16x16x32_bf16 a[48:51], a[208:211], v[168:171], a[48:51]
    v_exp_f32 v224, v64
    v_mfma_f32_16x16x32_bf16 a[80:83], a[208:211], v[172:175], a[80:83]
    ds_read_b128 a[180:183], v205 offset:40960
    v_cvt_pk_bf16_f32 v150, v248, v249
    v_mfma_f32_16x16x32_bf16 a[112:115], a[208:211], v[176:179], a[112:115]
    v_exp_f32 v225, v65
    v_mfma_f32_16x16x32_bf16 a[20:23], a[212:215], v[164:167], a[20:23]
    v_exp_f32 v226, v66
    v_mfma_f32_16x16x32_bf16 a[52:55], a[212:215], v[168:171], a[52:55]
    ds_read_b128 a[184:187], v206 offset:40960
    v_cvt_pk_bf16_f32 v151, v250, v251
    v_mfma_f32_16x16x32_bf16 a[84:87], a[212:215], v[172:175], a[84:87]
    v_exp_f32 v227, v67
    v_mfma_f32_16x16x32_bf16 a[116:119], a[212:215], v[176:179], a[116:119]
    buffer_load_dwordx4 v216, s[16:19], s63 offen offset:2048 lds
    v_or3_b32 v245, v245, v150, v151
    v_mfma_f32_16x16x32_bf16 a[24:27], a[216:219], v[164:167], a[24:27]
    v_exp_f32 v248, v68
    v_mfma_f32_16x16x32_bf16 a[56:59], a[216:219], v[168:171], a[56:59]
    v_exp_f32 v249, v69
    v_mfma_f32_16x16x32_bf16 a[88:91], a[216:219], v[172:175], a[88:91]
    ds_read_b128 a[188:191], v207 offset:40960
    v_cvt_pk_bf16_f32 v144, v224, v225
    v_mfma_f32_16x16x32_bf16 a[120:123], a[216:219], v[176:179], a[120:123]
    v_exp_f32 v250, v70
    v_mfma_f32_16x16x32_bf16 a[28:31], a[220:223], v[164:167], a[28:31]
    v_exp_f32 v251, v71
    v_mfma_f32_16x16x32_bf16 a[60:63], a[220:223], v[168:171], a[60:63]
    v_cvt_pk_bf16_f32 v145, v226, v227
    v_or3_b32 v245, v245, v144, v145
    v_mfma_f32_16x16x32_bf16 a[92:95], a[220:223], v[172:175], a[92:95]
    v_cvt_pk_bf16_f32 v146, v248, v249
    v_cvt_pk_bf16_f32 v147, v250, v251
    v_mfma_f32_16x16x32_bf16 a[124:127], a[220:223], v[176:179], a[124:127]
    buffer_load_dwordx4 v217, s[16:19], s63 offen offset:3072 lds
    v_or3_b32 v245, v245, v146, v147
    v_mfma_f32_16x16x32_bf16 a[240:243], v[228:231], v[164:167], a[240:243]
    s_sub_u32 s42, s42, 1
    v_and_b32 v244, 0x40004000, v245
    v_cmp_ne_u32 vcc, 0, v244
    v_mfma_f32_16x16x32_bf16 a[244:247], v[228:231], v[168:171], a[244:247]
    s_waitcnt lgkmcnt(0)
    v_mfma_f32_16x16x32_bf16 a[248:251], v[228:231], v[172:175], a[248:251]
    s_cselect_b64 vcc, -1, vcc
    v_mfma_f32_16x16x32_bf16 a[252:255], v[228:231], v[176:179], a[252:255]
    s_cbranch_vccnz Lx4_0
Lxb4_0:
    v_mfma_f32_16x16x32_bf16 v[64:67], a[160:163], v[0:3], v[184:187]
    ds_read_b64_tr_b16 a[192:193], v208 offset:32768
    v_mfma_f32_16x16x32_bf16 v[72:75], a[160:163], v[16:19], v[188:191]
    ds_read_b64_tr_b16 a[194:195], v208 offset:40960
    v_mfma_f32_16x16x32_bf16 v[80:83], a[160:163], v[32:35], v[192:195]
    v_exp_f32 v224, v128
    v_mfma_f32_16x16x32_bf16 v[88:91], a[160:163], v[48:51], v[196:199]
    ds_read_b64_tr_b16 a[196:197], v209 offset:32768
    v_mfma_f32_16x16x32_bf16 v[64:67], a[164:167], v[4:7], v[64:67]
    ds_read_b64_tr_b16 a[198:199], v209 offset:40960
    v_mfma_f32_16x16x32_bf16 v[72:75], a[164:167], v[20:23], v[72:75]
    v_exp_f32 v225, v129
    v_mfma_f32_16x16x32_bf16 v[80:83], a[164:167], v[36:39], v[80:83]
    ds_read_b64_tr_b16 a[200:201], v210 offset:32768
    v_cvt_pk_bf16_f32 v176, v224, v225
    v_mfma_f32_16x16x32_bf16 v[88:91], a[164:167], v[52:55], v[88:91]
    v_exp_f32 v226, v130
    v_mfma_f32_16x16x32_bf16 v[64:67], a[168:171], v[8:11], v[64:67]
    ds_read_b64_tr_b16 a[202:203], v210 offset:40960
    v_mfma_f32_16x16x32_bf16 v[72:75], a[168:171], v[24:27], v[72:75]
    ds_read_b64_tr_b16 a[204:205], v211 offset:32768
    v_mfma_f32_16x16x32_bf16 v[80:83], a[168:171], v[40:43], v[80:83]
    v_exp_f32 v227, v131
    v_mfma_f32_16x16x32_bf16 v[88:91], a[168:171], v[56:59], v[88:91]
    ds_read_b64_tr_b16 a[206:207], v211 offset:40960
    v_cvt_pk_bf16_f32 v177, v226, v227
    v_mfma_f32_16x16x32_bf16 v[64:67], a[172:175], v[12:15], v[64:67]
    v_exp_f32 v248, v132
    v_mfma_f32_16x16x32_bf16 v[72:75], a[172:175], v[28:31], v[72:75]
    ds_read_b64_tr_b16 a[208:209], v212 offset:32768
    v_or_b32 v245, v176, v177
    v_mfma_f32_16x16x32_bf16 v[80:83], a[172:175], v[44:47], v[80:83]
    ds_read_b64_tr_b16 a[210:211], v212 offset:40960
    v_mfma_f32_16x16x32_bf16 v[88:91], a[172:175], v[60:63], v[88:91]
    v_exp_f32 v249, v133
    v_mfma_f32_16x16x32_bf16 v[68:71], a[176:179], v[0:3], v[184:187]
    ds_read_b64_tr_b16 a[212:213], v213 offset:32768
    v_cvt_pk_bf16_f32 v178, v248, v249
    v_mfma_f32_16x16x32_bf16 v[76:79], a[176:179], v[16:19], v[188:191]
    ds_read_b64_tr_b16 a[214:215], v213 offset:40960
    v_mfma_f32_16x16x32_bf16 v[84:87], a[176:179], v[32:35], v[192:195]
    v_exp_f32 v250, v134
    v_mfma_f32_16x16x32_bf16 v[92:95], a[176:179], v[48:51], v[196:199]
    ds_read_b64_tr_b16 a[216:217], v214 offset:32768
    v_mfma_f32_16x16x32_bf16 v[68:71], a[180:183], v[4:7], v[68:71]
    v_exp_f32 v251, v135
    v_mfma_f32_16x16x32_bf16 v[76:79], a[180:183], v[20:23], v[76:79]
    ds_read_b64_tr_b16 a[218:219], v214 offset:40960
    v_cvt_pk_bf16_f32 v179, v250, v251
    v_mfma_f32_16x16x32_bf16 v[84:87], a[180:183], v[36:39], v[84:87]
    ds_read_b64_tr_b16 a[220:221], v215 offset:32768
    v_or3_b32 v245, v245, v178, v179
    v_mfma_f32_16x16x32_bf16 v[92:95], a[180:183], v[52:55], v[92:95]
    v_exp_f32 v224, v120
    v_mfma_f32_16x16x32_bf16 v[68:71], a[184:187], v[8:11], v[68:71]
    ds_read_b64_tr_b16 a[222:223], v215 offset:40960
    v_mfma_f32_16x16x32_bf16 v[76:79], a[184:187], v[24:27], v[76:79]
    v_exp_f32 v225, v121
    v_mfma_f32_16x16x32_bf16 v[84:87], a[184:187], v[40:43], v[84:87]
    v_exp_f32 v226, v122
    v_mfma_f32_16x16x32_bf16 v[92:95], a[184:187], v[56:59], v[92:95]
    s_add_u32 m0, s41, 32768
    v_exp_f32 v227, v123
    v_mfma_f32_16x16x32_bf16 v[68:71], a[188:191], v[12:15], v[68:71]
    s_add_u32 s40, s40, 131072
    v_exp_f32 v248, v124
    v_mfma_f32_16x16x32_bf16 v[76:79], a[188:191], v[28:31], v[76:79]
    s_add_u32 s63, s63, 131072
    v_exp_f32 v249, v125
    v_mfma_f32_16x16x32_bf16 v[84:87], a[188:191], v[44:47], v[84:87]
    s_waitcnt vmcnt(8) lgkmcnt(0)
    v_exp_f32 v250, v126
    v_mfma_f32_16x16x32_bf16 v[92:95], a[188:191], v[60:63], v[92:95]
    s_barrier
    v_mfma_f32_16x16x32_bf16 a[0:3], a[192:195], v[144:147], a[0:3]
    ds_read_b128 a[160:163], v204 offset:49152
    v_cvt_pk_bf16_f32 v172, v224, v225
    v_mfma_f32_16x16x32_bf16 a[32:35], a[192:195], v[148:151], a[32:35]
    v_exp_f32 v251, v127
    v_mfma_f32_16x16x32_bf16 a[64:67], a[192:195], v[152:155], a[64:67]
    ds_read_b128 a[164:167], v205 offset:49152
    v_cvt_pk_bf16_f32 v173, v226, v227
    v_mfma_f32_16x16x32_bf16 a[96:99], a[192:195], v[156:159], a[96:99]
    v_exp_f32 v224, v112
    v_mfma_f32_16x16x32_bf16 a[4:7], a[196:199], v[144:147], a[4:7]
    v_exp_f32 v225, v113
    v_mfma_f32_16x16x32_bf16 a[36:39], a[196:199], v[148:151], a[36:39]
    buffer_load_dwordx4 v218, s[20:23], s40 offen lds
    v_or3_b32 v245, v245, v172, v173
    v_mfma_f32_16x16x32_bf16 a[68:71], a[196:199], v[152:155], a[68:71]
    v_exp_f32 v226, v114
    v_mfma_f32_16x16x32_bf16 a[100:103], a[196:199], v[156:159], a[100:103]
    ds_read_b128 a[168:171], v206 offset:49152
    v_cvt_pk_bf16_f32 v174, v248, v249
    v_mfma_f32_16x16x32_bf16 a[8:11], a[200:203], v[144:147], a[8:11]
    v_exp_f32 v227, v115
    v_mfma_f32_16x16x32_bf16 a[40:43], a[200:203], v[148:151], a[40:43]
    v_exp_f32 v248, v116
    v_mfma_f32_16x16x32_bf16 a[72:75], a[200:203], v[152:155], a[72:75]
    ds_read_b128 a[172:175], v207 offset:49152
    v_cvt_pk_bf16_f32 v175, v250, v251
    v_mfma_f32_16x16x32_bf16 a[104:107], a[200:203], v[156:159], a[104:107]
    v_exp_f32 v249, v117
    v_mfma_f32_16x16x32_bf16 a[12:15], a[204:207], v[144:147], a[12:15]
    v_exp_f32 v250, v118
    v_mfma_f32_16x16x32_bf16 a[44:47], a[204:207], v[148:151], a[44:47]
    buffer_load_dwordx4 v219, s[20:23], s40 offen offset:1024 lds
    v_or3_b32 v245, v245, v174, v175
    v_mfma_f32_16x16x32_bf16 a[76:79], a[204:207], v[152:155], a[76:79]
    v_cvt_pk_bf16_f32 v168, v224, v225
    v_cvt_pk_bf16_f32 v169, v226, v227
    v_mfma_f32_16x16x32_bf16 a[108:111], a[204:207], v[156:159], a[108:111]
    ds_read_b128 a[176:179], v204 offset:57344
    v_or3_b32 v245, v245, v168, v169
    v_mfma_f32_16x16x32_bf16 a[16:19], a[208:211], v[144:147], a[16:19]
    v_exp_f32 v251, v119
    v_mfma_f32_16x16x32_bf16 a[48:51], a[208:211], v[148:151], a[48:51]
    v_exp_f32 v224, v104
    v_mfma_f32_16x16x32_bf16 a[80:83], a[208:211], v[152:155], a[80:83]
    ds_read_b128 a[180:183], v205 offset:57344
    v_cvt_pk_bf16_f32 v170, v248, v249
    v_mfma_f32_16x16x32_bf16 a[112:115], a[208:211], v[156:159], a[112:115]
    v_exp_f32 v225, v105
    v_mfma_f32_16x16x32_bf16 a[20:23], a[212:215], v[144:147], a[20:23]
    v_exp_f32 v226, v106
    v_mfma_f32_16x16x32_bf16 a[52:55], a[212:215], v[148:151], a[52:55]
    ds_read_b128 a[184:187], v206 offset:57344
    v_cvt_pk_bf16_f32 v171, v250, v251
    v_mfma_f32_16x16x32_bf16 a[84:87], a[212:215], v[152:155], a[84:87]
    v_exp_f32 v227, v107
    v_mfma_f32_16x16x32_bf16 a[116:119], a[212:215], v[156:159], a[116:119]
    buffer_load_dwordx4 v216, s[16:19], s63 offen offset:2048 lds
    v_or3_b32 v245, v245, v170, v171
    v_mfma_f32_16x16x32_bf16 a[24:27], a[216:219], v[144:147], a[24:27]
    v_exp_f32 v248, v108
    v_mfma_f32_16x16x32_bf16 a[56:59], a[216:219], v[148:151], a[56:59]
    v_exp_f32 v249, v109
    v_mfma_f32_16x16x32_bf16 a[88:91], a[216:219], v[152:155], a[88:91]
    ds_read_b128 a[188:191], v207 offset:57344
    v_cvt_pk_bf16_f32 v164, v224, v225
    v_mfma_f32_16x16x32_bf16 a[120:123], a[216:219], v[156:159], a[120:123]
    v_exp_f32 v250, v110
    v_mfma_f32_16x16x32_bf16 a[28:31], a[220:223], v[144:147], a[28:31]
    v_exp_f32 v251, v111
    v_mfma_f32_16x16x32_bf16 a[60:63], a[220:223], v[148:151], a[60:63]
    v_cvt_pk_bf16_f32 v165, v226, v227
    v_or3_b32 v245, v245, v164, v165
    v_mfma_f32_16x16x32_bf16 a[92:95], a[220:223], v[152:155], a[92:95]
    v_cvt_pk_bf16_f32 v166, v248, v249
    v_cvt_pk_bf16_f32 v167, v250, v251
    v_mfma_f32_16x16x32_bf16 a[124:127], a[220:223], v[156:159], a[124:127]
    buffer_load_dwordx4 v217, s[16:19], s63 offen offset:3072 lds
    v_or3_b32 v245, v245, v166, v167
    v_mfma_f32_16x16x32_bf16 a[240:243], v[228:231], v[144:147], a[240:243]
    s_sub_u32 s42, s42, 1
    v_and_b32 v244, 0x40004000, v245
    v_cmp_ne_u32 vcc, 0, v244
    v_mfma_f32_16x16x32_bf16 a[244:247], v[228:231], v[148:151], a[244:247]
    s_waitcnt lgkmcnt(0)
    v_mfma_f32_16x16x32_bf16 a[248:251], v[228:231], v[152:155], a[248:251]
    s_cselect_b64 vcc, -1, vcc
    v_mfma_f32_16x16x32_bf16 a[252:255], v[228:231], v[156:159], a[252:255]
    s_cbranch_vccnz Lx4_1
Lxb4_1:
    s_branch Lsloop4
Lx4_0:
    v_cmp_ne_u32 vcc, 0, v244
    s_cbranch_vccnz Lrare_x4_0
Lback_x4_0:
    s_branch Lxb4_0
Lx4_1:
    v_cmp_ne_u32 vcc, 0, v244
    s_cbranch_vccnz Lrare_x4_1
Lback_x4_1:
    s_cbranch_scc1 Lxs4_1
    s_branch Lxb4_1
Lx4_2:
    v_cmp_ne_u32 vcc, 0, v244
    s_cbranch_vccnz Lrare_x4_2
Lback_x4_2:
    s_cbranch_scc1 Lxs4_2
    s_branch Lxb4_2
Lx4_3:
    v_cmp_ne_u32 vcc, 0, v244
    s_cbranch_vccnz Lrare_x4_3
Lback_x4_3:
    s_branch Lxb4_3
Lxs4_1:
    s_cmp_lg_u32 s29, 0
    s_cbranch_scc1 Ltail4_2_1
Ltail4_2_0:
    v_mfma_f32_16x16x32_bf16 a[240:243], v[228:231], v[164:167], a[240:243]
    ds_read_b64_tr_b16 a[192:193], v208 offset:49152
    v_mfma_f32_16x16x32_bf16 a[244:247], v[228:231], v[168:171], a[244:247]
    ds_read_b64_tr_b16 a[194:195], v208 offset:57344
    v_mfma_f32_16x16x32_bf16 a[248:251], v[228:231], v[172:175], a[248:251]
    ds_read_b64_tr_b16 a[196:197], v209 offset:49152
    v_mfma_f32_16x16x32_bf16 a[252:255], v[228:231], v[176:179], a[252:255]
    ds_read_b64_tr_b16 a[198:199], v209 offset:57344
    ds_read_b64_tr_b16 a[200:201], v210 offset:49152
    ds_read_b64_tr_b16 a[202:203], v210 offset:57344
    ds_read_b64_tr_b16 a[204:205], v211 offset:49152
    ds_read_b64_tr_b16 a[206:207], v211 offset:57344
    ds_read_b64_tr_b16 a[208:209], v212 offset:49152
    ds_read_b64_tr_b16 a[210:211], v212 offset:57344
    ds_read_b64_tr_b16 a[212:213], v213 offset:49152
    ds_read_b64_tr_b16 a[214:215], v213 offset:57344
    ds_read_b64_tr_b16 a[216:217], v214 offset:49152
    ds_read_b64_tr_b16 a[218:219], v214 offset:57344
    ds_read_b64_tr_b16 a[220:221], v215 offset:49152
    ds_read_b64_tr_b16 a[222:223], v215 offset:57344
    v_accvgpr_read_b32 v252, a240
    v_accvgpr_read_b32 v253, a244
    v_accvgpr_read_b32 v254, a248
    v_accvgpr_read_b32 v255, a252
    v_max3_f32 v237, v252, v253, v254
    v_max_f32 v237, v237, v255
    v_cmp_le_f32 vcc, s66, v237
    v_exp_f32 v224, v88
    v_exp_f32 v225, v89
    s_cmp_lg_u64 vcc, 0
    s_cselect_b32 s61, 1, 0
    s_andn2_b32 s61, s61, s65
    v_mov_b32 v237, s61
    ds_write_b32 v239, v237 offset:16384
    v_exp_f32 v226, v90
    v_exp_f32 v227, v91
    v_cvt_pk_bf16_f32 v156, v224, v225
    v_exp_f32 v248, v92
    v_exp_f32 v249, v93
    v_cvt_pk_bf16_f32 v157, v226, v227
    v_or_b32 v245, v156, v157
    v_exp_f32 v250, v94
    v_exp_f32 v251, v95
    v_cvt_pk_bf16_f32 v158, v248, v249
    v_exp_f32 v224, v80
    v_exp_f32 v225, v81
    v_cvt_pk_bf16_f32 v159, v250, v251
    v_or3_b32 v245, v245, v158, v159
    v_exp_f32 v226, v82
    v_exp_f32 v227, v83
    s_waitcnt vmcnt(8) lgkmcnt(0)
    s_barrier
    v_mfma_f32_16x16x32_bf16 a[0:3], a[192:195], v[164:167], a[0:3]
    ds_read_b32 v237, v236
    v_cvt_pk_bf16_f32 v152, v224, v225
    v_mfma_f32_16x16x32_bf16 a[32:35], a[192:195], v[168:171], a[32:35]
    ds_read_b64_tr_b16 a[160:161], v208 offset:0
    v_cvt_pk_bf16_f32 v153, v226, v227
    v_mfma_f32_16x16x32_bf16 a[64:67], a[192:195], v[172:175], a[64:67]
    v_exp_f32 v248, v84
    v_mfma_f32_16x16x32_bf16 a[96:99], a[192:195], v[176:179], a[96:99]
    ds_read_b64_tr_b16 a[162:163], v208 offset:8192
    v_or3_b32 v245, v245, v152, v153
    v_mfma_f32_16x16x32_bf16 a[4:7], a[196:199], v[164:167], a[4:7]
    v_exp_f32 v249, v85
    v_mfma_f32_16x16x32_bf16 a[36:39], a[196:199], v[168:171], a[36:39]
    ds_read_b64_tr_b16 a[164:165], v209 offset:0
    v_cvt_pk_bf16_f32 v154, v248, v249
    v_mfma_f32_16x16x32_bf16 a[68:71], a[196:199], v[172:175], a[68:71]
    v_exp_f32 v250, v86
    v_exp_f32 v251, v87
    v_mfma_f32_16x16x32_bf16 a[100:103], a[196:199], v[176:179], a[100:103]
    ds_read_b64_tr_b16 a[166:167], v209 offset:8192
    v_cvt_pk_bf16_f32 v155, v250, v251
    v_mfma_f32_16x16x32_bf16 a[8:11], a[200:203], v[164:167], a[8:11]
    ds_read_b64_tr_b16 a[168:169], v210 offset:0
    v_or3_b32 v245, v245, v154, v155
    v_mfma_f32_16x16x32_bf16 a[40:43], a[200:203], v[168:171], a[40:43]
    v_exp_f32 v224, v72
    v_mfma_f32_16x16x32_bf16 a[72:75], a[200:203], v[172:175], a[72:75]
    ds_read_b64_tr_b16 a[170:171], v210 offset:8192
    v_exp_f32 v225, v73
    v_mfma_f32_16x16x32_bf16 a[104:107], a[200:203], v[176:179], a[104:107]
    v_exp_f32 v226, v74
    v_mfma_f32_16x16x32_bf16 a[12:15], a[204:207], v[164:167], a[12:15]
    ds_read_b64_tr_b16 a[172:173], v211 offset:0
    v_cvt_pk_bf16_f32 v148, v224, v225
    v_exp_f32 v227, v75
    v_mfma_f32_16x16x32_bf16 a[44:47], a[204:207], v[168:171], a[44:47]
    v_exp_f32 v248, v76
    v_mfma_f32_16x16x32_bf16 a[76:79], a[204:207], v[172:175], a[76:79]
    ds_read_b64_tr_b16 a[174:175], v211 offset:8192
    v_cvt_pk_bf16_f32 v149, v226, v227
    v_mfma_f32_16x16x32_bf16 a[108:111], a[204:207], v[176:179], a[108:111]
    ds_read_b64_tr_b16 a[176:177], v212 offset:0
    v_or3_b32 v245, v245, v148, v149
    v_mfma_f32_16x16x32_bf16 a[16:19], a[208:211], v[164:167], a[16:19]
    v_exp_f32 v249, v77
    v_exp_f32 v250, v78
    v_mfma_f32_16x16x32_bf16 a[48:51], a[208:211], v[168:171], a[48:51]
    ds_read_b64_tr_b16 a[178:179], v212 offset:8192
    v_cvt_pk_bf16_f32 v150, v248, v249
    v_mfma_f32_16x16x32_bf16 a[80:83], a[208:211], v[172:175], a[80:83]
    v_exp_f32 v251, v79
    v_mfma_f32_16x16x32_bf16 a[112:115], a[208:211], v[176:179], a[112:115]
    ds_read_b64_tr_b16 a[180:181], v213 offset:0
    v_cvt_pk_bf16_f32 v151, v250, v251
    v_mfma_f32_16x16x32_bf16 a[20:23], a[212:215], v[164:167], a[20:23]
    v_exp_f32 v224, v64
    v_or3_b32 v245, v245, v150, v151
    v_mfma_f32_16x16x32_bf16 a[52:55], a[212:215], v[168:171], a[52:55]
    ds_read_b64_tr_b16 a[182:183], v213 offset:8192
    v_exp_f32 v225, v65
    v_mfma_f32_16x16x32_bf16 a[84:87], a[212:215], v[172:175], a[84:87]
    ds_read_b64_tr_b16 a[184:185], v214 offset:0
    v_cvt_pk_bf16_f32 v144, v224, v225
    v_mfma_f32_16x16x32_bf16 a[116:119], a[212:215], v[176:179], a[116:119]
    v_exp_f32 v226, v66
    v_mfma_f32_16x16x32_bf16 a[24:27], a[216:219], v[164:167], a[24:27]
    ds_read_b64_tr_b16 a[186:187], v214 offset:8192
    v_exp_f32 v227, v67
    v_mfma_f32_16x16x32_bf16 a[56:59], a[216:219], v[168:171], a[56:59]
    v_exp_f32 v248, v68
    v_mfma_f32_16x16x32_bf16 a[88:91], a[216:219], v[172:175], a[88:91]
    ds_read_b64_tr_b16 a[188:189], v215 offset:0
    v_cvt_pk_bf16_f32 v145, v226, v227
    v_or3_b32 v245, v245, v144, v145
    v_mfma_f32_16x16x32_bf16 a[120:123], a[216:219], v[176:179], a[120:123]
    v_exp_f32 v249, v69
    v_mfma_f32_16x16x32_bf16 a[28:31], a[220:223], v[164:167], a[28:31]
    ds_read_b64_tr_b16 a[190:191], v215 offset:8192
    v_cvt_pk_bf16_f32 v146, v248, v249
    v_exp_f32 v250, v70
    v_mfma_f32_16x16x32_bf16 a[60:63], a[220:223], v[168:171], a[60:63]
    v_exp_f32 v251, v71
    v_mfma_f32_16x16x32_bf16 a[92:95], a[220:223], v[172:175], a[92:95]
    v_cvt_pk_bf16_f32 v147, v250, v251
    v_or3_b32 v245, v245, v146, v147
    v_mfma_f32_16x16x32_bf16 a[124:127], a[220:223], v[176:179], a[124:127]
    v_and_b32 v244, 0x40004000, v245
    v_cmp_ne_u32 vcc, 0, v244
    s_cbranch_vccnz Lrare_t4t2_0
Lback_t4t2_0:
    s_waitcnt lgkmcnt(8)
    v_cmp_ne_u32 vcc, 0, v237
    s_cbranch_vccnz Lrestart
    v_mfma_f32_16x16x32_bf16 a[240:243], v[228:231], v[144:147], a[240:243]
    v_xor_b32 v184, 0, v240
    v_mfma_f32_16x16x32_bf16 a[244:247], v[228:231], v[148:151], a[244:247]
    v_xor_b32 v185, 32, v240
    v_mfma_f32_16x16x32_bf16 a[248:251], v[228:231], v[152:155], a[248:251]
    v_mfma_f32_16x16x32_bf16 a[252:255], v[228:231], v[156:159], a[252:255]
    s_waitcnt lgkmcnt(6)
    v_xor_b32 v186, 64, v240
    v_mfma_f32_16x16x32_bf16 a[0:3], a[160:163], v[144:147], a[0:3]
    v_xor_b32 v187, 96, v240
    v_mfma_f32_16x16x32_bf16 a[4:7], a[164:167], v[144:147], a[4:7]
    v_mfma_f32_16x16x32_bf16 a[8:11], a[168:171], v[144:147], a[8:11]
    v_xor_b32 v188, 128, v240
    v_mfma_f32_16x16x32_bf16 a[12:15], a[172:175], v[144:147], a[12:15]
    v_xor_b32 v189, 160, v240
    v_mfma_f32_16x16x32_bf16 a[16:19], a[176:179], v[144:147], a[16:19]
    s_waitcnt lgkmcnt(0)
    v_mfma_f32_16x16x32_bf16 a[20:23], a[180:183], v[144:147], a[20:23]
    v_xor_b32 v190, 192, v240
    v_mfma_f32_16x16x32_bf16 a[24:27], a[184:187], v[144:147], a[24:27]
    v_xor_b32 v191, 224, v240
    v_mfma_f32_16x16x32_bf16 a[28:31], a[188:191], v[144:147], a[28:31]
    v_mfma_f32_16x16x32_bf16 a[32:35], a[160:163], v[148:151], a[32:35]
    v_accvgpr_read_b32 v244, a240
    v_accvgpr_read_b32 v245, a244
    v_mfma_f32_16x16x32_bf16 a[36:39], a[164:167], v[148:151], a[36:39]
    v_accvgpr_read_b32 v246, a248
    v_accvgpr_read_b32 v247, a252
    v_mfma_f32_16x16x32_bf16 a[40:43], a[168:171], v[148:151], a[40:43]
    v_rcp_f32 v192, v244
    v_mfma_f32_16x16x32_bf16 a[44:47], a[172:175], v[148:151], a[44:47]
    v_rcp_f32 v193, v245
    v_rcp_f32 v194, v246
    v_mfma_f32_16x16x32_bf16 a[48:51], a[176:179], v[148:151], a[48:51]
    v_rcp_f32 v195, v247
    v_accvgpr_read_b32 v0, a0
    v_mfma_f32_16x16x32_bf16 a[52:55], a[180:183], v[148:151], a[52:55]
    v_accvgpr_read_b32 v1, a1
    v_mfma_f32_16x16x32_bf16 a[56:59], a[184:187], v[148:151], a[56:59]
    v_accvgpr_read_b32 v2, a2
    v_accvgpr_read_b32 v3, a3
    v_mfma_f32_16x16x32_bf16 a[60:63], a[188:191], v[148:151], a[60:63]
    v_accvgpr_read_b32 v4, a4
    v_accvgpr_read_b32 v5, a5
    v_mfma_f32_16x16x32_bf16 a[64:67], a[160:163], v[152:155], a[64:67]
    v_accvgpr_read_b32 v6, a6
    v_mfma_f32_16x16x32_bf16 a[68:71], a[164:167], v[152:155], a[68:71]
    v_accvgpr_read_b32 v7, a7
    v_accvgpr_read_b32 v8, a8
    v_mfma_f32_16x16x32_bf16 a[72:75], a[168:171], v[152:155], a[72:75]
    v_accvgpr_read_b32 v9, a9
    v_accvgpr_read_b32 v10, a10
    v_mfma_f32_16x16x32_bf16 a[76:79], a[172:175], v[152:155], a[76:79]
    v_accvgpr_read_b32 v11, a11
    v_mfma_f32_16x16x32_bf16 a[80:83], a[176:179], v[152:155], a[80:83]
    v_accvgpr_read_b32 v12, a12
    v_accvgpr_read_b32 v13, a13
    v_mfma_f32_16x16x32_bf16 a[84:87], a[180:183], v[152:155], a[84:87]
    v_accvgpr_read_b32 v14, a14
    v_accvgpr_read_b32 v15, a15
    v_mfma_f32_16x16x32_bf16 a[88:91], a[184:187], v[152:155], a[88:91]
    v_accvgpr_read_b32 v16, a16
    v_mfma_f32_16x16x32_bf16 a[92:95], a[188:191], v[152:155], a[92:95]
    v_accvgpr_read_b32 v17, a17
    v_accvgpr_read_b32 v18, a18
    v_mfma_f32_16x16x32_bf16 a[96:99], a[160:163], v[156:159], a[96:99]
    v_accvgpr_read_b32 v19, a19
    v_accvgpr_read_b32 v20, a20
    v_mfma_f32_16x16x32_bf16 a[100:103], a[164:167], v[156:159], a[100:103]
    v_accvgpr_read_b32 v21, a21
    v_mfma_f32_16x16x32_bf16 a[104:107], a[168:171], v[156:159], a[104:107]
    v_accvgpr_read_b32 v22, a22
    v_accvgpr_read_b32 v23, a23
    v_mfma_f32_16x16x32_bf16 a[108:111], a[172:175], v[156:159], a[108:111]
    v_accvgpr_read_b32 v24, a24
    v_accvgpr_read_b32 v25, a25
    v_mfma_f32_16x16x32_bf16 a[112:115], a[176:179], v[156:159], a[112:115]
    v_accvgpr_read_b32 v26, a26
    v_mfma_f32_16x16x32_bf16 a[116:119], a[180:183], v[156:159], a[116:119]
    v_accvgpr_read_b32 v27, a27
    v_accvgpr_read_b32 v28, a28
    v_mfma_f32_16x16x32_bf16 a[120:123], a[184:187], v[156:159], a[120:123]
    v_accvgpr_read_b32 v29, a29
    v_accvgpr_read_b32 v30, a30
    v_mfma_f32_16x16x32_bf16 a[124:127], a[188:191], v[156:159], a[124:127]
    v_accvgpr_read_b32 v31, a31
    s_branch Lepi4
Ltail4_2_1:
    v_mfma_f32_16x16x32_bf16 a[240:243], v[228:231], v[164:167], a[240:243]
    ds_read_b64_tr_b16 a[192:193], v208 offset:49152
    v_mfma_f32_16x16x32_bf16 a[244:247], v[228:231], v[168:171], a[244:247]
    ds_read_b64_tr_b16 a[194:195], v208 offset:57344
    v_mfma_f32_16x16x32_bf16 a[248:251], v[228:231], v[172:175], a[248:251]
    ds_read_b64_tr_b16 a[196:197], v209 offset:49152
    v_mfma_f32_16x16x32_bf16 a[252:255], v[228:231], v[176:179], a[252:255]
    ds_read_b64_tr_b16 a[198:199], v209 offset:57344
    ds_read_b64_tr_b16 a[200:201], v210 offset:49152
    ds_read_b64_tr_b16 a[202:203], v210 offset:57344
    ds_read_b64_tr_b16 a[204:205], v211 offset:49152
    ds_read_b64_tr_b16 a[206:207], v211 offset:57344
    ds_read_b64_tr_b16 a[208:209], v212 offset:49152
    ds_read_b64_tr_b16 a[210:211], v212 offset:57344
    ds_read_b64_tr_b16 a[212:213], v213 offset:49152
    ds_read_b64_tr_b16 a[214:215], v213 offset:57344
    ds_read_b64_tr_b16 a[216:217], v214 offset:49152
    ds_read_b64_tr_b16 a[218:219], v214 offset:57344
    ds_read_b64_tr_b16 a[220:221], v215 offset:49152
    ds_read_b64_tr_b16 a[222:223], v215 offset:57344
    v_accvgpr_read_b32 v252, a240
    v_accvgpr_read_b32 v253, a244
    v_accvgpr_read_b32 v254, a248
    v_accvgpr_read_b32 v255, a252
    v_max3_f32 v237, v252, v253, v254
    v_max_f32 v237, v237, v255
    v_cmp_le_f32 vcc, s66, v237
    v_exp_f32 v224, v88
    v_exp_f32 v225, v89
    s_cmp_lg_u64 vcc, 0
    s_cselect_b32 s61, 1, 0
    s_andn2_b32 s61, s61, s65
    v_mov_b32 v237, s61
    ds_write_b32 v239, v237 offset:16384
    v_exp_f32 v226, v90
    v_exp_f32 v227, v91
    v_cvt_pk_bf16_f32 v156, v224, v225
    v_exp_f32 v248, v92
    v_exp_f32 v249, v93
    v_cvt_pk_bf16_f32 v157, v226, v227
    v_or_b32 v245, v156, v157
    v_exp_f32 v250, v94
    v_exp_f32 v251, v95
    v_cvt_pk_bf16_f32 v158, v248, v249
    v_exp_f32 v224, v80
    v_exp_f32 v225, v81
    v_cvt_pk_bf16_f32 v159, v250, v251
    v_or3_b32 v245, v245, v158, v159
    v_exp_f32 v226, v82
    v_exp_f32 v227, v83
    s_waitcnt vmcnt(8) lgkmcnt(0)
    s_barrier
    v_mfma_f32_16x16x32_bf16 a[0:3], a[192:195], v[164:167], a[0:3]
    ds_read_b32 v237, v236
    s_mov_b32 m0, s41
    s_add_u32 s18, s30, 4096
    buffer_load_dwordx4 v216, s[16:19], s31 offen offset:2048 lds
    v_mfma_f32_16x16x32_bf16 a[32:35], a[192:195], v[168:171], a[32:35]
    ds_read_b64_tr_b16 a[160:161], v208 offset:0
    v_cvt_pk_bf16_f32 v152, v224, v225
    v_cvt_pk_bf16_f32 v153, v226, v227
    v_mfma_f32_16x16x32_bf16 a[64:67], a[192:195], v[172:175], a[64:67]
    v_exp_f32 v248, v84
    v_or3_b32 v245, v245, v152, v153
    v_mfma_f32_16x16x32_bf16 a[96:99], a[192:195], v[176:179], a[96:99]
    ds_read_b64_tr_b16 a[162:163], v208 offset:8192
    v_exp_f32 v249, v85
    v_mfma_f32_16x16x32_bf16 a[4:7], a[196:199], v[164:167], a[4:7]
    v_exp_f32 v250, v86
    v_cvt_pk_bf16_f32 v154, v248, v249
    v_mfma_f32_16x16x32_bf16 a[36:39], a[196:199], v[168:171], a[36:39]
    ds_read_b64_tr_b16 a[164:165], v209 offset:0
    buffer_load_dwordx4 v217, s[16:19], s31 offen offset:3072 lds
    v_mfma_f32_16x16x32_bf16 a[68:71], a[196:199], v[172:175], a[68:71]
    v_exp_f32 v251, v87
    v_exp_f32 v224, v72
    v_mfma_f32_16x16x32_bf16 a[100:103], a[196:199], v[176:179], a[100:103]
    ds_read_b64_tr_b16 a[166:167], v209 offset:8192
    v_cvt_pk_bf16_f32 v155, v250, v251
    v_or3_b32 v245, v245, v154, v155
    v_mfma_f32_16x16x32_bf16 a[8:11], a[200:203], v[164:167], a[8:11]
    ds_read_b64_tr_b16 a[168:169], v210 offset:0
    v_exp_f32 v225, v73
    v_mfma_f32_16x16x32_bf16 a[40:43], a[200:203], v[168:171], a[40:43]
    v_exp_f32 v226, v74
    v_mfma_f32_16x16x32_bf16 a[72:75], a[200:203], v[172:175], a[72:75]
    ds_read_b64_tr_b16 a[170:171], v210 offset:8192
    s_mov_b32 m0, s3
    s_add_u32 s61, s55, 0
    buffer_load_dwordx4 v220, s[12:15], s61 offen offset:0 nt lds
    v_mfma_f32_16x16x32_bf16 a[104:107], a[200:203], v[176:179], a[104:107]
    v_exp_f32 v227, v75
    v_cvt_pk_bf16_f32 v148, v224, v225
    v_mfma_f32_16x16x32_bf16 a[12:15], a[204:207], v[164:167], a[12:15]
    ds_read_b64_tr_b16 a[172:173], v211 offset:0
    v_cvt_pk_bf16_f32 v149, v226, v227
    v_or3_b32 v245, v245, v148, v149
    v_mfma_f32_16x16x32_bf16 a[44:47], a[204:207], v[168:171], a[44:47]
    v_exp_f32 v248, v76
    v_mfma_f32_16x16x32_bf16 a[76:79], a[204:207], v[172:175], a[76:79]
    ds_read_b64_tr_b16 a[174:175], v211 offset:8192
    v_exp_f32 v249, v77
    v_mfma_f32_16x16x32_bf16 a[108:111], a[204:207], v[176:179], a[108:111]
    ds_read_b64_tr_b16 a[176:177], v212 offset:0
    v_cvt_pk_bf16_f32 v150, v248, v249
    v_mfma_f32_16x16x32_bf16 a[16:19], a[208:211], v[164:167], a[16:19]
    buffer_load_dwordx4 v221, s[12:15], s61 offen offset:1024 nt lds
    v_exp_f32 v250, v78
    v_mfma_f32_16x16x32_bf16 a[48:51], a[208:211], v[168:171], a[48:51]
    ds_read_b64_tr_b16 a[178:179], v212 offset:8192
    v_exp_f32 v251, v79
    v_mfma_f32_16x16x32_bf16 a[80:83], a[208:211], v[172:175], a[80:83]
    v_exp_f32 v224, v64
    v_mfma_f32_16x16x32_bf16 a[112:115], a[208:211], v[176:179], a[112:115]
    ds_read_b64_tr_b16 a[180:181], v213 offset:0
    v_cvt_pk_bf16_f32 v151, v250, v251
    v_mfma_f32_16x16x32_bf16 a[20:23], a[212:215], v[164:167], a[20:23]
    v_exp_f32 v225, v65
    v_or3_b32 v245, v245, v150, v151
    v_mfma_f32_16x16x32_bf16 a[52:55], a[212:215], v[168:171], a[52:55]
    ds_read_b64_tr_b16 a[182:183], v213 offset:8192
    buffer_load_dwordx4 v222, s[12:15], s61 offen offset:2048 nt lds
    v_mfma_f32_16x16x32_bf16 a[84:87], a[212:215], v[172:175], a[84:87]
    ds_read_b64_tr_b16 a[184:185], v214 offset:0
    v_cvt_pk_bf16_f32 v144, v224, v225
    v_exp_f32 v226, v66
    v_mfma_f32_16x16x32_bf16 a[116:119], a[212:215], v[176:179], a[116:119]
    v_exp_f32 v227, v67
    v_mfma_f32_16x16x32_bf16 a[24:27], a[216:219], v[164:167], a[24:27]
    ds_read_b64_tr_b16 a[186:187], v214 offset:8192
    v_cvt_pk_bf16_f32 v145, v226, v227
    v_mfma_f32_16x16x32_bf16 a[56:59], a[216:219], v[168:171], a[56:59]
    v_exp_f32 v248, v68
    v_mfma_f32_16x16x32_bf16 a[88:91], a[216:219], v[172:175], a[88:91]
    ds_read_b64_tr_b16 a[188:189], v215 offset:0
    buffer_load_dwordx4 v223, s[12:15], s61 offen offset:3072 nt lds
    v_mfma_f32_16x16x32_bf16 a[120:123], a[216:219], v[176:179], a[120:123]
    v_exp_f32 v249, v69
    v_or3_b32 v245, v245, v144, v145
    v_mfma_f32_16x16x32_bf16 a[28:31], a[220:223], v[164:167], a[28:31]
    ds_read_b64_tr_b16 a[190:191], v215 offset:8192
    v_cvt_pk_bf16_f32 v146, v248, v249
    v_exp_f32 v250, v70
    v_mfma_f32_16x16x32_bf16 a[60:63], a[220:223], v[168:171], a[60:63]
    v_exp_f32 v251, v71
    v_mfma_f32_16x16x32_bf16 a[92:95], a[220:223], v[172:175], a[92:95]
    v_cvt_pk_bf16_f32 v147, v250, v251
    v_or3_b32 v245, v245, v146, v147
    v_mfma_f32_16x16x32_bf16 a[124:127], a[220:223], v[176:179], a[124:127]
    v_and_b32 v244, 0x40004000, v245
    v_cmp_ne_u32 vcc, 0, v244
    s_cbranch_vccnz Lrare_t4t2_1
Lback_t4t2_1:
    s_waitcnt lgkmcnt(8)
    v_cmp_ne_u32 vcc, 0, v237
    s_cbranch_vccnz Lrestart
    v_mfma_f32_16x16x32_bf16 a[240:243], v[228:231], v[144:147], a[240:243]
    s_add_u32 m0, s3, 4096
    s_add_u32 s61, s55, 65536
    buffer_load_dwordx4 v220, s[12:15], s61 offen offset:0 nt lds
    v_xor_b32 v184, 0, v240
    v_mfma_f32_16x16x32_bf16 a[244:247], v[228:231], v[148:151], a[244:247]
    v_xor_b32 v185, 32, v240
    v_mfma_f32_16x16x32_bf16 a[248:251], v[228:231], v[152:155], a[248:251]
    v_mfma_f32_16x16x32_bf16 a[252:255], v[228:231], v[156:159], a[252:255]
    s_waitcnt lgkmcnt(6)
    v_xor_b32 v186, 64, v240
    v_mfma_f32_16x16x32_bf16 a[0:3], a[160:163], v[144:147], a[0:3]
    v_xor_b32 v187, 96, v240
    v_mfma_f32_16x16x32_bf16 a[4:7], a[164:167], v[144:147], a[4:7]
    v_mfma_f32_16x16x32_bf16 a[8:11], a[168:171], v[144:147], a[8:11]
    buffer_load_dwordx4 v221, s[12:15], s61 offen offset:1024 nt lds
    v_xor_b32 v188, 128, v240
    v_mfma_f32_16x16x32_bf16 a[12:15], a[172:175], v[144:147], a[12:15]
    v_xor_b32 v189, 160, v240
    v_mfma_f32_16x16x32_bf16 a[16:19], a[176:179], v[144:147], a[16:19]
    s_waitcnt lgkmcnt(0)
    v_mfma_f32_16x16x32_bf16 a[20:23], a[180:183], v[144:147], a[20:23]
    v_xor_b32 v190, 192, v240
    v_mfma_f32_16x16x32_bf16 a[24:27], a[184:187], v[144:147], a[24:27]
    v_xor_b32 v191, 224, v240
    v_mfma_f32_16x16x32_bf16 a[28:31], a[188:191], v[144:147], a[28:31]
    v_mfma_f32_16x16x32_bf16 a[32:35], a[160:163], v[148:151], a[32:35]
    buffer_load_dwordx4 v222, s[12:15], s61 offen offset:2048 nt lds
    v_accvgpr_read_b32 v244, a240
    v_accvgpr_read_b32 v245, a244
    v_mfma_f32_16x16x32_bf16 a[36:39], a[164:167], v[148:151], a[36:39]
    v_accvgpr_read_b32 v246, a248
    v_accvgpr_read_b32 v247, a252
    v_mfma_f32_16x16x32_bf16 a[40:43], a[168:171], v[148:151], a[40:43]
    v_rcp_f32 v192, v244
    v_mfma_f32_16x16x32_bf16 a[44:47], a[172:175], v[148:151], a[44:47]
    v_rcp_f32 v193, v245
    v_rcp_f32 v194, v246
    v_mfma_f32_16x16x32_bf16 a[48:51], a[176:179], v[148:151], a[48:51]
    v_rcp_f32 v195, v247
    v_accvgpr_read_b32 v0, a0
    v_mfma_f32_16x16x32_bf16 a[52:55], a[180:183], v[148:151], a[52:55]
    v_accvgpr_read_b32 v1, a1
    v_mfma_f32_16x16x32_bf16 a[56:59], a[184:187], v[148:151], a[56:59]
    buffer_load_dwordx4 v223, s[12:15], s61 offen offset:3072 nt lds
    v_accvgpr_read_b32 v2, a2
    v_accvgpr_read_b32 v3, a3
    v_mfma_f32_16x16x32_bf16 a[60:63], a[188:191], v[148:151], a[60:63]
    v_accvgpr_read_b32 v4, a4
    v_accvgpr_read_b32 v5, a5
    v_mfma_f32_16x16x32_bf16 a[64:67], a[160:163], v[152:155], a[64:67]
    v_accvgpr_read_b32 v6, a6
    v_mfma_f32_16x16x32_bf16 a[68:71], a[164:167], v[152:155], a[68:71]
    v_accvgpr_read_b32 v7, a7
    v_accvgpr_read_b32 v8, a8
    v_mfma_f32_16x16x32_bf16 a[72:75], a[168:171], v[152:155], a[72:75]
    v_accvgpr_read_b32 v9, a9
    v_accvgpr_read_b32 v10, a10
    v_mfma_f32_16x16x32_bf16 a[76:79], a[172:175], v[152:155], a[76:79]
    v_accvgpr_read_b32 v11, a11
    v_mfma_f32_16x16x32_bf16 a[80:83], a[176:179], v[152:155], a[80:83]
    s_add_u32 m0, s41, 16384
    s_nop 0
    buffer_load_dwordx4 v216, s[16:19], s28 offen offset:2048 lds
    v_accvgpr_read_b32 v12, a12
    v_accvgpr_read_b32 v13, a13
    v_mfma_f32_16x16x32_bf16 a[84:87], a[180:183], v[152:155], a[84:87]
    v_accvgpr_read_b32 v14, a14
    v_accvgpr_read_b32 v15, a15
    v_mfma_f32_16x16x32_bf16 a[88:91], a[184:187], v[152:155], a[88:91]
    v_accvgpr_read_b32 v16, a16
    v_mfma_f32_16x16x32_bf16 a[92:95], a[188:191], v[152:155], a[92:95]
    v_accvgpr_read_b32 v17, a17
    v_accvgpr_read_b32 v18, a18
    v_mfma_f32_16x16x32_bf16 a[96:99], a[160:163], v[156:159], a[96:99]
    v_accvgpr_read_b32 v19, a19
    v_accvgpr_read_b32 v20, a20
    v_mfma_f32_16x16x32_bf16 a[100:103], a[164:167], v[156:159], a[100:103]
    v_accvgpr_read_b32 v21, a21
    v_mfma_f32_16x16x32_bf16 a[104:107], a[168:171], v[156:159], a[104:107]
    buffer_load_dwordx4 v217, s[16:19], s28 offen offset:3072 lds
    v_accvgpr_read_b32 v22, a22
    v_accvgpr_read_b32 v23, a23
    v_mfma_f32_16x16x32_bf16 a[108:111], a[172:175], v[156:159], a[108:111]
    v_accvgpr_read_b32 v24, a24
    v_accvgpr_read_b32 v25, a25
    v_mfma_f32_16x16x32_bf16 a[112:115], a[176:179], v[156:159], a[112:115]
    v_accvgpr_read_b32 v26, a26
    v_mfma_f32_16x16x32_bf16 a[116:119], a[180:183], v[156:159], a[116:119]
    v_accvgpr_read_b32 v27, a27
    v_accvgpr_read_b32 v28, a28
    v_mfma_f32_16x16x32_bf16 a[120:123], a[184:187], v[156:159], a[120:123]
    v_accvgpr_read_b32 v29, a29
    v_accvgpr_read_b32 v30, a30
    v_mfma_f32_16x16x32_bf16 a[124:127], a[188:191], v[156:159], a[124:127]
    v_accvgpr_read_b32 v31, a31
    s_branch Lepi4
Lxs4_2:
Ltail4_3_0:
    v_mfma_f32_16x16x32_bf16 a[240:243], v[228:231], v[144:147], a[240:243]
    ds_read_b64_tr_b16 a[192:193], v208 offset:0
    v_mfma_f32_16x16x32_bf16 a[244:247], v[228:231], v[148:151], a[244:247]
    ds_read_b64_tr_b16 a[194:195], v208 offset:8192
    v_mfma_f32_16x16x32_bf16 a[248:251], v[228:231], v[152:155], a[248:251]
    ds_read_b64_tr_b16 a[196:197], v209 offset:0
    v_mfma_f32_16x16x32_bf16 a[252:255], v[228:231], v[156:159], a[252:255]
    ds_read_b64_tr_b16 a[198:199], v209 offset:8192
    ds_read_b64_tr_b16 a[200:201], v210 offset:0
    ds_read_b64_tr_b16 a[202:203], v210 offset:8192
    ds_read_b64_tr_b16 a[204:205], v211 offset:0
    ds_read_b64_tr_b16 a[206:207], v211 offset:8192
    ds_read_b64_tr_b16 a[208:209], v212 offset:0
    ds_read_b64_tr_b16 a[210:211], v212 offset:8192
    ds_read_b64_tr_b16 a[212:213], v213 offset:0
    ds_read_b64_tr_b16 a[214:215], v213 offset:8192
    ds_read_b64_tr_b16 a[216:217], v214 offset:0
    ds_read_b64_tr_b16 a[218:219], v214 offset:8192
    ds_read_b64_tr_b16 a[220:221], v215 offset:0
    ds_read_b64_tr_b16 a[222:223], v215 offset:8192
    v_accvgpr_read_b32 v252, a240
    v_accvgpr_read_b32 v253, a244
    v_accvgpr_read_b32 v254, a248
    v_accvgpr_read_b32 v255, a252
    v_max3_f32 v237, v252, v253, v254
    v_max_f32 v237, v237, v255
    v_cmp_le_f32 vcc, s66, v237
    v_exp_f32 v224, v128
    v_exp_f32 v225, v129
    s_cmp_lg_u64 vcc, 0
    s_cselect_b32 s61, 1, 0
    s_andn2_b32 s61, s61, s65
    v_mov_b32 v237, s61
    ds_write_b32 v239, v237 offset:16384
    v_exp_f32 v226, v130
    v_exp_f32 v227, v131
    v_cvt_pk_bf16_f32 v176, v224, v225
    v_exp_f32 v248, v132
    v_exp_f32 v249, v133
    v_cvt_pk_bf16_f32 v177, v226, v227
    v_or_b32 v245, v176, v177
    v_exp_f32 v250, v134
    v_exp_f32 v251, v135
    v_cvt_pk_bf16_f32 v178, v248, v249
    v_exp_f32 v224, v120
    v_exp_f32 v225, v121
    v_cvt_pk_bf16_f32 v179, v250, v251
    v_or3_b32 v245, v245, v178, v179
    v_exp_f32 v226, v122
    v_exp_f32 v227, v123
    s_waitcnt vmcnt(8) lgkmcnt(0)
    s_barrier
    v_mfma_f32_16x16x32_bf16 a[0:3], a[192:195], v[144:147], a[0:3]
    ds_read_b32 v237, v236
    v_cvt_pk_bf16_f32 v172, v224, v225
    v_mfma_f32_16x16x32_bf16 a[32:35], a[192:195], v[148:151], a[32:35]
    ds_read_b64_tr_b16 a[160:161], v208 offset:16384
    v_cvt_pk_bf16_f32 v173, v226, v227
    v_mfma_f32_16x16x32_bf16 a[64:67], a[192:195], v[152:155], a[64:67]
    v_exp_f32 v248, v124
    v_mfma_f32_16x16x32_bf16 a[96:99], a[192:195], v[156:159], a[96:99]
    ds_read_b64_tr_b16 a[162:163], v208 offset:24576
    v_or3_b32 v245, v245, v172, v173
    v_mfma_f32_16x16x32_bf16 a[4:7], a[196:199], v[144:147], a[4:7]
    v_exp_f32 v249, v125
    v_mfma_f32_16x16x32_bf16 a[36:39], a[196:199], v[148:151], a[36:39]
    ds_read_b64_tr_b16 a[164:165], v209 offset:16384
    v_cvt_pk_bf16_f32 v174, v248, v249
    v_mfma_f32_16x16x32_bf16 a[68:71], a[196:199], v[152:155], a[68:71]
    v_exp_f32 v250, v126
    v_exp_f32 v251, v127
    v_mfma_f32_16x16x32_bf16 a[100:103], a[196:199], v[156:159], a[100:103]
    ds_read_b64_tr_b16 a[166:167], v209 offset:24576
    v_cvt_pk_bf16_f32 v175, v250, v251
    v_mfma_f32_16x16x32_bf16 a[8:11], a[200:203], v[144:147], a[8:11]
    ds_read_b64_tr_b16 a[168:169], v210 offset:16384
    v_or3_b32 v245, v245, v174, v175
    v_mfma_f32_16x16x32_bf16 a[40:43], a[200:203], v[148:151], a[40:43]
    v_exp_f32 v224, v112
    v_mfma_f32_16x16x32_bf16 a[72:75], a[200:203], v[152:155], a[72:75]
    ds_read_b64_tr_b16 a[170:171], v210 offset:24576
    v_exp_f32 v225, v113
    v_mfma_f32_16x16x32_bf16 a[104:107], a[200:203], v[156:159], a[104:107]
    v_exp_f32 v226, v114
    v_mfma_f32_16x16x32_bf16 a[12:15], a[204:207], v[144:147], a[12:15]
    ds_read_b64_tr_b16 a[172:173], v211 offset:16384
    v_cvt_pk_bf16_f32 v168, v224, v225
    v_exp_f32 v227, v115
    v_mfma_f32_16x16x32_bf16 a[44:47], a[204:207], v[148:151], a[44:47]
    v_exp_f32 v248, v116
    v_mfma_f32_16x16x32_bf16 a[76:79], a[204:207], v[152:155], a[76:79]
    ds_read_b64_tr_b16 a[174:175], v211 offset:24576
    v_cvt_pk_bf16_f32 v169, v226, v227
    v_mfma_f32_16x16x32_bf16 a[108:111], a[204:207], v[156:159], a[108:111]
    ds_read_b64_tr_b16 a[176:177], v212 offset:16384
    v_or3_b32 v245, v245, v168, v169
    v_mfma_f32_16x16x32_bf16 a[16:19], a[208:211], v[144:147], a[16:19]
    v_exp_f32 v249, v117
    v_exp_f32 v250, v118
    v_mfma_f32_16x16x32_bf16 a[48:51], a[208:211], v[148:151], a[48:51]
    ds_read_b64_tr_b16 a[178:179], v212 offset:24576
    v_cvt_pk_bf16_f32 v170, v248, v249
    v_mfma_f32_16x16x32_bf16 a[80:83], a[208:211], v[152:155], a[80:83]
    v_exp_f32 v251, v119
    v_mfma_f32_16x16x32_bf16 a[112:115], a[208:211], v[156:159], a[112:115]
    ds_read_b64_tr_b16 a[180:181], v213 offset:16384
    v_cvt_pk_bf16_f32 v171, v250, v251
    v_mfma_f32_16x16x32_bf16 a[20:23], a[212:215], v[144:147], a[20:23]
    v_exp_f32 v224, v104
    v_or3_b32 v245, v245, v170, v171
    v_mfma_f32_16x16x32_bf16 a[52:55], a[212:215], v[148:151], a[52:55]
    ds_read_b64_tr_b16 a[182:183], v213 offset:24576
    v_exp_f32 v225, v105
    v_mfma_f32_16x16x32_bf16 a[84:87], a[212:215], v[152:155], a[84:87]
    ds_read_b64_tr_b16 a[184:185], v214 offset:16384
    v_cvt_pk_bf16_f32 v164, v224, v225
    v_mfma_f32_16x16x32_bf16 a[116:119], a[212:215], v[156:159], a[116:119]
    v_exp_f32 v226, v106
    v_mfma_f32_16x16x32_bf16 a[24:27], a[216:219], v[144:147], a[24:27]
    ds_read_b64_tr_b16 a[186:187], v214 offset:24576
    v_exp_f32 v227, v107
    v_mfma_f32_16x16x32_bf16 a[56:59], a[216:219], v[148:151], a[56:59]
    v_exp_f32 v248, v108
    v_mfma_f32_16x16x32_bf16 a[88:91], a[216:219], v[152:155], a[88:91]
    ds_read_b64_tr_b16 a[188:189], v215 offset:16384
    v_cvt_pk_bf16_f32 v165, v226, v227
    v_or3_b32 v245, v245, v164, v165
    v_mfma_f32_16x16x32_bf16 a[120:123], a[216:219], v[156:159], a[120:123]
    v_exp_f32 v249, v109
    v_mfma_f32_16x16x32_bf16 a[28:31], a[220:223], v[144:147], a[28:31]
    ds_read_b64_tr_b16 a[190:191], v215 offset:24576
    v_cvt_pk_bf16_f32 v166, v248, v249
    v_exp_f32 v250, v110
    v_mfma_f32_16x16x32_bf16 a[60:63], a[220:223], v[148:151], a[60:63]
    v_exp_f32 v251, v111
    v_mfma_f32_16x16x32_bf16 a[92:95], a[220:223], v[152:155], a[92:95]
    v_cvt_pk_bf16_f32 v167, v250, v251
    v_or3_b32 v245, v245, v166, v167
    v_mfma_f32_16x16x32_bf16 a[124:127], a[220:223], v[156:159], a[124:127]
    v_and_b32 v244, 0x40004000, v245
    v_cmp_ne_u32 vcc, 0, v244
    s_cbranch_vccnz Lrare_t4t3_0
Lback_t4t3_0:
    s_waitcnt lgkmcnt(8)
    v_cmp_ne_u32 vcc, 0, v237
    s_cbranch_vccnz Lrestart
    v_mfma_f32_16x16x32_bf16 a[240:243], v[228:231], v[164:167], a[240:243]
    v_xor_b32 v184, 0, v240
    v_mfma_f32_16x16x32_bf16 a[244:247], v[228:231], v[168:171], a[244:247]
    v_xor_b32 v185, 32, v240
    v_mfma_f32_16x16x32_bf16 a[248:251], v[228:231], v[172:175], a[248:251]
    v_mfma_f32_16x16x32_bf16 a[252:255], v[228:231], v[176:179], a[252:255]
    s_waitcnt lgkmcnt(6)
    v_xor_b32 v186, 64, v240
    v_mfma_f32_16x16x32_bf16 a[0:3], a[160:163], v[164:167], a[0:3]
    v_xor_b32 v187, 96, v240
    v_mfma_f32_16x16x32_bf16 a[4:7], a[164:167], v[164:167], a[4:7]
    v_mfma_f32_16x16x32_bf16 a[8:11], a[168:171], v[164:167], a[8:11]
    v_xor_b32 v188, 128, v240
    v_mfma_f32_16x16x32_bf16 a[12:15], a[172:175], v[164:167], a[12:15]
    v_xor_b32 v189, 160, v240
    v_mfma_f32_16x16x32_bf16 a[16:19], a[176:179], v[164:167], a[16:19]
    s_waitcnt lgkmcnt(0)
    v_mfma_f32_16x16x32_bf16 a[20:23], a[180:183], v[164:167], a[20:23]
    v_xor_b32 v190, 192, v240
    v_mfma_f32_16x16x32_bf16 a[24:27], a[184:187], v[164:167], a[24:27]
    v_xor_b32 v191, 224, v240
    v_mfma_f32_16x16x32_bf16 a[28:31], a[188:191], v[164:167], a[28:31]
    v_mfma_f32_16x16x32_bf16 a[32:35], a[160:163], v[168:171], a[32:35]
    v_accvgpr_read_b32 v244, a240
    v_accvgpr_read_b32 v245, a244
    v_mfma_f32_16x16x32_bf16 a[36:39], a[164:167], v[168:171], a[36:39]
    v_accvgpr_read_b32 v246, a248
    v_accvgpr_read_b32 v247, a252
    v_mfma_f32_16x16x32_bf16 a[40:43], a[168:171], v[168:171], a[40:43]
    v_rcp_f32 v192, v244
    v_mfma_f32_16x16x32_bf16 a[44:47], a[172:175], v[168:171], a[44:47]
    v_rcp_f32 v193, v245
    v_rcp_f32 v194, v246
    v_mfma_f32_16x16x32_bf16 a[48:51], a[176:179], v[168:171], a[48:51]
    v_rcp_f32 v195, v247
    v_accvgpr_read_b32 v0, a0
    v_mfma_f32_16x16x32_bf16 a[52:55], a[180:183], v[168:171], a[52:55]
    v_accvgpr_read_b32 v1, a1
    v_mfma_f32_16x16x32_bf16 a[56:59], a[184:187], v[168:171], a[56:59]
    v_accvgpr_read_b32 v2, a2
    v_accvgpr_read_b32 v3, a3
    v_mfma_f32_16x16x32_bf16 a[60:63], a[188:191], v[168:171], a[60:63]
    v_accvgpr_read_b32 v4, a4
    v_accvgpr_read_b32 v5, a5
    v_mfma_f32_16x16x32_bf16 a[64:67], a[160:163], v[172:175], a[64:67]
    v_accvgpr_read_b32 v6, a6
    v_mfma_f32_16x16x32_bf16 a[68:71], a[164:167], v[172:175], a[68:71]
    v_accvgpr_read_b32 v7, a7
    v_accvgpr_read_b32 v8, a8
    v_mfma_f32_16x16x32_bf16 a[72:75], a[168:171], v[172:175], a[72:75]
    v_accvgpr_read_b32 v9, a9
    v_accvgpr_read_b32 v10, a10
    v_mfma_f32_16x16x32_bf16 a[76:79], a[172:175], v[172:175], a[76:79]
    v_accvgpr_read_b32 v11, a11
    v_mfma_f32_16x16x32_bf16 a[80:83], a[176:179], v[172:175], a[80:83]
    v_accvgpr_read_b32 v12, a12
    v_accvgpr_read_b32 v13, a13
    v_mfma_f32_16x16x32_bf16 a[84:87], a[180:183], v[172:175], a[84:87]
    v_accvgpr_read_b32 v14, a14
    v_accvgpr_read_b32 v15, a15
    v_mfma_f32_16x16x32_bf16 a[88:91], a[184:187], v[172:175], a[88:91]
    v_accvgpr_read_b32 v16, a16
    v_mfma_f32_16x16x32_bf16 a[92:95], a[188:191], v[172:175], a[92:95]
    v_accvgpr_read_b32 v17, a17
    v_accvgpr_read_b32 v18, a18
    v_mfma_f32_16x16x32_bf16 a[96:99], a[160:163], v[176:179], a[96:99]
    v_accvgpr_read_b32 v19, a19
    v_accvgpr_read_b32 v20, a20
    v_mfma_f32_16x16x32_bf16 a[100:103], a[164:167], v[176:179], a[100:103]
    v_accvgpr_read_b32 v21, a21
    v_mfma_f32_16x16x32_bf16 a[104:107], a[168:171], v[176:179], a[104:107]
    v_accvgpr_read_b32 v22, a22
    v_accvgpr_read_b32 v23, a23
    v_mfma_f32_16x16x32_bf16 a[108:111], a[172:175], v[176:179], a[108:111]
    v_accvgpr_read_b32 v24, a24
    v_accvgpr_read_b32 v25, a25
    v_mfma_f32_16x16x32_bf16 a[112:115], a[176:179], v[176:179], a[112:115]
    v_accvgpr_read_b32 v26, a26
    v_mfma_f32_16x16x32_bf16 a[116:119], a[180:183], v[176:179], a[116:119]
    v_accvgpr_read_b32 v27, a27
    v_accvgpr_read_b32 v28, a28
    v_mfma_f32_16x16x32_bf16 a[120:123], a[184:187], v[176:179], a[120:123]
    v_accvgpr_read_b32 v29, a29
    v_accvgpr_read_b32 v30, a30
    v_mfma_f32_16x16x32_bf16 a[124:127], a[188:191], v[176:179], a[124:127]
    v_accvgpr_read_b32 v31, a31
    s_branch Lepi4
Lepi4:
    v_pk_mul_f32 v[0:1], v[0:1], v[192:193] op_sel_hi:[1,0]
    v_pk_mul_f32 v[2:3], v[2:3], v[192:193] op_sel_hi:[1,0]
    v_pk_mul_f32 v[4:5], v[4:5], v[192:193] op_sel_hi:[1,0]
    v_pk_mul_f32 v[6:7], v[6:7], v[192:193] op_sel_hi:[1,0]
    v_cvt_pk_bf16_f32 v32, v0, v1
    v_cvt_pk_bf16_f32 v33, v2, v3
    v_cvt_pk_bf16_f32 v34, v4, v5
    v_cvt_pk_bf16_f32 v35, v6, v7
    ds_write_b64 v184, v[32:33]
    ds_write_b64 v185, v[34:35]
    v_pk_mul_f32 v[8:9], v[8:9], v[192:193] op_sel_hi:[1,0]
    v_pk_mul_f32 v[10:11], v[10:11], v[192:193] op_sel_hi:[1,0]
    v_pk_mul_f32 v[12:13], v[12:13], v[192:193] op_sel_hi:[1,0]
    v_pk_mul_f32 v[14:15], v[14:15], v[192:193] op_sel_hi:[1,0]
    v_cvt_pk_bf16_f32 v36, v8, v9
    v_cvt_pk_bf16_f32 v37, v10, v11
    v_cvt_pk_bf16_f32 v38, v12, v13
    v_cvt_pk_bf16_f32 v39, v14, v15
    ds_write_b64 v186, v[36:37]
    ds_write_b64 v187, v[38:39]
    v_pk_mul_f32 v[16:17], v[16:17], v[192:193] op_sel_hi:[1,0]
    v_pk_mul_f32 v[18:19], v[18:19], v[192:193] op_sel_hi:[1,0]
    v_pk_mul_f32 v[20:21], v[20:21], v[192:193] op_sel_hi:[1,0]
    v_pk_mul_f32 v[22:23], v[22:23], v[192:193] op_sel_hi:[1,0]
    v_cvt_pk_bf16_f32 v40, v16, v17
    v_cvt_pk_bf16_f32 v41, v18, v19
    v_cvt_pk_bf16_f32 v42, v20, v21
    v_cvt_pk_bf16_f32 v43, v22, v23
    ds_write_b64 v188, v[40:41]
    ds_write_b64 v189, v[42:43]
    v_pk_mul_f32 v[24:25], v[24:25], v[192:193] op_sel_hi:[1,0]
    v_pk_mul_f32 v[26:27], v[26:27], v[192:193] op_sel_hi:[1,0]
    v_pk_mul_f32 v[28:29], v[28:29], v[192:193] op_sel_hi:[1,0]
    v_pk_mul_f32 v[30:31], v[30:31], v[192:193] op_sel_hi:[1,0]
    v_cvt_pk_bf16_f32 v44, v24, v25
    v_cvt_pk_bf16_f32 v45, v26, v27
    v_cvt_pk_bf16_f32 v46, v28, v29
    v_cvt_pk_bf16_f32 v47, v30, v31
    ds_write_b64 v190, v[44:45]
    ds_write_b64 v191, v[46:47]
    ds_read_b128 v[64:67], v241 offset:0
    ds_read_b128 v[68:71], v241 offset:1024
    ds_read_b128 v[72:75], v241 offset:2048
    ds_read_b128 v[76:79], v241 offset:3072
    v_accvgpr_read_b32 v0, a32
    v_accvgpr_read_b32 v1, a33
    v_accvgpr_read_b32 v2, a34
    v_accvgpr_read_b32 v3, a35
    v_accvgpr_read_b32 v4, a36
    v_accvgpr_read_b32 v5, a37
    v_accvgpr_read_b32 v6, a38
    v_accvgpr_read_b32 v7, a39
    v_pk_mul_f32 v[0:1], v[0:1], v[192:193] op_sel:[0,1] op_sel_hi:[1,1]
    v_pk_mul_f32 v[2:3], v[2:3], v[192:193] op_sel:[0,1] op_sel_hi:[1,1]
    v_pk_mul_f32 v[4:5], v[4:5], v[192:193] op_sel:[0,1] op_sel_hi:[1,1]
    v_pk_mul_f32 v[6:7], v[6:7], v[192:193] op_sel:[0,1] op_sel_hi:[1,1]
    v_cvt_pk_bf16_f32 v48, v0, v1
    v_cvt_pk_bf16_f32 v49, v2, v3
    v_cvt_pk_bf16_f32 v50, v4, v5
    v_cvt_pk_bf16_f32 v51, v6, v7
    ds_write_b64 v184, v[48:49]
    ds_write_b64 v185, v[50:51]
    v_accvgpr_read_b32 v8, a40
    v_accvgpr_read_b32 v9, a41
    v_accvgpr_read_b32 v10, a42
    v_accvgpr_read_b32 v11, a43
    v_accvgpr_read_b32 v12, a44
    v_accvgpr_read_b32 v13, a45
    v_accvgpr_read_b32 v14, a46
    v_accvgpr_read_b32 v15, a47
    s_add_u32 s61, s56, 0
    s_waitcnt lgkmcnt(2)
    buffer_store_dwordx4 v[64:67], v220, s[24:27], s61 offen offset:0 sc0 sc1
    v_pk_mul_f32 v[8:9], v[8:9], v[192:193] op_sel:[0,1] op_sel_hi:[1,1]
    v_pk_mul_f32 v[10:11], v[10:11], v[192:193] op_sel:[0,1] op_sel_hi:[1,1]
    v_pk_mul_f32 v[12:13], v[12:13], v[192:193] op_sel:[0,1] op_sel_hi:[1,1]
    v_pk_mul_f32 v[14:15], v[14:15], v[192:193] op_sel:[0,1] op_sel_hi:[1,1]
    v_cvt_pk_bf16_f32 v52, v8, v9
    v_cvt_pk_bf16_f32 v53, v10, v11
    v_cvt_pk_bf16_f32 v54, v12, v13
    v_cvt_pk_bf16_f32 v55, v14, v15
    ds_write_b64 v186, v[52:53]
    ds_write_b64 v187, v[54:55]
    v_accvgpr_read_b32 v16, a48
    v_accvgpr_read_b32 v17, a49
    v_accvgpr_read_b32 v18, a50
    v_accvgpr_read_b32 v19, a51
    v_accvgpr_read_b32 v20, a52
    v_accvgpr_read_b32 v21, a53
    v_accvgpr_read_b32 v22, a54
    v_accvgpr_read_b32 v23, a55
    buffer_store_dwordx4 v[68:71], v221, s[24:27], s61 offen offset:1024 sc0 sc1
    v_pk_mul_f32 v[16:17], v[16:17], v[192:193] op_sel:[0,1] op_sel_hi:[1,1]
    v_pk_mul_f32 v[18:19], v[18:19], v[192:193] op_sel:[0,1] op_sel_hi:[1,1]
    v_pk_mul_f32 v[20:21], v[20:21], v[192:193] op_sel:[0,1] op_sel_hi:[1,1]
    v_pk_mul_f32 v[22:23], v[22:23], v[192:193] op_sel:[0,1] op_sel_hi:[1,1]
    v_cvt_pk_bf16_f32 v56, v16, v17
    v_cvt_pk_bf16_f32 v57, v18, v19
    v_cvt_pk_bf16_f32 v58, v20, v21
    v_cvt_pk_bf16_f32 v59, v22, v23
    ds_write_b64 v188, v[56:57]
    ds_write_b64 v189, v[58:59]
    v_accvgpr_read_b32 v24, a56
    v_accvgpr_read_b32 v25, a57
    v_accvgpr_read_b32 v26, a58
    v_accvgpr_read_b32 v27, a59
    v_accvgpr_read_b32 v28, a60
    v_accvgpr_read_b32 v29, a61
    v_accvgpr_read_b32 v30, a62
    v_accvgpr_read_b32 v31, a63
    buffer_store_dwordx4 v[72:75], v222, s[24:27], s61 offen offset:2048 sc0 sc1
    v_pk_mul_f32 v[24:25], v[24:25], v[192:193] op_sel:[0,1] op_sel_hi:[1,1]
    v_pk_mul_f32 v[26:27], v[26:27], v[192:193] op_sel:[0,1] op_sel_hi:[1,1]
    v_pk_mul_f32 v[28:29], v[28:29], v[192:193] op_sel:[0,1] op_sel_hi:[1,1]
    v_pk_mul_f32 v[30:31], v[30:31], v[192:193] op_sel:[0,1] op_sel_hi:[1,1]
    v_cvt_pk_bf16_f32 v60, v24, v25
    v_cvt_pk_bf16_f32 v61, v26, v27
    v_cvt_pk_bf16_f32 v62, v28, v29
    v_cvt_pk_bf16_f32 v63, v30, v31
    ds_write_b64 v190, v[60:61]
    ds_write_b64 v191, v[62:63]
    ds_read_b128 v[80:83], v241 offset:0
    ds_read_b128 v[84:87], v241 offset:1024
    ds_read_b128 v[88:91], v241 offset:2048
    ds_read_b128 v[92:95], v241 offset:3072
    v_accvgpr_read_b32 v0, a64
    v_accvgpr_read_b32 v1, a65
    v_accvgpr_read_b32 v2, a66
    v_accvgpr_read_b32 v3, a67
    v_accvgpr_read_b32 v4, a68
    v_accvgpr_read_b32 v5, a69
    v_accvgpr_read_b32 v6, a70
    v_accvgpr_read_b32 v7, a71
    buffer_store_dwordx4 v[76:79], v223, s[24:27], s61 offen offset:3072 sc0 sc1
    v_pk_mul_f32 v[0:1], v[0:1], v[194:195] op_sel_hi:[1,0]
    v_pk_mul_f32 v[2:3], v[2:3], v[194:195] op_sel_hi:[1,0]
    v_pk_mul_f32 v[4:5], v[4:5], v[194:195] op_sel_hi:[1,0]
    v_pk_mul_f32 v[6:7], v[6:7], v[194:195] op_sel_hi:[1,0]
    v_cvt_pk_bf16_f32 v32, v0, v1
    v_cvt_pk_bf16_f32 v33, v2, v3
    v_cvt_pk_bf16_f32 v34, v4, v5
    v_cvt_pk_bf16_f32 v35, v6, v7
    ds_write_b64 v184, v[32:33]
    ds_write_b64 v185, v[34:35]
    v_accvgpr_read_b32 v8, a72
    v_accvgpr_read_b32 v9, a73
    v_accvgpr_read_b32 v10, a74
    v_accvgpr_read_b32 v11, a75
    v_accvgpr_read_b32 v12, a76
    v_accvgpr_read_b32 v13, a77
    v_accvgpr_read_b32 v14, a78
    v_accvgpr_read_b32 v15, a79
    s_add_u32 s62, s56, 65536
    s_waitcnt lgkmcnt(2)
    buffer_store_dwordx4 v[80:83], v220, s[24:27], s62 offen offset:0 sc0 sc1
    v_pk_mul_f32 v[8:9], v[8:9], v[194:195] op_sel_hi:[1,0]
    v_pk_mul_f32 v[10:11], v[10:11], v[194:195] op_sel_hi:[1,0]
    v_pk_mul_f32 v[12:13], v[12:13], v[194:195] op_sel_hi:[1,0]
    v_pk_mul_f32 v[14:15], v[14:15], v[194:195] op_sel_hi:[1,0]
    v_cvt_pk_bf16_f32 v36, v8, v9
    v_cvt_pk_bf16_f32 v37, v10, v11
    v_cvt_pk_bf16_f32 v38, v12, v13
    v_cvt_pk_bf16_f32 v39, v14, v15
    ds_write_b64 v186, v[36:37]
    ds_write_b64 v187, v[38:39]
    v_accvgpr_read_b32 v16, a80
    v_accvgpr_read_b32 v17, a81
    v_accvgpr_read_b32 v18, a82
    v_accvgpr_read_b32 v19, a83
    v_accvgpr_read_b32 v20, a84
    v_accvgpr_read_b32 v21, a85
    v_accvgpr_read_b32 v22, a86
    v_accvgpr_read_b32 v23, a87
    buffer_store_dwordx4 v[84:87], v221, s[24:27], s62 offen offset:1024 sc0 sc1
    v_pk_mul_f32 v[16:17], v[16:17], v[194:195] op_sel_hi:[1,0]
    v_pk_mul_f32 v[18:19], v[18:19], v[194:195] op_sel_hi:[1,0]
    v_pk_mul_f32 v[20:21], v[20:21], v[194:195] op_sel_hi:[1,0]
    v_pk_mul_f32 v[22:23], v[22:23], v[194:195] op_sel_hi:[1,0]
    v_cvt_pk_bf16_f32 v40, v16, v17
    v_cvt_pk_bf16_f32 v41, v18, v19
    v_cvt_pk_bf16_f32 v42, v20, v21
    v_cvt_pk_bf16_f32 v43, v22, v23
    ds_write_b64 v188, v[40:41]
    ds_write_b64 v189, v[42:43]
    v_accvgpr_read_b32 v24, a88
    v_accvgpr_read_b32 v25, a89
    v_accvgpr_read_b32 v26, a90
    v_accvgpr_read_b32 v27, a91
    v_accvgpr_read_b32 v28, a92
    v_accvgpr_read_b32 v29, a93
    v_accvgpr_read_b32 v30, a94
    v_accvgpr_read_b32 v31, a95
    buffer_store_dwordx4 v[88:91], v222, s[24:27], s62 offen offset:2048 sc0 sc1
    v_pk_mul_f32 v[24:25], v[24:25], v[194:195] op_sel_hi:[1,0]
    v_pk_mul_f32 v[26:27], v[26:27], v[194:195] op_sel_hi:[1,0]
    v_pk_mul_f32 v[28:29], v[28:29], v[194:195] op_sel_hi:[1,0]
    v_pk_mul_f32 v[30:31], v[30:31], v[194:195] op_sel_hi:[1,0]
    v_cvt_pk_bf16_f32 v44, v24, v25
    v_cvt_pk_bf16_f32 v45, v26, v27
    v_cvt_pk_bf16_f32 v46, v28, v29
    v_cvt_pk_bf16_f32 v47, v30, v31
    ds_write_b64 v190, v[44:45]
    ds_write_b64 v191, v[46:47]
    ds_read_b128 v[96:99], v241 offset:0
    ds_read_b128 v[100:103], v241 offset:1024
    ds_read_b128 v[104:107], v241 offset:2048
    ds_read_b128 v[108:111], v241 offset:3072
    v_accvgpr_read_b32 v0, a96
    v_accvgpr_read_b32 v1, a97
    v_accvgpr_read_b32 v2, a98
    v_accvgpr_read_b32 v3, a99
    v_accvgpr_read_b32 v4, a100
    v_accvgpr_read_b32 v5, a101
    v_accvgpr_read_b32 v6, a102
    v_accvgpr_read_b32 v7, a103
    buffer_store_dwordx4 v[92:95], v223, s[24:27], s62 offen offset:3072 sc0 sc1
    v_pk_mul_f32 v[0:1], v[0:1], v[194:195] op_sel:[0,1] op_sel_hi:[1,1]
    v_pk_mul_f32 v[2:3], v[2:3], v[194:195] op_sel:[0,1] op_sel_hi:[1,1]
    v_pk_mul_f32 v[4:5], v[4:5], v[194:195] op_sel:[0,1] op_sel_hi:[1,1]
    v_pk_mul_f32 v[6:7], v[6:7], v[194:195] op_sel:[0,1] op_sel_hi:[1,1]
    v_cvt_pk_bf16_f32 v48, v0, v1
    v_cvt_pk_bf16_f32 v49, v2, v3
    v_cvt_pk_bf16_f32 v50, v4, v5
    v_cvt_pk_bf16_f32 v51, v6, v7
    ds_write_b64 v184, v[48:49]
    ds_write_b64 v185, v[50:51]
    v_accvgpr_read_b32 v8, a104
    v_accvgpr_read_b32 v9, a105
    v_accvgpr_read_b32 v10, a106
    v_accvgpr_read_b32 v11, a107
    v_accvgpr_read_b32 v12, a108
    v_accvgpr_read_b32 v13, a109
    v_accvgpr_read_b32 v14, a110
    v_accvgpr_read_b32 v15, a111
    s_add_u32 s61, s56, 131072
    s_waitcnt lgkmcnt(2)
    buffer_store_dwordx4 v[96:99], v220, s[24:27], s61 offen offset:0 sc0 sc1
    v_pk_mul_f32 v[8:9], v[8:9], v[194:195] op_sel:[0,1] op_sel_hi:[1,1]
    v_pk_mul_f32 v[10:11], v[10:11], v[194:195] op_sel:[0,1] op_sel_hi:[1,1]
    v_pk_mul_f32 v[12:13], v[12:13], v[194:195] op_sel:[0,1] op_sel_hi:[1,1]
    v_pk_mul_f32 v[14:15], v[14:15], v[194:195] op_sel:[0,1] op_sel_hi:[1,1]
    v_cvt_pk_bf16_f32 v52, v8, v9
    v_cvt_pk_bf16_f32 v53, v10, v11
    v_cvt_pk_bf16_f32 v54, v12, v13
    v_cvt_pk_bf16_f32 v55, v14, v15
    ds_write_b64 v186, v[52:53]
    ds_write_b64 v187, v[54:55]
    v_accvgpr_read_b32 v16, a112
    v_accvgpr_read_b32 v17, a113
    v_accvgpr_read_b32 v18, a114
    v_accvgpr_read_b32 v19, a115
    v_accvgpr_read_b32 v20, a116
    v_accvgpr_read_b32 v21, a117
    v_accvgpr_read_b32 v22, a118
    v_accvgpr_read_b32 v23, a119
    buffer_store_dwordx4 v[100:103], v221, s[24:27], s61 offen offset:1024 sc0 sc1
    v_pk_mul_f32 v[16:17], v[16:17], v[194:195] op_sel:[0,1] op_sel_hi:[1,1]
    v_pk_mul_f32 v[18:19], v[18:19], v[194:195] op_sel:[0,1] op_sel_hi:[1,1]
    v_pk_mul_f32 v[20:21], v[20:21], v[194:195] op_sel:[0,1] op_sel_hi:[1,1]
    v_pk_mul_f32 v[22:23], v[22:23], v[194:195] op_sel:[0,1] op_sel_hi:[1,1]
    v_cvt_pk_bf16_f32 v56, v16, v17
    v_cvt_pk_bf16_f32 v57, v18, v19
    v_cvt_pk_bf16_f32 v58, v20, v21
    v_cvt_pk_bf16_f32 v59, v22, v23
    ds_write_b64 v188, v[56:57]
    ds_write_b64 v189, v[58:59]
    v_accvgpr_read_b32 v24, a120
    v_accvgpr_read_b32 v25, a121
    v_accvgpr_read_b32 v26, a122
    v_accvgpr_read_b32 v27, a123
    v_accvgpr_read_b32 v28, a124
    v_accvgpr_read_b32 v29, a125
    v_accvgpr_read_b32 v30, a126
    v_accvgpr_read_b32 v31, a127
    buffer_store_dwordx4 v[104:107], v222, s[24:27], s61 offen offset:2048 sc0 sc1
    v_pk_mul_f32 v[24:25], v[24:25], v[194:195] op_sel:[0,1] op_sel_hi:[1,1]
    v_pk_mul_f32 v[26:27], v[26:27], v[194:195] op_sel:[0,1] op_sel_hi:[1,1]
    v_pk_mul_f32 v[28:29], v[28:29], v[194:195] op_sel:[0,1] op_sel_hi:[1,1]
    v_pk_mul_f32 v[30:31], v[30:31], v[194:195] op_sel:[0,1] op_sel_hi:[1,1]
    v_cvt_pk_bf16_f32 v60, v24, v25
    v_cvt_pk_bf16_f32 v61, v26, v27
    v_cvt_pk_bf16_f32 v62, v28, v29
    v_cvt_pk_bf16_f32 v63, v30, v31
    ds_write_b64 v190, v[60:61]
    ds_write_b64 v191, v[62:63]
    ds_read_b128 v[112:115], v241 offset:0
    ds_read_b128 v[116:119], v241 offset:1024
    ds_read_b128 v[120:123], v241 offset:2048
    ds_read_b128 v[124:127], v241 offset:3072
    buffer_store_dwordx4 v[108:111], v223, s[24:27], s61 offen offset:3072 sc0 sc1
    s_add_u32 s62, s56, 196608
    s_waitcnt lgkmcnt(3)
    buffer_store_dwordx4 v[112:115], v220, s[24:27], s62 offen offset:0 sc0 sc1
    s_waitcnt lgkmcnt(2)
    buffer_store_dwordx4 v[116:119], v221, s[24:27], s62 offen offset:1024 sc0 sc1
    s_waitcnt lgkmcnt(1)
    buffer_store_dwordx4 v[120:123], v222, s[24:27], s62 offen offset:2048 sc0 sc1
    s_waitcnt lgkmcnt(0)
    buffer_store_dwordx4 v[124:127], v223, s[24:27], s62 offen offset:3072 sc0 sc1
    s_cmp_eq_u32 s29, 0
    s_cbranch_scc1 Ldone
    s_mov_b32 s64, 0
    s_mov_b32 s65, 0
    s_waitcnt vmcnt(16)
    s_branch Lstart
Lsafe5:
    s_waitcnt lgkmcnt(0)
    v_mfma_f32_16x16x32_bf16 v[64:67], a[160:163], v[0:3], v[184:187]
    ds_read_b64_tr_b16 a[192:193], v208 offset:32768
    v_mfma_f32_16x16x32_bf16 v[72:75], a[160:163], v[16:19], v[188:191]
    v_exp_f32 v224, v136
    v_mfma_f32_16x16x32_bf16 v[80:83], a[160:163], v[32:35], v[192:195]
    ds_read_b64_tr_b16 a[194:195], v208 offset:40960
    v_mfma_f32_16x16x32_bf16 v[88:91], a[160:163], v[48:51], v[196:199]
    v_exp_f32 v225, v137
    v_mfma_f32_16x16x32_bf16 v[96:99], a[160:163], a[224:227], v[200:203]
    ds_read_b64_tr_b16 a[196:197], v209 offset:32768
    v_cvt_pk_bf16_f32 v180, v224, v225
    v_mfma_f32_16x16x32_bf16 v[64:67], a[164:167], v[4:7], v[64:67]
    v_exp_f32 v226, v138
    v_mfma_f32_16x16x32_bf16 v[72:75], a[164:167], v[20:23], v[72:75]
    ds_read_b64_tr_b16 a[198:199], v209 offset:40960
    v_add_f32 v235, v235, v234
    v_mfma_f32_16x16x32_bf16 v[80:83], a[164:167], v[36:39], v[80:83]
    v_exp_f32 v227, v139
    v_mfma_f32_16x16x32_bf16 v[88:91], a[164:167], v[52:55], v[88:91]
    ds_read_b64_tr_b16 a[200:201], v210 offset:32768
    v_add_f32 v234, v224, v225
    v_mfma_f32_16x16x32_bf16 v[96:99], a[164:167], a[228:231], v[96:99]
    v_exp_f32 v248, v140
    v_mfma_f32_16x16x32_bf16 v[64:67], a[168:171], v[8:11], v[64:67]
    ds_read_b64_tr_b16 a[202:203], v210 offset:40960
    v_cvt_pk_bf16_f32 v181, v226, v227
    v_mfma_f32_16x16x32_bf16 v[72:75], a[168:171], v[24:27], v[72:75]
    v_exp_f32 v249, v141
    v_mfma_f32_16x16x32_bf16 v[80:83], a[168:171], v[40:43], v[80:83]
    ds_read_b64_tr_b16 a[204:205], v211 offset:32768
    v_add_f32 v247, v226, v227
    v_mfma_f32_16x16x32_bf16 v[88:91], a[168:171], v[56:59], v[88:91]
    v_exp_f32 v250, v142
    v_mfma_f32_16x16x32_bf16 v[96:99], a[168:171], a[232:235], v[96:99]
    ds_read_b64_tr_b16 a[206:207], v211 offset:40960
    v_add_f32 v234, v234, v247
    v_mfma_f32_16x16x32_bf16 v[64:67], a[172:175], v[12:15], v[64:67]
    v_exp_f32 v251, v143
    v_mfma_f32_16x16x32_bf16 v[72:75], a[172:175], v[28:31], v[72:75]
    v_exp_f32 v224, v128
    v_mfma_f32_16x16x32_bf16 v[80:83], a[172:175], v[44:47], v[80:83]
    ds_read_b64_tr_b16 a[208:209], v212 offset:32768
    v_or_b32 v245, v180, v181
    v_mfma_f32_16x16x32_bf16 v[88:91], a[172:175], v[60:63], v[88:91]
    v_exp_f32 v225, v129
    v_mfma_f32_16x16x32_bf16 v[96:99], a[172:175], a[236:239], v[96:99]
    ds_read_b64_tr_b16 a[210:211], v212 offset:40960
    v_cvt_pk_bf16_f32 v182, v248, v249
    v_mfma_f32_16x16x32_bf16 v[68:71], a[176:179], v[0:3], v[184:187]
    v_exp_f32 v226, v130
    v_mfma_f32_16x16x32_bf16 v[76:79], a[176:179], v[16:19], v[188:191]
    ds_read_b64_tr_b16 a[212:213], v213 offset:32768
    v_add_f32 v247, v248, v249
    v_mfma_f32_16x16x32_bf16 v[84:87], a[176:179], v[32:35], v[192:195]
    v_exp_f32 v227, v131
    v_mfma_f32_16x16x32_bf16 v[92:95], a[176:179], v[48:51], v[196:199]
    ds_read_b64_tr_b16 a[214:215], v213 offset:40960
    v_add_f32 v234, v234, v247
    v_mfma_f32_16x16x32_bf16 v[100:103], a[176:179], a[224:227], v[200:203]
    v_exp_f32 v248, v132
    v_mfma_f32_16x16x32_bf16 v[68:71], a[180:183], v[4:7], v[68:71]
    ds_read_b64_tr_b16 a[216:217], v214 offset:32768
    v_cvt_pk_bf16_f32 v183, v250, v251
    v_mfma_f32_16x16x32_bf16 v[76:79], a[180:183], v[20:23], v[76:79]
    v_exp_f32 v249, v133
    v_mfma_f32_16x16x32_bf16 v[84:87], a[180:183], v[36:39], v[84:87]
    ds_read_b64_tr_b16 a[218:219], v214 offset:40960
    v_add_f32 v247, v250, v251
    v_mfma_f32_16x16x32_bf16 v[92:95], a[180:183], v[52:55], v[92:95]
    v_exp_f32 v250, v134
    v_mfma_f32_16x16x32_bf16 v[100:103], a[180:183], a[228:231], v[100:103]
    ds_read_b64_tr_b16 a[220:221], v215 offset:32768
    v_add_f32 v234, v234, v247
    v_mfma_f32_16x16x32_bf16 v[68:71], a[184:187], v[8:11], v[68:71]
    v_or3_b32 v245, v245, v182, v183
    v_cvt_pk_bf16_f32 v176, v224, v225
    v_mfma_f32_16x16x32_bf16 v[76:79], a[184:187], v[24:27], v[76:79]
    ds_read_b64_tr_b16 a[222:223], v215 offset:40960
    v_add_f32 v233, v233, v232
    v_mfma_f32_16x16x32_bf16 v[84:87], a[184:187], v[40:43], v[84:87]
    v_exp_f32 v251, v135
    v_mfma_f32_16x16x32_bf16 v[92:95], a[184:187], v[56:59], v[92:95]
    v_add_f32 v232, v224, v225
    v_cvt_pk_bf16_f32 v177, v226, v227
    v_mfma_f32_16x16x32_bf16 v[100:103], a[184:187], a[232:235], v[100:103]
    v_exp_f32 v224, v120
    v_mfma_f32_16x16x32_bf16 v[68:71], a[188:191], v[12:15], v[68:71]
    s_add_u32 m0, s41, 32768
    v_exp_f32 v225, v121
    v_mfma_f32_16x16x32_bf16 v[76:79], a[188:191], v[28:31], v[76:79]
    s_add_u32 s40, s40, 131072
    v_add_f32 v247, v226, v227
    v_add_f32 v232, v232, v247
    v_mfma_f32_16x16x32_bf16 v[84:87], a[188:191], v[44:47], v[84:87]
    s_add_u32 s63, s63, 131072
    v_exp_f32 v226, v122
    v_mfma_f32_16x16x32_bf16 v[92:95], a[188:191], v[60:63], v[92:95]
    s_waitcnt vmcnt(8) lgkmcnt(0)
    v_exp_f32 v227, v123
    v_mfma_f32_16x16x32_bf16 v[100:103], a[188:191], a[236:239], v[100:103]
    s_barrier
    v_mfma_f32_16x16x32_bf16 a[0:3], a[192:195], v[144:147], 0
    ds_read_b128 a[160:163], v204 offset:49152
    v_or3_b32 v245, v245, v176, v177
    v_mfma_f32_16x16x32_bf16 a[32:35], a[192:195], v[148:151], 0
    v_cvt_pk_bf16_f32 v178, v248, v249
    v_add_f32 v247, v248, v249
    v_mfma_f32_16x16x32_bf16 a[64:67], a[192:195], v[152:155], 0
    v_exp_f32 v248, v124
    v_mfma_f32_16x16x32_bf16 a[96:99], a[192:195], v[156:159], 0
    ds_read_b128 a[164:167], v205 offset:49152
    v_add_f32 v232, v232, v247
    v_mfma_f32_16x16x32_bf16 a[128:131], a[192:195], v[160:163], 0
    v_exp_f32 v249, v125
    v_mfma_f32_16x16x32_bf16 a[4:7], a[196:199], v[144:147], 0
    v_cvt_pk_bf16_f32 v179, v250, v251
    v_add_f32 v247, v250, v251
    v_mfma_f32_16x16x32_bf16 a[36:39], a[196:199], v[148:151], 0
    buffer_load_dwordx4 v218, s[20:23], s40 offen lds
    v_add_f32 v232, v232, v247
    v_mfma_f32_16x16x32_bf16 a[68:71], a[196:199], v[152:155], 0
    v_exp_f32 v250, v126
    v_mfma_f32_16x16x32_bf16 a[100:103], a[196:199], v[156:159], 0
    v_exp_f32 v251, v127
    v_mfma_f32_16x16x32_bf16 a[132:135], a[196:199], v[160:163], 0
    ds_read_b128 a[168:171], v206 offset:49152
    v_or3_b32 v245, v245, v178, v179
    v_mfma_f32_16x16x32_bf16 a[8:11], a[200:203], v[144:147], 0
    v_cvt_pk_bf16_f32 v172, v224, v225
    v_cvt_pk_bf16_f32 v173, v226, v227
    v_mfma_f32_16x16x32_bf16 a[40:43], a[200:203], v[148:151], 0
    v_exp_f32 v224, v112
    v_mfma_f32_16x16x32_bf16 a[72:75], a[200:203], v[152:155], 0
    v_exp_f32 v225, v113
    v_mfma_f32_16x16x32_bf16 a[104:107], a[200:203], v[156:159], 0
    ds_read_b128 a[172:175], v207 offset:49152
    v_or3_b32 v245, v245, v172, v173
    v_mfma_f32_16x16x32_bf16 a[136:139], a[200:203], v[160:163], 0
    v_exp_f32 v226, v114
    v_mfma_f32_16x16x32_bf16 a[12:15], a[204:207], v[144:147], 0
    v_exp_f32 v227, v115
    v_mfma_f32_16x16x32_bf16 a[44:47], a[204:207], v[148:151], 0
    buffer_load_dwordx4 v219, s[20:23], s40 offen offset:1024 lds
    v_cvt_pk_bf16_f32 v174, v248, v249
    v_mfma_f32_16x16x32_bf16 a[76:79], a[204:207], v[152:155], 0
    v_exp_f32 v248, v116
    v_mfma_f32_16x16x32_bf16 a[108:111], a[204:207], v[156:159], 0
    v_cvt_pk_bf16_f32 v175, v250, v251
    v_or3_b32 v245, v245, v174, v175
    v_mfma_f32_16x16x32_bf16 a[140:143], a[204:207], v[160:163], 0
    ds_read_b128 a[176:179], v204 offset:57344
    v_cvt_pk_bf16_f32 v168, v224, v225
    v_mfma_f32_16x16x32_bf16 a[16:19], a[208:211], v[144:147], 0
    v_exp_f32 v249, v117
    v_mfma_f32_16x16x32_bf16 a[48:51], a[208:211], v[148:151], 0
    v_exp_f32 v250, v118
    v_mfma_f32_16x16x32_bf16 a[80:83], a[208:211], v[152:155], 0
    ds_read_b128 a[180:183], v205 offset:57344
    v_cvt_pk_bf16_f32 v169, v226, v227
    v_mfma_f32_16x16x32_bf16 a[112:115], a[208:211], v[156:159], 0
    v_exp_f32 v251, v119
    v_mfma_f32_16x16x32_bf16 a[144:147], a[208:211], v[160:163], 0
    v_or3_b32 v245, v245, v168, v169
    v_cvt_pk_bf16_f32 v170, v248, v249
    v_mfma_f32_16x16x32_bf16 a[20:23], a[212:215], v[144:147], 0
    v_exp_f32 v224, v104
    v_mfma_f32_16x16x32_bf16 a[52:55], a[212:215], v[148:151], 0
    ds_read_b128 a[184:187], v206 offset:57344
    v_cvt_pk_bf16_f32 v171, v250, v251
    v_mfma_f32_16x16x32_bf16 a[84:87], a[212:215], v[152:155], 0
    v_exp_f32 v225, v105
    v_mfma_f32_16x16x32_bf16 a[116:119], a[212:215], v[156:159], 0
    v_exp_f32 v226, v106
    v_mfma_f32_16x16x32_bf16 a[148:151], a[212:215], v[160:163], 0
    buffer_load_dwordx4 v216, s[16:19], s63 offen offset:2048 lds
    v_or3_b32 v245, v245, v170, v171
    v_mfma_f32_16x16x32_bf16 a[24:27], a[216:219], v[144:147], 0
    v_exp_f32 v227, v107
    v_mfma_f32_16x16x32_bf16 a[56:59], a[216:219], v[148:151], 0
    v_exp_f32 v248, v108
    v_mfma_f32_16x16x32_bf16 a[88:91], a[216:219], v[152:155], 0
    ds_read_b128 a[188:191], v207 offset:57344
    v_cvt_pk_bf16_f32 v164, v224, v225
    v_mfma_f32_16x16x32_bf16 a[120:123], a[216:219], v[156:159], 0
    v_exp_f32 v249, v109
    v_mfma_f32_16x16x32_bf16 a[152:155], a[216:219], v[160:163], 0
    v_exp_f32 v250, v110
    v_mfma_f32_16x16x32_bf16 a[28:31], a[220:223], v[144:147], 0
    v_exp_f32 v251, v111
    v_mfma_f32_16x16x32_bf16 a[60:63], a[220:223], v[148:151], 0
    v_cvt_pk_bf16_f32 v165, v226, v227
    v_or3_b32 v245, v245, v164, v165
    v_mfma_f32_16x16x32_bf16 a[92:95], a[220:223], v[152:155], 0
    v_cvt_pk_bf16_f32 v166, v248, v249
    v_cvt_pk_bf16_f32 v167, v250, v251
    v_mfma_f32_16x16x32_bf16 a[124:127], a[220:223], v[156:159], 0
    buffer_load_dwordx4 v217, s[16:19], s63 offen offset:3072 lds
    v_or3_b32 v245, v245, v166, v167
    v_mfma_f32_16x16x32_bf16 a[156:159], a[220:223], v[160:163], 0
    s_sub_u32 s42, s42, 1
    v_and_b32 v244, 0x40004000, v245
    v_cmp_ne_u32 vcc, 0, v244
    v_mfma_f32_16x16x32_bf16 a[240:243], v[228:231], v[144:147], 0
    s_waitcnt lgkmcnt(0)
    v_mfma_f32_16x16x32_bf16 a[244:247], v[228:231], v[148:151], 0
    v_mfma_f32_16x16x32_bf16 a[248:251], v[228:231], v[152:155], 0
    s_cbranch_vccnz Lrare_t5p1
Lback_t5p1:
Lsloop5:
    v_mfma_f32_16x16x32_bf16 v[104:107], a[160:163], v[0:3], v[184:187]
    ds_read_b64_tr_b16 a[192:193], v208 offset:49152
    v_mfma_f32_16x16x32_bf16 v[112:115], a[160:163], v[16:19], v[188:191]
    v_exp_f32 v224, v96
    v_mfma_f32_16x16x32_bf16 v[120:123], a[160:163], v[32:35], v[192:195]
    ds_read_b64_tr_b16 a[194:195], v208 offset:57344
    v_mfma_f32_16x16x32_bf16 v[128:131], a[160:163], v[48:51], v[196:199]
    v_exp_f32 v225, v97
    v_mfma_f32_16x16x32_bf16 v[136:139], a[160:163], a[224:227], v[200:203]
    ds_read_b64_tr_b16 a[196:197], v209 offset:49152
    v_cvt_pk_bf16_f32 v160, v224, v225
    v_mfma_f32_16x16x32_bf16 v[104:107], a[164:167], v[4:7], v[104:107]
    v_exp_f32 v226, v98
    v_mfma_f32_16x16x32_bf16 v[112:115], a[164:167], v[20:23], v[112:115]
    ds_read_b64_tr_b16 a[198:199], v209 offset:57344
    v_add_f32 v235, v235, v234
    v_mfma_f32_16x16x32_bf16 v[120:123], a[164:167], v[36:39], v[120:123]
    v_exp_f32 v227, v99
    v_mfma_f32_16x16x32_bf16 v[128:131], a[164:167], v[52:55], v[128:131]
    ds_read_b64_tr_b16 a[200:201], v210 offset:49152
    v_add_f32 v234, v224, v225
    v_mfma_f32_16x16x32_bf16 v[136:139], a[164:167], a[228:231], v[136:139]
    v_exp_f32 v248, v100
    v_mfma_f32_16x16x32_bf16 v[104:107], a[168:171], v[8:11], v[104:107]
    ds_read_b64_tr_b16 a[202:203], v210 offset:57344
    v_cvt_pk_bf16_f32 v161, v226, v227
    v_mfma_f32_16x16x32_bf16 v[112:115], a[168:171], v[24:27], v[112:115]
    v_exp_f32 v249, v101
    v_mfma_f32_16x16x32_bf16 v[120:123], a[168:171], v[40:43], v[120:123]
    ds_read_b64_tr_b16 a[204:205], v211 offset:49152
    v_add_f32 v247, v226, v227
    v_mfma_f32_16x16x32_bf16 v[128:131], a[168:171], v[56:59], v[128:131]
    v_exp_f32 v250, v102
    v_mfma_f32_16x16x32_bf16 v[136:139], a[168:171], a[232:235], v[136:139]
    ds_read_b64_tr_b16 a[206:207], v211 offset:57344
    v_add_f32 v234, v234, v247
    v_mfma_f32_16x16x32_bf16 v[104:107], a[172:175], v[12:15], v[104:107]
    v_exp_f32 v251, v103
    v_mfma_f32_16x16x32_bf16 v[112:115], a[172:175], v[28:31], v[112:115]
    v_exp_f32 v224, v88
    v_mfma_f32_16x16x32_bf16 v[120:123], a[172:175], v[44:47], v[120:123]
    ds_read_b64_tr_b16 a[208:209], v212 offset:49152
    v_or_b32 v245, v160, v161
    v_mfma_f32_16x16x32_bf16 v[128:131], a[172:175], v[60:63], v[128:131]
    v_exp_f32 v225, v89
    v_mfma_f32_16x16x32_bf16 v[136:139], a[172:175], a[236:239], v[136:139]
    ds_read_b64_tr_b16 a[210:211], v212 offset:57344
    v_cvt_pk_bf16_f32 v162, v248, v249
    v_mfma_f32_16x16x32_bf16 v[108:111], a[176:179], v[0:3], v[184:187]
    v_exp_f32 v226, v90
    v_mfma_f32_16x16x32_bf16 v[116:119], a[176:179], v[16:19], v[188:191]
    ds_read_b64_tr_b16 a[212:213], v213 offset:49152
    v_add_f32 v247, v248, v249
    v_mfma_f32_16x16x32_bf16 v[124:127], a[176:179], v[32:35], v[192:195]
    v_exp_f32 v227, v91
    v_mfma_f32_16x16x32_bf16 v[132:135], a[176:179], v[48:51], v[196:199]
    ds_read_b64_tr_b16 a[214:215], v213 offset:57344
    v_add_f32 v234, v234, v247
    v_mfma_f32_16x16x32_bf16 v[140:143], a[176:179], a[224:227], v[200:203]
    v_exp_f32 v248, v92
    v_mfma_f32_16x16x32_bf16 v[108:111], a[180:183], v[4:7], v[108:111]
    ds_read_b64_tr_b16 a[216:217], v214 offset:49152
    v_cvt_pk_bf16_f32 v163, v250, v251
    v_mfma_f32_16x16x32_bf16 v[116:119], a[180:183], v[20:23], v[116:119]
    v_exp_f32 v249, v93
    v_mfma_f32_16x16x32_bf16 v[124:127], a[180:183], v[36:39], v[124:127]
    ds_read_b64_tr_b16 a[218:219], v214 offset:57344
    v_add_f32 v247, v250, v251
    v_mfma_f32_16x16x32_bf16 v[132:135], a[180:183], v[52:55], v[132:135]
    v_exp_f32 v250, v94
    v_mfma_f32_16x16x32_bf16 v[140:143], a[180:183], a[228:231], v[140:143]
    ds_read_b64_tr_b16 a[220:221], v215 offset:49152
    v_add_f32 v234, v234, v247
    v_mfma_f32_16x16x32_bf16 v[108:111], a[184:187], v[8:11], v[108:111]
    v_or3_b32 v245, v245, v162, v163
    v_cvt_pk_bf16_f32 v156, v224, v225
    v_mfma_f32_16x16x32_bf16 v[116:119], a[184:187], v[24:27], v[116:119]
    ds_read_b64_tr_b16 a[222:223], v215 offset:57344
    v_add_f32 v233, v233, v232
    v_mfma_f32_16x16x32_bf16 v[124:127], a[184:187], v[40:43], v[124:127]
    v_exp_f32 v251, v95
    v_mfma_f32_16x16x32_bf16 v[132:135], a[184:187], v[56:59], v[132:135]
    v_add_f32 v232, v224, v225
    v_cvt_pk_bf16_f32 v157, v226, v227
    v_mfma_f32_16x16x32_bf16 v[140:143], a[184:187], a[232:235], v[140:143]
    v_exp_f32 v224, v80
    v_mfma_f32_16x16x32_bf16 v[108:111], a[188:191], v[12:15], v[108:111]
    s_add_u32 m0, s41, 49152
    v_exp_f32 v225, v81
    v_mfma_f32_16x16x32_bf16 v[116:119], a[188:191], v[28:31], v[116:119]
    s_add_u32 s40, s40, 131072
    v_add_f32 v247, v226, v227
    v_add_f32 v232, v232, v247
    v_mfma_f32_16x16x32_bf16 v[124:127], a[188:191], v[44:47], v[124:127]
    s_add_u32 s63, s63, 131072
    v_exp_f32 v226, v82
    v_mfma_f32_16x16x32_bf16 v[132:135], a[188:191], v[60:63], v[132:135]
    s_waitcnt vmcnt(8) lgkmcnt(0)
    v_exp_f32 v227, v83
    v_mfma_f32_16x16x32_bf16 v[140:143], a[188:191], a[236:239], v[140:143]
    s_barrier
    v_mfma_f32_16x16x32_bf16 a[0:3], a[192:195], v[164:167], a[0:3]
    ds_read_b128 a[160:163], v204 offset:0
    v_or3_b32 v245, v245, v156, v157
    v_mfma_f32_16x16x32_bf16 a[32:35], a[192:195], v[168:171], a[32:35]
    v_cvt_pk_bf16_f32 v158, v248, v249
    v_add_f32 v247, v248, v249
    v_mfma_f32_16x16x32_bf16 a[64:67], a[192:195], v[172:175], a[64:67]
    v_exp_f32 v248, v84
    v_mfma_f32_16x16x32_bf16 a[96:99], a[192:195], v[176:179], a[96:99]
    ds_read_b128 a[164:167], v205 offset:0
    v_add_f32 v232, v232, v247
    v_mfma_f32_16x16x32_bf16 a[128:131], a[192:195], v[180:183], a[128:131]
    v_exp_f32 v249, v85
    v_mfma_f32_16x16x32_bf16 a[4:7], a[196:199], v[164:167], a[4:7]
    v_cvt_pk_bf16_f32 v159, v250, v251
    v_add_f32 v247, v250, v251
    v_mfma_f32_16x16x32_bf16 a[36:39], a[196:199], v[168:171], a[36:39]
    buffer_load_dwordx4 v218, s[20:23], s40 offen lds
    v_add_f32 v232, v232, v247
    v_mfma_f32_16x16x32_bf16 a[68:71], a[196:199], v[172:175], a[68:71]
    v_exp_f32 v250, v86
    v_mfma_f32_16x16x32_bf16 a[100:103], a[196:199], v[176:179], a[100:103]
    v_exp_f32 v251, v87
    v_mfma_f32_16x16x32_bf16 a[132:135], a[196:199], v[180:183], a[132:135]
    ds_read_b128 a[168:171], v206 offset:0
    v_or3_b32 v245, v245, v158, v159
    v_mfma_f32_16x16x32_bf16 a[8:11], a[200:203], v[164:167], a[8:11]
    v_cvt_pk_bf16_f32 v152, v224, v225
    v_cvt_pk_bf16_f32 v153, v226, v227
    v_mfma_f32_16x16x32_bf16 a[40:43], a[200:203], v[168:171], a[40:43]
    v_exp_f32 v224, v72
    v_mfma_f32_16x16x32_bf16 a[72:75], a[200:203], v[172:175], a[72:75]
    v_exp_f32 v225, v73
    v_mfma_f32_16x16x32_bf16 a[104:107], a[200:203], v[176:179], a[104:107]
    ds_read_b128 a[172:175], v207 offset:0
    v_or3_b32 v245, v245, v152, v153
    v_mfma_f32_16x16x32_bf16 a[136:139], a[200:203], v[180:183], a[136:139]
    v_exp_f32 v226, v74
    v_mfma_f32_16x16x32_bf16 a[12:15], a[204:207], v[164:167], a[12:15]
    v_exp_f32 v227, v75
    v_mfma_f32_16x16x32_bf16 a[44:47], a[204:207], v[168:171], a[44:47]
    buffer_load_dwordx4 v219, s[20:23], s40 offen offset:1024 lds
    v_cvt_pk_bf16_f32 v154, v248, v249
    v_mfma_f32_16x16x32_bf16 a[76:79], a[204:207], v[172:175], a[76:79]
    v_exp_f32 v248, v76
    v_mfma_f32_16x16x32_bf16 a[108:111], a[204:207], v[176:179], a[108:111]
    v_cvt_pk_bf16_f32 v155, v250, v251
    v_or3_b32 v245, v245, v154, v155
    v_mfma_f32_16x16x32_bf16 a[140:143], a[204:207], v[180:183], a[140:143]
    ds_read_b128 a[176:179], v204 offset:8192
    v_cvt_pk_bf16_f32 v148, v224, v225
    v_mfma_f32_16x16x32_bf16 a[16:19], a[208:211], v[164:167], a[16:19]
    v_exp_f32 v249, v77
    v_mfma_f32_16x16x32_bf16 a[48:51], a[208:211], v[168:171], a[48:51]
    v_exp_f32 v250, v78
    v_mfma_f32_16x16x32_bf16 a[80:83], a[208:211], v[172:175], a[80:83]
    ds_read_b128 a[180:183], v205 offset:8192
    v_cvt_pk_bf16_f32 v149, v226, v227
    v_mfma_f32_16x16x32_bf16 a[112:115], a[208:211], v[176:179], a[112:115]
    v_exp_f32 v251, v79
    v_mfma_f32_16x16x32_bf16 a[144:147], a[208:211], v[180:183], a[144:147]
    v_or3_b32 v245, v245, v148, v149
    v_cvt_pk_bf16_f32 v150, v248, v249
    v_mfma_f32_16x16x32_bf16 a[20:23], a[212:215], v[164:167], a[20:23]
    v_exp_f32 v224, v64
    v_mfma_f32_16x16x32_bf16 a[52:55], a[212:215], v[168:171], a[52:55]
    ds_read_b128 a[184:187], v206 offset:8192
    v_cvt_pk_bf16_f32 v151, v250, v251
    v_mfma_f32_16x16x32_bf16 a[84:87], a[212:215], v[172:175], a[84:87]
    v_exp_f32 v225, v65
    v_mfma_f32_16x16x32_bf16 a[116:119], a[212:215], v[176:179], a[116:119]
    v_exp_f32 v226, v66
    v_mfma_f32_16x16x32_bf16 a[148:151], a[212:215], v[180:183], a[148:151]
    buffer_load_dwordx4 v216, s[16:19], s63 offen offset:2048 lds
    v_or3_b32 v245, v245, v150, v151
    v_mfma_f32_16x16x32_bf16 a[24:27], a[216:219], v[164:167], a[24:27]
    v_exp_f32 v227, v67
    v_mfma_f32_16x16x32_bf16 a[56:59], a[216:219], v[168:171], a[56:59]
    v_exp_f32 v248, v68
    v_mfma_f32_16x16x32_bf16 a[88:91], a[216:219], v[172:175], a[88:91]
    ds_read_b128 a[188:191], v207 offset:8192
    v_cvt_pk_bf16_f32 v144, v224, v225
    v_mfma_f32_16x16x32_bf16 a[120:123], a[216:219], v[176:179], a[120:123]
    v_exp_f32 v249, v69
    v_mfma_f32_16x16x32_bf16 a[152:155], a[216:219], v[180:183], a[152:155]
    v_exp_f32 v250, v70
    v_mfma_f32_16x16x32_bf16 a[28:31], a[220:223], v[164:167], a[28:31]
    v_exp_f32 v251, v71
    v_mfma_f32_16x16x32_bf16 a[60:63], a[220:223], v[168:171], a[60:63]
    v_cvt_pk_bf16_f32 v145, v226, v227
    v_or3_b32 v245, v245, v144, v145
    v_mfma_f32_16x16x32_bf16 a[92:95], a[220:223], v[172:175], a[92:95]
    v_cvt_pk_bf16_f32 v146, v248, v249
    v_cvt_pk_bf16_f32 v147, v250, v251
    v_mfma_f32_16x16x32_bf16 a[124:127], a[220:223], v[176:179], a[124:127]
    buffer_load_dwordx4 v217, s[16:19], s63 offen offset:3072 lds
    v_or3_b32 v245, v245, v146, v147
    v_mfma_f32_16x16x32_bf16 a[156:159], a[220:223], v[180:183], a[156:159]
    s_sub_u32 s42, s42, 1
    v_and_b32 v244, 0x40004000, v245
    v_cmp_ne_u32 vcc, 0, v244
    v_mfma_f32_16x16x32_bf16 a[240:243], v[228:231], v[164:167], a[240:243]
    s_waitcnt lgkmcnt(0)
    v_mfma_f32_16x16x32_bf16 a[244:247], v[228:231], v[168:171], a[244:247]
    s_cselect_b64 vcc, -1, vcc
    v_mfma_f32_16x16x32_bf16 a[248:251], v[228:231], v[172:175], a[248:251]
    s_cbranch_vccnz Lx5_2
Lxb5_2:
    v_mfma_f32_16x16x32_bf16 v[64:67], a[160:163], v[0:3], v[184:187]
    ds_read_b64_tr_b16 a[192:193], v208 offset:0
    v_mfma_f32_16x16x32_bf16 v[72:75], a[160:163], v[16:19], v[188:191]
    v_exp_f32 v224, v136
    v_mfma_f32_16x16x32_bf16 v[80:83], a[160:163], v[32:35], v[192:195]
    ds_read_b64_tr_b16 a[194:195], v208 offset:8192
    v_mfma_f32_16x16x32_bf16 v[88:91], a[160:163], v[48:51], v[196:199]
    v_exp_f32 v225, v137
    v_mfma_f32_16x16x32_bf16 v[96:99], a[160:163], a[224:227], v[200:203]
    ds_read_b64_tr_b16 a[196:197], v209 offset:0
    v_cvt_pk_bf16_f32 v180, v224, v225
    v_mfma_f32_16x16x32_bf16 v[64:67], a[164:167], v[4:7], v[64:67]
    v_exp_f32 v226, v138
    v_mfma_f32_16x16x32_bf16 v[72:75], a[164:167], v[20:23], v[72:75]
    ds_read_b64_tr_b16 a[198:199], v209 offset:8192
    v_add_f32 v235, v235, v234
    v_mfma_f32_16x16x32_bf16 v[80:83], a[164:167], v[36:39], v[80:83]
    v_exp_f32 v227, v139
    v_mfma_f32_16x16x32_bf16 v[88:91], a[164:167], v[52:55], v[88:91]
    ds_read_b64_tr_b16 a[200:201], v210 offset:0
    v_add_f32 v234, v224, v225
    v_mfma_f32_16x16x32_bf16 v[96:99], a[164:167], a[228:231], v[96:99]
    v_exp_f32 v248, v140
    v_mfma_f32_16x16x32_bf16 v[64:67], a[168:171], v[8:11], v[64:67]
    ds_read_b64_tr_b16 a[202:203], v210 offset:8192
    v_cvt_pk_bf16_f32 v181, v226, v227
    v_mfma_f32_16x16x32_bf16 v[72:75], a[168:171], v[24:27], v[72:75]
    v_exp_f32 v249, v141
    v_mfma_f32_16x16x32_bf16 v[80:83], a[168:171], v[40:43], v[80:83]
    ds_read_b64_tr_b16 a[204:205], v211 offset:0
    v_add_f32 v247, v226, v227
    v_mfma_f32_16x16x32_bf16 v[88:91], a[168:171], v[56:59], v[88:91]
    v_exp_f32 v250, v142
    v_mfma_f32_16x16x32_bf16 v[96:99], a[168:171], a[232:235], v[96:99]
    ds_read_b64_tr_b16 a[206:207], v211 offset:8192
    v_add_f32 v234, v234, v247
    v_mfma_f32_16x16x32_bf16 v[64:67], a[172:175], v[12:15], v[64:67]
    v_exp_f32 v251, v143
    v_mfma_f32_16x16x32_bf16 v[72:75], a[172:175], v[28:31], v[72:75]
    v_exp_f32 v224, v128
    v_mfma_f32_16x16x32_bf16 v[80:83], a[172:175], v[44:47], v[80:83]
    ds_read_b64_tr_b16 a[208:209], v212 offset:0
    v_or_b32 v245, v180, v181
    v_mfma_f32_16x16x32_bf16 v[88:91], a[172:175], v[60:63], v[88:91]
    v_exp_f32 v225, v129
    v_mfma_f32_16x16x32_bf16 v[96:99], a[172:175], a[236:239], v[96:99]
    ds_read_b64_tr_b16 a[210:211], v212 offset:8192
    v_cvt_pk_bf16_f32 v182, v248, v249
    v_mfma_f32_16x16x32_bf16 v[68:71], a[176:179], v[0:3], v[184:187]
    v_exp_f32 v226, v130
    v_mfma_f32_16x16x32_bf16 v[76:79], a[176:179], v[16:19], v[188:191]
    ds_read_b64_tr_b16 a[212:213], v213 offset:0
    v_add_f32 v247, v248, v249
    v_mfma_f32_16x16x32_bf16 v[84:87], a[176:179], v[32:35], v[192:195]
    v_exp_f32 v227, v131
    v_mfma_f32_16x16x32_bf16 v[92:95], a[176:179], v[48:51], v[196:199]
    ds_read_b64_tr_b16 a[214:215], v213 offset:8192
    v_add_f32 v234, v234, v247
    v_mfma_f32_16x16x32_bf16 v[100:103], a[176:179], a[224:227], v[200:203]
    v_exp_f32 v248, v132
    v_mfma_f32_16x16x32_bf16 v[68:71], a[180:183], v[4:7], v[68:71]
    ds_read_b64_tr_b16 a[216:217], v214 offset:0
    v_cvt_pk_bf16_f32 v183, v250, v251
    v_mfma_f32_16x16x32_bf16 v[76:79], a[180:183], v[20:23], v[76:79]
    v_exp_f32 v249, v133
    v_mfma_f32_16x16x32_bf16 v[84:87], a[180:183], v[36:39], v[84:87]
    ds_read_b64_tr_b16 a[218:219], v214 offset:8192
    v_add_f32 v247, v250, v251
    v_mfma_f32_16x16x32_bf16 v[92:95], a[180:183], v[52:55], v[92:95]
    v_exp_f32 v250, v134
    v_mfma_f32_16x16x32_bf16 v[100:103], a[180:183], a[228:231], v[100:103]
    ds_read_b64_tr_b16 a[220:221], v215 offset:0
    v_add_f32 v234, v234, v247
    v_mfma_f32_16x16x32_bf16 v[68:71], a[184:187], v[8:11], v[68:71]
    v_or3_b32 v245, v245, v182, v183
    v_cvt_pk_bf16_f32 v176, v224, v225
    v_mfma_f32_16x16x32_bf16 v[76:79], a[184:187], v[24:27], v[76:79]
    ds_read_b64_tr_b16 a[222:223], v215 offset:8192
    v_add_f32 v233, v233, v232
    v_mfma_f32_16x16x32_bf16 v[84:87], a[184:187], v[40:43], v[84:87]
    v_exp_f32 v251, v135
    v_mfma_f32_16x16x32_bf16 v[92:95], a[184:187], v[56:59], v[92:95]
    v_add_f32 v232, v224, v225
    v_cvt_pk_bf16_f32 v177, v226, v227
    v_mfma_f32_16x16x32_bf16 v[100:103], a[184:187], a[232:235], v[100:103]
    v_exp_f32 v224, v120
    v_mfma_f32_16x16x32_bf16 v[68:71], a[188:191], v[12:15], v[68:71]
    s_mov_b32 m0, s41
    v_exp_f32 v225, v121
    v_mfma_f32_16x16x32_bf16 v[76:79], a[188:191], v[28:31], v[76:79]
    s_add_u32 s40, s40, 131072
    v_add_f32 v247, v226, v227
    v_add_f32 v232, v232, v247
    v_mfma_f32_16x16x32_bf16 v[84:87], a[188:191], v[44:47], v[84:87]
    s_add_u32 s63, s63, 131072
    v_exp_f32 v226, v122
    v_mfma_f32_16x16x32_bf16 v[92:95], a[188:191], v[60:63], v[92:95]
    s_waitcnt vmcnt(8) lgkmcnt(0)
    v_exp_f32 v227, v123
    v_mfma_f32_16x16x32_bf16 v[100:103], a[188:191], a[236:239], v[100:103]
    s_barrier
    v_mfma_f32_16x16x32_bf16 a[0:3], a[192:195], v[144:147], a[0:3]
    ds_read_b128 a[160:163], v204 offset:16384
    v_or3_b32 v245, v245, v176, v177
    v_mfma_f32_16x16x32_bf16 a[32:35], a[192:195], v[148:151], a[32:35]
    v_cvt_pk_bf16_f32 v178, v248, v249
    v_add_f32 v247, v248, v249
    v_mfma_f32_16x16x32_bf16 a[64:67], a[192:195], v[152:155], a[64:67]
    v_exp_f32 v248, v124
    v_mfma_f32_16x16x32_bf16 a[96:99], a[192:195], v[156:159], a[96:99]
    ds_read_b128 a[164:167], v205 offset:16384
    v_add_f32 v232, v232, v247
    v_mfma_f32_16x16x32_bf16 a[128:131], a[192:195], v[160:163], a[128:131]
    v_exp_f32 v249, v125
    v_mfma_f32_16x16x32_bf16 a[4:7], a[196:199], v[144:147], a[4:7]
    v_cvt_pk_bf16_f32 v179, v250, v251
    v_add_f32 v247, v250, v251
    v_mfma_f32_16x16x32_bf16 a[36:39], a[196:199], v[148:151], a[36:39]
    buffer_load_dwordx4 v218, s[20:23], s40 offen lds
    v_add_f32 v232, v232, v247
    v_mfma_f32_16x16x32_bf16 a[68:71], a[196:199], v[152:155], a[68:71]
    v_exp_f32 v250, v126
    v_mfma_f32_16x16x32_bf16 a[100:103], a[196:199], v[156:159], a[100:103]
    v_exp_f32 v251, v127
    v_mfma_f32_16x16x32_bf16 a[132:135], a[196:199], v[160:163], a[132:135]
    ds_read_b128 a[168:171], v206 offset:16384
    v_or3_b32 v245, v245, v178, v179
    v_mfma_f32_16x16x32_bf16 a[8:11], a[200:203], v[144:147], a[8:11]
    v_cvt_pk_bf16_f32 v172, v224, v225
    v_cvt_pk_bf16_f32 v173, v226, v227
    v_mfma_f32_16x16x32_bf16 a[40:43], a[200:203], v[148:151], a[40:43]
    v_exp_f32 v224, v112
    v_mfma_f32_16x16x32_bf16 a[72:75], a[200:203], v[152:155], a[72:75]
    v_exp_f32 v225, v113
    v_mfma_f32_16x16x32_bf16 a[104:107], a[200:203], v[156:159], a[104:107]
    ds_read_b128 a[172:175], v207 offset:16384
    v_or3_b32 v245, v245, v172, v173
    v_mfma_f32_16x16x32_bf16 a[136:139], a[200:203], v[160:163], a[136:139]
    v_exp_f32 v226, v114
    v_mfma_f32_16x16x32_bf16 a[12:15], a[204:207], v[144:147], a[12:15]
    v_exp_f32 v227, v115
    v_mfma_f32_16x16x32_bf16 a[44:47], a[204:207], v[148:151], a[44:47]
    buffer_load_dwordx4 v219, s[20:23], s40 offen offset:1024 lds
    v_cvt_pk_bf16_f32 v174, v248, v249
    v_mfma_f32_16x16x32_bf16 a[76:79], a[204:207], v[152:155], a[76:79]
    v_exp_f32 v248, v116
    v_mfma_f32_16x16x32_bf16 a[108:111], a[204:207], v[156:159], a[108:111]
    v_cvt_pk_bf16_f32 v175, v250, v251
    v_or3_b32 v245, v245, v174, v175
    v_mfma_f32_16x16x32_bf16 a[140:143], a[204:207], v[160:163], a[140:143]
    ds_read_b128 a[176:179], v204 offset:24576
    v_cvt_pk_bf16_f32 v168, v224, v225
    v_mfma_f32_16x16x32_bf16 a[16:19], a[208:211], v[144:147], a[16:19]
    v_exp_f32 v249, v117
    v_mfma_f32_16x16x32_bf16 a[48:51], a[208:211], v[148:151], a[48:51]
    v_exp_f32 v250, v118
    v_mfma_f32_16x16x32_bf16 a[80:83], a[208:211], v[152:155], a[80:83]
    ds_read_b128 a[180:183], v205 offset:24576
    v_cvt_pk_bf16_f32 v169, v226, v227
    v_mfma_f32_16x16x32_bf16 a[112:115], a[208:211], v[156:159], a[112:115]
    v_exp_f32 v251, v119
    v_mfma_f32_16x16x32_bf16 a[144:147], a[208:211], v[160:163], a[144:147]
    v_or3_b32 v245, v245, v168, v169
    v_cvt_pk_bf16_f32 v170, v248, v249
    v_mfma_f32_16x16x32_bf16 a[20:23], a[212:215], v[144:147], a[20:23]
    v_exp_f32 v224, v104
    v_mfma_f32_16x16x32_bf16 a[52:55], a[212:215], v[148:151], a[52:55]
    ds_read_b128 a[184:187], v206 offset:24576
    v_cvt_pk_bf16_f32 v171, v250, v251
    v_mfma_f32_16x16x32_bf16 a[84:87], a[212:215], v[152:155], a[84:87]
    v_exp_f32 v225, v105
    v_mfma_f32_16x16x32_bf16 a[116:119], a[212:215], v[156:159], a[116:119]
    v_exp_f32 v226, v106
    v_mfma_f32_16x16x32_bf16 a[148:151], a[212:215], v[160:163], a[148:151]
    buffer_load_dwordx4 v216, s[16:19], s63 offen offset:2048 lds
    v_or3_b32 v245, v245, v170, v171
    v_mfma_f32_16x16x32_bf16 a[24:27], a[216:219], v[144:147], a[24:27]
    v_exp_f32 v227, v107
    v_mfma_f32_16x16x32_bf16 a[56:59], a[216:219], v[148:151], a[56:59]
    v_exp_f32 v248, v108
    v_mfma_f32_16x16x32_bf16 a[88:91], a[216:219], v[152:155], a[88:91]
    ds_read_b128 a[188:191], v207 offset:24576
    v_cvt_pk_bf16_f32 v164, v224, v225
    v_mfma_f32_16x16x32_bf16 a[120:123], a[216:219], v[156:159], a[120:123]
    v_exp_f32 v249, v109
    v_mfma_f32_16x16x32_bf16 a[152:155], a[216:219], v[160:163], a[152:155]
    v_exp_f32 v250, v110
    v_mfma_f32_16x16x32_bf16 a[28:31], a[220:223], v[144:147], a[28:31]
    v_exp_f32 v251, v111
    v_mfma_f32_16x16x32_bf16 a[60:63], a[220:223], v[148:151], a[60:63]
    v_cvt_pk_bf16_f32 v165, v226, v227
    v_or3_b32 v245, v245, v164, v165
    v_mfma_f32_16x16x32_bf16 a[92:95], a[220:223], v[152:155], a[92:95]
    v_cvt_pk_bf16_f32 v166, v248, v249
    v_cvt_pk_bf16_f32 v167, v250, v251
    v_mfma_f32_16x16x32_bf16 a[124:127], a[220:223], v[156:159], a[124:127]
    buffer_load_dwordx4 v217, s[16:19], s63 offen offset:3072 lds
    v_or3_b32 v245, v245, v166, v167
    v_mfma_f32_16x16x32_bf16 a[156:159], a[220:223], v[160:163], a[156:159]
    s_sub_u32 s42, s42, 1
    v_and_b32 v244, 0x40004000, v245
    v_cmp_ne_u32 vcc, 0, v244
    v_mfma_f32_16x16x32_bf16 a[240:243], v[228:231], v[144:147], a[240:243]
    s_waitcnt lgkmcnt(0)
    v_mfma_f32_16x16x32_bf16 a[244:247], v[228:231], v[148:151], a[244:247]
    s_cselect_b64 vcc, -1, vcc
    v_mfma_f32_16x16x32_bf16 a[248:251], v[228:231], v[152:155], a[248:251]
    s_cbranch_vccnz Lx5_3
Lxb5_3:
    v_mfma_f32_16x16x32_bf16 v[104:107], a[160:163], v[0:3], v[184:187]
    ds_read_b64_tr_b16 a[192:193], v208 offset:16384
    v_mfma_f32_16x16x32_bf16 v[112:115], a[160:163], v[16:19], v[188:191]
    v_exp_f32 v224, v96
    v_mfma_f32_16x16x32_bf16 v[120:123], a[160:163], v[32:35], v[192:195]
    ds_read_b64_tr_b16 a[194:195], v208 offset:24576
    v_mfma_f32_16x16x32_bf16 v[128:131], a[160:163], v[48:51], v[196:199]
    v_exp_f32 v225, v97
    v_mfma_f32_16x16x32_bf16 v[136:139], a[160:163], a[224:227], v[200:203]
    ds_read_b64_tr_b16 a[196:197], v209 offset:16384
    v_cvt_pk_bf16_f32 v160, v224, v225
    v_mfma_f32_16x16x32_bf16 v[104:107], a[164:167], v[4:7], v[104:107]
    v_exp_f32 v226, v98
    v_mfma_f32_16x16x32_bf16 v[112:115], a[164:167], v[20:23], v[112:115]
    ds_read_b64_tr_b16 a[198:199], v209 offset:24576
    v_add_f32 v235, v235, v234
    v_mfma_f32_16x16x32_bf16 v[120:123], a[164:167], v[36:39], v[120:123]
    v_exp_f32 v227, v99
    v_mfma_f32_16x16x32_bf16 v[128:131], a[164:167], v[52:55], v[128:131]
    ds_read_b64_tr_b16 a[200:201], v210 offset:16384
    v_add_f32 v234, v224, v225
    v_mfma_f32_16x16x32_bf16 v[136:139], a[164:167], a[228:231], v[136:139]
    v_exp_f32 v248, v100
    v_mfma_f32_16x16x32_bf16 v[104:107], a[168:171], v[8:11], v[104:107]
    ds_read_b64_tr_b16 a[202:203], v210 offset:24576
    v_cvt_pk_bf16_f32 v161, v226, v227
    v_mfma_f32_16x16x32_bf16 v[112:115], a[168:171], v[24:27], v[112:115]
    v_exp_f32 v249, v101
    v_mfma_f32_16x16x32_bf16 v[120:123], a[168:171], v[40:43], v[120:123]
    ds_read_b64_tr_b16 a[204:205], v211 offset:16384
    v_add_f32 v247, v226, v227
    v_mfma_f32_16x16x32_bf16 v[128:131], a[168:171], v[56:59], v[128:131]
    v_exp_f32 v250, v102
    v_mfma_f32_16x16x32_bf16 v[136:139], a[168:171], a[232:235], v[136:139]
    ds_read_b64_tr_b16 a[206:207], v211 offset:24576
    v_add_f32 v234, v234, v247
    v_mfma_f32_16x16x32_bf16 v[104:107], a[172:175], v[12:15], v[104:107]
    v_exp_f32 v251, v103
    v_mfma_f32_16x16x32_bf16 v[112:115], a[172:175], v[28:31], v[112:115]
    v_exp_f32 v224, v88
    v_mfma_f32_16x16x32_bf16 v[120:123], a[172:175], v[44:47], v[120:123]
    ds_read_b64_tr_b16 a[208:209], v212 offset:16384
    v_or_b32 v245, v160, v161
    v_mfma_f32_16x16x32_bf16 v[128:131], a[172:175], v[60:63], v[128:131]
    v_exp_f32 v225, v89
    v_mfma_f32_16x16x32_bf16 v[136:139], a[172:175], a[236:239], v[136:139]
    ds_read_b64_tr_b16 a[210:211], v212 offset:24576
    v_cvt_pk_bf16_f32 v162, v248, v249
    v_mfma_f32_16x16x32_bf16 v[108:111], a[176:179], v[0:3], v[184:187]
    v_exp_f32 v226, v90
    v_mfma_f32_16x16x32_bf16 v[116:119], a[176:179], v[16:19], v[188:191]
    ds_read_b64_tr_b16 a[212:213], v213 offset:16384
    v_add_f32 v247, v248, v249
    v_mfma_f32_16x16x32_bf16 v[124:127], a[176:179], v[32:35], v[192:195]
    v_exp_f32 v227, v91
    v_mfma_f32_16x16x32_bf16 v[132:135], a[176:179], v[48:51], v[196:199]
    ds_read_b64_tr_b16 a[214:215], v213 offset:24576
    v_add_f32 v234, v234, v247
    v_mfma_f32_16x16x32_bf16 v[140:143], a[176:179], a[224:227], v[200:203]
    v_exp_f32 v248, v92
    v_mfma_f32_16x16x32_bf16 v[108:111], a[180:183], v[4:7], v[108:111]
    ds_read_b64_tr_b16 a[216:217], v214 offset:16384
    v_cvt_pk_bf16_f32 v163, v250, v251
    v_mfma_f32_16x16x32_bf16 v[116:119], a[180:183], v[20:23], v[116:119]
    v_exp_f32 v249, v93
    v_mfma_f32_16x16x32_bf16 v[124:127], a[180:183], v[36:39], v[124:127]
    ds_read_b64_tr_b16 a[218:219], v214 offset:24576
    v_add_f32 v247, v250, v251
    v_mfma_f32_16x16x32_bf16 v[132:135], a[180:183], v[52:55], v[132:135]
    v_exp_f32 v250, v94
    v_mfma_f32_16x16x32_bf16 v[140:143], a[180:183], a[228:231], v[140:143]
    ds_read_b64_tr_b16 a[220:221], v215 offset:16384
    v_add_f32 v234, v234, v247
    v_mfma_f32_16x16x32_bf16 v[108:111], a[184:187], v[8:11], v[108:111]
    v_or3_b32 v245, v245, v162, v163
    v_cvt_pk_bf16_f32 v156, v224, v225
    v_mfma_f32_16x16x32_bf16 v[116:119], a[184:187], v[24:27], v[116:119]
    ds_read_b64_tr_b16 a[222:223], v215 offset:24576
    v_add_f32 v233, v233, v232
    v_mfma_f32_16x16x32_bf16 v[124:127], a[184:187], v[40:43], v[124:127]
    v_exp_f32 v251, v95
    v_mfma_f32_16x16x32_bf16 v[132:135], a[184:187], v[56:59], v[132:135]
    v_add_f32 v232, v224, v225
    v_cvt_pk_bf16_f32 v157, v226, v227
    v_mfma_f32_16x16x32_bf16 v[140:143], a[184:187], a[232:235], v[140:143]
    v_exp_f32 v224, v80
    v_mfma_f32_16x16x32_bf16 v[108:111], a[188:191], v[12:15], v[108:111]
    s_add_u32 m0, s41, 16384
    v_exp_f32 v225, v81
    v_mfma_f32_16x16x32_bf16 v[116:119], a[188:191], v[28:31], v[116:119]
    s_add_u32 s40, s40, 131072
    v_add_f32 v247, v226, v227
    v_add_f32 v232, v232, v247
    v_mfma_f32_16x16x32_bf16 v[124:127], a[188:191], v[44:47], v[124:127]
    s_add_u32 s63, s63, 131072
    v_exp_f32 v226, v82
    v_mfma_f32_16x16x32_bf16 v[132:135], a[188:191], v[60:63], v[132:135]
    s_waitcnt vmcnt(8) lgkmcnt(0)
    v_exp_f32 v227, v83
    v_mfma_f32_16x16x32_bf16 v[140:143], a[188:191], a[236:239], v[140:143]
    s_barrier
    v_mfma_f32_16x16x32_bf16 a[0:3], a[192:195], v[164:167], a[0:3]
    ds_read_b128 a[160:163], v204 offset:32768
    v_or3_b32 v245, v245, v156, v157
    v_mfma_f32_16x16x32_bf16 a[32:35], a[192:195], v[168:171], a[32:35]
    v_cvt_pk_bf16_f32 v158, v248, v249
    v_add_f32 v247, v248, v249
    v_mfma_f32_16x16x32_bf16 a[64:67], a[192:195], v[172:175], a[64:67]
    v_exp_f32 v248, v84
    v_mfma_f32_16x16x32_bf16 a[96:99], a[192:195], v[176:179], a[96:99]
    ds_read_b128 a[164:167], v205 offset:32768
    v_add_f32 v232, v232, v247
    v_mfma_f32_16x16x32_bf16 a[128:131], a[192:195], v[180:183], a[128:131]
    v_exp_f32 v249, v85
    v_mfma_f32_16x16x32_bf16 a[4:7], a[196:199], v[164:167], a[4:7]
    v_cvt_pk_bf16_f32 v159, v250, v251
    v_add_f32 v247, v250, v251
    v_mfma_f32_16x16x32_bf16 a[36:39], a[196:199], v[168:171], a[36:39]
    buffer_load_dwordx4 v218, s[20:23], s40 offen lds
    v_add_f32 v232, v232, v247
    v_mfma_f32_16x16x32_bf16 a[68:71], a[196:199], v[172:175], a[68:71]
    v_exp_f32 v250, v86
    v_mfma_f32_16x16x32_bf16 a[100:103], a[196:199], v[176:179], a[100:103]
    v_exp_f32 v251, v87
    v_mfma_f32_16x16x32_bf16 a[132:135], a[196:199], v[180:183], a[132:135]
    ds_read_b128 a[168:171], v206 offset:32768
    v_or3_b32 v245, v245, v158, v159
    v_mfma_f32_16x16x32_bf16 a[8:11], a[200:203], v[164:167], a[8:11]
    v_cvt_pk_bf16_f32 v152, v224, v225
    v_cvt_pk_bf16_f32 v153, v226, v227
    v_mfma_f32_16x16x32_bf16 a[40:43], a[200:203], v[168:171], a[40:43]
    v_exp_f32 v224, v72
    v_mfma_f32_16x16x32_bf16 a[72:75], a[200:203], v[172:175], a[72:75]
    v_exp_f32 v225, v73
    v_mfma_f32_16x16x32_bf16 a[104:107], a[200:203], v[176:179], a[104:107]
    ds_read_b128 a[172:175], v207 offset:32768
    v_or3_b32 v245, v245, v152, v153
    v_mfma_f32_16x16x32_bf16 a[136:139], a[200:203], v[180:183], a[136:139]
    v_exp_f32 v226, v74
    v_mfma_f32_16x16x32_bf16 a[12:15], a[204:207], v[164:167], a[12:15]
    v_exp_f32 v227, v75
    v_mfma_f32_16x16x32_bf16 a[44:47], a[204:207], v[168:171], a[44:47]
    buffer_load_dwordx4 v219, s[20:23], s40 offen offset:1024 lds
    v_cvt_pk_bf16_f32 v154, v248, v249
    v_mfma_f32_16x16x32_bf16 a[76:79], a[204:207], v[172:175], a[76:79]
    v_exp_f32 v248, v76
    v_mfma_f32_16x16x32_bf16 a[108:111], a[204:207], v[176:179], a[108:111]
    v_cvt_pk_bf16_f32 v155, v250, v251
    v_or3_b32 v245, v245, v154, v155
    v_mfma_f32_16x16x32_bf16 a[140:143], a[204:207], v[180:183], a[140:143]
    ds_read_b128 a[176:179], v204 offset:40960
    v_cvt_pk_bf16_f32 v148, v224, v225
    v_mfma_f32_16x16x32_bf16 a[16:19], a[208:211], v[164:167], a[16:19]
    v_exp_f32 v249, v77
    v_mfma_f32_16x16x32_bf16 a[48:51], a[208:211], v[168:171], a[48:51]
    v_exp_f32 v250, v78
    v_mfma_f32_16x16x32_bf16 a[80:83], a[208:211], v[172:175], a[80:83]
    ds_read_b128 a[180:183], v205 offset:40960
    v_cvt_pk_bf16_f32 v149, v226, v227
    v_mfma_f32_16x16x32_bf16 a[112:115], a[208:211], v[176:179], a[112:115]
    v_exp_f32 v251, v79
    v_mfma_f32_16x16x32_bf16 a[144:147], a[208:211], v[180:183], a[144:147]
    v_or3_b32 v245, v245, v148, v149
    v_cvt_pk_bf16_f32 v150, v248, v249
    v_mfma_f32_16x16x32_bf16 a[20:23], a[212:215], v[164:167], a[20:23]
    v_exp_f32 v224, v64
    v_mfma_f32_16x16x32_bf16 a[52:55], a[212:215], v[168:171], a[52:55]
    ds_read_b128 a[184:187], v206 offset:40960
    v_cvt_pk_bf16_f32 v151, v250, v251
    v_mfma_f32_16x16x32_bf16 a[84:87], a[212:215], v[172:175], a[84:87]
    v_exp_f32 v225, v65
    v_mfma_f32_16x16x32_bf16 a[116:119], a[212:215], v[176:179], a[116:119]
    v_exp_f32 v226, v66
    v_mfma_f32_16x16x32_bf16 a[148:151], a[212:215], v[180:183], a[148:151]
    buffer_load_dwordx4 v216, s[16:19], s63 offen offset:2048 lds
    v_or3_b32 v245, v245, v150, v151
    v_mfma_f32_16x16x32_bf16 a[24:27], a[216:219], v[164:167], a[24:27]
    v_exp_f32 v227, v67
    v_mfma_f32_16x16x32_bf16 a[56:59], a[216:219], v[168:171], a[56:59]
    v_exp_f32 v248, v68
    v_mfma_f32_16x16x32_bf16 a[88:91], a[216:219], v[172:175], a[88:91]
    ds_read_b128 a[188:191], v207 offset:40960
    v_cvt_pk_bf16_f32 v144, v224, v225
    v_mfma_f32_16x16x32_bf16 a[120:123], a[216:219], v[176:179], a[120:123]
    v_exp_f32 v249, v69
    v_mfma_f32_16x16x32_bf16 a[152:155], a[216:219], v[180:183], a[152:155]
    v_exp_f32 v250, v70
    v_mfma_f32_16x16x32_bf16 a[28:31], a[220:223], v[164:167], a[28:31]
    v_exp_f32 v251, v71
    v_mfma_f32_16x16x32_bf16 a[60:63], a[220:223], v[168:171], a[60:63]
    v_cvt_pk_bf16_f32 v145, v226, v227
    v_or3_b32 v245, v245, v144, v145
    v_mfma_f32_16x16x32_bf16 a[92:95], a[220:223], v[172:175], a[92:95]
    v_cvt_pk_bf16_f32 v146, v248, v249
    v_cvt_pk_bf16_f32 v147, v250, v251
    v_mfma_f32_16x16x32_bf16 a[124:127], a[220:223], v[176:179], a[124:127]
    buffer_load_dwordx4 v217, s[16:19], s63 offen offset:3072 lds
    v_or3_b32 v245, v245, v146, v147
    v_mfma_f32_16x16x32_bf16 a[156:159], a[220:223], v[180:183], a[156:159]
    s_sub_u32 s42, s42, 1
    v_and_b32 v244, 0x40004000, v245
    v_cmp_ne_u32 vcc, 0, v244
    v_mfma_f32_16x16x32_bf16 a[240:243], v[228:231], v[164:167], a[240:243]
    s_waitcnt lgkmcnt(0)
    v_mfma_f32_16x16x32_bf16 a[244:247], v[228:231], v[168:171], a[244:247]
    s_cselect_b64 vcc, -1, vcc
    v_mfma_f32_16x16x32_bf16 a[248:251], v[228:231], v[172:175], a[248:251]
    s_cbranch_vccnz Lx5_0
Lxb5_0:
    v_mfma_f32_16x16x32_bf16 v[64:67], a[160:163], v[0:3], v[184:187]
    ds_read_b64_tr_b16 a[192:193], v208 offset:32768
    v_mfma_f32_16x16x32_bf16 v[72:75], a[160:163], v[16:19], v[188:191]
    v_exp_f32 v224, v136
    v_mfma_f32_16x16x32_bf16 v[80:83], a[160:163], v[32:35], v[192:195]
    ds_read_b64_tr_b16 a[194:195], v208 offset:40960
    v_mfma_f32_16x16x32_bf16 v[88:91], a[160:163], v[48:51], v[196:199]
    v_exp_f32 v225, v137
    v_mfma_f32_16x16x32_bf16 v[96:99], a[160:163], a[224:227], v[200:203]
    ds_read_b64_tr_b16 a[196:197], v209 offset:32768
    v_cvt_pk_bf16_f32 v180, v224, v225
    v_mfma_f32_16x16x32_bf16 v[64:67], a[164:167], v[4:7], v[64:67]
    v_exp_f32 v226, v138
    v_mfma_f32_16x16x32_bf16 v[72:75], a[164:167], v[20:23], v[72:75]
    ds_read_b64_tr_b16 a[198:199], v209 offset:40960
    v_add_f32 v235, v235, v234
    v_mfma_f32_16x16x32_bf16 v[80:83], a[164:167], v[36:39], v[80:83]
    v_exp_f32 v227, v139
    v_mfma_f32_16x16x32_bf16 v[88:91], a[164:167], v[52:55], v[88:91]
    ds_read_b64_tr_b16 a[200:201], v210 offset:32768
    v_add_f32 v234, v224, v225
    v_mfma_f32_16x16x32_bf16 v[96:99], a[164:167], a[228:231], v[96:99]
    v_exp_f32 v248, v140
    v_mfma_f32_16x16x32_bf16 v[64:67], a[168:171], v[8:11], v[64:67]
    ds_read_b64_tr_b16 a[202:203], v210 offset:40960
    v_cvt_pk_bf16_f32 v181, v226, v227
    v_mfma_f32_16x16x32_bf16 v[72:75], a[168:171], v[24:27], v[72:75]
    v_exp_f32 v249, v141
    v_mfma_f32_16x16x32_bf16 v[80:83], a[168:171], v[40:43], v[80:83]
    ds_read_b64_tr_b16 a[204:205], v211 offset:32768
    v_add_f32 v247, v226, v227
    v_mfma_f32_16x16x32_bf16 v[88:91], a[168:171], v[56:59], v[88:91]
    v_exp_f32 v250, v142
    v_mfma_f32_16x16x32_bf16 v[96:99], a[168:171], a[232:235], v[96:99]
    ds_read_b64_tr_b16 a[206:207], v211 offset:40960
    v_add_f32 v234, v234, v247
    v_mfma_f32_16x16x32_bf16 v[64:67], a[172:175], v[12:15], v[64:67]
    v_exp_f32 v251, v143
    v_mfma_f32_16x16x32_bf16 v[72:75], a[172:175], v[28:31], v[72:75]
    v_exp_f32 v224, v128
    v_mfma_f32_16x16x32_bf16 v[80:83], a[172:175], v[44:47], v[80:83]
    ds_read_b64_tr_b16 a[208:209], v212 offset:32768
    v_or_b32 v245, v180, v181
    v_mfma_f32_16x16x32_bf16 v[88:91], a[172:175], v[60:63], v[88:91]
    v_exp_f32 v225, v129
    v_mfma_f32_16x16x32_bf16 v[96:99], a[172:175], a[236:239], v[96:99]
    ds_read_b64_tr_b16 a[210:211], v212 offset:40960
    v_cvt_pk_bf16_f32 v182, v248, v249
    v_mfma_f32_16x16x32_bf16 v[68:71], a[176:179], v[0:3], v[184:187]
    v_exp_f32 v226, v130
    v_mfma_f32_16x16x32_bf16 v[76:79], a[176:179], v[16:19], v[188:191]
    ds_read_b64_tr_b16 a[212:213], v213 offset:32768
    v_add_f32 v247, v248, v249
    v_mfma_f32_16x16x32_bf16 v[84:87], a[176:179], v[32:35], v[192:195]
    v_exp_f32 v227, v131
    v_mfma_f32_16x16x32_bf16 v[92:95], a[176:179], v[48:51], v[196:199]
    ds_read_b64_tr_b16 a[214:215], v213 offset:40960
    v_add_f32 v234, v234, v247
    v_mfma_f32_16x16x32_bf16 v[100:103], a[176:179], a[224:227], v[200:203]
    v_exp_f32 v248, v132
    v_mfma_f32_16x16x32_bf16 v[68:71], a[180:183], v[4:7], v[68:71]
    ds_read_b64_tr_b16 a[216:217], v214 offset:32768
    v_cvt_pk_bf16_f32 v183, v250, v251
    v_mfma_f32_16x16x32_bf16 v[76:79], a[180:183], v[20:23], v[76:79]
    v_exp_f32 v249, v133
    v_mfma_f32_16x16x32_bf16 v[84:87], a[180:183], v[36:39], v[84:87]
    ds_read_b64_tr_b16 a[218:219], v214 offset:40960
    v_add_f32 v247, v250, v251
    v_mfma_f32_16x16x32_bf16 v[92:95], a[180:183], v[52:55], v[92:95]
    v_exp_f32 v250, v134
    v_mfma_f32_16x16x32_bf16 v[100:103], a[180:183], a[228:231], v[100:103]
    ds_read_b64_tr_b16 a[220:221], v215 offset:32768
    v_add_f32 v234, v234, v247
    v_mfma_f32_16x16x32_bf16 v[68:71], a[184:187], v[8:11], v[68:71]
    v_or3_b32 v245, v245, v182, v183
    v_cvt_pk_bf16_f32 v176, v224, v225
    v_mfma_f32_16x16x32_bf16 v[76:79], a[184:187], v[24:27], v[76:79]
    ds_read_b64_tr_b16 a[222:223], v215 offset:40960
    v_add_f32 v233, v233, v232
    v_mfma_f32_16x16x32_bf16 v[84:87], a[184:187], v[40:43], v[84:87]
    v_exp_f32 v251, v135
    v_mfma_f32_16x16x32_bf16 v[92:95], a[184:187], v[56:59], v[92:95]
    v_add_f32 v232, v224, v225
    v_cvt_pk_bf16_f32 v177, v226, v227
    v_mfma_f32_16x16x32_bf16 v[100:103], a[184:187], a[232:235], v[100:103]
    v_exp_f32 v224, v120
    v_mfma_f32_16x16x32_bf16 v[68:71], a[188:191], v[12:15], v[68:71]
    s_add_u32 m0, s41, 32768
    v_exp_f32 v225, v121
    v_mfma_f32_16x16x32_bf16 v[76:79], a[188:191], v[28:31], v[76:79]
    s_add_u32 s40, s40, 131072
    v_add_f32 v247, v226, v227
    v_add_f32 v232, v232, v247
    v_mfma_f32_16x16x32_bf16 v[84:87], a[188:191], v[44:47], v[84:87]
    s_add_u32 s63, s63, 131072
    v_exp_f32 v226, v122
    v_mfma_f32_16x16x32_bf16 v[92:95], a[188:191], v[60:63], v[92:95]
    s_waitcnt vmcnt(8) lgkmcnt(0)
    v_exp_f32 v227, v123
    v_mfma_f32_16x16x32_bf16 v[100:103], a[188:191], a[236:239], v[100:103]
    s_barrier
    v_mfma_f32_16x16x32_bf16 a[0:3], a[192:195], v[144:147], a[0:3]
    ds_read_b128 a[160:163], v204 offset:49152
    v_or3_b32 v245, v245, v176, v177
    v_mfma_f32_16x16x32_bf16 a[32:35], a[192:195], v[148:151], a[32:35]
    v_cvt_pk_bf16_f32 v178, v248, v249
    v_add_f32 v247, v248, v249
    v_mfma_f32_16x16x32_bf16 a[64:67], a[192:195], v[152:155], a[64:67]
    v_exp_f32 v248, v124
    v_mfma_f32_16x16x32_bf16 a[96:99], a[192:195], v[156:159], a[96:99]
    ds_read_b128 a[164:167], v205 offset:49152
    v_add_f32 v232, v232, v247
    v_mfma_f32_16x16x32_bf16 a[128:131], a[192:195], v[160:163], a[128:131]
    v_exp_f32 v249, v125
    v_mfma_f32_16x16x32_bf16 a[4:7], a[196:199], v[144:147], a[4:7]
    v_cvt_pk_bf16_f32 v179, v250, v251
    v_add_f32 v247, v250, v251
    v_mfma_f32_16x16x32_bf16 a[36:39], a[196:199], v[148:151], a[36:39]
    buffer_load_dwordx4 v218, s[20:23], s40 offen lds
    v_add_f32 v232, v232, v247
    v_mfma_f32_16x16x32_bf16 a[68:71], a[196:199], v[152:155], a[68:71]
    v_exp_f32 v250, v126
    v_mfma_f32_16x16x32_bf16 a[100:103], a[196:199], v[156:159], a[100:103]
    v_exp_f32 v251, v127
    v_mfma_f32_16x16x32_bf16 a[132:135], a[196:199], v[160:163], a[132:135]
    ds_read_b128 a[168:171], v206 offset:49152
    v_or3_b32 v245, v245, v178, v179
    v_mfma_f32_16x16x32_bf16 a[8:11], a[200:203], v[144:147], a[8:11]
    v_cvt_pk_bf16_f32 v172, v224, v225
    v_cvt_pk_bf16_f32 v173, v226, v227
    v_mfma_f32_16x16x32_bf16 a[40:43], a[200:203], v[148:151], a[40:43]
    v_exp_f32 v224, v112
    v_mfma_f32_16x16x32_bf16 a[72:75], a[200:203], v[152:155], a[72:75]
    v_exp_f32 v225, v113
    v_mfma_f32_16x16x32_bf16 a[104:107], a[200:203], v[156:159], a[104:107]
    ds_read_b128 a[172:175], v207 offset:49152
    v_or3_b32 v245, v245, v172, v173
    v_mfma_f32_16x16x32_bf16 a[136:139], a[200:203], v[160:163], a[136:139]
    v_exp_f32 v226, v114
    v_mfma_f32_16x16x32_bf16 a[12:15], a[204:207], v[144:147], a[12:15]
    v_exp_f32 v227, v115
    v_mfma_f32_16x16x32_bf16 a[44:47], a[204:207], v[148:151], a[44:47]
    buffer_load_dwordx4 v219, s[20:23], s40 offen offset:1024 lds
    v_cvt_pk_bf16_f32 v174, v248, v249
    v_mfma_f32_16x16x32_bf16 a[76:79], a[204:207], v[152:155], a[76:79]
    v_exp_f32 v248, v116
    v_mfma_f32_16x16x32_bf16 a[108:111], a[204:207], v[156:159], a[108:111]
    v_cvt_pk_bf16_f32 v175, v250, v251
    v_or3_b32 v245, v245, v174, v175
    v_mfma_f32_16x16x32_bf16 a[140:143], a[204:207], v[160:163], a[140:143]
    ds_read_b128 a[176:179], v204 offset:57344
    v_cvt_pk_bf16_f32 v168, v224, v225
    v_mfma_f32_16x16x32_bf16 a[16:19], a[208:211], v[144:147], a[16:19]
    v_exp_f32 v249, v117
    v_mfma_f32_16x16x32_bf16 a[48:51], a[208:211], v[148:151], a[48:51]
    v_exp_f32 v250, v118
    v_mfma_f32_16x16x32_bf16 a[80:83], a[208:211], v[152:155], a[80:83]
    ds_read_b128 a[180:183], v205 offset:57344
    v_cvt_pk_bf16_f32 v169, v226, v227
    v_mfma_f32_16x16x32_bf16 a[112:115], a[208:211], v[156:159], a[112:115]
    v_exp_f32 v251, v119
    v_mfma_f32_16x16x32_bf16 a[144:147], a[208:211], v[160:163], a[144:147]
    v_or3_b32 v245, v245, v168, v169
    v_cvt_pk_bf16_f32 v170, v248, v249
    v_mfma_f32_16x16x32_bf16 a[20:23], a[212:215], v[144:147], a[20:23]
    v_exp_f32 v224, v104
    v_mfma_f32_16x16x32_bf16 a[52:55], a[212:215], v[148:151], a[52:55]
    ds_read_b128 a[184:187], v206 offset:57344
    v_cvt_pk_bf16_f32 v171, v250, v251
    v_mfma_f32_16x16x32_bf16 a[84:87], a[212:215], v[152:155], a[84:87]
    v_exp_f32 v225, v105
    v_mfma_f32_16x16x32_bf16 a[116:119], a[212:215], v[156:159], a[116:119]
    v_exp_f32 v226, v106
    v_mfma_f32_16x16x32_bf16 a[148:151], a[212:215], v[160:163], a[148:151]
    buffer_load_dwordx4 v216, s[16:19], s63 offen offset:2048 lds
    v_or3_b32 v245, v245, v170, v171
    v_mfma_f32_16x16x32_bf16 a[24:27], a[216:219], v[144:147], a[24:27]
    v_exp_f32 v227, v107
    v_mfma_f32_16x16x32_bf16 a[56:59], a[216:219], v[148:151], a[56:59]
    v_exp_f32 v248, v108
    v_mfma_f32_16x16x32_bf16 a[88:91], a[216:219], v[152:155], a[88:91]
    ds_read_b128 a[188:191], v207 offset:57344
    v_cvt_pk_bf16_f32 v164, v224, v225
    v_mfma_f32_16x16x32_bf16 a[120:123], a[216:219], v[156:159], a[120:123]
    v_exp_f32 v249, v109
    v_mfma_f32_16x16x32_bf16 a[152:155], a[216:219], v[160:163], a[152:155]
    v_exp_f32 v250, v110
    v_mfma_f32_16x16x32_bf16 a[28:31], a[220:223], v[144:147], a[28:31]
    v_exp_f32 v251, v111
    v_mfma_f32_16x16x32_bf16 a[60:63], a[220:223], v[148:151], a[60:63]
    v_cvt_pk_bf16_f32 v165, v226, v227
    v_or3_b32 v245, v245, v164, v165
    v_mfma_f32_16x16x32_bf16 a[92:95], a[220:223], v[152:155], a[92:95]
    v_cvt_pk_bf16_f32 v166, v248, v249
    v_cvt_pk_bf16_f32 v167, v250, v251
    v_mfma_f32_16x16x32_bf16 a[124:127], a[220:223], v[156:159], a[124:127]
    buffer_load_dwordx4 v217, s[16:19], s63 offen offset:3072 lds
    v_or3_b32 v245, v245, v166, v167
    v_mfma_f32_16x16x32_bf16 a[156:159], a[220:223], v[160:163], a[156:159]
    s_sub_u32 s42, s42, 1
    v_and_b32 v244, 0x40004000, v245
    v_cmp_ne_u32 vcc, 0, v244
    v_mfma_f32_16x16x32_bf16 a[240:243], v[228:231], v[144:147], a[240:243]
    s_waitcnt lgkmcnt(0)
    v_mfma_f32_16x16x32_bf16 a[244:247], v[228:231], v[148:151], a[244:247]
    s_cselect_b64 vcc, -1, vcc
    v_mfma_f32_16x16x32_bf16 a[248:251], v[228:231], v[152:155], a[248:251]
    s_cbranch_vccnz Lx5_1
Lxb5_1:
    s_branch Lsloop5
Lx5_0:
    v_cmp_ne_u32 vcc, 0, v244
    s_cbranch_vccnz Lrare_x5_0
Lback_x5_0:
    s_branch Lxb5_0
Lx5_1:
    v_cmp_ne_u32 vcc, 0, v244
    s_cbranch_vccnz Lrare_x5_1
Lback_x5_1:
    s_branch Lxb5_1
Lx5_2:
    v_cmp_ne_u32 vcc, 0, v244
    s_cbranch_vccnz Lrare_x5_2
Lback_x5_2:
    s_branch Lxb5_2
Lx5_3:
    v_cmp_ne_u32 vcc, 0, v244
    s_cbranch_vccnz Lrare_x5_3
Lback_x5_3:
    s_cbranch_scc1 Lxs5_3
    s_branch Lxb5_3
Lxs5_3:
Ltail5_0_0:
    v_mfma_f32_16x16x32_bf16 a[240:243], v[228:231], v[164:167], a[240:243]
    ds_read_b64_tr_b16 a[192:193], v208 offset:16384
    v_mfma_f32_16x16x32_bf16 a[244:247], v[228:231], v[168:171], a[244:247]
    ds_read_b64_tr_b16 a[194:195], v208 offset:24576
    v_mfma_f32_16x16x32_bf16 a[248:251], v[228:231], v[172:175], a[248:251]
    ds_read_b64_tr_b16 a[196:197], v209 offset:16384
    ds_read_b64_tr_b16 a[198:199], v209 offset:24576
    ds_read_b64_tr_b16 a[200:201], v210 offset:16384
    ds_read_b64_tr_b16 a[202:203], v210 offset:24576
    ds_read_b64_tr_b16 a[204:205], v211 offset:16384
    ds_read_b64_tr_b16 a[206:207], v211 offset:24576
    ds_read_b64_tr_b16 a[208:209], v212 offset:16384
    ds_read_b64_tr_b16 a[210:211], v212 offset:24576
    ds_read_b64_tr_b16 a[212:213], v213 offset:16384
    ds_read_b64_tr_b16 a[214:215], v213 offset:24576
    ds_read_b64_tr_b16 a[216:217], v214 offset:16384
    ds_read_b64_tr_b16 a[218:219], v214 offset:24576
    ds_read_b64_tr_b16 a[220:221], v215 offset:16384
    ds_read_b64_tr_b16 a[222:223], v215 offset:24576
    v_accvgpr_read_b32 v252, a240
    v_accvgpr_read_b32 v253, a244
    v_accvgpr_read_b32 v254, a248
    v_add_f32 v255, v232, v233
    v_add_f32 v246, v234, v235
    v_max3_f32 v237, v252, v253, v254
    v_max3_f32 v237, v237, v255, v246
    v_cmp_le_f32 vcc, s66, v237
    v_exp_f32 v224, v96
    v_exp_f32 v225, v97
    s_cmp_lg_u64 vcc, 0
    s_cselect_b32 s61, 1, 0
    s_andn2_b32 s61, s61, s65
    v_mov_b32 v237, s61
    ds_write_b32 v239, v237 offset:16384
    v_exp_f32 v226, v98
    v_exp_f32 v227, v99
    v_cvt_pk_bf16_f32 v160, v224, v225
    v_add_f32 v235, v235, v234
    v_add_f32 v234, v224, v225
    v_exp_f32 v248, v100
    v_exp_f32 v249, v101
    v_cvt_pk_bf16_f32 v161, v226, v227
    v_add_f32 v247, v226, v227
    v_add_f32 v234, v234, v247
    v_or_b32 v245, v160, v161
    v_exp_f32 v250, v102
    v_exp_f32 v251, v103
    v_cvt_pk_bf16_f32 v162, v248, v249
    v_add_f32 v247, v248, v249
    v_add_f32 v234, v234, v247
    s_waitcnt vmcnt(8) lgkmcnt(0)
    s_barrier
    v_mfma_f32_16x16x32_bf16 a[0:3], a[192:195], v[164:167], a[0:3]
    ds_read_b32 v237, v236
    v_cvt_pk_bf16_f32 v163, v250, v251
    v_add_f32 v247, v250, v251
    v_mfma_f32_16x16x32_bf16 a[32:35], a[192:195], v[168:171], a[32:35]
    v_exp_f32 v224, v88
    v_add_f32 v234, v234, v247
    v_mfma_f32_16x16x32_bf16 a[64:67], a[192:195], v[172:175], a[64:67]
    ds_read_b64_tr_b16 a[160:161], v208 offset:32768
    v_or3_b32 v245, v245, v162, v163
    v_exp_f32 v225, v89
    v_mfma_f32_16x16x32_bf16 a[96:99], a[192:195], v[176:179], a[96:99]
    v_exp_f32 v226, v90
    v_cvt_pk_bf16_f32 v156, v224, v225
    v_mfma_f32_16x16x32_bf16 a[128:131], a[192:195], v[180:183], a[128:131]
    ds_read_b64_tr_b16 a[162:163], v208 offset:40960
    v_add_f32 v233, v233, v232
    v_add_f32 v232, v224, v225
    v_mfma_f32_16x16x32_bf16 a[4:7], a[196:199], v[164:167], a[4:7]
    v_exp_f32 v227, v91
    v_exp_f32 v248, v92
    v_mfma_f32_16x16x32_bf16 a[36:39], a[196:199], v[168:171], a[36:39]
    ds_read_b64_tr_b16 a[164:165], v209 offset:32768
    v_cvt_pk_bf16_f32 v157, v226, v227
    v_add_f32 v247, v226, v227
    v_mfma_f32_16x16x32_bf16 a[68:71], a[196:199], v[172:175], a[68:71]
    v_exp_f32 v249, v93
    v_add_f32 v232, v232, v247
    v_mfma_f32_16x16x32_bf16 a[100:103], a[196:199], v[176:179], a[100:103]
    ds_read_b64_tr_b16 a[166:167], v209 offset:40960
    v_or3_b32 v245, v245, v156, v157
    v_cvt_pk_bf16_f32 v158, v248, v249
    v_mfma_f32_16x16x32_bf16 a[132:135], a[196:199], v[180:183], a[132:135]
    v_exp_f32 v250, v94
    v_add_f32 v247, v248, v249
    v_mfma_f32_16x16x32_bf16 a[8:11], a[200:203], v[164:167], a[8:11]
    v_exp_f32 v251, v95
    v_add_f32 v232, v232, v247
    v_mfma_f32_16x16x32_bf16 a[40:43], a[200:203], v[168:171], a[40:43]
    ds_read_b64_tr_b16 a[168:169], v210 offset:32768
    v_cvt_pk_bf16_f32 v159, v250, v251
    v_add_f32 v247, v250, v251
    v_mfma_f32_16x16x32_bf16 a[72:75], a[200:203], v[172:175], a[72:75]
    v_exp_f32 v224, v80
    v_add_f32 v232, v232, v247
    v_mfma_f32_16x16x32_bf16 a[104:107], a[200:203], v[176:179], a[104:107]
    ds_read_b64_tr_b16 a[170:171], v210 offset:40960
    v_or3_b32 v245, v245, v158, v159
    v_exp_f32 v225, v81
    v_mfma_f32_16x16x32_bf16 a[136:139], a[200:203], v[180:183], a[136:139]
    v_exp_f32 v226, v82
    v_cvt_pk_bf16_f32 v152, v224, v225
    v_mfma_f32_16x16x32_bf16 a[12:15], a[204:207], v[164:167], a[12:15]
    ds_read_b64_tr_b16 a[172:173], v211 offset:32768
    v_exp_f32 v227, v83
    v_mfma_f32_16x16x32_bf16 a[44:47], a[204:207], v[168:171], a[44:47]
    v_exp_f32 v248, v84
    v_cvt_pk_bf16_f32 v153, v226, v227
    v_mfma_f32_16x16x32_bf16 a[76:79], a[204:207], v[172:175], a[76:79]
    ds_read_b64_tr_b16 a[174:175], v211 offset:40960
    v_or3_b32 v245, v245, v152, v153
    v_exp_f32 v249, v85
    v_mfma_f32_16x16x32_bf16 a[108:111], a[204:207], v[176:179], a[108:111]
    v_exp_f32 v250, v86
    v_cvt_pk_bf16_f32 v154, v248, v249
    v_mfma_f32_16x16x32_bf16 a[140:143], a[204:207], v[180:183], a[140:143]
    v_exp_f32 v251, v87
    v_exp_f32 v224, v72
    v_mfma_f32_16x16x32_bf16 a[16:19], a[208:211], v[164:167], a[16:19]
    ds_read_b64_tr_b16 a[176:177], v212 offset:32768
    v_cvt_pk_bf16_f32 v155, v250, v251
    v_or3_b32 v245, v245, v154, v155
    v_mfma_f32_16x16x32_bf16 a[48:51], a[208:211], v[168:171], a[48:51]
    v_exp_f32 v225, v73
    v_exp_f32 v226, v74
    v_mfma_f32_16x16x32_bf16 a[80:83], a[208:211], v[172:175], a[80:83]
    ds_read_b64_tr_b16 a[178:179], v212 offset:40960
    v_cvt_pk_bf16_f32 v148, v224, v225
    v_exp_f32 v227, v75
    v_mfma_f32_16x16x32_bf16 a[112:115], a[208:211], v[176:179], a[112:115]
    v_exp_f32 v248, v76
    v_cvt_pk_bf16_f32 v149, v226, v227
    v_mfma_f32_16x16x32_bf16 a[144:147], a[208:211], v[180:183], a[144:147]
    ds_read_b64_tr_b16 a[180:181], v213 offset:32768
    v_or3_b32 v245, v245, v148, v149
    v_exp_f32 v249, v77
    v_mfma_f32_16x16x32_bf16 a[20:23], a[212:215], v[164:167], a[20:23]
    v_exp_f32 v250, v78
    v_mfma_f32_16x16x32_bf16 a[52:55], a[212:215], v[168:171], a[52:55]
    ds_read_b64_tr_b16 a[182:183], v213 offset:40960
    v_cvt_pk_bf16_f32 v150, v248, v249
    v_mfma_f32_16x16x32_bf16 a[84:87], a[212:215], v[172:175], a[84:87]
    v_exp_f32 v251, v79
    v_mfma_f32_16x16x32_bf16 a[116:119], a[212:215], v[176:179], a[116:119]
    v_exp_f32 v224, v64
    v_cvt_pk_bf16_f32 v151, v250, v251
    v_mfma_f32_16x16x32_bf16 a[148:151], a[212:215], v[180:183], a[148:151]
    ds_read_b64_tr_b16 a[184:185], v214 offset:32768
    v_or3_b32 v245, v245, v150, v151
    v_mfma_f32_16x16x32_bf16 a[24:27], a[216:219], v[164:167], a[24:27]
    v_exp_f32 v225, v65
    v_exp_f32 v226, v66
    v_mfma_f32_16x16x32_bf16 a[56:59], a[216:219], v[168:171], a[56:59]
    ds_read_b64_tr_b16 a[186:187], v214 offset:40960
    v_cvt_pk_bf16_f32 v144, v224, v225
    v_mfma_f32_16x16x32_bf16 a[88:91], a[216:219], v[172:175], a[88:91]
    v_exp_f32 v227, v67
    v_mfma_f32_16x16x32_bf16 a[120:123], a[216:219], v[176:179], a[120:123]
    ds_read_b64_tr_b16 a[188:189], v215 offset:32768
    v_cvt_pk_bf16_f32 v145, v226, v227
    v_mfma_f32_16x16x32_bf16 a[152:155], a[216:219], v[180:183], a[152:155]
    v_exp_f32 v248, v68
    v_or3_b32 v245, v245, v144, v145
    v_mfma_f32_16x16x32_bf16 a[28:31], a[220:223], v[164:167], a[28:31]
    ds_read_b64_tr_b16 a[190:191], v215 offset:40960
    v_exp_f32 v249, v69
    v_mfma_f32_16x16x32_bf16 a[60:63], a[220:223], v[168:171], a[60:63]
    v_exp_f32 v250, v70
    v_mfma_f32_16x16x32_bf16 a[92:95], a[220:223], v[172:175], a[92:95]
    v_exp_f32 v251, v71
    v_mfma_f32_16x16x32_bf16 a[124:127], a[220:223], v[176:179], a[124:127]
    v_cvt_pk_bf16_f32 v146, v248, v249
    v_cvt_pk_bf16_f32 v147, v250, v251
    v_or3_b32 v245, v245, v146, v147
    v_mfma_f32_16x16x32_bf16 a[156:159], a[220:223], v[180:183], a[156:159]
    v_and_b32 v244, 0x40004000, v245
    v_cmp_ne_u32 vcc, 0, v244
    s_cbranch_vccnz Lrare_t5t0_0
Lback_t5t0_0:
    s_waitcnt lgkmcnt(8)
    v_cmp_ne_u32 vcc, 0, v237
    s_cbranch_vccnz Lrestart
    v_mfma_f32_16x16x32_bf16 a[240:243], v[228:231], v[144:147], a[240:243]
    v_add_f32 v233, v233, v232
    v_add_f32 v235, v235, v234
    v_mov_b32 v250, v233
    v_mfma_f32_16x16x32_bf16 a[244:247], v[228:231], v[148:151], a[244:247]
    v_mov_b32 v251, v235
    s_nop 1
    v_mfma_f32_16x16x32_bf16 a[248:251], v[228:231], v[152:155], a[248:251]
    s_waitcnt lgkmcnt(6)
    v_permlane32_swap_b32 v233, v250
    v_permlane32_swap_b32 v235, v251
    s_nop 1
    v_mfma_f32_16x16x32_bf16 a[0:3], a[160:163], v[144:147], a[0:3]
    v_add_f32 v233, v233, v250
    v_add_f32 v235, v235, v251
    v_mfma_f32_16x16x32_bf16 a[4:7], a[164:167], v[144:147], a[4:7]
    v_mov_b32 v250, v233
    v_mov_b32 v251, v235
    v_mfma_f32_16x16x32_bf16 a[8:11], a[168:171], v[144:147], a[8:11]
    s_nop 1
    v_permlane16_swap_b32 v233, v250
    v_permlane16_swap_b32 v235, v251
    v_mfma_f32_16x16x32_bf16 a[12:15], a[172:175], v[144:147], a[12:15]
    s_nop 1
    v_add_f32 v233, v233, v250
    v_mfma_f32_16x16x32_bf16 a[16:19], a[176:179], v[144:147], a[16:19]
    s_waitcnt lgkmcnt(0)
    v_add_f32 v235, v235, v251
    v_xor_b32 v184, 0, v240
    v_mfma_f32_16x16x32_bf16 a[20:23], a[180:183], v[144:147], a[20:23]
    v_xor_b32 v185, 32, v240
    v_xor_b32 v186, 64, v240
    v_xor_b32 v187, 96, v240
    v_mfma_f32_16x16x32_bf16 a[24:27], a[184:187], v[144:147], a[24:27]
    v_xor_b32 v188, 128, v240
    v_xor_b32 v189, 160, v240
    v_mfma_f32_16x16x32_bf16 a[28:31], a[188:191], v[144:147], a[28:31]
    v_xor_b32 v190, 192, v240
    v_xor_b32 v191, 224, v240
    v_mfma_f32_16x16x32_bf16 a[32:35], a[160:163], v[148:151], a[32:35]
    v_accvgpr_read_b32 v244, a240
    v_accvgpr_read_b32 v245, a244
    v_mfma_f32_16x16x32_bf16 a[36:39], a[164:167], v[148:151], a[36:39]
    v_accvgpr_read_b32 v246, a248
    v_mfma_f32_16x16x32_bf16 a[40:43], a[168:171], v[148:151], a[40:43]
    v_rcp_f32 v192, v244
    v_mfma_f32_16x16x32_bf16 a[44:47], a[172:175], v[148:151], a[44:47]
    v_rcp_f32 v193, v245
    v_mfma_f32_16x16x32_bf16 a[48:51], a[176:179], v[148:151], a[48:51]
    v_rcp_f32 v194, v246
    v_rcp_f32 v195, v233
    v_mfma_f32_16x16x32_bf16 a[52:55], a[180:183], v[148:151], a[52:55]
    v_rcp_f32 v196, v235
    v_mfma_f32_16x16x32_bf16 a[56:59], a[184:187], v[148:151], a[56:59]
    v_accvgpr_read_b32 v0, a0
    v_mfma_f32_16x16x32_bf16 a[60:63], a[188:191], v[148:151], a[60:63]
    v_accvgpr_read_b32 v1, a1
    v_mfma_f32_16x16x32_bf16 a[64:67], a[160:163], v[152:155], a[64:67]
    v_accvgpr_read_b32 v2, a2
    v_accvgpr_read_b32 v3, a3
    v_mfma_f32_16x16x32_bf16 a[68:71], a[164:167], v[152:155], a[68:71]
    v_accvgpr_read_b32 v4, a4
    v_mfma_f32_16x16x32_bf16 a[72:75], a[168:171], v[152:155], a[72:75]
    v_accvgpr_read_b32 v5, a5
    v_mfma_f32_16x16x32_bf16 a[76:79], a[172:175], v[152:155], a[76:79]
    v_accvgpr_read_b32 v6, a6
    v_mfma_f32_16x16x32_bf16 a[80:83], a[176:179], v[152:155], a[80:83]
    v_accvgpr_read_b32 v7, a7
    v_accvgpr_read_b32 v8, a8
    v_mfma_f32_16x16x32_bf16 a[84:87], a[180:183], v[152:155], a[84:87]
    v_accvgpr_read_b32 v9, a9
    v_mfma_f32_16x16x32_bf16 a[88:91], a[184:187], v[152:155], a[88:91]
    v_accvgpr_read_b32 v10, a10
    v_mfma_f32_16x16x32_bf16 a[92:95], a[188:191], v[152:155], a[92:95]
    v_accvgpr_read_b32 v11, a11
    v_mfma_f32_16x16x32_bf16 a[96:99], a[160:163], v[156:159], a[96:99]
    v_accvgpr_read_b32 v12, a12
    v_accvgpr_read_b32 v13, a13
    v_mfma_f32_16x16x32_bf16 a[100:103], a[164:167], v[156:159], a[100:103]
    v_accvgpr_read_b32 v14, a14
    v_mfma_f32_16x16x32_bf16 a[104:107], a[168:171], v[156:159], a[104:107]
    v_accvgpr_read_b32 v15, a15
    v_mfma_f32_16x16x32_bf16 a[108:111], a[172:175], v[156:159], a[108:111]
    v_accvgpr_read_b32 v16, a16
    v_mfma_f32_16x16x32_bf16 a[112:115], a[176:179], v[156:159], a[112:115]
    v_accvgpr_read_b32 v17, a17
    v_accvgpr_read_b32 v18, a18
    v_mfma_f32_16x16x32_bf16 a[116:119], a[180:183], v[156:159], a[116:119]
    v_accvgpr_read_b32 v19, a19
    v_mfma_f32_16x16x32_bf16 a[120:123], a[184:187], v[156:159], a[120:123]
    v_accvgpr_read_b32 v20, a20
    v_mfma_f32_16x16x32_bf16 a[124:127], a[188:191], v[156:159], a[124:127]
    v_accvgpr_read_b32 v21, a21
    v_mfma_f32_16x16x32_bf16 a[128:131], a[160:163], v[160:163], a[128:131]
    v_accvgpr_read_b32 v22, a22
    v_accvgpr_read_b32 v23, a23
    v_mfma_f32_16x16x32_bf16 a[132:135], a[164:167], v[160:163], a[132:135]
    v_accvgpr_read_b32 v24, a24
    v_mfma_f32_16x16x32_bf16 a[136:139], a[168:171], v[160:163], a[136:139]
    v_accvgpr_read_b32 v25, a25
    v_mfma_f32_16x16x32_bf16 a[140:143], a[172:175], v[160:163], a[140:143]
    v_accvgpr_read_b32 v26, a26
    v_mfma_f32_16x16x32_bf16 a[144:147], a[176:179], v[160:163], a[144:147]
    v_accvgpr_read_b32 v27, a27
    v_accvgpr_read_b32 v28, a28
    v_mfma_f32_16x16x32_bf16 a[148:151], a[180:183], v[160:163], a[148:151]
    v_accvgpr_read_b32 v29, a29
    v_mfma_f32_16x16x32_bf16 a[152:155], a[184:187], v[160:163], a[152:155]
    v_accvgpr_read_b32 v30, a30
    v_mfma_f32_16x16x32_bf16 a[156:159], a[188:191], v[160:163], a[156:159]
    v_accvgpr_read_b32 v31, a31
    s_branch Lepi5
Lepi5:
    v_pk_mul_f32 v[0:1], v[0:1], v[192:193] op_sel_hi:[1,0]
    v_pk_mul_f32 v[2:3], v[2:3], v[192:193] op_sel_hi:[1,0]
    v_pk_mul_f32 v[4:5], v[4:5], v[192:193] op_sel_hi:[1,0]
    v_pk_mul_f32 v[6:7], v[6:7], v[192:193] op_sel_hi:[1,0]
    v_cvt_pk_bf16_f32 v32, v0, v1
    v_cvt_pk_bf16_f32 v33, v2, v3
    v_cvt_pk_bf16_f32 v34, v4, v5
    v_cvt_pk_bf16_f32 v35, v6, v7
    ds_write_b64 v184, v[32:33]
    ds_write_b64 v185, v[34:35]
    v_pk_mul_f32 v[8:9], v[8:9], v[192:193] op_sel_hi:[1,0]
    v_pk_mul_f32 v[10:11], v[10:11], v[192:193] op_sel_hi:[1,0]
    v_pk_mul_f32 v[12:13], v[12:13], v[192:193] op_sel_hi:[1,0]
    v_pk_mul_f32 v[14:15], v[14:15], v[192:193] op_sel_hi:[1,0]
    v_cvt_pk_bf16_f32 v36, v8, v9
    v_cvt_pk_bf16_f32 v37, v10, v11
    v_cvt_pk_bf16_f32 v38, v12, v13
    v_cvt_pk_bf16_f32 v39, v14, v15
    ds_write_b64 v186, v[36:37]
    ds_write_b64 v187, v[38:39]
    v_pk_mul_f32 v[16:17], v[16:17], v[192:193] op_sel_hi:[1,0]
    v_pk_mul_f32 v[18:19], v[18:19], v[192:193] op_sel_hi:[1,0]
    v_pk_mul_f32 v[20:21], v[20:21], v[192:193] op_sel_hi:[1,0]
    v_pk_mul_f32 v[22:23], v[22:23], v[192:193] op_sel_hi:[1,0]
    v_cvt_pk_bf16_f32 v40, v16, v17
    v_cvt_pk_bf16_f32 v41, v18, v19
    v_cvt_pk_bf16_f32 v42, v20, v21
    v_cvt_pk_bf16_f32 v43, v22, v23
    ds_write_b64 v188, v[40:41]
    ds_write_b64 v189, v[42:43]
    v_pk_mul_f32 v[24:25], v[24:25], v[192:193] op_sel_hi:[1,0]
    v_pk_mul_f32 v[26:27], v[26:27], v[192:193] op_sel_hi:[1,0]
    v_pk_mul_f32 v[28:29], v[28:29], v[192:193] op_sel_hi:[1,0]
    v_pk_mul_f32 v[30:31], v[30:31], v[192:193] op_sel_hi:[1,0]
    v_cvt_pk_bf16_f32 v44, v24, v25
    v_cvt_pk_bf16_f32 v45, v26, v27
    v_cvt_pk_bf16_f32 v46, v28, v29
    v_cvt_pk_bf16_f32 v47, v30, v31
    ds_write_b64 v190, v[44:45]
    ds_write_b64 v191, v[46:47]
    ds_read_b128 v[64:67], v241 offset:0
    ds_read_b128 v[68:71], v241 offset:1024
    ds_read_b128 v[72:75], v241 offset:2048
    ds_read_b128 v[76:79], v241 offset:3072
    v_accvgpr_read_b32 v0, a32
    v_accvgpr_read_b32 v1, a33
    v_accvgpr_read_b32 v2, a34
    v_accvgpr_read_b32 v3, a35
    v_accvgpr_read_b32 v4, a36
    v_accvgpr_read_b32 v5, a37
    v_accvgpr_read_b32 v6, a38
    v_accvgpr_read_b32 v7, a39
    v_pk_mul_f32 v[0:1], v[0:1], v[192:193] op_sel:[0,1] op_sel_hi:[1,1]
    v_pk_mul_f32 v[2:3], v[2:3], v[192:193] op_sel:[0,1] op_sel_hi:[1,1]
    v_pk_mul_f32 v[4:5], v[4:5], v[192:193] op_sel:[0,1] op_sel_hi:[1,1]
    v_pk_mul_f32 v[6:7], v[6:7], v[192:193] op_sel:[0,1] op_sel_hi:[1,1]
    v_cvt_pk_bf16_f32 v48, v0, v1
    v_cvt_pk_bf16_f32 v49, v2, v3
    v_cvt_pk_bf16_f32 v50, v4, v5
    v_cvt_pk_bf16_f32 v51, v6, v7
    ds_write_b64 v184, v[48:49]
    ds_write_b64 v185, v[50:51]
    v_accvgpr_read_b32 v8, a40
    v_accvgpr_read_b32 v9, a41
    v_accvgpr_read_b32 v10, a42
    v_accvgpr_read_b32 v11, a43
    v_accvgpr_read_b32 v12, a44
    v_accvgpr_read_b32 v13, a45
    v_accvgpr_read_b32 v14, a46
    v_accvgpr_read_b32 v15, a47
    s_add_u32 s61, s56, 0
    s_waitcnt lgkmcnt(2)
    buffer_store_dwordx4 v[64:67], v220, s[24:27], s61 offen offset:0 sc0 sc1
    v_pk_mul_f32 v[8:9], v[8:9], v[192:193] op_sel:[0,1] op_sel_hi:[1,1]
    v_pk_mul_f32 v[10:11], v[10:11], v[192:193] op_sel:[0,1] op_sel_hi:[1,1]
    v_pk_mul_f32 v[12:13], v[12:13], v[192:193] op_sel:[0,1] op_sel_hi:[1,1]
    v_pk_mul_f32 v[14:15], v[14:15], v[192:193] op_sel:[0,1] op_sel_hi:[1,1]
    v_cvt_pk_bf16_f32 v52, v8, v9
    v_cvt_pk_bf16_f32 v53, v10, v11
    v_cvt_pk_bf16_f32 v54, v12, v13
    v_cvt_pk_bf16_f32 v55, v14, v15
    ds_write_b64 v186, v[52:53]
    ds_write_b64 v187, v[54:55]
    v_accvgpr_read_b32 v16, a48
    v_accvgpr_read_b32 v17, a49
    v_accvgpr_read_b32 v18, a50
    v_accvgpr_read_b32 v19, a51
    v_accvgpr_read_b32 v20, a52
    v_accvgpr_read_b32 v21, a53
    v_accvgpr_read_b32 v22, a54
    v_accvgpr_read_b32 v23, a55
    buffer_store_dwordx4 v[68:71], v221, s[24:27], s61 offen offset:1024 sc0 sc1
    v_pk_mul_f32 v[16:17], v[16:17], v[192:193] op_sel:[0,1] op_sel_hi:[1,1]
    v_pk_mul_f32 v[18:19], v[18:19], v[192:193] op_sel:[0,1] op_sel_hi:[1,1]
    v_pk_mul_f32 v[20:21], v[20:21], v[192:193] op_sel:[0,1] op_sel_hi:[1,1]
    v_pk_mul_f32 v[22:23], v[22:23], v[192:193] op_sel:[0,1] op_sel_hi:[1,1]
    v_cvt_pk_bf16_f32 v56, v16, v17
    v_cvt_pk_bf16_f32 v57, v18, v19
    v_cvt_pk_bf16_f32 v58, v20, v21
    v_cvt_pk_bf16_f32 v59, v22, v23
    ds_write_b64 v188, v[56:57]
    ds_write_b64 v189, v[58:59]
    v_accvgpr_read_b32 v24, a56
    v_accvgpr_read_b32 v25, a57
    v_accvgpr_read_b32 v26, a58
    v_accvgpr_read_b32 v27, a59
    v_accvgpr_read_b32 v28, a60
    v_accvgpr_read_b32 v29, a61
    v_accvgpr_read_b32 v30, a62
    v_accvgpr_read_b32 v31, a63
    buffer_store_dwordx4 v[72:75], v222, s[24:27], s61 offen offset:2048 sc0 sc1
    v_pk_mul_f32 v[24:25], v[24:25], v[192:193] op_sel:[0,1] op_sel_hi:[1,1]
    v_pk_mul_f32 v[26:27], v[26:27], v[192:193] op_sel:[0,1] op_sel_hi:[1,1]
    v_pk_mul_f32 v[28:29], v[28:29], v[192:193] op_sel:[0,1] op_sel_hi:[1,1]
    v_pk_mul_f32 v[30:31], v[30:31], v[192:193] op_sel:[0,1] op_sel_hi:[1,1]
    v_cvt_pk_bf16_f32 v60, v24, v25
    v_cvt_pk_bf16_f32 v61, v26, v27
    v_cvt_pk_bf16_f32 v62, v28, v29
    v_cvt_pk_bf16_f32 v63, v30, v31
    ds_write_b64 v190, v[60:61]
    ds_write_b64 v191, v[62:63]
    ds_read_b128 v[80:83], v241 offset:0
    ds_read_b128 v[84:87], v241 offset:1024
    ds_read_b128 v[88:91], v241 offset:2048
    ds_read_b128 v[92:95], v241 offset:3072
    v_accvgpr_read_b32 v0, a64
    v_accvgpr_read_b32 v1, a65
    v_accvgpr_read_b32 v2, a66
    v_accvgpr_read_b32 v3, a67
    v_accvgpr_read_b32 v4, a68
    v_accvgpr_read_b32 v5, a69
    v_accvgpr_read_b32 v6, a70
    v_accvgpr_read_b32 v7, a71
    buffer_store_dwordx4 v[76:79], v223, s[24:27], s61 offen offset:3072 sc0 sc1
    v_pk_mul_f32 v[0:1], v[0:1], v[194:195] op_sel_hi:[1,0]
    v_pk_mul_f32 v[2:3], v[2:3], v[194:195] op_sel_hi:[1,0]
    v_pk_mul_f32 v[4:5], v[4:5], v[194:195] op_sel_hi:[1,0]
    v_pk_mul_f32 v[6:7], v[6:7], v[194:195] op_sel_hi:[1,0]
    v_cvt_pk_bf16_f32 v32, v0, v1
    v_cvt_pk_bf16_f32 v33, v2, v3
    v_cvt_pk_bf16_f32 v34, v4, v5
    v_cvt_pk_bf16_f32 v35, v6, v7
    ds_write_b64 v184, v[32:33]
    ds_write_b64 v185, v[34:35]
    v_accvgpr_read_b32 v8, a72
    v_accvgpr_read_b32 v9, a73
    v_accvgpr_read_b32 v10, a74
    v_accvgpr_read_b32 v11, a75
    v_accvgpr_read_b32 v12, a76
    v_accvgpr_read_b32 v13, a77
    v_accvgpr_read_b32 v14, a78
    v_accvgpr_read_b32 v15, a79
    s_add_u32 s62, s56, 65536
    s_waitcnt lgkmcnt(2)
    buffer_store_dwordx4 v[80:83], v220, s[24:27], s62 offen offset:0 sc0 sc1
    v_pk_mul_f32 v[8:9], v[8:9], v[194:195] op_sel_hi:[1,0]
    v_pk_mul_f32 v[10:11], v[10:11], v[194:195] op_sel_hi:[1,0]
    v_pk_mul_f32 v[12:13], v[12:13], v[194:195] op_sel_hi:[1,0]
    v_pk_mul_f32 v[14:15], v[14:15], v[194:195] op_sel_hi:[1,0]
    v_cvt_pk_bf16_f32 v36, v8, v9
    v_cvt_pk_bf16_f32 v37, v10, v11
    v_cvt_pk_bf16_f32 v38, v12, v13
    v_cvt_pk_bf16_f32 v39, v14, v15
    ds_write_b64 v186, v[36:37]
    ds_write_b64 v187, v[38:39]
    v_accvgpr_read_b32 v16, a80
    v_accvgpr_read_b32 v17, a81
    v_accvgpr_read_b32 v18, a82
    v_accvgpr_read_b32 v19, a83
    v_accvgpr_read_b32 v20, a84
    v_accvgpr_read_b32 v21, a85
    v_accvgpr_read_b32 v22, a86
    v_accvgpr_read_b32 v23, a87
    buffer_store_dwordx4 v[84:87], v221, s[24:27], s62 offen offset:1024 sc0 sc1
    v_pk_mul_f32 v[16:17], v[16:17], v[194:195] op_sel_hi:[1,0]
    v_pk_mul_f32 v[18:19], v[18:19], v[194:195] op_sel_hi:[1,0]
    v_pk_mul_f32 v[20:21], v[20:21], v[194:195] op_sel_hi:[1,0]
    v_pk_mul_f32 v[22:23], v[22:23], v[194:195] op_sel_hi:[1,0]
    v_cvt_pk_bf16_f32 v40, v16, v17
    v_cvt_pk_bf16_f32 v41, v18, v19
    v_cvt_pk_bf16_f32 v42, v20, v21
    v_cvt_pk_bf16_f32 v43, v22, v23
    ds_write_b64 v188, v[40:41]
    ds_write_b64 v189, v[42:43]
    v_accvgpr_read_b32 v24, a88
    v_accvgpr_read_b32 v25, a89
    v_accvgpr_read_b32 v26, a90
    v_accvgpr_read_b32 v27, a91
    v_accvgpr_read_b32 v28, a92
    v_accvgpr_read_b32 v29, a93
    v_accvgpr_read_b32 v30, a94
    v_accvgpr_read_b32 v31, a95
    buffer_store_dwordx4 v[88:91], v222, s[24:27], s62 offen offset:2048 sc0 sc1
    v_pk_mul_f32 v[24:25], v[24:25], v[194:195] op_sel_hi:[1,0]
    v_pk_mul_f32 v[26:27], v[26:27], v[194:195] op_sel_hi:[1,0]
    v_pk_mul_f32 v[28:29], v[28:29], v[194:195] op_sel_hi:[1,0]
    v_pk_mul_f32 v[30:31], v[30:31], v[194:195] op_sel_hi:[1,0]
    v_cvt_pk_bf16_f32 v44, v24, v25
    v_cvt_pk_bf16_f32 v45, v26, v27
    v_cvt_pk_bf16_f32 v46, v28, v29
    v_cvt_pk_bf16_f32 v47, v30, v31
    ds_write_b64 v190, v[44:45]
    ds_write_b64 v191, v[46:47]
    ds_read_b128 v[96:99], v241 offset:0
    ds_read_b128 v[100:103], v241 offset:1024
    ds_read_b128 v[104:107], v241 offset:2048
    ds_read_b128 v[108:111], v241 offset:3072
    v_accvgpr_read_b32 v0, a96
    v_accvgpr_read_b32 v1, a97
    v_accvgpr_read_b32 v2, a98
    v_accvgpr_read_b32 v3, a99
    v_accvgpr_read_b32 v4, a100
    v_accvgpr_read_b32 v5, a101
    v_accvgpr_read_b32 v6, a102
    v_accvgpr_read_b32 v7, a103
    buffer_store_dwordx4 v[92:95], v223, s[24:27], s62 offen offset:3072 sc0 sc1
    v_pk_mul_f32 v[0:1], v[0:1], v[194:195] op_sel:[0,1] op_sel_hi:[1,1]
    v_pk_mul_f32 v[2:3], v[2:3], v[194:195] op_sel:[0,1] op_sel_hi:[1,1]
    v_pk_mul_f32 v[4:5], v[4:5], v[194:195] op_sel:[0,1] op_sel_hi:[1,1]
    v_pk_mul_f32 v[6:7], v[6:7], v[194:195] op_sel:[0,1] op_sel_hi:[1,1]
    v_cvt_pk_bf16_f32 v48, v0, v1
    v_cvt_pk_bf16_f32 v49, v2, v3
    v_cvt_pk_bf16_f32 v50, v4, v5
    v_cvt_pk_bf16_f32 v51, v6, v7
    ds_write_b64 v184, v[48:49]
    ds_write_b64 v185, v[50:51]
    v_accvgpr_read_b32 v8, a104
    v_accvgpr_read_b32 v9, a105
    v_accvgpr_read_b32 v10, a106
    v_accvgpr_read_b32 v11, a107
    v_accvgpr_read_b32 v12, a108
    v_accvgpr_read_b32 v13, a109
    v_accvgpr_read_b32 v14, a110
    v_accvgpr_read_b32 v15, a111
    s_add_u32 s61, s56, 131072
    s_waitcnt lgkmcnt(2)
    buffer_store_dwordx4 v[96:99], v220, s[24:27], s61 offen offset:0 sc0 sc1
    v_pk_mul_f32 v[8:9], v[8:9], v[194:195] op_sel:[0,1] op_sel_hi:[1,1]
    v_pk_mul_f32 v[10:11], v[10:11], v[194:195] op_sel:[0,1] op_sel_hi:[1,1]
    v_pk_mul_f32 v[12:13], v[12:13], v[194:195] op_sel:[0,1] op_sel_hi:[1,1]
    v_pk_mul_f32 v[14:15], v[14:15], v[194:195] op_sel:[0,1] op_sel_hi:[1,1]
    v_cvt_pk_bf16_f32 v52, v8, v9
    v_cvt_pk_bf16_f32 v53, v10, v11
    v_cvt_pk_bf16_f32 v54, v12, v13
    v_cvt_pk_bf16_f32 v55, v14, v15
    ds_write_b64 v186, v[52:53]
    ds_write_b64 v187, v[54:55]
    v_accvgpr_read_b32 v16, a112
    v_accvgpr_read_b32 v17, a113
    v_accvgpr_read_b32 v18, a114
    v_accvgpr_read_b32 v19, a115
    v_accvgpr_read_b32 v20, a116
    v_accvgpr_read_b32 v21, a117
    v_accvgpr_read_b32 v22, a118
    v_accvgpr_read_b32 v23, a119
    buffer_store_dwordx4 v[100:103], v221, s[24:27], s61 offen offset:1024 sc0 sc1
    v_pk_mul_f32 v[16:17], v[16:17], v[194:195] op_sel:[0,1] op_sel_hi:[1,1]
    v_pk_mul_f32 v[18:19], v[18:19], v[194:195] op_sel:[0,1] op_sel_hi:[1,1]
    v_pk_mul_f32 v[20:21], v[20:21], v[194:195] op_sel:[0,1] op_sel_hi:[1,1]
    v_pk_mul_f32 v[22:23], v[22:23], v[194:195] op_sel:[0,1] op_sel_hi:[1,1]
    v_cvt_pk_bf16_f32 v56, v16, v17
    v_cvt_pk_bf16_f32 v57, v18, v19
    v_cvt_pk_bf16_f32 v58, v20, v21
    v_cvt_pk_bf16_f32 v59, v22, v23
    ds_write_b64 v188, v[56:57]
    ds_write_b64 v189, v[58:59]
    v_accvgpr_read_b32 v24, a120
    v_accvgpr_read_b32 v25, a121
    v_accvgpr_read_b32 v26, a122
    v_accvgpr_read_b32 v27, a123
    v_accvgpr_read_b32 v28, a124
    v_accvgpr_read_b32 v29, a125
    v_accvgpr_read_b32 v30, a126
    v_accvgpr_read_b32 v31, a127
    buffer_store_dwordx4 v[104:107], v222, s[24:27], s61 offen offset:2048 sc0 sc1
    v_pk_mul_f32 v[24:25], v[24:25], v[194:195] op_sel:[0,1] op_sel_hi:[1,1]
    v_pk_mul_f32 v[26:27], v[26:27], v[194:195] op_sel:[0,1] op_sel_hi:[1,1]
    v_pk_mul_f32 v[28:29], v[28:29], v[194:195] op_sel:[0,1] op_sel_hi:[1,1]
    v_pk_mul_f32 v[30:31], v[30:31], v[194:195] op_sel:[0,1] op_sel_hi:[1,1]
    v_cvt_pk_bf16_f32 v60, v24, v25
    v_cvt_pk_bf16_f32 v61, v26, v27
    v_cvt_pk_bf16_f32 v62, v28, v29
    v_cvt_pk_bf16_f32 v63, v30, v31
    ds_write_b64 v190, v[60:61]
    ds_write_b64 v191, v[62:63]
    ds_read_b128 v[112:115], v241 offset:0
    ds_read_b128 v[116:119], v241 offset:1024
    ds_read_b128 v[120:123], v241 offset:2048
    ds_read_b128 v[124:127], v241 offset:3072
    v_accvgpr_read_b32 v0, a128
    v_accvgpr_read_b32 v1, a129
    v_accvgpr_read_b32 v2, a130
    v_accvgpr_read_b32 v3, a131
    v_accvgpr_read_b32 v4, a132
    v_accvgpr_read_b32 v5, a133
    v_accvgpr_read_b32 v6, a134
    v_accvgpr_read_b32 v7, a135
    buffer_store_dwordx4 v[108:111], v223, s[24:27], s61 offen offset:3072 sc0 sc1
    v_pk_mul_f32 v[0:1], v[0:1], v[196:197] op_sel_hi:[1,0]
    v_pk_mul_f32 v[2:3], v[2:3], v[196:197] op_sel_hi:[1,0]
    v_pk_mul_f32 v[4:5], v[4:5], v[196:197] op_sel_hi:[1,0]
    v_pk_mul_f32 v[6:7], v[6:7], v[196:197] op_sel_hi:[1,0]
    v_cvt_pk_bf16_f32 v32, v0, v1
    v_cvt_pk_bf16_f32 v33, v2, v3
    v_cvt_pk_bf16_f32 v34, v4, v5
    v_cvt_pk_bf16_f32 v35, v6, v7
    ds_write_b64 v184, v[32:33]
    ds_write_b64 v185, v[34:35]
    v_accvgpr_read_b32 v8, a136
    v_accvgpr_read_b32 v9, a137
    v_accvgpr_read_b32 v10, a138
    v_accvgpr_read_b32 v11, a139
    v_accvgpr_read_b32 v12, a140
    v_accvgpr_read_b32 v13, a141
    v_accvgpr_read_b32 v14, a142
    v_accvgpr_read_b32 v15, a143
    s_add_u32 s62, s56, 196608
    s_waitcnt lgkmcnt(2)
    buffer_store_dwordx4 v[112:115], v220, s[24:27], s62 offen offset:0 sc0 sc1
    v_pk_mul_f32 v[8:9], v[8:9], v[196:197] op_sel_hi:[1,0]
    v_pk_mul_f32 v[10:11], v[10:11], v[196:197] op_sel_hi:[1,0]
    v_pk_mul_f32 v[12:13], v[12:13], v[196:197] op_sel_hi:[1,0]
    v_pk_mul_f32 v[14:15], v[14:15], v[196:197] op_sel_hi:[1,0]
    v_cvt_pk_bf16_f32 v36, v8, v9
    v_cvt_pk_bf16_f32 v37, v10, v11
    v_cvt_pk_bf16_f32 v38, v12, v13
    v_cvt_pk_bf16_f32 v39, v14, v15
    ds_write_b64 v186, v[36:37]
    ds_write_b64 v187, v[38:39]
    v_accvgpr_read_b32 v16, a144
    v_accvgpr_read_b32 v17, a145
    v_accvgpr_read_b32 v18, a146
    v_accvgpr_read_b32 v19, a147
    v_accvgpr_read_b32 v20, a148
    v_accvgpr_read_b32 v21, a149
    v_accvgpr_read_b32 v22, a150
    v_accvgpr_read_b32 v23, a151
    buffer_store_dwordx4 v[116:119], v221, s[24:27], s62 offen offset:1024 sc0 sc1
    v_pk_mul_f32 v[16:17], v[16:17], v[196:197] op_sel_hi:[1,0]
    v_pk_mul_f32 v[18:19], v[18:19], v[196:197] op_sel_hi:[1,0]
    v_pk_mul_f32 v[20:21], v[20:21], v[196:197] op_sel_hi:[1,0]
    v_pk_mul_f32 v[22:23], v[22:23], v[196:197] op_sel_hi:[1,0]
    v_cvt_pk_bf16_f32 v40, v16, v17
    v_cvt_pk_bf16_f32 v41, v18, v19
    v_cvt_pk_bf16_f32 v42, v20, v21
    v_cvt_pk_bf16_f32 v43, v22, v23
    ds_write_b64 v188, v[40:41]
    ds_write_b64 v189, v[42:43]
    v_accvgpr_read_b32 v24, a152
    v_accvgpr_read_b32 v25, a153
    v_accvgpr_read_b32 v26, a154
    v_accvgpr_read_b32 v27, a155
    v_accvgpr_read_b32 v28, a156
    v_accvgpr_read_b32 v29, a157
    v_accvgpr_read_b32 v30, a158
    v_accvgpr_read_b32 v31, a159
    buffer_store_dwordx4 v[120:123], v222, s[24:27], s62 offen offset:2048 sc0 sc1
    v_pk_mul_f32 v[24:25], v[24:25], v[196:197] op_sel_hi:[1,0]
    v_pk_mul_f32 v[26:27], v[26:27], v[196:197] op_sel_hi:[1,0]
    v_pk_mul_f32 v[28:29], v[28:29], v[196:197] op_sel_hi:[1,0]
    v_pk_mul_f32 v[30:31], v[30:31], v[196:197] op_sel_hi:[1,0]
    v_cvt_pk_bf16_f32 v44, v24, v25
    v_cvt_pk_bf16_f32 v45, v26, v27
    v_cvt_pk_bf16_f32 v46, v28, v29
    v_cvt_pk_bf16_f32 v47, v30, v31
    ds_write_b64 v190, v[44:45]
    ds_write_b64 v191, v[46:47]
    ds_read_b128 v[128:131], v241 offset:0
    ds_read_b128 v[132:135], v241 offset:1024
    ds_read_b128 v[136:139], v241 offset:2048
    ds_read_b128 v[140:143], v241 offset:3072
    buffer_store_dwordx4 v[124:127], v223, s[24:27], s62 offen offset:3072 sc0 sc1
    s_add_u32 s61, s56, 262144
    s_waitcnt lgkmcnt(3)
    buffer_store_dwordx4 v[128:131], v220, s[24:27], s61 offen offset:0 sc0 sc1
    s_waitcnt lgkmcnt(2)
    buffer_store_dwordx4 v[132:135], v221, s[24:27], s61 offen offset:1024 sc0 sc1
    s_waitcnt lgkmcnt(1)
    buffer_store_dwordx4 v[136:139], v222, s[24:27], s61 offen offset:2048 sc0 sc1
    s_waitcnt lgkmcnt(0)
    buffer_store_dwordx4 v[140:143], v223, s[24:27], s61 offen offset:3072 sc0 sc1
    s_branch Ldone
Lsafe3:
    s_waitcnt lgkmcnt(0)
    v_mfma_f32_16x16x32_bf16 v[64:67], a[160:163], v[0:3], v[184:187]
    ds_read_b64_tr_b16 a[192:193], v208 offset:32768
    v_exp_f32 v224, v120
    v_mfma_f32_16x16x32_bf16 v[72:75], a[160:163], v[16:19], v[188:191]
    ds_read_b64_tr_b16 a[194:195], v208 offset:40960
    v_exp_f32 v225, v121
    v_mfma_f32_16x16x32_bf16 v[80:83], a[160:163], v[32:35], v[192:195]
    ds_read_b64_tr_b16 a[196:197], v209 offset:32768
    v_cvt_pk_bf16_f32 v172, v224, v225
    v_mfma_f32_16x16x32_bf16 v[64:67], a[164:167], v[4:7], v[64:67]
    ds_read_b64_tr_b16 a[198:199], v209 offset:40960
    v_exp_f32 v226, v122
    v_mfma_f32_16x16x32_bf16 v[72:75], a[164:167], v[20:23], v[72:75]
    ds_read_b64_tr_b16 a[200:201], v210 offset:32768
    v_exp_f32 v227, v123
    v_mfma_f32_16x16x32_bf16 v[80:83], a[164:167], v[36:39], v[80:83]
    ds_read_b64_tr_b16 a[202:203], v210 offset:40960
    v_cvt_pk_bf16_f32 v173, v226, v227
    v_mfma_f32_16x16x32_bf16 v[64:67], a[168:171], v[8:11], v[64:67]
    ds_read_b64_tr_b16 a[204:205], v211 offset:32768
    v_or_b32 v245, v172, v173
    v_mfma_f32_16x16x32_bf16 v[72:75], a[168:171], v[24:27], v[72:75]
    ds_read_b64_tr_b16 a[206:207], v211 offset:40960
    v_exp_f32 v248, v124
    v_mfma_f32_16x16x32_bf16 v[80:83], a[168:171], v[40:43], v[80:83]
    v_exp_f32 v249, v125
    v_mfma_f32_16x16x32_bf16 v[64:67], a[172:175], v[12:15], v[64:67]
    ds_read_b64_tr_b16 a[208:209], v212 offset:32768
    v_cvt_pk_bf16_f32 v174, v248, v249
    v_mfma_f32_16x16x32_bf16 v[72:75], a[172:175], v[28:31], v[72:75]
    ds_read_b64_tr_b16 a[210:211], v212 offset:40960
    v_mfma_f32_16x16x32_bf16 v[80:83], a[172:175], v[44:47], v[80:83]
    ds_read_b64_tr_b16 a[212:213], v213 offset:32768
    v_mfma_f32_16x16x32_bf16 v[68:71], a[176:179], v[0:3], v[184:187]
    ds_read_b64_tr_b16 a[214:215], v213 offset:40960
    v_mfma_f32_16x16x32_bf16 v[76:79], a[176:179], v[16:19], v[188:191]
    ds_read_b64_tr_b16 a[216:217], v214 offset:32768
    v_mfma_f32_16x16x32_bf16 v[84:87], a[176:179], v[32:35], v[192:195]
    ds_read_b64_tr_b16 a[218:219], v214 offset:40960
    v_mfma_f32_16x16x32_bf16 v[68:71], a[180:183], v[4:7], v[68:71]
    ds_read_b64_tr_b16 a[220:221], v215 offset:32768
    v_exp_f32 v250, v126
    v_mfma_f32_16x16x32_bf16 v[76:79], a[180:183], v[20:23], v[76:79]
    ds_read_b64_tr_b16 a[222:223], v215 offset:40960
    v_mfma_f32_16x16x32_bf16 v[84:87], a[180:183], v[36:39], v[84:87]
    v_exp_f32 v251, v127
    v_mfma_f32_16x16x32_bf16 v[68:71], a[184:187], v[8:11], v[68:71]
    v_exp_f32 v224, v112
    v_mfma_f32_16x16x32_bf16 v[76:79], a[184:187], v[24:27], v[76:79]
    s_add_u32 m0, s41, 32768
    v_exp_f32 v225, v113
    v_mfma_f32_16x16x32_bf16 v[84:87], a[184:187], v[40:43], v[84:87]
    s_add_u32 s40, s40, 131072
    v_exp_f32 v226, v114
    v_mfma_f32_16x16x32_bf16 v[68:71], a[188:191], v[12:15], v[68:71]
    s_add_u32 s63, s63, 131072
    v_exp_f32 v227, v115
    v_mfma_f32_16x16x32_bf16 v[76:79], a[188:191], v[28:31], v[76:79]
    s_waitcnt vmcnt(8) lgkmcnt(0)
    v_exp_f32 v248, v116
    v_mfma_f32_16x16x32_bf16 v[84:87], a[188:191], v[44:47], v[84:87]
    s_barrier
    v_mfma_f32_16x16x32_bf16 a[0:3], a[192:195], v[144:147], 0
    ds_read_b128 a[160:163], v204 offset:49152
    v_cvt_pk_bf16_f32 v175, v250, v251
    v_mfma_f32_16x16x32_bf16 a[32:35], a[192:195], v[148:151], 0
    ds_read_b128 a[164:167], v205 offset:49152
    v_or3_b32 v245, v245, v174, v175
    v_mfma_f32_16x16x32_bf16 a[64:67], a[192:195], v[152:155], 0
    v_exp_f32 v249, v117
    v_mfma_f32_16x16x32_bf16 a[4:7], a[196:199], v[144:147], 0
    buffer_load_dwordx4 v218, s[20:23], s40 offen lds
    v_cvt_pk_bf16_f32 v168, v224, v225
    v_mfma_f32_16x16x32_bf16 a[36:39], a[196:199], v[148:151], 0
    v_exp_f32 v250, v118
    v_mfma_f32_16x16x32_bf16 a[68:71], a[196:199], v[152:155], 0
    ds_read_b128 a[168:171], v206 offset:49152
    v_cvt_pk_bf16_f32 v169, v226, v227
    v_mfma_f32_16x16x32_bf16 a[8:11], a[200:203], v[144:147], 0
    v_exp_f32 v251, v119
    v_mfma_f32_16x16x32_bf16 a[40:43], a[200:203], v[148:151], 0
    ds_read_b128 a[172:175], v207 offset:49152
    v_or3_b32 v245, v245, v168, v169
    v_mfma_f32_16x16x32_bf16 a[72:75], a[200:203], v[152:155], 0
    v_exp_f32 v224, v104
    v_mfma_f32_16x16x32_bf16 a[12:15], a[204:207], v[144:147], 0
    buffer_load_dwordx4 v219, s[20:23], s40 offen offset:1024 lds
    v_cvt_pk_bf16_f32 v170, v248, v249
    v_mfma_f32_16x16x32_bf16 a[44:47], a[204:207], v[148:151], 0
    ds_read_b128 a[176:179], v204 offset:57344
    v_cvt_pk_bf16_f32 v171, v250, v251
    v_mfma_f32_16x16x32_bf16 a[76:79], a[204:207], v[152:155], 0
    v_exp_f32 v225, v105
    v_mfma_f32_16x16x32_bf16 a[16:19], a[208:211], v[144:147], 0
    ds_read_b128 a[180:183], v205 offset:57344
    v_or3_b32 v245, v245, v170, v171
    v_mfma_f32_16x16x32_bf16 a[48:51], a[208:211], v[148:151], 0
    v_exp_f32 v226, v106
    v_mfma_f32_16x16x32_bf16 a[80:83], a[208:211], v[152:155], 0
    ds_read_b128 a[184:187], v206 offset:57344
    v_cvt_pk_bf16_f32 v164, v224, v225
    v_mfma_f32_16x16x32_bf16 a[20:23], a[212:215], v[144:147], 0
    v_exp_f32 v227, v107
    v_mfma_f32_16x16x32_bf16 a[52:55], a[212:215], v[148:151], 0
    buffer_load_dwordx4 v216, s[16:19], s63 offen offset:2048 lds
    v_cvt_pk_bf16_f32 v165, v226, v227
    v_mfma_f32_16x16x32_bf16 a[84:87], a[212:215], v[152:155], 0
    v_exp_f32 v248, v108
    v_mfma_f32_16x16x32_bf16 a[24:27], a[216:219], v[144:147], 0
    ds_read_b128 a[188:191], v207 offset:57344
    v_or3_b32 v245, v245, v164, v165
    v_mfma_f32_16x16x32_bf16 a[56:59], a[216:219], v[148:151], 0
    v_exp_f32 v249, v109
    v_mfma_f32_16x16x32_bf16 a[88:91], a[216:219], v[152:155], 0
    v_exp_f32 v250, v110
    v_mfma_f32_16x16x32_bf16 a[28:31], a[220:223], v[144:147], 0
    v_exp_f32 v251, v111
    v_mfma_f32_16x16x32_bf16 a[60:63], a[220:223], v[148:151], 0
    buffer_load_dwordx4 v217, s[16:19], s63 offen offset:3072 lds
    v_cvt_pk_bf16_f32 v166, v248, v249
    v_mfma_f32_16x16x32_bf16 a[92:95], a[220:223], v[152:155], 0
    s_sub_u32 s42, s42, 1
    v_cvt_pk_bf16_f32 v167, v250, v251
    v_or3_b32 v245, v245, v166, v167
    v_mfma_f32_16x16x32_bf16 a[240:243], v[228:231], v[144:147], 0
    s_waitcnt lgkmcnt(0)
    v_and_b32 v244, 0x40004000, v245
    v_cmp_ne_u32 vcc, 0, v244
    v_mfma_f32_16x16x32_bf16 a[244:247], v[228:231], v[148:151], 0
    v_mfma_f32_16x16x32_bf16 a[248:251], v[228:231], v[152:155], 0
    s_cbranch_vccnz Lrare_t3p1
Lback_t3p1:
Lsloop3:
    v_mfma_f32_16x16x32_bf16 v[104:107], a[160:163], v[0:3], v[184:187]
    ds_read_b64_tr_b16 a[192:193], v208 offset:49152
    v_exp_f32 v224, v80
    v_mfma_f32_16x16x32_bf16 v[112:115], a[160:163], v[16:19], v[188:191]
    ds_read_b64_tr_b16 a[194:195], v208 offset:57344
    v_exp_f32 v225, v81
    v_mfma_f32_16x16x32_bf16 v[120:123], a[160:163], v[32:35], v[192:195]
    ds_read_b64_tr_b16 a[196:197], v209 offset:49152
    v_cvt_pk_bf16_f32 v152, v224, v225
    v_mfma_f32_16x16x32_bf16 v[104:107], a[164:167], v[4:7], v[104:107]
    ds_read_b64_tr_b16 a[198:199], v209 offset:57344
    v_exp_f32 v226, v82
    v_mfma_f32_16x16x32_bf16 v[112:115], a[164:167], v[20:23], v[112:115]
    ds_read_b64_tr_b16 a[200:201], v210 offset:49152
    v_exp_f32 v227, v83
    v_mfma_f32_16x16x32_bf16 v[120:123], a[164:167], v[36:39], v[120:123]
    ds_read_b64_tr_b16 a[202:203], v210 offset:57344
    v_cvt_pk_bf16_f32 v153, v226, v227
    v_mfma_f32_16x16x32_bf16 v[104:107], a[168:171], v[8:11], v[104:107]
    ds_read_b64_tr_b16 a[204:205], v211 offset:49152
    v_or_b32 v245, v152, v153
    v_mfma_f32_16x16x32_bf16 v[112:115], a[168:171], v[24:27], v[112:115]
    ds_read_b64_tr_b16 a[206:207], v211 offset:57344
    v_exp_f32 v248, v84
    v_mfma_f32_16x16x32_bf16 v[120:123], a[168:171], v[40:43], v[120:123]
    v_exp_f32 v249, v85
    v_mfma_f32_16x16x32_bf16 v[104:107], a[172:175], v[12:15], v[104:107]
    ds_read_b64_tr_b16 a[208:209], v212 offset:49152
    v_cvt_pk_bf16_f32 v154, v248, v249
    v_mfma_f32_16x16x32_bf16 v[112:115], a[172:175], v[28:31], v[112:115]
    ds_read_b64_tr_b16 a[210:211], v212 offset:57344
    v_mfma_f32_16x16x32_bf16 v[120:123], a[172:175], v[44:47], v[120:123]
    ds_read_b64_tr_b16 a[212:213], v213 offset:49152
    v_mfma_f32_16x16x32_bf16 v[108:111], a[176:179], v[0:3], v[184:187]
    ds_read_b64_tr_b16 a[214:215], v213 offset:57344
    v_mfma_f32_16x16x32_bf16 v[116:119], a[176:179], v[16:19], v[188:191]
    ds_read_b64_tr_b16 a[216:217], v214 offset:49152
    v_mfma_f32_16x16x32_bf16 v[124:127], a[176:179], v[32:35], v[192:195]
    ds_read_b64_tr_b16 a[218:219], v214 offset:57344
    v_mfma_f32_16x16x32_bf16 v[108:111], a[180:183], v[4:7], v[108:111]
    ds_read_b64_tr_b16 a[220:221], v215 offset:49152
    v_exp_f32 v250, v86
    v_mfma_f32_16x16x32_bf16 v[116:119], a[180:183], v[20:23], v[116:119]
    ds_read_b64_tr_b16 a[222:223], v215 offset:57344
    v_mfma_f32_16x16x32_bf16 v[124:127], a[180:183], v[36:39], v[124:127]
    v_exp_f32 v251, v87
    v_mfma_f32_16x16x32_bf16 v[108:111], a[184:187], v[8:11], v[108:111]
    v_exp_f32 v224, v72
    v_mfma_f32_16x16x32_bf16 v[116:119], a[184:187], v[24:27], v[116:119]
    s_add_u32 m0, s41, 49152
    v_exp_f32 v225, v73
    v_mfma_f32_16x16x32_bf16 v[124:127], a[184:187], v[40:43], v[124:127]
    s_add_u32 s40, s40, 131072
    v_exp_f32 v226, v74
    v_mfma_f32_16x16x32_bf16 v[108:111], a[188:191], v[12:15], v[108:111]
    s_add_u32 s63, s63, 131072
    v_exp_f32 v227, v75
    v_mfma_f32_16x16x32_bf16 v[116:119], a[188:191], v[28:31], v[116:119]
    s_waitcnt vmcnt(8) lgkmcnt(0)
    v_exp_f32 v248, v76
    v_mfma_f32_16x16x32_bf16 v[124:127], a[188:191], v[44:47], v[124:127]
    s_barrier
    v_mfma_f32_16x16x32_bf16 a[0:3], a[192:195], v[164:167], a[0:3]
    ds_read_b128 a[160:163], v204 offset:0
    v_cvt_pk_bf16_f32 v155, v250, v251
    v_mfma_f32_16x16x32_bf16 a[32:35], a[192:195], v[168:171], a[32:35]
    ds_read_b128 a[164:167], v205 offset:0
    v_or3_b32 v245, v245, v154, v155
    v_mfma_f32_16x16x32_bf16 a[64:67], a[192:195], v[172:175], a[64:67]
    v_exp_f32 v249, v77
    v_mfma_f32_16x16x32_bf16 a[4:7], a[196:199], v[164:167], a[4:7]
    buffer_load_dwordx4 v218, s[20:23], s40 offen lds
    v_cvt_pk_bf16_f32 v148, v224, v225
    v_mfma_f32_16x16x32_bf16 a[36:39], a[196:199], v[168:171], a[36:39]
    v_exp_f32 v250, v78
    v_mfma_f32_16x16x32_bf16 a[68:71], a[196:199], v[172:175], a[68:71]
    ds_read_b128 a[168:171], v206 offset:0
    v_cvt_pk_bf16_f32 v149, v226, v227
    v_mfma_f32_16x16x32_bf16 a[8:11], a[200:203], v[164:167], a[8:11]
    v_exp_f32 v251, v79
    v_mfma_f32_16x16x32_bf16 a[40:43], a[200:203], v[168:171], a[40:43]
    ds_read_b128 a[172:175], v207 offset:0
    v_or3_b32 v245, v245, v148, v149
    v_mfma_f32_16x16x32_bf16 a[72:75], a[200:203], v[172:175], a[72:75]
    v_exp_f32 v224, v64
    v_mfma_f32_16x16x32_bf16 a[12:15], a[204:207], v[164:167], a[12:15]
    buffer_load_dwordx4 v219, s[20:23], s40 offen offset:1024 lds
    v_cvt_pk_bf16_f32 v150, v248, v249
    v_mfma_f32_16x16x32_bf16 a[44:47], a[204:207], v[168:171], a[44:47]
    ds_read_b128 a[176:179], v204 offset:8192
    v_cvt_pk_bf16_f32 v151, v250, v251
    v_mfma_f32_16x16x32_bf16 a[76:79], a[204:207], v[172:175], a[76:79]
    v_exp_f32 v225, v65
    v_mfma_f32_16x16x32_bf16 a[16:19], a[208:211], v[164:167], a[16:19]
    ds_read_b128 a[180:183], v205 offset:8192
    v_or3_b32 v245, v245, v150, v151
    v_mfma_f32_16x16x32_bf16 a[48:51], a[208:211], v[168:171], a[48:51]
    v_exp_f32 v226, v66
    v_mfma_f32_16x16x32_bf16 a[80:83], a[208:211], v[172:175], a[80:83]
    ds_read_b128 a[184:187], v206 offset:8192
    v_cvt_pk_bf16_f32 v144, v224, v225
    v_mfma_f32_16x16x32_bf16 a[20:23], a[212:215], v[164:167], a[20:23]
    v_exp_f32 v227, v67
    v_mfma_f32_16x16x32_bf16 a[52:55], a[212:215], v[168:171], a[52:55]
    buffer_load_dwordx4 v216, s[16:19], s63 offen offset:2048 lds
    v_cvt_pk_bf16_f32 v145, v226, v227
    v_mfma_f32_16x16x32_bf16 a[84:87], a[212:215], v[172:175], a[84:87]
    v_exp_f32 v248, v68
    v_mfma_f32_16x16x32_bf16 a[24:27], a[216:219], v[164:167], a[24:27]
    ds_read_b128 a[188:191], v207 offset:8192
    v_or3_b32 v245, v245, v144, v145
    v_mfma_f32_16x16x32_bf16 a[56:59], a[216:219], v[168:171], a[56:59]
    v_exp_f32 v249, v69
    v_mfma_f32_16x16x32_bf16 a[88:91], a[216:219], v[172:175], a[88:91]
    v_exp_f32 v250, v70
    v_mfma_f32_16x16x32_bf16 a[28:31], a[220:223], v[164:167], a[28:31]
    v_exp_f32 v251, v71
    v_mfma_f32_16x16x32_bf16 a[60:63], a[220:223], v[168:171], a[60:63]
    buffer_load_dwordx4 v217, s[16:19], s63 offen offset:3072 lds
    v_cvt_pk_bf16_f32 v146, v248, v249
    v_mfma_f32_16x16x32_bf16 a[92:95], a[220:223], v[172:175], a[92:95]
    s_sub_u32 s42, s42, 1
    v_cvt_pk_bf16_f32 v147, v250, v251
    v_or3_b32 v245, v245, v146, v147
    v_mfma_f32_16x16x32_bf16 a[240:243], v[228:231], v[164:167], a[240:243]
    s_waitcnt lgkmcnt(0)
    v_and_b32 v244, 0x40004000, v245
    v_cmp_ne_u32 vcc, 0, v244
    v_mfma_f32_16x16x32_bf16 a[244:247], v[228:231], v[168:171], a[244:247]
    s_cselect_b64 vcc, -1, vcc
    v_mfma_f32_16x16x32_bf16 a[248:251], v[228:231], v[172:175], a[248:251]
    s_cbranch_vccnz Lx3_2
Lxb3_2:
    v_mfma_f32_16x16x32_bf16 v[64:67], a[160:163], v[0:3], v[184:187]
    ds_read_b64_tr_b16 a[192:193], v208 offset:0
    v_exp_f32 v224, v120
    v_mfma_f32_16x16x32_bf16 v[72:75], a[160:163], v[16:19], v[188:191]
    ds_read_b64_tr_b16 a[194:195], v208 offset:8192
    v_exp_f32 v225, v121
    v_mfma_f32_16x16x32_bf16 v[80:83], a[160:163], v[32:35], v[192:195]
    ds_read_b64_tr_b16 a[196:197], v209 offset:0
    v_cvt_pk_bf16_f32 v172, v224, v225
    v_mfma_f32_16x16x32_bf16 v[64:67], a[164:167], v[4:7], v[64:67]
    ds_read_b64_tr_b16 a[198:199], v209 offset:8192
    v_exp_f32 v226, v122
    v_mfma_f32_16x16x32_bf16 v[72:75], a[164:167], v[20:23], v[72:75]
    ds_read_b64_tr_b16 a[200:201], v210 offset:0
    v_exp_f32 v227, v123
    v_mfma_f32_16x16x32_bf16 v[80:83], a[164:167], v[36:39], v[80:83]
    ds_read_b64_tr_b16 a[202:203], v210 offset:8192
    v_cvt_pk_bf16_f32 v173, v226, v227
    v_mfma_f32_16x16x32_bf16 v[64:67], a[168:171], v[8:11], v[64:67]
    ds_read_b64_tr_b16 a[204:205], v211 offset:0
    v_or_b32 v245, v172, v173
    v_mfma_f32_16x16x32_bf16 v[72:75], a[168:171], v[24:27], v[72:75]
    ds_read_b64_tr_b16 a[206:207], v211 offset:8192
    v_exp_f32 v248, v124
    v_mfma_f32_16x16x32_bf16 v[80:83], a[168:171], v[40:43], v[80:83]
    v_exp_f32 v249, v125
    v_mfma_f32_16x16x32_bf16 v[64:67], a[172:175], v[12:15], v[64:67]
    ds_read_b64_tr_b16 a[208:209], v212 offset:0
    v_cvt_pk_bf16_f32 v174, v248, v249
    v_mfma_f32_16x16x32_bf16 v[72:75], a[172:175], v[28:31], v[72:75]
    ds_read_b64_tr_b16 a[210:211], v212 offset:8192
    v_mfma_f32_16x16x32_bf16 v[80:83], a[172:175], v[44:47], v[80:83]
    ds_read_b64_tr_b16 a[212:213], v213 offset:0
    v_mfma_f32_16x16x32_bf16 v[68:71], a[176:179], v[0:3], v[184:187]
    ds_read_b64_tr_b16 a[214:215], v213 offset:8192
    v_mfma_f32_16x16x32_bf16 v[76:79], a[176:179], v[16:19], v[188:191]
    ds_read_b64_tr_b16 a[216:217], v214 offset:0
    v_mfma_f32_16x16x32_bf16 v[84:87], a[176:179], v[32:35], v[192:195]
    ds_read_b64_tr_b16 a[218:219], v214 offset:8192
    v_mfma_f32_16x16x32_bf16 v[68:71], a[180:183], v[4:7], v[68:71]
    ds_read_b64_tr_b16 a[220:221], v215 offset:0
    v_exp_f32 v250, v126
    v_mfma_f32_16x16x32_bf16 v[76:79], a[180:183], v[20:23], v[76:79]
    ds_read_b64_tr_b16 a[222:223], v215 offset:8192
    v_mfma_f32_16x16x32_bf16 v[84:87], a[180:183], v[36:39], v[84:87]
    v_exp_f32 v251, v127
    v_mfma_f32_16x16x32_bf16 v[68:71], a[184:187], v[8:11], v[68:71]
    v_exp_f32 v224, v112
    v_mfma_f32_16x16x32_bf16 v[76:79], a[184:187], v[24:27], v[76:79]
    s_mov_b32 m0, s41
    v_exp_f32 v225, v113
    v_mfma_f32_16x16x32_bf16 v[84:87], a[184:187], v[40:43], v[84:87]
    s_add_u32 s40, s40, 131072
    v_exp_f32 v226, v114
    v_mfma_f32_16x16x32_bf16 v[68:71], a[188:191], v[12:15], v[68:71]
    s_add_u32 s63, s63, 131072
    v_exp_f32 v227, v115
    v_mfma_f32_16x16x32_bf16 v[76:79], a[188:191], v[28:31], v[76:79]
    s_waitcnt vmcnt(8) lgkmcnt(0)
    v_exp_f32 v248, v116
    v_mfma_f32_16x16x32_bf16 v[84:87], a[188:191], v[44:47], v[84:87]
    s_barrier
    v_mfma_f32_16x16x32_bf16 a[0:3], a[192:195], v[144:147], a[0:3]
    ds_read_b128 a[160:163], v204 offset:16384
    v_cvt_pk_bf16_f32 v175, v250, v251
    v_mfma_f32_16x16x32_bf16 a[32:35], a[192:195], v[148:151], a[32:35]
    ds_read_b128 a[164:167], v205 offset:16384
    v_or3_b32 v245, v245, v174, v175
    v_mfma_f32_16x16x32_bf16 a[64:67], a[192:195], v[152:155], a[64:67]
    v_exp_f32 v249, v117
    v_mfma_f32_16x16x32_bf16 a[4:7], a[196:199], v[144:147], a[4:7]
    buffer_load_dwordx4 v218, s[20:23], s40 offen lds
    v_cvt_pk_bf16_f32 v168, v224, v225
    v_mfma_f32_16x16x32_bf16 a[36:39], a[196:199], v[148:151], a[36:39]
    v_exp_f32 v250, v118
    v_mfma_f32_16x16x32_bf16 a[68:71], a[196:199], v[152:155], a[68:71]
    ds_read_b128 a[168:171], v206 offset:16384
    v_cvt_pk_bf16_f32 v169, v226, v227
    v_mfma_f32_16x16x32_bf16 a[8:11], a[200:203], v[144:147], a[8:11]
    v_exp_f32 v251, v119
    v_mfma_f32_16x16x32_bf16 a[40:43], a[200:203], v[148:151], a[40:43]
    ds_read_b128 a[172:175], v207 offset:16384
    v_or3_b32 v245, v245, v168, v169
    v_mfma_f32_16x16x32_bf16 a[72:75], a[200:203], v[152:155], a[72:75]
    v_exp_f32 v224, v104
    v_mfma_f32_16x16x32_bf16 a[12:15], a[204:207], v[144:147], a[12:15]
    buffer_load_dwordx4 v219, s[20:23], s40 offen offset:1024 lds
    v_cvt_pk_bf16_f32 v170, v248, v249
    v_mfma_f32_16x16x32_bf16 a[44:47], a[204:207], v[148:151], a[44:47]
    ds_read_b128 a[176:179], v204 offset:24576
    v_cvt_pk_bf16_f32 v171, v250, v251
    v_mfma_f32_16x16x32_bf16 a[76:79], a[204:207], v[152:155], a[76:79]
    v_exp_f32 v225, v105
    v_mfma_f32_16x16x32_bf16 a[16:19], a[208:211], v[144:147], a[16:19]
    ds_read_b128 a[180:183], v205 offset:24576
    v_or3_b32 v245, v245, v170, v171
    v_mfma_f32_16x16x32_bf16 a[48:51], a[208:211], v[148:151], a[48:51]
    v_exp_f32 v226, v106
    v_mfma_f32_16x16x32_bf16 a[80:83], a[208:211], v[152:155], a[80:83]
    ds_read_b128 a[184:187], v206 offset:24576
    v_cvt_pk_bf16_f32 v164, v224, v225
    v_mfma_f32_16x16x32_bf16 a[20:23], a[212:215], v[144:147], a[20:23]
    v_exp_f32 v227, v107
    v_mfma_f32_16x16x32_bf16 a[52:55], a[212:215], v[148:151], a[52:55]
    buffer_load_dwordx4 v216, s[16:19], s63 offen offset:2048 lds
    v_cvt_pk_bf16_f32 v165, v226, v227
    v_mfma_f32_16x16x32_bf16 a[84:87], a[212:215], v[152:155], a[84:87]
    v_exp_f32 v248, v108
    v_mfma_f32_16x16x32_bf16 a[24:27], a[216:219], v[144:147], a[24:27]
    ds_read_b128 a[188:191], v207 offset:24576
    v_or3_b32 v245, v245, v164, v165
    v_mfma_f32_16x16x32_bf16 a[56:59], a[216:219], v[148:151], a[56:59]
    v_exp_f32 v249, v109
    v_mfma_f32_16x16x32_bf16 a[88:91], a[216:219], v[152:155], a[88:91]
    v_exp_f32 v250, v110
    v_mfma_f32_16x16x32_bf16 a[28:31], a[220:223], v[144:147], a[28:31]
    v_exp_f32 v251, v111
    v_mfma_f32_16x16x32_bf16 a[60:63], a[220:223], v[148:151], a[60:63]
    buffer_load_dwordx4 v217, s[16:19], s63 offen offset:3072 lds
    v_cvt_pk_bf16_f32 v166, v248, v249
    v_mfma_f32_16x16x32_bf16 a[92:95], a[220:223], v[152:155], a[92:95]
    s_sub_u32 s42, s42, 1
    v_cvt_pk_bf16_f32 v167, v250, v251
    v_or3_b32 v245, v245, v166, v167
    v_mfma_f32_16x16x32_bf16 a[240:243], v[228:231], v[144:147], a[240:243]
    s_waitcnt lgkmcnt(0)
    v_and_b32 v244, 0x40004000, v245
    v_cmp_ne_u32 vcc, 0, v244
    v_mfma_f32_16x16x32_bf16 a[244:247], v[228:231], v[148:151], a[244:247]
    s_cselect_b64 vcc, -1, vcc
    v_mfma_f32_16x16x32_bf16 a[248:251], v[228:231], v[152:155], a[248:251]
    s_cbranch_vccnz Lx3_3
Lxb3_3:
    v_mfma_f32_16x16x32_bf16 v[104:107], a[160:163], v[0:3], v[184:187]
    ds_read_b64_tr_b16 a[192:193], v208 offset:16384
    v_exp_f32 v224, v80
    v_mfma_f32_16x16x32_bf16 v[112:115], a[160:163], v[16:19], v[188:191]
    ds_read_b64_tr_b16 a[194:195], v208 offset:24576
    v_exp_f32 v225, v81
    v_mfma_f32_16x16x32_bf16 v[120:123], a[160:163], v[32:35], v[192:195]
    ds_read_b64_tr_b16 a[196:197], v209 offset:16384
    v_cvt_pk_bf16_f32 v152, v224, v225
    v_mfma_f32_16x16x32_bf16 v[104:107], a[164:167], v[4:7], v[104:107]
    ds_read_b64_tr_b16 a[198:199], v209 offset:24576
    v_exp_f32 v226, v82
    v_mfma_f32_16x16x32_bf16 v[112:115], a[164:167], v[20:23], v[112:115]
    ds_read_b64_tr_b16 a[200:201], v210 offset:16384
    v_exp_f32 v227, v83
    v_mfma_f32_16x16x32_bf16 v[120:123], a[164:167], v[36:39], v[120:123]
    ds_read_b64_tr_b16 a[202:203], v210 offset:24576
    v_cvt_pk_bf16_f32 v153, v226, v227
    v_mfma_f32_16x16x32_bf16 v[104:107], a[168:171], v[8:11], v[104:107]
    ds_read_b64_tr_b16 a[204:205], v211 offset:16384
    v_or_b32 v245, v152, v153
    v_mfma_f32_16x16x32_bf16 v[112:115], a[168:171], v[24:27], v[112:115]
    ds_read_b64_tr_b16 a[206:207], v211 offset:24576
    v_exp_f32 v248, v84
    v_mfma_f32_16x16x32_bf16 v[120:123], a[168:171], v[40:43], v[120:123]
    v_exp_f32 v249, v85
    v_mfma_f32_16x16x32_bf16 v[104:107], a[172:175], v[12:15], v[104:107]
    ds_read_b64_tr_b16 a[208:209], v212 offset:16384
    v_cvt_pk_bf16_f32 v154, v248, v249
    v_mfma_f32_16x16x32_bf16 v[112:115], a[172:175], v[28:31], v[112:115]
    ds_read_b64_tr_b16 a[210:211], v212 offset:24576
    v_mfma_f32_16x16x32_bf16 v[120:123], a[172:175], v[44:47], v[120:123]
    ds_read_b64_tr_b16 a[212:213], v213 offset:16384
    v_mfma_f32_16x16x32_bf16 v[108:111], a[176:179], v[0:3], v[184:187]
    ds_read_b64_tr_b16 a[214:215], v213 offset:24576
    v_mfma_f32_16x16x32_bf16 v[116:119], a[176:179], v[16:19], v[188:191]
    ds_read_b64_tr_b16 a[216:217], v214 offset:16384
    v_mfma_f32_16x16x32_bf16 v[124:127], a[176:179], v[32:35], v[192:195]
    ds_read_b64_tr_b16 a[218:219], v214 offset:24576
    v_mfma_f32_16x16x32_bf16 v[108:111], a[180:183], v[4:7], v[108:111]
    ds_read_b64_tr_b16 a[220:221], v215 offset:16384
    v_exp_f32 v250, v86
    v_mfma_f32_16x16x32_bf16 v[116:119], a[180:183], v[20:23], v[116:119]
    ds_read_b64_tr_b16 a[222:223], v215 offset:24576
    v_mfma_f32_16x16x32_bf16 v[124:127], a[180:183], v[36:39], v[124:127]
    v_exp_f32 v251, v87
    v_mfma_f32_16x16x32_bf16 v[108:111], a[184:187], v[8:11], v[108:111]
    v_exp_f32 v224, v72
    v_mfma_f32_16x16x32_bf16 v[116:119], a[184:187], v[24:27], v[116:119]
    s_add_u32 m0, s41, 16384
    v_exp_f32 v225, v73
    v_mfma_f32_16x16x32_bf16 v[124:127], a[184:187], v[40:43], v[124:127]
    s_add_u32 s40, s40, 131072
    v_exp_f32 v226, v74
    v_mfma_f32_16x16x32_bf16 v[108:111], a[188:191], v[12:15], v[108:111]
    s_add_u32 s63, s63, 131072
    v_exp_f32 v227, v75
    v_mfma_f32_16x16x32_bf16 v[116:119], a[188:191], v[28:31], v[116:119]
    s_waitcnt vmcnt(8) lgkmcnt(0)
    v_exp_f32 v248, v76
    v_mfma_f32_16x16x32_bf16 v[124:127], a[188:191], v[44:47], v[124:127]
    s_barrier
    v_mfma_f32_16x16x32_bf16 a[0:3], a[192:195], v[164:167], a[0:3]
    ds_read_b128 a[160:163], v204 offset:32768
    v_cvt_pk_bf16_f32 v155, v250, v251
    v_mfma_f32_16x16x32_bf16 a[32:35], a[192:195], v[168:171], a[32:35]
    ds_read_b128 a[164:167], v205 offset:32768
    v_or3_b32 v245, v245, v154, v155
    v_mfma_f32_16x16x32_bf16 a[64:67], a[192:195], v[172:175], a[64:67]
    v_exp_f32 v249, v77
    v_mfma_f32_16x16x32_bf16 a[4:7], a[196:199], v[164:167], a[4:7]
    buffer_load_dwordx4 v218, s[20:23], s40 offen lds
    v_cvt_pk_bf16_f32 v148, v224, v225
    v_mfma_f32_16x16x32_bf16 a[36:39], a[196:199], v[168:171], a[36:39]
    v_exp_f32 v250, v78
    v_mfma_f32_16x16x32_bf16 a[68:71], a[196:199], v[172:175], a[68:71]
    ds_read_b128 a[168:171], v206 offset:32768
    v_cvt_pk_bf16_f32 v149, v226, v227
    v_mfma_f32_16x16x32_bf16 a[8:11], a[200:203], v[164:167], a[8:11]
    v_exp_f32 v251, v79
    v_mfma_f32_16x16x32_bf16 a[40:43], a[200:203], v[168:171], a[40:43]
    ds_read_b128 a[172:175], v207 offset:32768
    v_or3_b32 v245, v245, v148, v149
    v_mfma_f32_16x16x32_bf16 a[72:75], a[200:203], v[172:175], a[72:75]
    v_exp_f32 v224, v64
    v_mfma_f32_16x16x32_bf16 a[12:15], a[204:207], v[164:167], a[12:15]
    buffer_load_dwordx4 v219, s[20:23], s40 offen offset:1024 lds
    v_cvt_pk_bf16_f32 v150, v248, v249
    v_mfma_f32_16x16x32_bf16 a[44:47], a[204:207], v[168:171], a[44:47]
    ds_read_b128 a[176:179], v204 offset:40960
    v_cvt_pk_bf16_f32 v151, v250, v251
    v_mfma_f32_16x16x32_bf16 a[76:79], a[204:207], v[172:175], a[76:79]
    v_exp_f32 v225, v65
    v_mfma_f32_16x16x32_bf16 a[16:19], a[208:211], v[164:167], a[16:19]
    ds_read_b128 a[180:183], v205 offset:40960
    v_or3_b32 v245, v245, v150, v151
    v_mfma_f32_16x16x32_bf16 a[48:51], a[208:211], v[168:171], a[48:51]
    v_exp_f32 v226, v66
    v_mfma_f32_16x16x32_bf16 a[80:83], a[208:211], v[172:175], a[80:83]
    ds_read_b128 a[184:187], v206 offset:40960
    v_cvt_pk_bf16_f32 v144, v224, v225
    v_mfma_f32_16x16x32_bf16 a[20:23], a[212:215], v[164:167], a[20:23]
    v_exp_f32 v227, v67
    v_mfma_f32_16x16x32_bf16 a[52:55], a[212:215], v[168:171], a[52:55]
    buffer_load_dwordx4 v216, s[16:19], s63 offen offset:2048 lds
    v_cvt_pk_bf16_f32 v145, v226, v227
    v_mfma_f32_16x16x32_bf16 a[84:87], a[212:215], v[172:175], a[84:87]
    v_exp_f32 v248, v68
    v_mfma_f32_16x16x32_bf16 a[24:27], a[216:219], v[164:167], a[24:27]
    ds_read_b128 a[188:191], v207 offset:40960
    v_or3_b32 v245, v245, v144, v145
    v_mfma_f32_16x16x32_bf16 a[56:59], a[216:219], v[168:171], a[56:59]
    v_exp_f32 v249, v69
    v_mfma_f32_16x16x32_bf16 a[88:91], a[216:219], v[172:175], a[88:91]
    v_exp_f32 v250, v70
    v_mfma_f32_16x16x32_bf16 a[28:31], a[220:223], v[164:167], a[28:31]
    v_exp_f32 v251, v71
    v_mfma_f32_16x16x32_bf16 a[60:63], a[220:223], v[168:171], a[60:63]
    buffer_load_dwordx4 v217, s[16:19], s63 offen offset:3072 lds
    v_cvt_pk_bf16_f32 v146, v248, v249
    v_mfma_f32_16x16x32_bf16 a[92:95], a[220:223], v[172:175], a[92:95]
    s_sub_u32 s42, s42, 1
    v_cvt_pk_bf16_f32 v147, v250, v251
    v_or3_b32 v245, v245, v146, v147
    v_mfma_f32_16x16x32_bf16 a[240:243], v[228:231], v[164:167], a[240:243]
    s_waitcnt lgkmcnt(0)
    v_and_b32 v244, 0x40004000, v245
    v_cmp_ne_u32 vcc, 0, v244
    v_mfma_f32_16x16x32_bf16 a[244:247], v[228:231], v[168:171], a[244:247]
    s_cselect_b64 vcc, -1, vcc
    v_mfma_f32_16x16x32_bf16 a[248:251], v[228:231], v[172:175], a[248:251]
    s_cbranch_vccnz Lx3_0
Lxb3_0:
    v_mfma_f32_16x16x32_bf16 v[64:67], a[160:163], v[0:3], v[184:187]
    ds_read_b64_tr_b16 a[192:193], v208 offset:32768
    v_exp_f32 v224, v120
    v_mfma_f32_16x16x32_bf16 v[72:75], a[160:163], v[16:19], v[188:191]
    ds_read_b64_tr_b16 a[194:195], v208 offset:40960
    v_exp_f32 v225, v121
    v_mfma_f32_16x16x32_bf16 v[80:83], a[160:163], v[32:35], v[192:195]
    ds_read_b64_tr_b16 a[196:197], v209 offset:32768
    v_cvt_pk_bf16_f32 v172, v224, v225
    v_mfma_f32_16x16x32_bf16 v[64:67], a[164:167], v[4:7], v[64:67]
    ds_read_b64_tr_b16 a[198:199], v209 offset:40960
    v_exp_f32 v226, v122
    v_mfma_f32_16x16x32_bf16 v[72:75], a[164:167], v[20:23], v[72:75]
    ds_read_b64_tr_b16 a[200:201], v210 offset:32768
    v_exp_f32 v227, v123
    v_mfma_f32_16x16x32_bf16 v[80:83], a[164:167], v[36:39], v[80:83]
    ds_read_b64_tr_b16 a[202:203], v210 offset:40960
    v_cvt_pk_bf16_f32 v173, v226, v227
    v_mfma_f32_16x16x32_bf16 v[64:67], a[168:171], v[8:11], v[64:67]
    ds_read_b64_tr_b16 a[204:205], v211 offset:32768
    v_or_b32 v245, v172, v173
    v_mfma_f32_16x16x32_bf16 v[72:75], a[168:171], v[24:27], v[72:75]
    ds_read_b64_tr_b16 a[206:207], v211 offset:40960
    v_exp_f32 v248, v124
    v_mfma_f32_16x16x32_bf16 v[80:83], a[168:171], v[40:43], v[80:83]
    v_exp_f32 v249, v125
    v_mfma_f32_16x16x32_bf16 v[64:67], a[172:175], v[12:15], v[64:67]
    ds_read_b64_tr_b16 a[208:209], v212 offset:32768
    v_cvt_pk_bf16_f32 v174, v248, v249
    v_mfma_f32_16x16x32_bf16 v[72:75], a[172:175], v[28:31], v[72:75]
    ds_read_b64_tr_b16 a[210:211], v212 offset:40960
    v_mfma_f32_16x16x32_bf16 v[80:83], a[172:175], v[44:47], v[80:83]
    ds_read_b64_tr_b16 a[212:213], v213 offset:32768
    v_mfma_f32_16x16x32_bf16 v[68:71], a[176:179], v[0:3], v[184:187]
    ds_read_b64_tr_b16 a[214:215], v213 offset:40960
    v_mfma_f32_16x16x32_bf16 v[76:79], a[176:179], v[16:19], v[188:191]
    ds_read_b64_tr_b16 a[216:217], v214 offset:32768
    v_mfma_f32_16x16x32_bf16 v[84:87], a[176:179], v[32:35], v[192:195]
    ds_read_b64_tr_b16 a[218:219], v214 offset:40960
    v_mfma_f32_16x16x32_bf16 v[68:71], a[180:183], v[4:7], v[68:71]
    ds_read_b64_tr_b16 a[220:221], v215 offset:32768
    v_exp_f32 v250, v126
    v_mfma_f32_16x16x32_bf16 v[76:79], a[180:183], v[20:23], v[76:79]
    ds_read_b64_tr_b16 a[222:223], v215 offset:40960
    v_mfma_f32_16x16x32_bf16 v[84:87], a[180:183], v[36:39], v[84:87]
    v_exp_f32 v251, v127
    v_mfma_f32_16x16x32_bf16 v[68:71], a[184:187], v[8:11], v[68:71]
    v_exp_f32 v224, v112
    v_mfma_f32_16x16x32_bf16 v[76:79], a[184:187], v[24:27], v[76:79]
    s_add_u32 m0, s41, 32768
    v_exp_f32 v225, v113
    v_mfma_f32_16x16x32_bf16 v[84:87], a[184:187], v[40:43], v[84:87]
    s_add_u32 s40, s40, 131072
    v_exp_f32 v226, v114
    v_mfma_f32_16x16x32_bf16 v[68:71], a[188:191], v[12:15], v[68:71]
    s_add_u32 s63, s63, 131072
    v_exp_f32 v227, v115
    v_mfma_f32_16x16x32_bf16 v[76:79], a[188:191], v[28:31], v[76:79]
    s_waitcnt vmcnt(8) lgkmcnt(0)
    v_exp_f32 v248, v116
    v_mfma_f32_16x16x32_bf16 v[84:87], a[188:191], v[44:47], v[84:87]
    s_barrier
    v_mfma_f32_16x16x32_bf16 a[0:3], a[192:195], v[144:147], a[0:3]
    ds_read_b128 a[160:163], v204 offset:49152
    v_cvt_pk_bf16_f32 v175, v250, v251
    v_mfma_f32_16x16x32_bf16 a[32:35], a[192:195], v[148:151], a[32:35]
    ds_read_b128 a[164:167], v205 offset:49152
    v_or3_b32 v245, v245, v174, v175
    v_mfma_f32_16x16x32_bf16 a[64:67], a[192:195], v[152:155], a[64:67]
    v_exp_f32 v249, v117
    v_mfma_f32_16x16x32_bf16 a[4:7], a[196:199], v[144:147], a[4:7]
    buffer_load_dwordx4 v218, s[20:23], s40 offen lds
    v_cvt_pk_bf16_f32 v168, v224, v225
    v_mfma_f32_16x16x32_bf16 a[36:39], a[196:199], v[148:151], a[36:39]
    v_exp_f32 v250, v118
    v_mfma_f32_16x16x32_bf16 a[68:71], a[196:199], v[152:155], a[68:71]
    ds_read_b128 a[168:171], v206 offset:49152
    v_cvt_pk_bf16_f32 v169, v226, v227
    v_mfma_f32_16x16x32_bf16 a[8:11], a[200:203], v[144:147], a[8:11]
    v_exp_f32 v251, v119
    v_mfma_f32_16x16x32_bf16 a[40:43], a[200:203], v[148:151], a[40:43]
    ds_read_b128 a[172:175], v207 offset:49152
    v_or3_b32 v245, v245, v168, v169
    v_mfma_f32_16x16x32_bf16 a[72:75], a[200:203], v[152:155], a[72:75]
    v_exp_f32 v224, v104
    v_mfma_f32_16x16x32_bf16 a[12:15], a[204:207], v[144:147], a[12:15]
    buffer_load_dwordx4 v219, s[20:23], s40 offen offset:1024 lds
    v_cvt_pk_bf16_f32 v170, v248, v249
    v_mfma_f32_16x16x32_bf16 a[44:47], a[204:207], v[148:151], a[44:47]
    ds_read_b128 a[176:179], v204 offset:57344
    v_cvt_pk_bf16_f32 v171, v250, v251
    v_mfma_f32_16x16x32_bf16 a[76:79], a[204:207], v[152:155], a[76:79]
    v_exp_f32 v225, v105
    v_mfma_f32_16x16x32_bf16 a[16:19], a[208:211], v[144:147], a[16:19]
    ds_read_b128 a[180:183], v205 offset:57344
    v_or3_b32 v245, v245, v170, v171
    v_mfma_f32_16x16x32_bf16 a[48:51], a[208:211], v[148:151], a[48:51]
    v_exp_f32 v226, v106
    v_mfma_f32_16x16x32_bf16 a[80:83], a[208:211], v[152:155], a[80:83]
    ds_read_b128 a[184:187], v206 offset:57344
    v_cvt_pk_bf16_f32 v164, v224, v225
    v_mfma_f32_16x16x32_bf16 a[20:23], a[212:215], v[144:147], a[20:23]
    v_exp_f32 v227, v107
    v_mfma_f32_16x16x32_bf16 a[52:55], a[212:215], v[148:151], a[52:55]
    buffer_load_dwordx4 v216, s[16:19], s63 offen offset:2048 lds
    v_cvt_pk_bf16_f32 v165, v226, v227
    v_mfma_f32_16x16x32_bf16 a[84:87], a[212:215], v[152:155], a[84:87]
    v_exp_f32 v248, v108
    v_mfma_f32_16x16x32_bf16 a[24:27], a[216:219], v[144:147], a[24:27]
    ds_read_b128 a[188:191], v207 offset:57344
    v_or3_b32 v245, v245, v164, v165
    v_mfma_f32_16x16x32_bf16 a[56:59], a[216:219], v[148:151], a[56:59]
    v_exp_f32 v249, v109
    v_mfma_f32_16x16x32_bf16 a[88:91], a[216:219], v[152:155], a[88:91]
    v_exp_f32 v250, v110
    v_mfma_f32_16x16x32_bf16 a[28:31], a[220:223], v[144:147], a[28:31]
    v_exp_f32 v251, v111
    v_mfma_f32_16x16x32_bf16 a[60:63], a[220:223], v[148:151], a[60:63]
    buffer_load_dwordx4 v217, s[16:19], s63 offen offset:3072 lds
    v_cvt_pk_bf16_f32 v166, v248, v249
    v_mfma_f32_16x16x32_bf16 a[92:95], a[220:223], v[152:155], a[92:95]
    s_sub_u32 s42, s42, 1
    v_cvt_pk_bf16_f32 v167, v250, v251
    v_or3_b32 v245, v245, v166, v167
    v_mfma_f32_16x16x32_bf16 a[240:243], v[228:231], v[144:147], a[240:243]
    s_waitcnt lgkmcnt(0)
    v_and_b32 v244, 0x40004000, v245
    v_cmp_ne_u32 vcc, 0, v244
    v_mfma_f32_16x16x32_bf16 a[244:247], v[228:231], v[148:151], a[244:247]
    s_cselect_b64 vcc, -1, vcc
    v_mfma_f32_16x16x32_bf16 a[248:251], v[228:231], v[152:155], a[248:251]
    s_cbranch_vccnz Lx3_1
Lxb3_1:
    s_branch Lsloop3
Lx3_0:
    v_cmp_ne_u32 vcc, 0, v244
    s_cbranch_vccnz Lrare_x3_0
Lback_x3_0:
    s_cbranch_scc1 Lxs3_0
    s_branch Lxb3_0
Lx3_1:
    v_cmp_ne_u32 vcc, 0, v244
    s_cbranch_vccnz Lrare_x3_1
Lback_x3_1:
    s_branch Lxb3_1
Lx3_2:
    v_cmp_ne_u32 vcc, 0, v244
    s_cbranch_vccnz Lrare_x3_2
Lback_x3_2:
    s_branch Lxb3_2
Lx3_3:
    v_cmp_ne_u32 vcc, 0, v244
    s_cbranch_vccnz Lrare_x3_3
Lback_x3_3:
    s_cbranch_scc1 Lxs3_3
    s_branch Lxb3_3
Lxs3_0:
Ltail3_1_1:
    v_mfma_f32_16x16x32_bf16 a[240:243], v[228:231], v[144:147], a[240:243]
    ds_read_b64_tr_b16 a[192:193], v208 offset:32768
    v_mfma_f32_16x16x32_bf16 a[244:247], v[228:231], v[148:151], a[244:247]
    ds_read_b64_tr_b16 a[194:195], v208 offset:40960
    v_mfma_f32_16x16x32_bf16 a[248:251], v[228:231], v[152:155], a[248:251]
    ds_read_b64_tr_b16 a[196:197], v209 offset:32768
    ds_read_b64_tr_b16 a[198:199], v209 offset:40960
    ds_read_b64_tr_b16 a[200:201], v210 offset:32768
    ds_read_b64_tr_b16 a[202:203], v210 offset:40960
    ds_read_b64_tr_b16 a[204:205], v211 offset:32768
    ds_read_b64_tr_b16 a[206:207], v211 offset:40960
    ds_read_b64_tr_b16 a[208:209], v212 offset:32768
    ds_read_b64_tr_b16 a[210:211], v212 offset:40960
    ds_read_b64_tr_b16 a[212:213], v213 offset:32768
    ds_read_b64_tr_b16 a[214:215], v213 offset:40960
    ds_read_b64_tr_b16 a[216:217], v214 offset:32768
    ds_read_b64_tr_b16 a[218:219], v214 offset:40960
    ds_read_b64_tr_b16 a[220:221], v215 offset:32768
    ds_read_b64_tr_b16 a[222:223], v215 offset:40960
    v_accvgpr_read_b32 v252, a240
    v_accvgpr_read_b32 v253, a244
    v_accvgpr_read_b32 v254, a248
    v_max3_f32 v237, v252, v253, v254
    v_cmp_le_f32 vcc, s66, v237
    v_exp_f32 v224, v120
    v_exp_f32 v225, v121
    s_cmp_lg_u64 vcc, 0
    s_cselect_b32 s61, 1, 0
    s_andn2_b32 s61, s61, s65
    v_mov_b32 v237, s61
    ds_write_b32 v239, v237 offset:16384
    v_exp_f32 v226, v122
    v_exp_f32 v227, v123
    v_cvt_pk_bf16_f32 v172, v224, v225
    v_exp_f32 v248, v124
    v_exp_f32 v249, v125
    v_cvt_pk_bf16_f32 v173, v226, v227
    v_or_b32 v245, v172, v173
    v_exp_f32 v250, v126
    v_exp_f32 v251, v127
    v_cvt_pk_bf16_f32 v174, v248, v249
    v_exp_f32 v224, v112
    v_exp_f32 v225, v113
    v_cvt_pk_bf16_f32 v175, v250, v251
    v_or3_b32 v245, v245, v174, v175
    v_exp_f32 v226, v114
    v_exp_f32 v227, v115
    s_waitcnt vmcnt(8) lgkmcnt(0)
    s_barrier
    v_mfma_f32_16x16x32_bf16 a[0:3], a[192:195], v[144:147], a[0:3]
    ds_read_b32 v237, v236
    s_mov_b32 m0, s41
    s_add_u32 s18, s30, 4096
    buffer_load_dwordx4 v216, s[16:19], s31 offen offset:2048 lds
    v_mfma_f32_16x16x32_bf16 a[32:35], a[192:195], v[148:151], a[32:35]
    ds_read_b64_tr_b16 a[160:161], v208 offset:49152
    v_cvt_pk_bf16_f32 v168, v224, v225
    v_cvt_pk_bf16_f32 v169, v226, v227
    v_mfma_f32_16x16x32_bf16 a[64:67], a[192:195], v[152:155], a[64:67]
    ds_read_b64_tr_b16 a[162:163], v208 offset:57344
    v_or3_b32 v245, v245, v168, v169
    v_exp_f32 v248, v116
    v_mfma_f32_16x16x32_bf16 a[4:7], a[196:199], v[144:147], a[4:7]
    ds_read_b64_tr_b16 a[164:165], v209 offset:49152
    v_exp_f32 v249, v117
    v_mfma_f32_16x16x32_bf16 a[36:39], a[196:199], v[148:151], a[36:39]
    buffer_load_dwordx4 v217, s[16:19], s31 offen offset:3072 lds
    v_cvt_pk_bf16_f32 v170, v248, v249
    v_exp_f32 v250, v118
    v_mfma_f32_16x16x32_bf16 a[68:71], a[196:199], v[152:155], a[68:71]
    ds_read_b64_tr_b16 a[166:167], v209 offset:57344
    v_exp_f32 v251, v119
    v_mfma_f32_16x16x32_bf16 a[8:11], a[200:203], v[144:147], a[8:11]
    ds_read_b64_tr_b16 a[168:169], v210 offset:49152
    v_cvt_pk_bf16_f32 v171, v250, v251
    v_mfma_f32_16x16x32_bf16 a[40:43], a[200:203], v[148:151], a[40:43]
    ds_read_b64_tr_b16 a[170:171], v210 offset:57344
    v_or3_b32 v245, v245, v170, v171
    v_mfma_f32_16x16x32_bf16 a[72:75], a[200:203], v[152:155], a[72:75]
    s_mov_b32 m0, s3
    s_add_u32 s61, s55, 0
    buffer_load_dwordx4 v220, s[12:15], s61 offen offset:0 nt lds
    v_mfma_f32_16x16x32_bf16 a[12:15], a[204:207], v[144:147], a[12:15]
    ds_read_b64_tr_b16 a[172:173], v211 offset:49152
    v_exp_f32 v224, v104
    v_mfma_f32_16x16x32_bf16 a[44:47], a[204:207], v[148:151], a[44:47]
    ds_read_b64_tr_b16 a[174:175], v211 offset:57344
    v_exp_f32 v225, v105
    v_mfma_f32_16x16x32_bf16 a[76:79], a[204:207], v[152:155], a[76:79]
    ds_read_b64_tr_b16 a[176:177], v212 offset:49152
    v_cvt_pk_bf16_f32 v164, v224, v225
    v_mfma_f32_16x16x32_bf16 a[16:19], a[208:211], v[144:147], a[16:19]
    ds_read_b64_tr_b16 a[178:179], v212 offset:57344
    buffer_load_dwordx4 v221, s[12:15], s61 offen offset:1024 nt lds
    v_mfma_f32_16x16x32_bf16 a[48:51], a[208:211], v[148:151], a[48:51]
    v_exp_f32 v226, v106
    v_mfma_f32_16x16x32_bf16 a[80:83], a[208:211], v[152:155], a[80:83]
    ds_read_b64_tr_b16 a[180:181], v213 offset:49152
    v_exp_f32 v227, v107
    v_mfma_f32_16x16x32_bf16 a[20:23], a[212:215], v[144:147], a[20:23]
    ds_read_b64_tr_b16 a[182:183], v213 offset:57344
    v_cvt_pk_bf16_f32 v165, v226, v227
    v_mfma_f32_16x16x32_bf16 a[52:55], a[212:215], v[148:151], a[52:55]
    ds_read_b64_tr_b16 a[184:185], v214 offset:49152
    buffer_load_dwordx4 v222, s[12:15], s61 offen offset:2048 nt lds
    v_mfma_f32_16x16x32_bf16 a[84:87], a[212:215], v[152:155], a[84:87]
    v_exp_f32 v248, v108
    v_or3_b32 v245, v245, v164, v165
    v_mfma_f32_16x16x32_bf16 a[24:27], a[216:219], v[144:147], a[24:27]
    ds_read_b64_tr_b16 a[186:187], v214 offset:57344
    v_exp_f32 v249, v109
    v_mfma_f32_16x16x32_bf16 a[56:59], a[216:219], v[148:151], a[56:59]
    ds_read_b64_tr_b16 a[188:189], v215 offset:49152
    v_cvt_pk_bf16_f32 v166, v248, v249
    v_mfma_f32_16x16x32_bf16 a[88:91], a[216:219], v[152:155], a[88:91]
    ds_read_b64_tr_b16 a[190:191], v215 offset:57344
    buffer_load_dwordx4 v223, s[12:15], s61 offen offset:3072 nt lds
    v_mfma_f32_16x16x32_bf16 a[28:31], a[220:223], v[144:147], a[28:31]
    v_exp_f32 v250, v110
    v_exp_f32 v251, v111
    v_mfma_f32_16x16x32_bf16 a[60:63], a[220:223], v[148:151], a[60:63]
    v_cvt_pk_bf16_f32 v167, v250, v251
    v_or3_b32 v245, v245, v166, v167
    v_mfma_f32_16x16x32_bf16 a[92:95], a[220:223], v[152:155], a[92:95]
    v_and_b32 v244, 0x40004000, v245
    v_cmp_ne_u32 vcc, 0, v244
    s_cbranch_vccnz Lrare_t3t1_1
Lback_t3t1_1:
    s_waitcnt lgkmcnt(8)
    v_cmp_ne_u32 vcc, 0, v237
    s_cbranch_vccnz Lrestart
    v_mfma_f32_16x16x32_bf16 a[240:243], v[228:231], v[164:167], a[240:243]
    s_add_u32 m0, s3, 4096
    s_add_u32 s61, s55, 65536
    buffer_load_dwordx4 v220, s[12:15], s61 offen offset:0 nt lds
    v_xor_b32 v184, 0, v240
    v_mfma_f32_16x16x32_bf16 a[244:247], v[228:231], v[168:171], a[244:247]
    v_xor_b32 v185, 32, v240
    v_mfma_f32_16x16x32_bf16 a[248:251], v[228:231], v[172:175], a[248:251]
    s_waitcnt lgkmcnt(6)
    v_xor_b32 v186, 64, v240
    v_mfma_f32_16x16x32_bf16 a[0:3], a[160:163], v[164:167], a[0:3]
    v_mfma_f32_16x16x32_bf16 a[4:7], a[164:167], v[164:167], a[4:7]
    buffer_load_dwordx4 v221, s[12:15], s61 offen offset:1024 nt lds
    v_xor_b32 v187, 96, v240
    v_mfma_f32_16x16x32_bf16 a[8:11], a[168:171], v[164:167], a[8:11]
    v_xor_b32 v188, 128, v240
    v_mfma_f32_16x16x32_bf16 a[12:15], a[172:175], v[164:167], a[12:15]
    v_xor_b32 v189, 160, v240
    v_mfma_f32_16x16x32_bf16 a[16:19], a[176:179], v[164:167], a[16:19]
    s_waitcnt lgkmcnt(0)
    v_mfma_f32_16x16x32_bf16 a[20:23], a[180:183], v[164:167], a[20:23]
    v_xor_b32 v190, 192, v240
    v_mfma_f32_16x16x32_bf16 a[24:27], a[184:187], v[164:167], a[24:27]
    buffer_load_dwordx4 v222, s[12:15], s61 offen offset:2048 nt lds
    v_xor_b32 v191, 224, v240
    v_mfma_f32_16x16x32_bf16 a[28:31], a[188:191], v[164:167], a[28:31]
    v_mfma_f32_16x16x32_bf16 a[32:35], a[160:163], v[168:171], a[32:35]
    v_accvgpr_read_b32 v244, a240
    v_accvgpr_read_b32 v245, a244
    v_accvgpr_read_b32 v246, a248
    v_mfma_f32_16x16x32_bf16 a[36:39], a[164:167], v[168:171], a[36:39]
    v_rcp_f32 v192, v244
    v_rcp_f32 v193, v245
    v_mfma_f32_16x16x32_bf16 a[40:43], a[168:171], v[168:171], a[40:43]
    buffer_load_dwordx4 v223, s[12:15], s61 offen offset:3072 nt lds
    v_rcp_f32 v194, v246
    v_accvgpr_read_b32 v0, a0
    v_accvgpr_read_b32 v1, a1
    v_mfma_f32_16x16x32_bf16 a[44:47], a[172:175], v[168:171], a[44:47]
    v_accvgpr_read_b32 v2, a2
    v_accvgpr_read_b32 v3, a3
    v_mfma_f32_16x16x32_bf16 a[48:51], a[176:179], v[168:171], a[48:51]
    v_accvgpr_read_b32 v4, a4
    v_accvgpr_read_b32 v5, a5
    v_mfma_f32_16x16x32_bf16 a[52:55], a[180:183], v[168:171], a[52:55]
    v_accvgpr_read_b32 v6, a6
    v_accvgpr_read_b32 v7, a7
    v_accvgpr_read_b32 v8, a8
    v_mfma_f32_16x16x32_bf16 a[56:59], a[184:187], v[168:171], a[56:59]
    v_accvgpr_read_b32 v9, a9
    v_accvgpr_read_b32 v10, a10
    v_mfma_f32_16x16x32_bf16 a[60:63], a[188:191], v[168:171], a[60:63]
    s_add_u32 m0, s41, 16384
    s_nop 0
    buffer_load_dwordx4 v216, s[16:19], s28 offen offset:2048 lds
    v_accvgpr_read_b32 v11, a11
    v_accvgpr_read_b32 v12, a12
    v_mfma_f32_16x16x32_bf16 a[64:67], a[160:163], v[172:175], a[64:67]
    v_accvgpr_read_b32 v13, a13
    v_accvgpr_read_b32 v14, a14
    v_accvgpr_read_b32 v15, a15
    v_mfma_f32_16x16x32_bf16 a[68:71], a[164:167], v[172:175], a[68:71]
    v_accvgpr_read_b32 v16, a16
    v_accvgpr_read_b32 v17, a17
    v_mfma_f32_16x16x32_bf16 a[72:75], a[168:171], v[172:175], a[72:75]
    v_accvgpr_read_b32 v18, a18
    v_accvgpr_read_b32 v19, a19
    v_accvgpr_read_b32 v20, a20
    v_mfma_f32_16x16x32_bf16 a[76:79], a[172:175], v[172:175], a[76:79]
    buffer_load_dwordx4 v217, s[16:19], s28 offen offset:3072 lds
    v_accvgpr_read_b32 v21, a21
    v_accvgpr_read_b32 v22, a22
    v_mfma_f32_16x16x32_bf16 a[80:83], a[176:179], v[172:175], a[80:83]
    v_accvgpr_read_b32 v23, a23
    v_accvgpr_read_b32 v24, a24
    v_mfma_f32_16x16x32_bf16 a[84:87], a[180:183], v[172:175], a[84:87]
    v_accvgpr_read_b32 v25, a25
    v_accvgpr_read_b32 v26, a26
    v_accvgpr_read_b32 v27, a27
    v_mfma_f32_16x16x32_bf16 a[88:91], a[184:187], v[172:175], a[88:91]
    v_accvgpr_read_b32 v28, a28
    v_accvgpr_read_b32 v29, a29
    v_mfma_f32_16x16x32_bf16 a[92:95], a[188:191], v[172:175], a[92:95]
    v_accvgpr_read_b32 v30, a30
    v_accvgpr_read_b32 v31, a31
    s_branch Lepi3
Lxs3_3:
    s_cmp_lg_u32 s29, 0
    s_cbranch_scc1 Ltail3_0_1
Ltail3_0_0:
    v_mfma_f32_16x16x32_bf16 a[240:243], v[228:231], v[164:167], a[240:243]
    ds_read_b64_tr_b16 a[192:193], v208 offset:16384
    v_mfma_f32_16x16x32_bf16 a[244:247], v[228:231], v[168:171], a[244:247]
    ds_read_b64_tr_b16 a[194:195], v208 offset:24576
    v_mfma_f32_16x16x32_bf16 a[248:251], v[228:231], v[172:175], a[248:251]
    ds_read_b64_tr_b16 a[196:197], v209 offset:16384
    ds_read_b64_tr_b16 a[198:199], v209 offset:24576
    ds_read_b64_tr_b16 a[200:201], v210 offset:16384
    ds_read_b64_tr_b16 a[202:203], v210 offset:24576
    ds_read_b64_tr_b16 a[204:205], v211 offset:16384
    ds_read_b64_tr_b16 a[206:207], v211 offset:24576
    ds_read_b64_tr_b16 a[208:209], v212 offset:16384
    ds_read_b64_tr_b16 a[210:211], v212 offset:24576
    ds_read_b64_tr_b16 a[212:213], v213 offset:16384
    ds_read_b64_tr_b16 a[214:215], v213 offset:24576
    ds_read_b64_tr_b16 a[216:217], v214 offset:16384
    ds_read_b64_tr_b16 a[218:219], v214 offset:24576
    ds_read_b64_tr_b16 a[220:221], v215 offset:16384
    ds_read_b64_tr_b16 a[222:223], v215 offset:24576
    v_accvgpr_read_b32 v252, a240
    v_accvgpr_read_b32 v253, a244
    v_accvgpr_read_b32 v254, a248
    v_max3_f32 v237, v252, v253, v254
    v_cmp_le_f32 vcc, s66, v237
    v_exp_f32 v224, v80
    v_exp_f32 v225, v81
    s_cmp_lg_u64 vcc, 0
    s_cselect_b32 s61, 1, 0
    s_andn2_b32 s61, s61, s65
    v_mov_b32 v237, s61
    ds_write_b32 v239, v237 offset:16384
    v_exp_f32 v226, v82
    v_exp_f32 v227, v83
    v_cvt_pk_bf16_f32 v152, v224, v225
    v_exp_f32 v248, v84
    v_exp_f32 v249, v85
    v_cvt_pk_bf16_f32 v153, v226, v227
    v_or_b32 v245, v152, v153
    v_exp_f32 v250, v86
    v_exp_f32 v251, v87
    v_cvt_pk_bf16_f32 v154, v248, v249
    v_exp_f32 v224, v72
    v_exp_f32 v225, v73
    v_cvt_pk_bf16_f32 v155, v250, v251
    v_or3_b32 v245, v245, v154, v155
    v_exp_f32 v226, v74
    v_exp_f32 v227, v75
    s_waitcnt vmcnt(8) lgkmcnt(0)
    s_barrier
    v_mfma_f32_16x16x32_bf16 a[0:3], a[192:195], v[164:167], a[0:3]
    ds_read_b32 v237, v236
    v_cvt_pk_bf16_f32 v148, v224, v225
    v_mfma_f32_16x16x32_bf16 a[32:35], a[192:195], v[168:171], a[32:35]
    ds_read_b64_tr_b16 a[160:161], v208 offset:32768
    v_cvt_pk_bf16_f32 v149, v226, v227
    v_mfma_f32_16x16x32_bf16 a[64:67], a[192:195], v[172:175], a[64:67]
    ds_read_b64_tr_b16 a[162:163], v208 offset:40960
    v_or3_b32 v245, v245, v148, v149
    v_mfma_f32_16x16x32_bf16 a[4:7], a[196:199], v[164:167], a[4:7]
    ds_read_b64_tr_b16 a[164:165], v209 offset:32768
    v_exp_f32 v248, v76
    v_mfma_f32_16x16x32_bf16 a[36:39], a[196:199], v[168:171], a[36:39]
    v_exp_f32 v249, v77
    v_mfma_f32_16x16x32_bf16 a[68:71], a[196:199], v[172:175], a[68:71]
    ds_read_b64_tr_b16 a[166:167], v209 offset:40960
    v_cvt_pk_bf16_f32 v150, v248, v249
    v_mfma_f32_16x16x32_bf16 a[8:11], a[200:203], v[164:167], a[8:11]
    ds_read_b64_tr_b16 a[168:169], v210 offset:32768
    v_exp_f32 v250, v78
    v_mfma_f32_16x16x32_bf16 a[40:43], a[200:203], v[168:171], a[40:43]
    ds_read_b64_tr_b16 a[170:171], v210 offset:40960
    v_exp_f32 v251, v79
    v_mfma_f32_16x16x32_bf16 a[72:75], a[200:203], v[172:175], a[72:75]
    v_exp_f32 v224, v64
    v_mfma_f32_16x16x32_bf16 a[12:15], a[204:207], v[164:167], a[12:15]
    ds_read_b64_tr_b16 a[172:173], v211 offset:32768
    v_cvt_pk_bf16_f32 v151, v250, v251
    v_mfma_f32_16x16x32_bf16 a[44:47], a[204:207], v[168:171], a[44:47]
    ds_read_b64_tr_b16 a[174:175], v211 offset:40960
    v_or3_b32 v245, v245, v150, v151
    v_mfma_f32_16x16x32_bf16 a[76:79], a[204:207], v[172:175], a[76:79]
    ds_read_b64_tr_b16 a[176:177], v212 offset:32768
    v_exp_f32 v225, v65
    v_mfma_f32_16x16x32_bf16 a[16:19], a[208:211], v[164:167], a[16:19]
    ds_read_b64_tr_b16 a[178:179], v212 offset:40960
    v_cvt_pk_bf16_f32 v144, v224, v225
    v_mfma_f32_16x16x32_bf16 a[48:51], a[208:211], v[168:171], a[48:51]
    v_exp_f32 v226, v66
    v_mfma_f32_16x16x32_bf16 a[80:83], a[208:211], v[172:175], a[80:83]
    ds_read_b64_tr_b16 a[180:181], v213 offset:32768
    v_exp_f32 v227, v67
    v_mfma_f32_16x16x32_bf16 a[20:23], a[212:215], v[164:167], a[20:23]
    ds_read_b64_tr_b16 a[182:183], v213 offset:40960
    v_cvt_pk_bf16_f32 v145, v226, v227
    v_mfma_f32_16x16x32_bf16 a[52:55], a[212:215], v[168:171], a[52:55]
    ds_read_b64_tr_b16 a[184:185], v214 offset:32768
    v_or3_b32 v245, v245, v144, v145
    v_mfma_f32_16x16x32_bf16 a[84:87], a[212:215], v[172:175], a[84:87]
    v_exp_f32 v248, v68
    v_mfma_f32_16x16x32_bf16 a[24:27], a[216:219], v[164:167], a[24:27]
    ds_read_b64_tr_b16 a[186:187], v214 offset:40960
    v_exp_f32 v249, v69
    v_mfma_f32_16x16x32_bf16 a[56:59], a[216:219], v[168:171], a[56:59]
    ds_read_b64_tr_b16 a[188:189], v215 offset:32768
    v_cvt_pk_bf16_f32 v146, v248, v249
    v_mfma_f32_16x16x32_bf16 a[88:91], a[216:219], v[172:175], a[88:91]
    ds_read_b64_tr_b16 a[190:191], v215 offset:40960
    v_exp_f32 v250, v70
    v_mfma_f32_16x16x32_bf16 a[28:31], a[220:223], v[164:167], a[28:31]
    v_exp_f32 v251, v71
    v_mfma_f32_16x16x32_bf16 a[60:63], a[220:223], v[168:171], a[60:63]
    v_cvt_pk_bf16_f32 v147, v250, v251
    v_or3_b32 v245, v245, v146, v147
    v_mfma_f32_16x16x32_bf16 a[92:95], a[220:223], v[172:175], a[92:95]
    v_and_b32 v244, 0x40004000, v245
    v_cmp_ne_u32 vcc, 0, v244
    s_cbranch_vccnz Lrare_t3t0_0
Lback_t3t0_0:
    s_waitcnt lgkmcnt(8)
    v_cmp_ne_u32 vcc, 0, v237
    s_cbranch_vccnz Lrestart
    v_mfma_f32_16x16x32_bf16 a[240:243], v[228:231], v[144:147], a[240:243]
    v_xor_b32 v184, 0, v240
    v_mfma_f32_16x16x32_bf16 a[244:247], v[228:231], v[148:151], a[244:247]
    v_xor_b32 v185, 32, v240
    v_mfma_f32_16x16x32_bf16 a[248:251], v[228:231], v[152:155], a[248:251]
    s_waitcnt lgkmcnt(6)
    v_xor_b32 v186, 64, v240
    v_mfma_f32_16x16x32_bf16 a[0:3], a[160:163], v[144:147], a[0:3]
    v_mfma_f32_16x16x32_bf16 a[4:7], a[164:167], v[144:147], a[4:7]
    v_xor_b32 v187, 96, v240
    v_mfma_f32_16x16x32_bf16 a[8:11], a[168:171], v[144:147], a[8:11]
    v_xor_b32 v188, 128, v240
    v_mfma_f32_16x16x32_bf16 a[12:15], a[172:175], v[144:147], a[12:15]
    v_xor_b32 v189, 160, v240
    v_mfma_f32_16x16x32_bf16 a[16:19], a[176:179], v[144:147], a[16:19]
    s_waitcnt lgkmcnt(0)
    v_mfma_f32_16x16x32_bf16 a[20:23], a[180:183], v[144:147], a[20:23]
    v_xor_b32 v190, 192, v240
    v_mfma_f32_16x16x32_bf16 a[24:27], a[184:187], v[144:147], a[24:27]
    v_xor_b32 v191, 224, v240
    v_mfma_f32_16x16x32_bf16 a[28:31], a[188:191], v[144:147], a[28:31]
    v_mfma_f32_16x16x32_bf16 a[32:35], a[160:163], v[148:151], a[32:35]
    v_accvgpr_read_b32 v244, a240
    v_accvgpr_read_b32 v245, a244
    v_accvgpr_read_b32 v246, a248
    v_mfma_f32_16x16x32_bf16 a[36:39], a[164:167], v[148:151], a[36:39]
    v_rcp_f32 v192, v244
    v_rcp_f32 v193, v245
    v_mfma_f32_16x16x32_bf16 a[40:43], a[168:171], v[148:151], a[40:43]
    v_rcp_f32 v194, v246
    v_accvgpr_read_b32 v0, a0
    v_accvgpr_read_b32 v1, a1
    v_mfma_f32_16x16x32_bf16 a[44:47], a[172:175], v[148:151], a[44:47]
    v_accvgpr_read_b32 v2, a2
    v_accvgpr_read_b32 v3, a3
    v_mfma_f32_16x16x32_bf16 a[48:51], a[176:179], v[148:151], a[48:51]
    v_accvgpr_read_b32 v4, a4
    v_accvgpr_read_b32 v5, a5
    v_mfma_f32_16x16x32_bf16 a[52:55], a[180:183], v[148:151], a[52:55]
    v_accvgpr_read_b32 v6, a6
    v_accvgpr_read_b32 v7, a7
    v_accvgpr_read_b32 v8, a8
    v_mfma_f32_16x16x32_bf16 a[56:59], a[184:187], v[148:151], a[56:59]
    v_accvgpr_read_b32 v9, a9
    v_accvgpr_read_b32 v10, a10
    v_mfma_f32_16x16x32_bf16 a[60:63], a[188:191], v[148:151], a[60:63]
    v_accvgpr_read_b32 v11, a11
    v_accvgpr_read_b32 v12, a12
    v_mfma_f32_16x16x32_bf16 a[64:67], a[160:163], v[152:155], a[64:67]
    v_accvgpr_read_b32 v13, a13
    v_accvgpr_read_b32 v14, a14
    v_accvgpr_read_b32 v15, a15
    v_mfma_f32_16x16x32_bf16 a[68:71], a[164:167], v[152:155], a[68:71]
    v_accvgpr_read_b32 v16, a16
    v_accvgpr_read_b32 v17, a17
    v_mfma_f32_16x16x32_bf16 a[72:75], a[168:171], v[152:155], a[72:75]
    v_accvgpr_read_b32 v18, a18
    v_accvgpr_read_b32 v19, a19
    v_accvgpr_read_b32 v20, a20
    v_mfma_f32_16x16x32_bf16 a[76:79], a[172:175], v[152:155], a[76:79]
    v_accvgpr_read_b32 v21, a21
    v_accvgpr_read_b32 v22, a22
    v_mfma_f32_16x16x32_bf16 a[80:83], a[176:179], v[152:155], a[80:83]
    v_accvgpr_read_b32 v23, a23
    v_accvgpr_read_b32 v24, a24
    v_mfma_f32_16x16x32_bf16 a[84:87], a[180:183], v[152:155], a[84:87]
    v_accvgpr_read_b32 v25, a25
    v_accvgpr_read_b32 v26, a26
    v_accvgpr_read_b32 v27, a27
    v_mfma_f32_16x16x32_bf16 a[88:91], a[184:187], v[152:155], a[88:91]
    v_accvgpr_read_b32 v28, a28
    v_accvgpr_read_b32 v29, a29
    v_mfma_f32_16x16x32_bf16 a[92:95], a[188:191], v[152:155], a[92:95]
    v_accvgpr_read_b32 v30, a30
    v_accvgpr_read_b32 v31, a31
    s_branch Lepi3
Ltail3_0_1:
    v_mfma_f32_16x16x32_bf16 a[240:243], v[228:231], v[164:167], a[240:243]
    ds_read_b64_tr_b16 a[192:193], v208 offset:16384
    v_mfma_f32_16x16x32_bf16 a[244:247], v[228:231], v[168:171], a[244:247]
    ds_read_b64_tr_b16 a[194:195], v208 offset:24576
    v_mfma_f32_16x16x32_bf16 a[248:251], v[228:231], v[172:175], a[248:251]
    ds_read_b64_tr_b16 a[196:197], v209 offset:16384
    ds_read_b64_tr_b16 a[198:199], v209 offset:24576
    ds_read_b64_tr_b16 a[200:201], v210 offset:16384
    ds_read_b64_tr_b16 a[202:203], v210 offset:24576
    ds_read_b64_tr_b16 a[204:205], v211 offset:16384
    ds_read_b64_tr_b16 a[206:207], v211 offset:24576
    ds_read_b64_tr_b16 a[208:209], v212 offset:16384
    ds_read_b64_tr_b16 a[210:211], v212 offset:24576
    ds_read_b64_tr_b16 a[212:213], v213 offset:16384
    ds_read_b64_tr_b16 a[214:215], v213 offset:24576
    ds_read_b64_tr_b16 a[216:217], v214 offset:16384
    ds_read_b64_tr_b16 a[218:219], v214 offset:24576
    ds_read_b64_tr_b16 a[220:221], v215 offset:16384
    ds_read_b64_tr_b16 a[222:223], v215 offset:24576
    v_accvgpr_read_b32 v252, a240
    v_accvgpr_read_b32 v253, a244
    v_accvgpr_read_b32 v254, a248
    v_max3_f32 v237, v252, v253, v254
    v_cmp_le_f32 vcc, s66, v237
    v_exp_f32 v224, v80
    v_exp_f32 v225, v81
    s_cmp_lg_u64 vcc, 0
    s_cselect_b32 s61, 1, 0
    s_andn2_b32 s61, s61, s65
    v_mov_b32 v237, s61
    ds_write_b32 v239, v237 offset:16384
    v_exp_f32 v226, v82
    v_exp_f32 v227, v83
    v_cvt_pk_bf16_f32 v152, v224, v225
    v_exp_f32 v248, v84
    v_exp_f32 v249, v85
    v_cvt_pk_bf16_f32 v153, v226, v227
    v_or_b32 v245, v152, v153
    v_exp_f32 v250, v86
    v_exp_f32 v251, v87
    v_cvt_pk_bf16_f32 v154, v248, v249
    v_exp_f32 v224, v72
    v_exp_f32 v225, v73
    v_cvt_pk_bf16_f32 v155, v250, v251
    v_or3_b32 v245, v245, v154, v155
    v_exp_f32 v226, v74
    v_exp_f32 v227, v75
    s_waitcnt vmcnt(8) lgkmcnt(0)
    s_barrier
    v_mfma_f32_16x16x32_bf16 a[0:3], a[192:195], v[164:167], a[0:3]
    ds_read_b32 v237, v236
    s_mov_b32 m0, s41
    s_add_u32 s18, s30, 4096
    buffer_load_dwordx4 v216, s[16:19], s31 offen offset:2048 lds
    v_mfma_f32_16x16x32_bf16 a[32:35], a[192:195], v[168:171], a[32:35]
    ds_read_b64_tr_b16 a[160:161], v208 offset:32768
    v_cvt_pk_bf16_f32 v148, v224, v225
    v_cvt_pk_bf16_f32 v149, v226, v227
    v_mfma_f32_16x16x32_bf16 a[64:67], a[192:195], v[172:175], a[64:67]
    ds_read_b64_tr_b16 a[162:163], v208 offset:40960
    v_or3_b32 v245, v245, v148, v149
    v_exp_f32 v248, v76
    v_mfma_f32_16x16x32_bf16 a[4:7], a[196:199], v[164:167], a[4:7]
    ds_read_b64_tr_b16 a[164:165], v209 offset:32768
    v_exp_f32 v249, v77
    v_mfma_f32_16x16x32_bf16 a[36:39], a[196:199], v[168:171], a[36:39]
    buffer_load_dwordx4 v217, s[16:19], s31 offen offset:3072 lds
    v_cvt_pk_bf16_f32 v150, v248, v249
    v_exp_f32 v250, v78
    v_mfma_f32_16x16x32_bf16 a[68:71], a[196:199], v[172:175], a[68:71]
    ds_read_b64_tr_b16 a[166:167], v209 offset:40960
    v_exp_f32 v251, v79
    v_mfma_f32_16x16x32_bf16 a[8:11], a[200:203], v[164:167], a[8:11]
    ds_read_b64_tr_b16 a[168:169], v210 offset:32768
    v_cvt_pk_bf16_f32 v151, v250, v251
    v_mfma_f32_16x16x32_bf16 a[40:43], a[200:203], v[168:171], a[40:43]
    ds_read_b64_tr_b16 a[170:171], v210 offset:40960
    v_or3_b32 v245, v245, v150, v151
    v_mfma_f32_16x16x32_bf16 a[72:75], a[200:203], v[172:175], a[72:75]
    s_mov_b32 m0, s3
    s_add_u32 s61, s55, 0
    buffer_load_dwordx4 v220, s[12:15], s61 offen offset:0 nt lds
    v_mfma_f32_16x16x32_bf16 a[12:15], a[204:207], v[164:167], a[12:15]
    ds_read_b64_tr_b16 a[172:173], v211 offset:32768
    v_exp_f32 v224, v64
    v_mfma_f32_16x16x32_bf16 a[44:47], a[204:207], v[168:171], a[44:47]
    ds_read_b64_tr_b16 a[174:175], v211 offset:40960
    v_exp_f32 v225, v65
    v_mfma_f32_16x16x32_bf16 a[76:79], a[204:207], v[172:175], a[76:79]
    ds_read_b64_tr_b16 a[176:177], v212 offset:32768
    v_cvt_pk_bf16_f32 v144, v224, v225
    v_mfma_f32_16x16x32_bf16 a[16:19], a[208:211], v[164:167], a[16:19]
    ds_read_b64_tr_b16 a[178:179], v212 offset:40960
    buffer_load_dwordx4 v221, s[12:15], s61 offen offset:1024 nt lds
    v_mfma_f32_16x16x32_bf16 a[48:51], a[208:211], v[168:171], a[48:51]
    v_exp_f32 v226, v66
    v_mfma_f32_16x16x32_bf16 a[80:83], a[208:211], v[172:175], a[80:83]
    ds_read_b64_tr_b16 a[180:181], v213 offset:32768
    v_exp_f32 v227, v67
    v_mfma_f32_16x16x32_bf16 a[20:23], a[212:215], v[164:167], a[20:23]
    ds_read_b64_tr_b16 a[182:183], v213 offset:40960
    v_cvt_pk_bf16_f32 v145, v226, v227
    v_mfma_f32_16x16x32_bf16 a[52:55], a[212:215], v[168:171], a[52:55]
    ds_read_b64_tr_b16 a[184:185], v214 offset:32768
    buffer_load_dwordx4 v222, s[12:15], s61 offen offset:2048 nt lds
    v_mfma_f32_16x16x32_bf16 a[84:87], a[212:215], v[172:175], a[84:87]
    v_exp_f32 v248, v68
    v_or3_b32 v245, v245, v144, v145
    v_mfma_f32_16x16x32_bf16 a[24:27], a[216:219], v[164:167], a[24:27]
    ds_read_b64_tr_b16 a[186:187], v214 offset:40960
    v_exp_f32 v249, v69
    v_mfma_f32_16x16x32_bf16 a[56:59], a[216:219], v[168:171], a[56:59]
    ds_read_b64_tr_b16 a[188:189], v215 offset:32768
    v_cvt_pk_bf16_f32 v146, v248, v249
    v_mfma_f32_16x16x32_bf16 a[88:91], a[216:219], v[172:175], a[88:91]
    ds_read_b64_tr_b16 a[190:191], v215 offset:40960
    buffer_load_dwordx4 v223, s[12:15], s61 offen offset:3072 nt lds
    v_mfma_f32_16x16x32_bf16 a[28:31], a[220:223], v[164:167], a[28:31]
    v_exp_f32 v250, v70
    v_exp_f32 v251, v71
    v_mfma_f32_16x16x32_bf16 a[60:63], a[220:223], v[168:171], a[60:63]
    v_cvt_pk_bf16_f32 v147, v250, v251
    v_or3_b32 v245, v245, v146, v147
    v_mfma_f32_16x16x32_bf16 a[92:95], a[220:223], v[172:175], a[92:95]
    v_and_b32 v244, 0x40004000, v245
    v_cmp_ne_u32 vcc, 0, v244
    s_cbranch_vccnz Lrare_t3t0_1
Lback_t3t0_1:
    s_waitcnt lgkmcnt(8)
    v_cmp_ne_u32 vcc, 0, v237
    s_cbranch_vccnz Lrestart
    v_mfma_f32_16x16x32_bf16 a[240:243], v[228:231], v[144:147], a[240:243]
    s_add_u32 m0, s3, 4096
    s_add_u32 s61, s55, 65536
    buffer_load_dwordx4 v220, s[12:15], s61 offen offset:0 nt lds
    v_xor_b32 v184, 0, v240
    v_mfma_f32_16x16x32_bf16 a[244:247], v[228:231], v[148:151], a[244:247]
    v_xor_b32 v185, 32, v240
    v_mfma_f32_16x16x32_bf16 a[248:251], v[228:231], v[152:155], a[248:251]
    s_waitcnt lgkmcnt(6)
    v_xor_b32 v186, 64, v240
    v_mfma_f32_16x16x32_bf16 a[0:3], a[160:163], v[144:147], a[0:3]
    v_mfma_f32_16x16x32_bf16 a[4:7], a[164:167], v[144:147], a[4:7]
    buffer_load_dwordx4 v221, s[12:15], s61 offen offset:1024 nt lds
    v_xor_b32 v187, 96, v240
    v_mfma_f32_16x16x32_bf16 a[8:11], a[168:171], v[144:147], a[8:11]
    v_xor_b32 v188, 128, v240
    v_mfma_f32_16x16x32_bf16 a[12:15], a[172:175], v[144:147], a[12:15]
    v_xor_b32 v189, 160, v240
    v_mfma_f32_16x16x32_bf16 a[16:19], a[176:179], v[144:147], a[16:19]
    s_waitcnt lgkmcnt(0)
    v_mfma_f32_16x16x32_bf16 a[20:23], a[180:183], v[144:147], a[20:23]
    v_xor_b32 v190, 192, v240
    v_mfma_f32_16x16x32_bf16 a[24:27], a[184:187], v[144:147], a[24:27]
    buffer_load_dwordx4 v222, s[12:15], s61 offen offset:2048 nt lds
    v_xor_b32 v191, 224, v240
    v_mfma_f32_16x16x32_bf16 a[28:31], a[188:191], v[144:147], a[28:31]
    v_mfma_f32_16x16x32_bf16 a[32:35], a[160:163], v[148:151], a[32:35]
    v_accvgpr_read_b32 v244, a240
    v_accvgpr_read_b32 v245, a244
    v_accvgpr_read_b32 v246, a248
    v_mfma_f32_16x16x32_bf16 a[36:39], a[164:167], v[148:151], a[36:39]
    v_rcp_f32 v192, v244
    v_rcp_f32 v193, v245
    v_mfma_f32_16x16x32_bf16 a[40:43], a[168:171], v[148:151], a[40:43]
    buffer_load_dwordx4 v223, s[12:15], s61 offen offset:3072 nt lds
    v_rcp_f32 v194, v246
    v_accvgpr_read_b32 v0, a0
    v_accvgpr_read_b32 v1, a1
    v_mfma_f32_16x16x32_bf16 a[44:47], a[172:175], v[148:151], a[44:47]
    v_accvgpr_read_b32 v2, a2
    v_accvgpr_read_b32 v3, a3
    v_mfma_f32_16x16x32_bf16 a[48:51], a[176:179], v[148:151], a[48:51]
    v_accvgpr_read_b32 v4, a4
    v_accvgpr_read_b32 v5, a5
    v_mfma_f32_16x16x32_bf16 a[52:55], a[180:183], v[148:151], a[52:55]
    v_accvgpr_read_b32 v6, a6
    v_accvgpr_read_b32 v7, a7
    v_accvgpr_read_b32 v8, a8
    v_mfma_f32_16x16x32_bf16 a[56:59], a[184:187], v[148:151], a[56:59]
    v_accvgpr_read_b32 v9, a9
    v_accvgpr_read_b32 v10, a10
    v_mfma_f32_16x16x32_bf16 a[60:63], a[188:191], v[148:151], a[60:63]
    s_add_u32 m0, s41, 16384
    s_nop 0
    buffer_load_dwordx4 v216, s[16:19], s28 offen offset:2048 lds
    v_accvgpr_read_b32 v11, a11
    v_accvgpr_read_b32 v12, a12
    v_mfma_f32_16x16x32_bf16 a[64:67], a[160:163], v[152:155], a[64:67]
    v_accvgpr_read_b32 v13, a13
    v_accvgpr_read_b32 v14, a14
    v_accvgpr_read_b32 v15, a15
    v_mfma_f32_16x16x32_bf16 a[68:71], a[164:167], v[152:155], a[68:71]
    v_accvgpr_read_b32 v16, a16
    v_accvgpr_read_b32 v17, a17
    v_mfma_f32_16x16x32_bf16 a[72:75], a[168:171], v[152:155], a[72:75]
    v_accvgpr_read_b32 v18, a18
    v_accvgpr_read_b32 v19, a19
    v_accvgpr_read_b32 v20, a20
    v_mfma_f32_16x16x32_bf16 a[76:79], a[172:175], v[152:155], a[76:79]
    buffer_load_dwordx4 v217, s[16:19], s28 offen offset:3072 lds
    v_accvgpr_read_b32 v21, a21
    v_accvgpr_read_b32 v22, a22
    v_mfma_f32_16x16x32_bf16 a[80:83], a[176:179], v[152:155], a[80:83]
    v_accvgpr_read_b32 v23, a23
    v_accvgpr_read_b32 v24, a24
    v_mfma_f32_16x16x32_bf16 a[84:87], a[180:183], v[152:155], a[84:87]
    v_accvgpr_read_b32 v25, a25
    v_accvgpr_read_b32 v26, a26
    v_accvgpr_read_b32 v27, a27
    v_mfma_f32_16x16x32_bf16 a[88:91], a[184:187], v[152:155], a[88:91]
    v_accvgpr_read_b32 v28, a28
    v_accvgpr_read_b32 v29, a29
    v_mfma_f32_16x16x32_bf16 a[92:95], a[188:191], v[152:155], a[92:95]
    v_accvgpr_read_b32 v30, a30
    v_accvgpr_read_b32 v31, a31
    s_branch Lepi3
Lepi3:
    v_pk_mul_f32 v[0:1], v[0:1], v[192:193] op_sel_hi:[1,0]
    v_pk_mul_f32 v[2:3], v[2:3], v[192:193] op_sel_hi:[1,0]
    v_pk_mul_f32 v[4:5], v[4:5], v[192:193] op_sel_hi:[1,0]
    v_pk_mul_f32 v[6:7], v[6:7], v[192:193] op_sel_hi:[1,0]
    v_cvt_pk_bf16_f32 v32, v0, v1
    v_cvt_pk_bf16_f32 v33, v2, v3
    v_cvt_pk_bf16_f32 v34, v4, v5
    v_cvt_pk_bf16_f32 v35, v6, v7
    ds_write_b64 v184, v[32:33]
    ds_write_b64 v185, v[34:35]
    v_pk_mul_f32 v[8:9], v[8:9], v[192:193] op_sel_hi:[1,0]
    v_pk_mul_f32 v[10:11], v[10:11], v[192:193] op_sel_hi:[1,0]
    v_pk_mul_f32 v[12:13], v[12:13], v[192:193] op_sel_hi:[1,0]
    v_pk_mul_f32 v[14:15], v[14:15], v[192:193] op_sel_hi:[1,0]
    v_cvt_pk_bf16_f32 v36, v8, v9
    v_cvt_pk_bf16_f32 v37, v10, v11
    v_cvt_pk_bf16_f32 v38, v12, v13
    v_cvt_pk_bf16_f32 v39, v14, v15
    ds_write_b64 v186, v[36:37]
    ds_write_b64 v187, v[38:39]
    v_pk_mul_f32 v[16:17], v[16:17], v[192:193] op_sel_hi:[1,0]
    v_pk_mul_f32 v[18:19], v[18:19], v[192:193] op_sel_hi:[1,0]
    v_pk_mul_f32 v[20:21], v[20:21], v[192:193] op_sel_hi:[1,0]
    v_pk_mul_f32 v[22:23], v[22:23], v[192:193] op_sel_hi:[1,0]
    v_cvt_pk_bf16_f32 v40, v16, v17
    v_cvt_pk_bf16_f32 v41, v18, v19
    v_cvt_pk_bf16_f32 v42, v20, v21
    v_cvt_pk_bf16_f32 v43, v22, v23
    ds_write_b64 v188, v[40:41]
    ds_write_b64 v189, v[42:43]
    v_pk_mul_f32 v[24:25], v[24:25], v[192:193] op_sel_hi:[1,0]
    v_pk_mul_f32 v[26:27], v[26:27], v[192:193] op_sel_hi:[1,0]
    v_pk_mul_f32 v[28:29], v[28:29], v[192:193] op_sel_hi:[1,0]
    v_pk_mul_f32 v[30:31], v[30:31], v[192:193] op_sel_hi:[1,0]
    v_cvt_pk_bf16_f32 v44, v24, v25
    v_cvt_pk_bf16_f32 v45, v26, v27
    v_cvt_pk_bf16_f32 v46, v28, v29
    v_cvt_pk_bf16_f32 v47, v30, v31
    ds_write_b64 v190, v[44:45]
    ds_write_b64 v191, v[46:47]
    ds_read_b128 v[64:67], v241 offset:0
    ds_read_b128 v[68:71], v241 offset:1024
    ds_read_b128 v[72:75], v241 offset:2048
    ds_read_b128 v[76:79], v241 offset:3072
    v_accvgpr_read_b32 v0, a32
    v_accvgpr_read_b32 v1, a33
    v_accvgpr_read_b32 v2, a34
    v_accvgpr_read_b32 v3, a35
    v_accvgpr_read_b32 v4, a36
    v_accvgpr_read_b32 v5, a37
    v_accvgpr_read_b32 v6, a38
    v_accvgpr_read_b32 v7, a39
    v_pk_mul_f32 v[0:1], v[0:1], v[192:193] op_sel:[0,1] op_sel_hi:[1,1]
    v_pk_mul_f32 v[2:3], v[2:3], v[192:193] op_sel:[0,1] op_sel_hi:[1,1]
    v_pk_mul_f32 v[4:5], v[4:5], v[192:193] op_sel:[0,1] op_sel_hi:[1,1]
    v_pk_mul_f32 v[6:7], v[6:7], v[192:193] op_sel:[0,1] op_sel_hi:[1,1]
    v_cvt_pk_bf16_f32 v48, v0, v1
    v_cvt_pk_bf16_f32 v49, v2, v3
    v_cvt_pk_bf16_f32 v50, v4, v5
    v_cvt_pk_bf16_f32 v51, v6, v7
    ds_write_b64 v184, v[48:49]
    ds_write_b64 v185, v[50:51]
    v_accvgpr_read_b32 v8, a40
    v_accvgpr_read_b32 v9, a41
    v_accvgpr_read_b32 v10, a42
    v_accvgpr_read_b32 v11, a43
    v_accvgpr_read_b32 v12, a44
    v_accvgpr_read_b32 v13, a45
    v_accvgpr_read_b32 v14, a46
    v_accvgpr_read_b32 v15, a47
    s_add_u32 s61, s56, 0
    s_waitcnt lgkmcnt(2)
    buffer_store_dwordx4 v[64:67], v220, s[24:27], s61 offen offset:0 sc0 sc1
    v_pk_mul_f32 v[8:9], v[8:9], v[192:193] op_sel:[0,1] op_sel_hi:[1,1]
    v_pk_mul_f32 v[10:11], v[10:11], v[192:193] op_sel:[0,1] op_sel_hi:[1,1]
    v_pk_mul_f32 v[12:13], v[12:13], v[192:193] op_sel:[0,1] op_sel_hi:[1,1]
    v_pk_mul_f32 v[14:15], v[14:15], v[192:193] op_sel:[0,1] op_sel_hi:[1,1]
    v_cvt_pk_bf16_f32 v52, v8, v9
    v_cvt_pk_bf16_f32 v53, v10, v11
    v_cvt_pk_bf16_f32 v54, v12, v13
    v_cvt_pk_bf16_f32 v55, v14, v15
    ds_write_b64 v186, v[52:53]
    ds_write_b64 v187, v[54:55]
    v_accvgpr_read_b32 v16, a48
    v_accvgpr_read_b32 v17, a49
    v_accvgpr_read_b32 v18, a50
    v_accvgpr_read_b32 v19, a51
    v_accvgpr_read_b32 v20, a52
    v_accvgpr_read_b32 v21, a53
    v_accvgpr_read_b32 v22, a54
    v_accvgpr_read_b32 v23, a55
    buffer_store_dwordx4 v[68:71], v221, s[24:27], s61 offen offset:1024 sc0 sc1
    v_pk_mul_f32 v[16:17], v[16:17], v[192:193] op_sel:[0,1] op_sel_hi:[1,1]
    v_pk_mul_f32 v[18:19], v[18:19], v[192:193] op_sel:[0,1] op_sel_hi:[1,1]
    v_pk_mul_f32 v[20:21], v[20:21], v[192:193] op_sel:[0,1] op_sel_hi:[1,1]
    v_pk_mul_f32 v[22:23], v[22:23], v[192:193] op_sel:[0,1] op_sel_hi:[1,1]
    v_cvt_pk_bf16_f32 v56, v16, v17
    v_cvt_pk_bf16_f32 v57, v18, v19
    v_cvt_pk_bf16_f32 v58, v20, v21
    v_cvt_pk_bf16_f32 v59, v22, v23
    ds_write_b64 v188, v[56:57]
    ds_write_b64 v189, v[58:59]
    v_accvgpr_read_b32 v24, a56
    v_accvgpr_read_b32 v25, a57
    v_accvgpr_read_b32 v26, a58
    v_accvgpr_read_b32 v27, a59
    v_accvgpr_read_b32 v28, a60
    v_accvgpr_read_b32 v29, a61
    v_accvgpr_read_b32 v30, a62
    v_accvgpr_read_b32 v31, a63
    buffer_store_dwordx4 v[72:75], v222, s[24:27], s61 offen offset:2048 sc0 sc1
    v_pk_mul_f32 v[24:25], v[24:25], v[192:193] op_sel:[0,1] op_sel_hi:[1,1]
    v_pk_mul_f32 v[26:27], v[26:27], v[192:193] op_sel:[0,1] op_sel_hi:[1,1]
    v_pk_mul_f32 v[28:29], v[28:29], v[192:193] op_sel:[0,1] op_sel_hi:[1,1]
    v_pk_mul_f32 v[30:31], v[30:31], v[192:193] op_sel:[0,1] op_sel_hi:[1,1]
    v_cvt_pk_bf16_f32 v60, v24, v25
    v_cvt_pk_bf16_f32 v61, v26, v27
    v_cvt_pk_bf16_f32 v62, v28, v29
    v_cvt_pk_bf16_f32 v63, v30, v31
    ds_write_b64 v190, v[60:61]
    ds_write_b64 v191, v[62:63]
    ds_read_b128 v[80:83], v241 offset:0
    ds_read_b128 v[84:87], v241 offset:1024
    ds_read_b128 v[88:91], v241 offset:2048
    ds_read_b128 v[92:95], v241 offset:3072
    v_accvgpr_read_b32 v0, a64
    v_accvgpr_read_b32 v1, a65
    v_accvgpr_read_b32 v2, a66
    v_accvgpr_read_b32 v3, a67
    v_accvgpr_read_b32 v4, a68
    v_accvgpr_read_b32 v5, a69
    v_accvgpr_read_b32 v6, a70
    v_accvgpr_read_b32 v7, a71
    buffer_store_dwordx4 v[76:79], v223, s[24:27], s61 offen offset:3072 sc0 sc1
    v_pk_mul_f32 v[0:1], v[0:1], v[194:195] op_sel_hi:[1,0]
    v_pk_mul_f32 v[2:3], v[2:3], v[194:195] op_sel_hi:[1,0]
    v_pk_mul_f32 v[4:5], v[4:5], v[194:195] op_sel_hi:[1,0]
    v_pk_mul_f32 v[6:7], v[6:7], v[194:195] op_sel_hi:[1,0]
    v_cvt_pk_bf16_f32 v32, v0, v1
    v_cvt_pk_bf16_f32 v33, v2, v3
    v_cvt_pk_bf16_f32 v34, v4, v5
    v_cvt_pk_bf16_f32 v35, v6, v7
    ds_write_b64 v184, v[32:33]
    ds_write_b64 v185, v[34:35]
    v_accvgpr_read_b32 v8, a72
    v_accvgpr_read_b32 v9, a73
    v_accvgpr_read_b32 v10, a74
    v_accvgpr_read_b32 v11, a75
    v_accvgpr_read_b32 v12, a76
    v_accvgpr_read_b32 v13, a77
    v_accvgpr_read_b32 v14, a78
    v_accvgpr_read_b32 v15, a79
    s_add_u32 s62, s56, 65536
    s_waitcnt lgkmcnt(2)
    buffer_store_dwordx4 v[80:83], v220, s[24:27], s62 offen offset:0 sc0 sc1
    v_pk_mul_f32 v[8:9], v[8:9], v[194:195] op_sel_hi:[1,0]
    v_pk_mul_f32 v[10:11], v[10:11], v[194:195] op_sel_hi:[1,0]
    v_pk_mul_f32 v[12:13], v[12:13], v[194:195] op_sel_hi:[1,0]
    v_pk_mul_f32 v[14:15], v[14:15], v[194:195] op_sel_hi:[1,0]
    v_cvt_pk_bf16_f32 v36, v8, v9
    v_cvt_pk_bf16_f32 v37, v10, v11
    v_cvt_pk_bf16_f32 v38, v12, v13
    v_cvt_pk_bf16_f32 v39, v14, v15
    ds_write_b64 v186, v[36:37]
    ds_write_b64 v187, v[38:39]
    v_accvgpr_read_b32 v16, a80
    v_accvgpr_read_b32 v17, a81
    v_accvgpr_read_b32 v18, a82
    v_accvgpr_read_b32 v19, a83
    v_accvgpr_read_b32 v20, a84
    v_accvgpr_read_b32 v21, a85
    v_accvgpr_read_b32 v22, a86
    v_accvgpr_read_b32 v23, a87
    buffer_store_dwordx4 v[84:87], v221, s[24:27], s62 offen offset:1024 sc0 sc1
    v_pk_mul_f32 v[16:17], v[16:17], v[194:195] op_sel_hi:[1,0]
    v_pk_mul_f32 v[18:19], v[18:19], v[194:195] op_sel_hi:[1,0]
    v_pk_mul_f32 v[20:21], v[20:21], v[194:195] op_sel_hi:[1,0]
    v_pk_mul_f32 v[22:23], v[22:23], v[194:195] op_sel_hi:[1,0]
    v_cvt_pk_bf16_f32 v40, v16, v17
    v_cvt_pk_bf16_f32 v41, v18, v19
    v_cvt_pk_bf16_f32 v42, v20, v21
    v_cvt_pk_bf16_f32 v43, v22, v23
    ds_write_b64 v188, v[40:41]
    ds_write_b64 v189, v[42:43]
    v_accvgpr_read_b32 v24, a88
    v_accvgpr_read_b32 v25, a89
    v_accvgpr_read_b32 v26, a90
    v_accvgpr_read_b32 v27, a91
    v_accvgpr_read_b32 v28, a92
    v_accvgpr_read_b32 v29, a93
    v_accvgpr_read_b32 v30, a94
    v_accvgpr_read_b32 v31, a95
    buffer_store_dwordx4 v[88:91], v222, s[24:27], s62 offen offset:2048 sc0 sc1
    v_pk_mul_f32 v[24:25], v[24:25], v[194:195] op_sel_hi:[1,0]
    v_pk_mul_f32 v[26:27], v[26:27], v[194:195] op_sel_hi:[1,0]
    v_pk_mul_f32 v[28:29], v[28:29], v[194:195] op_sel_hi:[1,0]
    v_pk_mul_f32 v[30:31], v[30:31], v[194:195] op_sel_hi:[1,0]
    v_cvt_pk_bf16_f32 v44, v24, v25
    v_cvt_pk_bf16_f32 v45, v26, v27
    v_cvt_pk_bf16_f32 v46, v28, v29
    v_cvt_pk_bf16_f32 v47, v30, v31
    ds_write_b64 v190, v[44:45]
    ds_write_b64 v191, v[46:47]
    ds_read_b128 v[96:99], v241 offset:0
    ds_read_b128 v[100:103], v241 offset:1024
    ds_read_b128 v[104:107], v241 offset:2048
    ds_read_b128 v[108:111], v241 offset:3072
    buffer_store_dwordx4 v[92:95], v223, s[24:27], s62 offen offset:3072 sc0 sc1
    s_add_u32 s61, s56, 131072
    s_waitcnt lgkmcnt(3)
    buffer_store_dwordx4 v[96:99], v220, s[24:27], s61 offen offset:0 sc0 sc1
    s_waitcnt lgkmcnt(2)
    buffer_store_dwordx4 v[100:103], v221, s[24:27], s61 offen offset:1024 sc0 sc1
    s_waitcnt lgkmcnt(1)
    buffer_store_dwordx4 v[104:107], v222, s[24:27], s61 offen offset:2048 sc0 sc1
    s_waitcnt lgkmcnt(0)
    buffer_store_dwordx4 v[108:111], v223, s[24:27], s61 offen offset:3072 sc0 sc1
    s_cmp_eq_u32 s29, 0
    s_cbranch_scc1 Ldone
    s_mov_b32 s64, 0
    s_mov_b32 s65, 0
    s_waitcnt vmcnt(12)
    s_branch Lstart
Lsafe2:
    s_waitcnt lgkmcnt(0)
    v_mfma_f32_16x16x32_bf16 v[64:67], a[160:163], v[0:3], v[184:187]
    ds_read_b64_tr_b16 a[192:193], v208 offset:32768
    ds_read_b64_tr_b16 a[194:195], v208 offset:40960
    v_mfma_f32_16x16x32_bf16 v[72:75], a[160:163], v[16:19], v[188:191]
    ds_read_b64_tr_b16 a[196:197], v209 offset:32768
    v_exp_f32 v224, v112
    v_mfma_f32_16x16x32_bf16 v[64:67], a[164:167], v[4:7], v[64:67]
    ds_read_b64_tr_b16 a[198:199], v209 offset:40960
    v_exp_f32 v225, v113
    v_mfma_f32_16x16x32_bf16 v[72:75], a[164:167], v[20:23], v[72:75]
    ds_read_b64_tr_b16 a[200:201], v210 offset:32768
    ds_read_b64_tr_b16 a[202:203], v210 offset:40960
    v_mfma_f32_16x16x32_bf16 v[64:67], a[168:171], v[8:11], v[64:67]
    ds_read_b64_tr_b16 a[204:205], v211 offset:32768
    v_cvt_pk_bf16_f32 v168, v224, v225
    v_mfma_f32_16x16x32_bf16 v[72:75], a[168:171], v[24:27], v[72:75]
    ds_read_b64_tr_b16 a[206:207], v211 offset:40960
    v_exp_f32 v226, v114
    v_mfma_f32_16x16x32_bf16 v[64:67], a[172:175], v[12:15], v[64:67]
    ds_read_b64_tr_b16 a[208:209], v212 offset:32768
    ds_read_b64_tr_b16 a[210:211], v212 offset:40960
    v_mfma_f32_16x16x32_bf16 v[72:75], a[172:175], v[28:31], v[72:75]
    ds_read_b64_tr_b16 a[212:213], v213 offset:32768
    v_exp_f32 v227, v115
    v_mfma_f32_16x16x32_bf16 v[68:71], a[176:179], v[0:3], v[184:187]
    ds_read_b64_tr_b16 a[214:215], v213 offset:40960
    v_cvt_pk_bf16_f32 v169, v226, v227
    v_mfma_f32_16x16x32_bf16 v[76:79], a[176:179], v[16:19], v[188:191]
    ds_read_b64_tr_b16 a[216:217], v214 offset:32768
    ds_read_b64_tr_b16 a[218:219], v214 offset:40960
    v_mfma_f32_16x16x32_bf16 v[68:71], a[180:183], v[4:7], v[68:71]
    ds_read_b64_tr_b16 a[220:221], v215 offset:32768
    v_or_b32 v245, v168, v169
    v_mfma_f32_16x16x32_bf16 v[76:79], a[180:183], v[20:23], v[76:79]
    ds_read_b64_tr_b16 a[222:223], v215 offset:40960
    v_exp_f32 v248, v116
    v_mfma_f32_16x16x32_bf16 v[68:71], a[184:187], v[8:11], v[68:71]
    s_add_u32 m0, s41, 32768
    v_exp_f32 v249, v117
    v_mfma_f32_16x16x32_bf16 v[76:79], a[184:187], v[24:27], v[76:79]
    s_add_u32 s40, s40, 131072
    v_exp_f32 v250, v118
    v_mfma_f32_16x16x32_bf16 v[68:71], a[188:191], v[12:15], v[68:71]
    s_add_u32 s63, s63, 131072
    v_exp_f32 v251, v119
    v_mfma_f32_16x16x32_bf16 v[76:79], a[188:191], v[28:31], v[76:79]
    s_waitcnt vmcnt(8) lgkmcnt(0)
    s_barrier
    v_mfma_f32_16x16x32_bf16 a[0:3], a[192:195], v[144:147], 0
    ds_read_b128 a[160:163], v204 offset:49152
    v_cvt_pk_bf16_f32 v170, v248, v249
    v_mfma_f32_16x16x32_bf16 a[32:35], a[192:195], v[148:151], 0
    ds_read_b128 a[164:167], v205 offset:49152
    v_cvt_pk_bf16_f32 v171, v250, v251
    v_mfma_f32_16x16x32_bf16 a[4:7], a[196:199], v[144:147], 0
    buffer_load_dwordx4 v218, s[20:23], s40 offen lds
    v_or3_b32 v245, v245, v170, v171
    v_mfma_f32_16x16x32_bf16 a[36:39], a[196:199], v[148:151], 0
    ds_read_b128 a[168:171], v206 offset:49152
    v_exp_f32 v224, v104
    v_mfma_f32_16x16x32_bf16 a[8:11], a[200:203], v[144:147], 0
    ds_read_b128 a[172:175], v207 offset:49152
    v_exp_f32 v225, v105
    v_mfma_f32_16x16x32_bf16 a[40:43], a[200:203], v[148:151], 0
    ds_read_b128 a[176:179], v204 offset:57344
    v_cvt_pk_bf16_f32 v164, v224, v225
    v_mfma_f32_16x16x32_bf16 a[12:15], a[204:207], v[144:147], 0
    v_exp_f32 v226, v106
    v_mfma_f32_16x16x32_bf16 a[44:47], a[204:207], v[148:151], 0
    buffer_load_dwordx4 v219, s[20:23], s40 offen offset:1024 lds
    v_exp_f32 v227, v107
    v_mfma_f32_16x16x32_bf16 a[16:19], a[208:211], v[144:147], 0
    ds_read_b128 a[180:183], v205 offset:57344
    v_cvt_pk_bf16_f32 v165, v226, v227
    v_mfma_f32_16x16x32_bf16 a[48:51], a[208:211], v[148:151], 0
    ds_read_b128 a[184:187], v206 offset:57344
    v_or3_b32 v245, v245, v164, v165
    v_mfma_f32_16x16x32_bf16 a[20:23], a[212:215], v[144:147], 0
    ds_read_b128 a[188:191], v207 offset:57344
    v_exp_f32 v248, v108
    v_mfma_f32_16x16x32_bf16 a[52:55], a[212:215], v[148:151], 0
    buffer_load_dwordx4 v216, s[16:19], s63 offen offset:2048 lds
    v_exp_f32 v249, v109
    v_mfma_f32_16x16x32_bf16 a[24:27], a[216:219], v[144:147], 0
    v_exp_f32 v250, v110
    v_mfma_f32_16x16x32_bf16 a[56:59], a[216:219], v[148:151], 0
    v_exp_f32 v251, v111
    v_mfma_f32_16x16x32_bf16 a[28:31], a[220:223], v[144:147], 0
    v_cvt_pk_bf16_f32 v166, v248, v249
    v_cvt_pk_bf16_f32 v167, v250, v251
    v_mfma_f32_16x16x32_bf16 a[60:63], a[220:223], v[148:151], 0
    v_or3_b32 v245, v245, v166, v167
    v_and_b32 v244, 0x40004000, v245
    v_mfma_f32_16x16x32_bf16 a[240:243], v[228:231], v[144:147], 0
    s_sub_u32 s42, s42, 1
    buffer_load_dwordx4 v217, s[16:19], s63 offen offset:3072 lds
    v_cmp_ne_u32 vcc, 0, v244
    v_mfma_f32_16x16x32_bf16 a[244:247], v[228:231], v[148:151], 0
    s_cbranch_vccnz Lrare_t2p1
Lback_t2p1:
Lsloop2:
    s_waitcnt lgkmcnt(0)
    v_mfma_f32_16x16x32_bf16 v[104:107], a[160:163], v[0:3], v[184:187]
    ds_read_b64_tr_b16 a[192:193], v208 offset:49152
    ds_read_b64_tr_b16 a[194:195], v208 offset:57344
    v_mfma_f32_16x16x32_bf16 v[112:115], a[160:163], v[16:19], v[188:191]
    ds_read_b64_tr_b16 a[196:197], v209 offset:49152
    v_exp_f32 v224, v72
    v_mfma_f32_16x16x32_bf16 v[104:107], a[164:167], v[4:7], v[104:107]
    ds_read_b64_tr_b16 a[198:199], v209 offset:57344
    v_exp_f32 v225, v73
    v_mfma_f32_16x16x32_bf16 v[112:115], a[164:167], v[20:23], v[112:115]
    ds_read_b64_tr_b16 a[200:201], v210 offset:49152
    ds_read_b64_tr_b16 a[202:203], v210 offset:57344
    v_mfma_f32_16x16x32_bf16 v[104:107], a[168:171], v[8:11], v[104:107]
    ds_read_b64_tr_b16 a[204:205], v211 offset:49152
    v_cvt_pk_bf16_f32 v148, v224, v225
    v_mfma_f32_16x16x32_bf16 v[112:115], a[168:171], v[24:27], v[112:115]
    ds_read_b64_tr_b16 a[206:207], v211 offset:57344
    v_exp_f32 v226, v74
    v_mfma_f32_16x16x32_bf16 v[104:107], a[172:175], v[12:15], v[104:107]
    ds_read_b64_tr_b16 a[208:209], v212 offset:49152
    ds_read_b64_tr_b16 a[210:211], v212 offset:57344
    v_mfma_f32_16x16x32_bf16 v[112:115], a[172:175], v[28:31], v[112:115]
    ds_read_b64_tr_b16 a[212:213], v213 offset:49152
    v_exp_f32 v227, v75
    v_mfma_f32_16x16x32_bf16 v[108:111], a[176:179], v[0:3], v[184:187]
    ds_read_b64_tr_b16 a[214:215], v213 offset:57344
    v_cvt_pk_bf16_f32 v149, v226, v227
    v_mfma_f32_16x16x32_bf16 v[116:119], a[176:179], v[16:19], v[188:191]
    ds_read_b64_tr_b16 a[216:217], v214 offset:49152
    ds_read_b64_tr_b16 a[218:219], v214 offset:57344
    v_mfma_f32_16x16x32_bf16 v[108:111], a[180:183], v[4:7], v[108:111]
    ds_read_b64_tr_b16 a[220:221], v215 offset:49152
    v_or_b32 v245, v148, v149
    v_mfma_f32_16x16x32_bf16 v[116:119], a[180:183], v[20:23], v[116:119]
    ds_read_b64_tr_b16 a[222:223], v215 offset:57344
    v_exp_f32 v248, v76
    v_mfma_f32_16x16x32_bf16 v[108:111], a[184:187], v[8:11], v[108:111]
    s_add_u32 m0, s41, 49152
    v_exp_f32 v249, v77
    v_mfma_f32_16x16x32_bf16 v[116:119], a[184:187], v[24:27], v[116:119]
    s_add_u32 s40, s40, 131072
    v_exp_f32 v250, v78
    v_mfma_f32_16x16x32_bf16 v[108:111], a[188:191], v[12:15], v[108:111]
    s_add_u32 s63, s63, 131072
    v_exp_f32 v251, v79
    v_mfma_f32_16x16x32_bf16 v[116:119], a[188:191], v[28:31], v[116:119]
    s_waitcnt vmcnt(8) lgkmcnt(0)
    s_barrier
    v_mfma_f32_16x16x32_bf16 a[0:3], a[192:195], v[164:167], a[0:3]
    ds_read_b128 a[160:163], v204 offset:0
    v_cvt_pk_bf16_f32 v150, v248, v249
    v_mfma_f32_16x16x32_bf16 a[32:35], a[192:195], v[168:171], a[32:35]
    ds_read_b128 a[164:167], v205 offset:0
    v_cvt_pk_bf16_f32 v151, v250, v251
    v_mfma_f32_16x16x32_bf16 a[4:7], a[196:199], v[164:167], a[4:7]
    buffer_load_dwordx4 v218, s[20:23], s40 offen lds
    v_or3_b32 v245, v245, v150, v151
    v_mfma_f32_16x16x32_bf16 a[36:39], a[196:199], v[168:171], a[36:39]
    ds_read_b128 a[168:171], v206 offset:0
    v_exp_f32 v224, v64
    v_mfma_f32_16x16x32_bf16 a[8:11], a[200:203], v[164:167], a[8:11]
    ds_read_b128 a[172:175], v207 offset:0
    v_exp_f32 v225, v65
    v_mfma_f32_16x16x32_bf16 a[40:43], a[200:203], v[168:171], a[40:43]
    ds_read_b128 a[176:179], v204 offset:8192
    v_cvt_pk_bf16_f32 v144, v224, v225
    v_mfma_f32_16x16x32_bf16 a[12:15], a[204:207], v[164:167], a[12:15]
    v_exp_f32 v226, v66
    v_mfma_f32_16x16x32_bf16 a[44:47], a[204:207], v[168:171], a[44:47]
    buffer_load_dwordx4 v219, s[20:23], s40 offen offset:1024 lds
    v_exp_f32 v227, v67
    v_mfma_f32_16x16x32_bf16 a[16:19], a[208:211], v[164:167], a[16:19]
    ds_read_b128 a[180:183], v205 offset:8192
    v_cvt_pk_bf16_f32 v145, v226, v227
    v_mfma_f32_16x16x32_bf16 a[48:51], a[208:211], v[168:171], a[48:51]
    ds_read_b128 a[184:187], v206 offset:8192
    v_or3_b32 v245, v245, v144, v145
    v_mfma_f32_16x16x32_bf16 a[20:23], a[212:215], v[164:167], a[20:23]
    ds_read_b128 a[188:191], v207 offset:8192
    v_exp_f32 v248, v68
    v_mfma_f32_16x16x32_bf16 a[52:55], a[212:215], v[168:171], a[52:55]
    buffer_load_dwordx4 v216, s[16:19], s63 offen offset:2048 lds
    v_exp_f32 v249, v69
    v_mfma_f32_16x16x32_bf16 a[24:27], a[216:219], v[164:167], a[24:27]
    v_exp_f32 v250, v70
    v_mfma_f32_16x16x32_bf16 a[56:59], a[216:219], v[168:171], a[56:59]
    v_exp_f32 v251, v71
    v_mfma_f32_16x16x32_bf16 a[28:31], a[220:223], v[164:167], a[28:31]
    v_cvt_pk_bf16_f32 v146, v248, v249
    v_cvt_pk_bf16_f32 v147, v250, v251
    v_mfma_f32_16x16x32_bf16 a[60:63], a[220:223], v[168:171], a[60:63]
    v_or3_b32 v245, v245, v146, v147
    v_and_b32 v244, 0x40004000, v245
    v_mfma_f32_16x16x32_bf16 a[240:243], v[228:231], v[164:167], a[240:243]
    s_sub_u32 s42, s42, 1
    buffer_load_dwordx4 v217, s[16:19], s63 offen offset:3072 lds
    v_cmp_ne_u32 vcc, 0, v244
    v_mfma_f32_16x16x32_bf16 a[244:247], v[228:231], v[168:171], a[244:247]
    s_cselect_b64 vcc, -1, vcc
    s_cbranch_vccnz Lx2_2
Lxb2_2:
    s_waitcnt lgkmcnt(0)
    v_mfma_f32_16x16x32_bf16 v[64:67], a[160:163], v[0:3], v[184:187]
    ds_read_b64_tr_b16 a[192:193], v208 offset:0
    ds_read_b64_tr_b16 a[194:195], v208 offset:8192
    v_mfma_f32_16x16x32_bf16 v[72:75], a[160:163], v[16:19], v[188:191]
    ds_read_b64_tr_b16 a[196:197], v209 offset:0
    v_exp_f32 v224, v112
    v_mfma_f32_16x16x32_bf16 v[64:67], a[164:167], v[4:7], v[64:67]
    ds_read_b64_tr_b16 a[198:199], v209 offset:8192
    v_exp_f32 v225, v113
    v_mfma_f32_16x16x32_bf16 v[72:75], a[164:167], v[20:23], v[72:75]
    ds_read_b64_tr_b16 a[200:201], v210 offset:0
    ds_read_b64_tr_b16 a[202:203], v210 offset:8192
    v_mfma_f32_16x16x32_bf16 v[64:67], a[168:171], v[8:11], v[64:67]
    ds_read_b64_tr_b16 a[204:205], v211 offset:0
    v_cvt_pk_bf16_f32 v168, v224, v225
    v_mfma_f32_16x16x32_bf16 v[72:75], a[168:171], v[24:27], v[72:75]
    ds_read_b64_tr_b16 a[206:207], v211 offset:8192
    v_exp_f32 v226, v114
    v_mfma_f32_16x16x32_bf16 v[64:67], a[172:175], v[12:15], v[64:67]
    ds_read_b64_tr_b16 a[208:209], v212 offset:0
    ds_read_b64_tr_b16 a[210:211], v212 offset:8192
    v_mfma_f32_16x16x32_bf16 v[72:75], a[172:175], v[28:31], v[72:75]
    ds_read_b64_tr_b16 a[212:213], v213 offset:0
    v_exp_f32 v227, v115
    v_mfma_f32_16x16x32_bf16 v[68:71], a[176:179], v[0:3], v[184:187]
    ds_read_b64_tr_b16 a[214:215], v213 offset:8192
    v_cvt_pk_bf16_f32 v169, v226, v227
    v_mfma_f32_16x16x32_bf16 v[76:79], a[176:179], v[16:19], v[188:191]
    ds_read_b64_tr_b16 a[216:217], v214 offset:0
    ds_read_b64_tr_b16 a[218:219], v214 offset:8192
    v_mfma_f32_16x16x32_bf16 v[68:71], a[180:183], v[4:7], v[68:71]
    ds_read_b64_tr_b16 a[220:221], v215 offset:0
    v_or_b32 v245, v168, v169
    v_mfma_f32_16x16x32_bf16 v[76:79], a[180:183], v[20:23], v[76:79]
    ds_read_b64_tr_b16 a[222:223], v215 offset:8192
    v_exp_f32 v248, v116
    v_mfma_f32_16x16x32_bf16 v[68:71], a[184:187], v[8:11], v[68:71]
    s_mov_b32 m0, s41
    v_exp_f32 v249, v117
    v_mfma_f32_16x16x32_bf16 v[76:79], a[184:187], v[24:27], v[76:79]
    s_add_u32 s40, s40, 131072
    v_exp_f32 v250, v118
    v_mfma_f32_16x16x32_bf16 v[68:71], a[188:191], v[12:15], v[68:71]
    s_add_u32 s63, s63, 131072
    v_exp_f32 v251, v119
    v_mfma_f32_16x16x32_bf16 v[76:79], a[188:191], v[28:31], v[76:79]
    s_waitcnt vmcnt(8) lgkmcnt(0)
    s_barrier
    v_mfma_f32_16x16x32_bf16 a[0:3], a[192:195], v[144:147], a[0:3]
    ds_read_b128 a[160:163], v204 offset:16384
    v_cvt_pk_bf16_f32 v170, v248, v249
    v_mfma_f32_16x16x32_bf16 a[32:35], a[192:195], v[148:151], a[32:35]
    ds_read_b128 a[164:167], v205 offset:16384
    v_cvt_pk_bf16_f32 v171, v250, v251
    v_mfma_f32_16x16x32_bf16 a[4:7], a[196:199], v[144:147], a[4:7]
    buffer_load_dwordx4 v218, s[20:23], s40 offen lds
    v_or3_b32 v245, v245, v170, v171
    v_mfma_f32_16x16x32_bf16 a[36:39], a[196:199], v[148:151], a[36:39]
    ds_read_b128 a[168:171], v206 offset:16384
    v_exp_f32 v224, v104
    v_mfma_f32_16x16x32_bf16 a[8:11], a[200:203], v[144:147], a[8:11]
    ds_read_b128 a[172:175], v207 offset:16384
    v_exp_f32 v225, v105
    v_mfma_f32_16x16x32_bf16 a[40:43], a[200:203], v[148:151], a[40:43]
    ds_read_b128 a[176:179], v204 offset:24576
    v_cvt_pk_bf16_f32 v164, v224, v225
    v_mfma_f32_16x16x32_bf16 a[12:15], a[204:207], v[144:147], a[12:15]
    v_exp_f32 v226, v106
    v_mfma_f32_16x16x32_bf16 a[44:47], a[204:207], v[148:151], a[44:47]
    buffer_load_dwordx4 v219, s[20:23], s40 offen offset:1024 lds
    v_exp_f32 v227, v107
    v_mfma_f32_16x16x32_bf16 a[16:19], a[208:211], v[144:147], a[16:19]
    ds_read_b128 a[180:183], v205 offset:24576
    v_cvt_pk_bf16_f32 v165, v226, v227
    v_mfma_f32_16x16x32_bf16 a[48:51], a[208:211], v[148:151], a[48:51]
    ds_read_b128 a[184:187], v206 offset:24576
    v_or3_b32 v245, v245, v164, v165
    v_mfma_f32_16x16x32_bf16 a[20:23], a[212:215], v[144:147], a[20:23]
    ds_read_b128 a[188:191], v207 offset:24576
    v_exp_f32 v248, v108
    v_mfma_f32_16x16x32_bf16 a[52:55], a[212:215], v[148:151], a[52:55]
    buffer_load_dwordx4 v216, s[16:19], s63 offen offset:2048 lds
    v_exp_f32 v249, v109
    v_mfma_f32_16x16x32_bf16 a[24:27], a[216:219], v[144:147], a[24:27]
    v_exp_f32 v250, v110
    v_mfma_f32_16x16x32_bf16 a[56:59], a[216:219], v[148:151], a[56:59]
    v_exp_f32 v251, v111
    v_mfma_f32_16x16x32_bf16 a[28:31], a[220:223], v[144:147], a[28:31]
    v_cvt_pk_bf16_f32 v166, v248, v249
    v_cvt_pk_bf16_f32 v167, v250, v251
    v_mfma_f32_16x16x32_bf16 a[60:63], a[220:223], v[148:151], a[60:63]
    v_or3_b32 v245, v245, v166, v167
    v_and_b32 v244, 0x40004000, v245
    v_mfma_f32_16x16x32_bf16 a[240:243], v[228:231], v[144:147], a[240:243]
    s_sub_u32 s42, s42, 1
    buffer_load_dwordx4 v217, s[16:19], s63 offen offset:3072 lds
    v_cmp_ne_u32 vcc, 0, v244
    v_mfma_f32_16x16x32_bf16 a[244:247], v[228:231], v[148:151], a[244:247]
    s_cselect_b64 vcc, -1, vcc
    s_cbranch_vccnz Lx2_3
Lxb2_3:
    s_waitcnt lgkmcnt(0)
    v_mfma_f32_16x16x32_bf16 v[104:107], a[160:163], v[0:3], v[184:187]
    ds_read_b64_tr_b16 a[192:193], v208 offset:16384
    ds_read_b64_tr_b16 a[194:195], v208 offset:24576
    v_mfma_f32_16x16x32_bf16 v[112:115], a[160:163], v[16:19], v[188:191]
    ds_read_b64_tr_b16 a[196:197], v209 offset:16384
    v_exp_f32 v224, v72
    v_mfma_f32_16x16x32_bf16 v[104:107], a[164:167], v[4:7], v[104:107]
    ds_read_b64_tr_b16 a[198:199], v209 offset:24576
    v_exp_f32 v225, v73
    v_mfma_f32_16x16x32_bf16 v[112:115], a[164:167], v[20:23], v[112:115]
    ds_read_b64_tr_b16 a[200:201], v210 offset:16384
    ds_read_b64_tr_b16 a[202:203], v210 offset:24576
    v_mfma_f32_16x16x32_bf16 v[104:107], a[168:171], v[8:11], v[104:107]
    ds_read_b64_tr_b16 a[204:205], v211 offset:16384
    v_cvt_pk_bf16_f32 v148, v224, v225
    v_mfma_f32_16x16x32_bf16 v[112:115], a[168:171], v[24:27], v[112:115]
    ds_read_b64_tr_b16 a[206:207], v211 offset:24576
    v_exp_f32 v226, v74
    v_mfma_f32_16x16x32_bf16 v[104:107], a[172:175], v[12:15], v[104:107]
    ds_read_b64_tr_b16 a[208:209], v212 offset:16384
    ds_read_b64_tr_b16 a[210:211], v212 offset:24576
    v_mfma_f32_16x16x32_bf16 v[112:115], a[172:175], v[28:31], v[112:115]
    ds_read_b64_tr_b16 a[212:213], v213 offset:16384
    v_exp_f32 v227, v75
    v_mfma_f32_16x16x32_bf16 v[108:111], a[176:179], v[0:3], v[184:187]
    ds_read_b64_tr_b16 a[214:215], v213 offset:24576
    v_cvt_pk_bf16_f32 v149, v226, v227
    v_mfma_f32_16x16x32_bf16 v[116:119], a[176:179], v[16:19], v[188:191]
    ds_read_b64_tr_b16 a[216:217], v214 offset:16384
    ds_read_b64_tr_b16 a[218:219], v214 offset:24576
    v_mfma_f32_16x16x32_bf16 v[108:111], a[180:183], v[4:7], v[108:111]
    ds_read_b64_tr_b16 a[220:221], v215 offset:16384
    v_or_b32 v245, v148, v149
    v_mfma_f32_16x16x32_bf16 v[116:119], a[180:183], v[20:23], v[116:119]
    ds_read_b64_tr_b16 a[222:223], v215 offset:24576
    v_exp_f32 v248, v76
    v_mfma_f32_16x16x32_bf16 v[108:111], a[184:187], v[8:11], v[108:111]
    s_add_u32 m0, s41, 16384
    v_exp_f32 v249, v77
    v_mfma_f32_16x16x32_bf16 v[116:119], a[184:187], v[24:27], v[116:119]
    s_add_u32 s40, s40, 131072
    v_exp_f32 v250, v78
    v_mfma_f32_16x16x32_bf16 v[108:111], a[188:191], v[12:15], v[108:111]
    s_add_u32 s63, s63, 131072
    v_exp_f32 v251, v79
    v_mfma_f32_16x16x32_bf16 v[116:119], a[188:191], v[28:31], v[116:119]
    s_waitcnt vmcnt(8) lgkmcnt(0)
    s_barrier
    v_mfma_f32_16x16x32_bf16 a[0:3], a[192:195], v[164:167], a[0:3]
    ds_read_b128 a[160:163], v204 offset:32768
    v_cvt_pk_bf16_f32 v150, v248, v249
    v_mfma_f32_16x16x32_bf16 a[32:35], a[192:195], v[168:171], a[32:35]
    ds_read_b128 a[164:167], v205 offset:32768
    v_cvt_pk_bf16_f32 v151, v250, v251
    v_mfma_f32_16x16x32_bf16 a[4:7], a[196:199], v[164:167], a[4:7]
    buffer_load_dwordx4 v218, s[20:23], s40 offen lds
    v_or3_b32 v245, v245, v150, v151
    v_mfma_f32_16x16x32_bf16 a[36:39], a[196:199], v[168:171], a[36:39]
    ds_read_b128 a[168:171], v206 offset:32768
    v_exp_f32 v224, v64
    v_mfma_f32_16x16x32_bf16 a[8:11], a[200:203], v[164:167], a[8:11]
    ds_read_b128 a[172:175], v207 offset:32768
    v_exp_f32 v225, v65
    v_mfma_f32_16x16x32_bf16 a[40:43], a[200:203], v[168:171], a[40:43]
    ds_read_b128 a[176:179], v204 offset:40960
    v_cvt_pk_bf16_f32 v144, v224, v225
    v_mfma_f32_16x16x32_bf16 a[12:15], a[204:207], v[164:167], a[12:15]
    v_exp_f32 v226, v66
    v_mfma_f32_16x16x32_bf16 a[44:47], a[204:207], v[168:171], a[44:47]
    buffer_load_dwordx4 v219, s[20:23], s40 offen offset:1024 lds
    v_exp_f32 v227, v67
    v_mfma_f32_16x16x32_bf16 a[16:19], a[208:211], v[164:167], a[16:19]
    ds_read_b128 a[180:183], v205 offset:40960
    v_cvt_pk_bf16_f32 v145, v226, v227
    v_mfma_f32_16x16x32_bf16 a[48:51], a[208:211], v[168:171], a[48:51]
    ds_read_b128 a[184:187], v206 offset:40960
    v_or3_b32 v245, v245, v144, v145
    v_mfma_f32_16x16x32_bf16 a[20:23], a[212:215], v[164:167], a[20:23]
    ds_read_b128 a[188:191], v207 offset:40960
    v_exp_f32 v248, v68
    v_mfma_f32_16x16x32_bf16 a[52:55], a[212:215], v[168:171], a[52:55]
    buffer_load_dwordx4 v216, s[16:19], s63 offen offset:2048 lds
    v_exp_f32 v249, v69
    v_mfma_f32_16x16x32_bf16 a[24:27], a[216:219], v[164:167], a[24:27]
    v_exp_f32 v250, v70
    v_mfma_f32_16x16x32_bf16 a[56:59], a[216:219], v[168:171], a[56:59]
    v_exp_f32 v251, v71
    v_mfma_f32_16x16x32_bf16 a[28:31], a[220:223], v[164:167], a[28:31]
    v_cvt_pk_bf16_f32 v146, v248, v249
    v_cvt_pk_bf16_f32 v147, v250, v251
    v_mfma_f32_16x16x32_bf16 a[60:63], a[220:223], v[168:171], a[60:63]
    v_or3_b32 v245, v245, v146, v147
    v_and_b32 v244, 0x40004000, v245
    v_mfma_f32_16x16x32_bf16 a[240:243], v[228:231], v[164:167], a[240:243]
    s_sub_u32 s42, s42, 1
    buffer_load_dwordx4 v217, s[16:19], s63 offen offset:3072 lds
    v_cmp_ne_u32 vcc, 0, v244
    v_mfma_f32_16x16x32_bf16 a[244:247], v[228:231], v[168:171], a[244:247]
    s_cselect_b64 vcc, -1, vcc
    s_cbranch_vccnz Lx2_0
Lxb2_0:
    s_waitcnt lgkmcnt(0)
    v_mfma_f32_16x16x32_bf16 v[64:67], a[160:163], v[0:3], v[184:187]
    ds_read_b64_tr_b16 a[192:193], v208 offset:32768
    ds_read_b64_tr_b16 a[194:195], v208 offset:40960
    v_mfma_f32_16x16x32_bf16 v[72:75], a[160:163], v[16:19], v[188:191]
    ds_read_b64_tr_b16 a[196:197], v209 offset:32768
    v_exp_f32 v224, v112
    v_mfma_f32_16x16x32_bf16 v[64:67], a[164:167], v[4:7], v[64:67]
    ds_read_b64_tr_b16 a[198:199], v209 offset:40960
    v_exp_f32 v225, v113
    v_mfma_f32_16x16x32_bf16 v[72:75], a[164:167], v[20:23], v[72:75]
    ds_read_b64_tr_b16 a[200:201], v210 offset:32768
    ds_read_b64_tr_b16 a[202:203], v210 offset:40960
    v_mfma_f32_16x16x32_bf16 v[64:67], a[168:171], v[8:11], v[64:67]
    ds_read_b64_tr_b16 a[204:205], v211 offset:32768
    v_cvt_pk_bf16_f32 v168, v224, v225
    v_mfma_f32_16x16x32_bf16 v[72:75], a[168:171], v[24:27], v[72:75]
    ds_read_b64_tr_b16 a[206:207], v211 offset:40960
    v_exp_f32 v226, v114
    v_mfma_f32_16x16x32_bf16 v[64:67], a[172:175], v[12:15], v[64:67]
    ds_read_b64_tr_b16 a[208:209], v212 offset:32768
    ds_read_b64_tr_b16 a[210:211], v212 offset:40960
    v_mfma_f32_16x16x32_bf16 v[72:75], a[172:175], v[28:31], v[72:75]
    ds_read_b64_tr_b16 a[212:213], v213 offset:32768
    v_exp_f32 v227, v115
    v_mfma_f32_16x16x32_bf16 v[68:71], a[176:179], v[0:3], v[184:187]
    ds_read_b64_tr_b16 a[214:215], v213 offset:40960
    v_cvt_pk_bf16_f32 v169, v226, v227
    v_mfma_f32_16x16x32_bf16 v[76:79], a[176:179], v[16:19], v[188:191]
    ds_read_b64_tr_b16 a[216:217], v214 offset:32768
    ds_read_b64_tr_b16 a[218:219], v214 offset:40960
    v_mfma_f32_16x16x32_bf16 v[68:71], a[180:183], v[4:7], v[68:71]
    ds_read_b64_tr_b16 a[220:221], v215 offset:32768
    v_or_b32 v245, v168, v169
    v_mfma_f32_16x16x32_bf16 v[76:79], a[180:183], v[20:23], v[76:79]
    ds_read_b64_tr_b16 a[222:223], v215 offset:40960
    v_exp_f32 v248, v116
    v_mfma_f32_16x16x32_bf16 v[68:71], a[184:187], v[8:11], v[68:71]
    s_add_u32 m0, s41, 32768
    v_exp_f32 v249, v117
    v_mfma_f32_16x16x32_bf16 v[76:79], a[184:187], v[24:27], v[76:79]
    s_add_u32 s40, s40, 131072
    v_exp_f32 v250, v118
    v_mfma_f32_16x16x32_bf16 v[68:71], a[188:191], v[12:15], v[68:71]
    s_add_u32 s63, s63, 131072
    v_exp_f32 v251, v119
    v_mfma_f32_16x16x32_bf16 v[76:79], a[188:191], v[28:31], v[76:79]
    s_waitcnt vmcnt(8) lgkmcnt(0)
    s_barrier
    v_mfma_f32_16x16x32_bf16 a[0:3], a[192:195], v[144:147], a[0:3]
    ds_read_b128 a[160:163], v204 offset:49152
    v_cvt_pk_bf16_f32 v170, v248, v249
    v_mfma_f32_16x16x32_bf16 a[32:35], a[192:195], v[148:151], a[32:35]
    ds_read_b128 a[164:167], v205 offset:49152
    v_cvt_pk_bf16_f32 v171, v250, v251
    v_mfma_f32_16x16x32_bf16 a[4:7], a[196:199], v[144:147], a[4:7]
    buffer_load_dwordx4 v218, s[20:23], s40 offen lds
    v_or3_b32 v245, v245, v170, v171
    v_mfma_f32_16x16x32_bf16 a[36:39], a[196:199], v[148:151], a[36:39]
    ds_read_b128 a[168:171], v206 offset:49152
    v_exp_f32 v224, v104
    v_mfma_f32_16x16x32_bf16 a[8:11], a[200:203], v[144:147], a[8:11]
    ds_read_b128 a[172:175], v207 offset:49152
    v_exp_f32 v225, v105
    v_mfma_f32_16x16x32_bf16 a[40:43], a[200:203], v[148:151], a[40:43]
    ds_read_b128 a[176:179], v204 offset:57344
    v_cvt_pk_bf16_f32 v164, v224, v225
    v_mfma_f32_16x16x32_bf16 a[12:15], a[204:207], v[144:147], a[12:15]
    v_exp_f32 v226, v106
    v_mfma_f32_16x16x32_bf16 a[44:47], a[204:207], v[148:151], a[44:47]
    buffer_load_dwordx4 v219, s[20:23], s40 offen offset:1024 lds
    v_exp_f32 v227, v107
    v_mfma_f32_16x16x32_bf16 a[16:19], a[208:211], v[144:147], a[16:19]
    ds_read_b128 a[180:183], v205 offset:57344
    v_cvt_pk_bf16_f32 v165, v226, v227
    v_mfma_f32_16x16x32_bf16 a[48:51], a[208:211], v[148:151], a[48:51]
    ds_read_b128 a[184:187], v206 offset:57344
    v_or3_b32 v245, v245, v164, v165
    v_mfma_f32_16x16x32_bf16 a[20:23], a[212:215], v[144:147], a[20:23]
    ds_read_b128 a[188:191], v207 offset:57344
    v_exp_f32 v248, v108
    v_mfma_f32_16x16x32_bf16 a[52:55], a[212:215], v[148:151], a[52:55]
    buffer_load_dwordx4 v216, s[16:19], s63 offen offset:2048 lds
    v_exp_f32 v249, v109
    v_mfma_f32_16x16x32_bf16 a[24:27], a[216:219], v[144:147], a[24:27]
    v_exp_f32 v250, v110
    v_mfma_f32_16x16x32_bf16 a[56:59], a[216:219], v[148:151], a[56:59]
    v_exp_f32 v251, v111
    v_mfma_f32_16x16x32_bf16 a[28:31], a[220:223], v[144:147], a[28:31]
    v_cvt_pk_bf16_f32 v166, v248, v249
    v_cvt_pk_bf16_f32 v167, v250, v251
    v_mfma_f32_16x16x32_bf16 a[60:63], a[220:223], v[148:151], a[60:63]
    v_or3_b32 v245, v245, v166, v167
    v_and_b32 v244, 0x40004000, v245
    v_mfma_f32_16x16x32_bf16 a[240:243], v[228:231], v[144:147], a[240:243]
    s_sub_u32 s42, s42, 1
    buffer_load_dwordx4 v217, s[16:19], s63 offen offset:3072 lds
    v_cmp_ne_u32 vcc, 0, v244
    v_mfma_f32_16x16x32_bf16 a[244:247], v[228:231], v[148:151], a[244:247]
    s_cselect_b64 vcc, -1, vcc
    s_cbranch_vccnz Lx2_1
Lxb2_1:
    s_branch Lsloop2
Lx2_0:
    v_cmp_ne_u32 vcc, 0, v244
    s_cbranch_vccnz Lrare_x2_0
Lback_x2_0:
    s_branch Lxb2_0
Lx2_1:
    v_cmp_ne_u32 vcc, 0, v244
    s_cbranch_vccnz Lrare_x2_1
Lback_x2_1:
    s_cbranch_scc1 Lxs2_1
    s_branch Lxb2_1
Lx2_2:
    v_cmp_ne_u32 vcc, 0, v244
    s_cbranch_vccnz Lrare_x2_2
Lback_x2_2:
    s_cbranch_scc1 Lxs2_2
    s_branch Lxb2_2
Lx2_3:
    v_cmp_ne_u32 vcc, 0, v244
    s_cbranch_vccnz Lrare_x2_3
Lback_x2_3:
    s_cbranch_scc1 Lxs2_3
    s_branch Lxb2_3
Lxs2_1:
Ltail2_2_0:
    v_mfma_f32_16x16x32_bf16 a[240:243], v[228:231], v[164:167], a[240:243]
    ds_read_b64_tr_b16 a[192:193], v208 offset:49152
    v_mfma_f32_16x16x32_bf16 a[244:247], v[228:231], v[168:171], a[244:247]
    ds_read_b64_tr_b16 a[194:195], v208 offset:57344
    ds_read_b64_tr_b16 a[196:197], v209 offset:49152
    ds_read_b64_tr_b16 a[198:199], v209 offset:57344
    ds_read_b64_tr_b16 a[200:201], v210 offset:49152
    ds_read_b64_tr_b16 a[202:203], v210 offset:57344
    ds_read_b64_tr_b16 a[204:205], v211 offset:49152
    ds_read_b64_tr_b16 a[206:207], v211 offset:57344
    ds_read_b64_tr_b16 a[208:209], v212 offset:49152
    ds_read_b64_tr_b16 a[210:211], v212 offset:57344
    ds_read_b64_tr_b16 a[212:213], v213 offset:49152
    ds_read_b64_tr_b16 a[214:215], v213 offset:57344
    ds_read_b64_tr_b16 a[216:217], v214 offset:49152
    ds_read_b64_tr_b16 a[218:219], v214 offset:57344
    ds_read_b64_tr_b16 a[220:221], v215 offset:49152
    ds_read_b64_tr_b16 a[222:223], v215 offset:57344
    v_accvgpr_read_b32 v252, a240
    v_accvgpr_read_b32 v253, a244
    v_max_f32 v237, v252, v253
    v_cmp_le_f32 vcc, s66, v237
    v_exp_f32 v224, v72
    v_exp_f32 v225, v73
    s_cmp_lg_u64 vcc, 0
    s_cselect_b32 s61, 1, 0
    s_andn2_b32 s61, s61, s65
    v_mov_b32 v237, s61
    ds_write_b32 v239, v237 offset:16384
    v_exp_f32 v226, v74
    v_exp_f32 v227, v75
    v_cvt_pk_bf16_f32 v148, v224, v225
    v_exp_f32 v248, v76
    v_exp_f32 v249, v77
    v_cvt_pk_bf16_f32 v149, v226, v227
    v_or_b32 v245, v148, v149
    v_exp_f32 v250, v78
    v_exp_f32 v251, v79
    v_cvt_pk_bf16_f32 v150, v248, v249
    v_exp_f32 v224, v64
    v_exp_f32 v225, v65
    v_cvt_pk_bf16_f32 v151, v250, v251
    v_or3_b32 v245, v245, v150, v151
    v_exp_f32 v226, v66
    v_exp_f32 v227, v67
    s_waitcnt vmcnt(8) lgkmcnt(0)
    s_barrier
    v_mfma_f32_16x16x32_bf16 a[0:3], a[192:195], v[164:167], a[0:3]
    ds_read_b32 v237, v236
    ds_read_b64_tr_b16 a[160:161], v208 offset:0
    v_mfma_f32_16x16x32_bf16 a[32:35], a[192:195], v[168:171], a[32:35]
    ds_read_b64_tr_b16 a[162:163], v208 offset:8192
    v_cvt_pk_bf16_f32 v144, v224, v225
    v_mfma_f32_16x16x32_bf16 a[4:7], a[196:199], v[164:167], a[4:7]
    ds_read_b64_tr_b16 a[164:165], v209 offset:0
    v_cvt_pk_bf16_f32 v145, v226, v227
    v_mfma_f32_16x16x32_bf16 a[36:39], a[196:199], v[168:171], a[36:39]
    ds_read_b64_tr_b16 a[166:167], v209 offset:8192
    v_or3_b32 v245, v245, v144, v145
    v_mfma_f32_16x16x32_bf16 a[8:11], a[200:203], v[164:167], a[8:11]
    ds_read_b64_tr_b16 a[168:169], v210 offset:0
    ds_read_b64_tr_b16 a[170:171], v210 offset:8192
    v_mfma_f32_16x16x32_bf16 a[40:43], a[200:203], v[168:171], a[40:43]
    ds_read_b64_tr_b16 a[172:173], v211 offset:0
    v_exp_f32 v248, v68
    v_mfma_f32_16x16x32_bf16 a[12:15], a[204:207], v[164:167], a[12:15]
    ds_read_b64_tr_b16 a[174:175], v211 offset:8192
    v_exp_f32 v249, v69
    v_mfma_f32_16x16x32_bf16 a[44:47], a[204:207], v[168:171], a[44:47]
    ds_read_b64_tr_b16 a[176:177], v212 offset:0
    v_cvt_pk_bf16_f32 v146, v248, v249
    v_mfma_f32_16x16x32_bf16 a[16:19], a[208:211], v[164:167], a[16:19]
    ds_read_b64_tr_b16 a[178:179], v212 offset:8192
    v_exp_f32 v250, v70
    v_mfma_f32_16x16x32_bf16 a[48:51], a[208:211], v[168:171], a[48:51]
    ds_read_b64_tr_b16 a[180:181], v213 offset:0
    ds_read_b64_tr_b16 a[182:183], v213 offset:8192
    v_mfma_f32_16x16x32_bf16 a[20:23], a[212:215], v[164:167], a[20:23]
    ds_read_b64_tr_b16 a[184:185], v214 offset:0
    v_mfma_f32_16x16x32_bf16 a[52:55], a[212:215], v[168:171], a[52:55]
    ds_read_b64_tr_b16 a[186:187], v214 offset:8192
    v_mfma_f32_16x16x32_bf16 a[24:27], a[216:219], v[164:167], a[24:27]
    ds_read_b64_tr_b16 a[188:189], v215 offset:0
    v_exp_f32 v251, v71
    v_mfma_f32_16x16x32_bf16 a[56:59], a[216:219], v[168:171], a[56:59]
    ds_read_b64_tr_b16 a[190:191], v215 offset:8192
    v_cvt_pk_bf16_f32 v147, v250, v251
    v_mfma_f32_16x16x32_bf16 a[28:31], a[220:223], v[164:167], a[28:31]
    v_or3_b32 v245, v245, v146, v147
    v_and_b32 v244, 0x40004000, v245
    v_mfma_f32_16x16x32_bf16 a[60:63], a[220:223], v[168:171], a[60:63]
    v_cmp_ne_u32 vcc, 0, v244
    s_cbranch_vccnz Lrare_t2t2_0
Lback_t2t2_0:
    s_waitcnt lgkmcnt(8)
    v_cmp_ne_u32 vcc, 0, v237
    s_cbranch_vccnz Lrestart
    v_mfma_f32_16x16x32_bf16 a[240:243], v[228:231], v[144:147], a[240:243]
    v_xor_b32 v184, 0, v240
    v_mfma_f32_16x16x32_bf16 a[244:247], v[228:231], v[148:151], a[244:247]
    s_waitcnt lgkmcnt(6)
    v_xor_b32 v185, 32, v240
    v_mfma_f32_16x16x32_bf16 a[0:3], a[160:163], v[144:147], a[0:3]
    v_xor_b32 v186, 64, v240
    v_mfma_f32_16x16x32_bf16 a[4:7], a[164:167], v[144:147], a[4:7]
    v_xor_b32 v187, 96, v240
    v_mfma_f32_16x16x32_bf16 a[8:11], a[168:171], v[144:147], a[8:11]
    v_mfma_f32_16x16x32_bf16 a[12:15], a[172:175], v[144:147], a[12:15]
    v_xor_b32 v188, 128, v240
    v_mfma_f32_16x16x32_bf16 a[16:19], a[176:179], v[144:147], a[16:19]
    s_waitcnt lgkmcnt(0)
    v_xor_b32 v189, 160, v240
    v_mfma_f32_16x16x32_bf16 a[20:23], a[180:183], v[144:147], a[20:23]
    v_xor_b32 v190, 192, v240
    v_mfma_f32_16x16x32_bf16 a[24:27], a[184:187], v[144:147], a[24:27]
    v_xor_b32 v191, 224, v240
    v_mfma_f32_16x16x32_bf16 a[28:31], a[188:191], v[144:147], a[28:31]
    v_mfma_f32_16x16x32_bf16 a[32:35], a[160:163], v[148:151], a[32:35]
    v_accvgpr_read_b32 v244, a240
    v_accvgpr_read_b32 v245, a244
    v_rcp_f32 v192, v244
    v_rcp_f32 v193, v245
    v_accvgpr_read_b32 v0, a0
    v_mfma_f32_16x16x32_bf16 a[36:39], a[164:167], v[148:151], a[36:39]
    v_accvgpr_read_b32 v1, a1
    v_accvgpr_read_b32 v2, a2
    v_accvgpr_read_b32 v3, a3
    v_accvgpr_read_b32 v4, a4
    v_mfma_f32_16x16x32_bf16 a[40:43], a[168:171], v[148:151], a[40:43]
    v_accvgpr_read_b32 v5, a5
    v_accvgpr_read_b32 v6, a6
    v_accvgpr_read_b32 v7, a7
    v_accvgpr_read_b32 v8, a8
    v_accvgpr_read_b32 v9, a9
    v_mfma_f32_16x16x32_bf16 a[44:47], a[172:175], v[148:151], a[44:47]
    v_accvgpr_read_b32 v10, a10
    v_accvgpr_read_b32 v11, a11
    v_accvgpr_read_b32 v12, a12
    v_accvgpr_read_b32 v13, a13
    v_mfma_f32_16x16x32_bf16 a[48:51], a[176:179], v[148:151], a[48:51]
    v_accvgpr_read_b32 v14, a14
    v_accvgpr_read_b32 v15, a15
    v_accvgpr_read_b32 v16, a16
    v_accvgpr_read_b32 v17, a17
    v_accvgpr_read_b32 v18, a18
    v_mfma_f32_16x16x32_bf16 a[52:55], a[180:183], v[148:151], a[52:55]
    v_accvgpr_read_b32 v19, a19
    v_accvgpr_read_b32 v20, a20
    v_accvgpr_read_b32 v21, a21
    v_accvgpr_read_b32 v22, a22
    v_mfma_f32_16x16x32_bf16 a[56:59], a[184:187], v[148:151], a[56:59]
    v_accvgpr_read_b32 v23, a23
    v_accvgpr_read_b32 v24, a24
    v_accvgpr_read_b32 v25, a25
    v_accvgpr_read_b32 v26, a26
    v_accvgpr_read_b32 v27, a27
    v_mfma_f32_16x16x32_bf16 a[60:63], a[188:191], v[148:151], a[60:63]
    v_accvgpr_read_b32 v28, a28
    v_accvgpr_read_b32 v29, a29
    v_accvgpr_read_b32 v30, a30
    v_accvgpr_read_b32 v31, a31
    s_branch Lepi2
Lxs2_2:
Ltail2_3_1:
    v_mfma_f32_16x16x32_bf16 a[240:243], v[228:231], v[144:147], a[240:243]
    ds_read_b64_tr_b16 a[192:193], v208 offset:0
    v_mfma_f32_16x16x32_bf16 a[244:247], v[228:231], v[148:151], a[244:247]
    ds_read_b64_tr_b16 a[194:195], v208 offset:8192
    ds_read_b64_tr_b16 a[196:197], v209 offset:0
    ds_read_b64_tr_b16 a[198:199], v209 offset:8192
    ds_read_b64_tr_b16 a[200:201], v210 offset:0
    ds_read_b64_tr_b16 a[202:203], v210 offset:8192
    ds_read_b64_tr_b16 a[204:205], v211 offset:0
    ds_read_b64_tr_b16 a[206:207], v211 offset:8192
    ds_read_b64_tr_b16 a[208:209], v212 offset:0
    ds_read_b64_tr_b16 a[210:211], v212 offset:8192
    ds_read_b64_tr_b16 a[212:213], v213 offset:0
    ds_read_b64_tr_b16 a[214:215], v213 offset:8192
    ds_read_b64_tr_b16 a[216:217], v214 offset:0
    ds_read_b64_tr_b16 a[218:219], v214 offset:8192
    ds_read_b64_tr_b16 a[220:221], v215 offset:0
    ds_read_b64_tr_b16 a[222:223], v215 offset:8192
    v_accvgpr_read_b32 v252, a240
    v_accvgpr_read_b32 v253, a244
    v_max_f32 v237, v252, v253
    v_cmp_le_f32 vcc, s66, v237
    v_exp_f32 v224, v112
    v_exp_f32 v225, v113
    s_cmp_lg_u64 vcc, 0
    s_cselect_b32 s61, 1, 0
    s_andn2_b32 s61, s61, s65
    v_mov_b32 v237, s61
    ds_write_b32 v239, v237 offset:16384
    v_exp_f32 v226, v114
    v_exp_f32 v227, v115
    v_cvt_pk_bf16_f32 v168, v224, v225
    v_exp_f32 v248, v116
    v_exp_f32 v249, v117
    v_cvt_pk_bf16_f32 v169, v226, v227
    v_or_b32 v245, v168, v169
    v_exp_f32 v250, v118
    v_exp_f32 v251, v119
    v_cvt_pk_bf16_f32 v170, v248, v249
    v_exp_f32 v224, v104
    v_exp_f32 v225, v105
    v_cvt_pk_bf16_f32 v171, v250, v251
    v_or3_b32 v245, v245, v170, v171
    v_exp_f32 v226, v106
    v_exp_f32 v227, v107
    s_waitcnt vmcnt(8) lgkmcnt(0)
    s_barrier
    v_mfma_f32_16x16x32_bf16 a[0:3], a[192:195], v[144:147], a[0:3]
    ds_read_b32 v237, v236
    ds_read_b64_tr_b16 a[160:161], v208 offset:16384
    s_mov_b32 m0, s41
    s_add_u32 s18, s30, 4096
    buffer_load_dwordx4 v216, s[16:19], s31 offen offset:2048 lds
    v_mfma_f32_16x16x32_bf16 a[32:35], a[192:195], v[148:151], a[32:35]
    ds_read_b64_tr_b16 a[162:163], v208 offset:24576
    v_cvt_pk_bf16_f32 v164, v224, v225
    v_mfma_f32_16x16x32_bf16 a[4:7], a[196:199], v[144:147], a[4:7]
    ds_read_b64_tr_b16 a[164:165], v209 offset:16384
    buffer_load_dwordx4 v217, s[16:19], s31 offen offset:3072 lds
    v_mfma_f32_16x16x32_bf16 a[36:39], a[196:199], v[148:151], a[36:39]
    ds_read_b64_tr_b16 a[166:167], v209 offset:24576
    v_cvt_pk_bf16_f32 v165, v226, v227
    v_mfma_f32_16x16x32_bf16 a[8:11], a[200:203], v[144:147], a[8:11]
    ds_read_b64_tr_b16 a[168:169], v210 offset:16384
    ds_read_b64_tr_b16 a[170:171], v210 offset:24576
    v_mfma_f32_16x16x32_bf16 a[40:43], a[200:203], v[148:151], a[40:43]
    ds_read_b64_tr_b16 a[172:173], v211 offset:16384
    s_mov_b32 m0, s3
    s_add_u32 s61, s55, 0
    buffer_load_dwordx4 v220, s[12:15], s61 offen offset:0 nt lds
    v_mfma_f32_16x16x32_bf16 a[12:15], a[204:207], v[144:147], a[12:15]
    ds_read_b64_tr_b16 a[174:175], v211 offset:24576
    v_or3_b32 v245, v245, v164, v165
    v_exp_f32 v248, v108
    v_mfma_f32_16x16x32_bf16 a[44:47], a[204:207], v[148:151], a[44:47]
    ds_read_b64_tr_b16 a[176:177], v212 offset:16384
    v_exp_f32 v249, v109
    v_mfma_f32_16x16x32_bf16 a[16:19], a[208:211], v[144:147], a[16:19]
    ds_read_b64_tr_b16 a[178:179], v212 offset:24576
    buffer_load_dwordx4 v221, s[12:15], s61 offen offset:1024 nt lds
    v_mfma_f32_16x16x32_bf16 a[48:51], a[208:211], v[148:151], a[48:51]
    ds_read_b64_tr_b16 a[180:181], v213 offset:16384
    ds_read_b64_tr_b16 a[182:183], v213 offset:24576
    v_mfma_f32_16x16x32_bf16 a[20:23], a[212:215], v[144:147], a[20:23]
    ds_read_b64_tr_b16 a[184:185], v214 offset:16384
    buffer_load_dwordx4 v222, s[12:15], s61 offen offset:2048 nt lds
    v_mfma_f32_16x16x32_bf16 a[52:55], a[212:215], v[148:151], a[52:55]
    ds_read_b64_tr_b16 a[186:187], v214 offset:24576
    v_cvt_pk_bf16_f32 v166, v248, v249
    v_exp_f32 v250, v110
    v_mfma_f32_16x16x32_bf16 a[24:27], a[216:219], v[144:147], a[24:27]
    ds_read_b64_tr_b16 a[188:189], v215 offset:16384
    v_exp_f32 v251, v111
    v_mfma_f32_16x16x32_bf16 a[56:59], a[216:219], v[148:151], a[56:59]
    ds_read_b64_tr_b16 a[190:191], v215 offset:24576
    buffer_load_dwordx4 v223, s[12:15], s61 offen offset:3072 nt lds
    v_mfma_f32_16x16x32_bf16 a[28:31], a[220:223], v[144:147], a[28:31]
    v_cvt_pk_bf16_f32 v167, v250, v251
    v_or3_b32 v245, v245, v166, v167
    v_mfma_f32_16x16x32_bf16 a[60:63], a[220:223], v[148:151], a[60:63]
    v_and_b32 v244, 0x40004000, v245
    v_cmp_ne_u32 vcc, 0, v244
    s_cbranch_vccnz Lrare_t2t3_1
Lback_t2t3_1:
    s_waitcnt lgkmcnt(8)
    v_cmp_ne_u32 vcc, 0, v237
    s_cbranch_vccnz Lrestart
    v_mfma_f32_16x16x32_bf16 a[240:243], v[228:231], v[164:167], a[240:243]
    s_add_u32 m0, s3, 4096
    s_add_u32 s61, s55, 65536
    buffer_load_dwordx4 v220, s[12:15], s61 offen offset:0 nt lds
    v_xor_b32 v184, 0, v240
    v_mfma_f32_16x16x32_bf16 a[244:247], v[228:231], v[168:171], a[244:247]
    s_waitcnt lgkmcnt(6)
    v_xor_b32 v185, 32, v240
    v_mfma_f32_16x16x32_bf16 a[0:3], a[160:163], v[164:167], a[0:3]
    v_xor_b32 v186, 64, v240
    v_mfma_f32_16x16x32_bf16 a[4:7], a[164:167], v[164:167], a[4:7]
    buffer_load_dwordx4 v221, s[12:15], s61 offen offset:1024 nt lds
    v_xor_b32 v187, 96, v240
    v_mfma_f32_16x16x32_bf16 a[8:11], a[168:171], v[164:167], a[8:11]
    v_mfma_f32_16x16x32_bf16 a[12:15], a[172:175], v[164:167], a[12:15]
    v_xor_b32 v188, 128, v240
    v_mfma_f32_16x16x32_bf16 a[16:19], a[176:179], v[164:167], a[16:19]
    buffer_load_dwordx4 v222, s[12:15], s61 offen offset:2048 nt lds
    s_waitcnt lgkmcnt(0)
    v_xor_b32 v189, 160, v240
    v_mfma_f32_16x16x32_bf16 a[20:23], a[180:183], v[164:167], a[20:23]
    v_xor_b32 v190, 192, v240
    v_mfma_f32_16x16x32_bf16 a[24:27], a[184:187], v[164:167], a[24:27]
    v_xor_b32 v191, 224, v240
    v_mfma_f32_16x16x32_bf16 a[28:31], a[188:191], v[164:167], a[28:31]
    buffer_load_dwordx4 v223, s[12:15], s61 offen offset:3072 nt lds
    v_mfma_f32_16x16x32_bf16 a[32:35], a[160:163], v[168:171], a[32:35]
    v_accvgpr_read_b32 v244, a240
    v_accvgpr_read_b32 v245, a244
    v_rcp_f32 v192, v244
    v_rcp_f32 v193, v245
    v_accvgpr_read_b32 v0, a0
    v_mfma_f32_16x16x32_bf16 a[36:39], a[164:167], v[168:171], a[36:39]
    v_accvgpr_read_b32 v1, a1
    v_accvgpr_read_b32 v2, a2
    v_accvgpr_read_b32 v3, a3
    v_accvgpr_read_b32 v4, a4
    v_mfma_f32_16x16x32_bf16 a[40:43], a[168:171], v[168:171], a[40:43]
    s_add_u32 m0, s41, 16384
    s_nop 0
    buffer_load_dwordx4 v216, s[16:19], s28 offen offset:2048 lds
    v_accvgpr_read_b32 v5, a5
    v_accvgpr_read_b32 v6, a6
    v_accvgpr_read_b32 v7, a7
    v_accvgpr_read_b32 v8, a8
    v_accvgpr_read_b32 v9, a9
    v_mfma_f32_16x16x32_bf16 a[44:47], a[172:175], v[168:171], a[44:47]
    v_accvgpr_read_b32 v10, a10
    v_accvgpr_read_b32 v11, a11
    v_accvgpr_read_b32 v12, a12
    v_accvgpr_read_b32 v13, a13
    v_mfma_f32_16x16x32_bf16 a[48:51], a[176:179], v[168:171], a[48:51]
    v_accvgpr_read_b32 v14, a14
    v_accvgpr_read_b32 v15, a15
    v_accvgpr_read_b32 v16, a16
    v_accvgpr_read_b32 v17, a17
    v_accvgpr_read_b32 v18, a18
    v_mfma_f32_16x16x32_bf16 a[52:55], a[180:183], v[168:171], a[52:55]
    buffer_load_dwordx4 v217, s[16:19], s28 offen offset:3072 lds
    v_accvgpr_read_b32 v19, a19
    v_accvgpr_read_b32 v20, a20
    v_accvgpr_read_b32 v21, a21
    v_accvgpr_read_b32 v22, a22
    v_mfma_f32_16x16x32_bf16 a[56:59], a[184:187], v[168:171], a[56:59]
    v_accvgpr_read_b32 v23, a23
    v_accvgpr_read_b32 v24, a24
    v_accvgpr_read_b32 v25, a25
    v_accvgpr_read_b32 v26, a26
    v_accvgpr_read_b32 v27, a27
    v_mfma_f32_16x16x32_bf16 a[60:63], a[188:191], v[168:171], a[60:63]
    v_accvgpr_read_b32 v28, a28
    v_accvgpr_read_b32 v29, a29
    v_accvgpr_read_b32 v30, a30
    v_accvgpr_read_b32 v31, a31
    s_branch Lepi2
Lxs2_3:
Ltail2_0_0:
    v_mfma_f32_16x16x32_bf16 a[240:243], v[228:231], v[164:167], a[240:243]
    ds_read_b64_tr_b16 a[192:193], v208 offset:16384
    v_mfma_f32_16x16x32_bf16 a[244:247], v[228:231], v[168:171], a[244:247]
    ds_read_b64_tr_b16 a[194:195], v208 offset:24576
    ds_read_b64_tr_b16 a[196:197], v209 offset:16384
    ds_read_b64_tr_b16 a[198:199], v209 offset:24576
    ds_read_b64_tr_b16 a[200:201], v210 offset:16384
    ds_read_b64_tr_b16 a[202:203], v210 offset:24576
    ds_read_b64_tr_b16 a[204:205], v211 offset:16384
    ds_read_b64_tr_b16 a[206:207], v211 offset:24576
    ds_read_b64_tr_b16 a[208:209], v212 offset:16384
    ds_read_b64_tr_b16 a[210:211], v212 offset:24576
    ds_read_b64_tr_b16 a[212:213], v213 offset:16384
    ds_read_b64_tr_b16 a[214:215], v213 offset:24576
    ds_read_b64_tr_b16 a[216:217], v214 offset:16384
    ds_read_b64_tr_b16 a[218:219], v214 offset:24576
    ds_read_b64_tr_b16 a[220:221], v215 offset:16384
    ds_read_b64_tr_b16 a[222:223], v215 offset:24576
    v_accvgpr_read_b32 v252, a240
    v_accvgpr_read_b32 v253, a244
    v_max_f32 v237, v252, v253
    v_cmp_le_f32 vcc, s66, v237
    v_exp_f32 v224, v72
    v_exp_f32 v225, v73
    s_cmp_lg_u64 vcc, 0
    s_cselect_b32 s61, 1, 0
    s_andn2_b32 s61, s61, s65
    v_mov_b32 v237, s61
    ds_write_b32 v239, v237 offset:16384
    v_exp_f32 v226, v74
    v_exp_f32 v227, v75
    v_cvt_pk_bf16_f32 v148, v224, v225
    v_exp_f32 v248, v76
    v_exp_f32 v249, v77
    v_cvt_pk_bf16_f32 v149, v226, v227
    v_or_b32 v245, v148, v149
    v_exp_f32 v250, v78
    v_exp_f32 v251, v79
    v_cvt_pk_bf16_f32 v150, v248, v249
    v_exp_f32 v224, v64
    v_exp_f32 v225, v65
    v_cvt_pk_bf16_f32 v151, v250, v251
    v_or3_b32 v245, v245, v150, v151
    v_exp_f32 v226, v66
    v_exp_f32 v227, v67
    s_waitcnt vmcnt(8) lgkmcnt(0)
    s_barrier
    v_mfma_f32_16x16x32_bf16 a[0:3], a[192:195], v[164:167], a[0:3]
    ds_read_b32 v237, v236
    ds_read_b64_tr_b16 a[160:161], v208 offset:32768
    v_mfma_f32_16x16x32_bf16 a[32:35], a[192:195], v[168:171], a[32:35]
    ds_read_b64_tr_b16 a[162:163], v208 offset:40960
    v_cvt_pk_bf16_f32 v144, v224, v225
    v_mfma_f32_16x16x32_bf16 a[4:7], a[196:199], v[164:167], a[4:7]
    ds_read_b64_tr_b16 a[164:165], v209 offset:32768
    v_cvt_pk_bf16_f32 v145, v226, v227
    v_mfma_f32_16x16x32_bf16 a[36:39], a[196:199], v[168:171], a[36:39]
    ds_read_b64_tr_b16 a[166:167], v209 offset:40960
    v_or3_b32 v245, v245, v144, v145
    v_mfma_f32_16x16x32_bf16 a[8:11], a[200:203], v[164:167], a[8:11]
    ds_read_b64_tr_b16 a[168:169], v210 offset:32768
    ds_read_b64_tr_b16 a[170:171], v210 offset:40960
    v_mfma_f32_16x16x32_bf16 a[40:43], a[200:203], v[168:171], a[40:43]
    ds_read_b64_tr_b16 a[172:173], v211 offset:32768
    v_exp_f32 v248, v68
    v_mfma_f32_16x16x32_bf16 a[12:15], a[204:207], v[164:167], a[12:15]
    ds_read_b64_tr_b16 a[174:175], v211 offset:40960
    v_exp_f32 v249, v69
    v_mfma_f32_16x16x32_bf16 a[44:47], a[204:207], v[168:171], a[44:47]
    ds_read_b64_tr_b16 a[176:177], v212 offset:32768
    v_cvt_pk_bf16_f32 v146, v248, v249
    v_mfma_f32_16x16x32_bf16 a[16:19], a[208:211], v[164:167], a[16:19]
    ds_read_b64_tr_b16 a[178:179], v212 offset:40960
    v_exp_f32 v250, v70
    v_mfma_f32_16x16x32_bf16 a[48:51], a[208:211], v[168:171], a[48:51]
    ds_read_b64_tr_b16 a[180:181], v213 offset:32768
    ds_read_b64_tr_b16 a[182:183], v213 offset:40960
    v_mfma_f32_16x16x32_bf16 a[20:23], a[212:215], v[164:167], a[20:23]
    ds_read_b64_tr_b16 a[184:185], v214 offset:32768
    v_mfma_f32_16x16x32_bf16 a[52:55], a[212:215], v[168:171], a[52:55]
    ds_read_b64_tr_b16 a[186:187], v214 offset:40960
    v_mfma_f32_16x16x32_bf16 a[24:27], a[216:219], v[164:167], a[24:27]
    ds_read_b64_tr_b16 a[188:189], v215 offset:32768
    v_exp_f32 v251, v71
    v_mfma_f32_16x16x32_bf16 a[56:59], a[216:219], v[168:171], a[56:59]
    ds_read_b64_tr_b16 a[190:191], v215 offset:40960
    v_cvt_pk_bf16_f32 v147, v250, v251
    v_mfma_f32_16x16x32_bf16 a[28:31], a[220:223], v[164:167], a[28:31]
    v_or3_b32 v245, v245, v146, v147
    v_and_b32 v244, 0x40004000, v245
    v_mfma_f32_16x16x32_bf16 a[60:63], a[220:223], v[168:171], a[60:63]
    v_cmp_ne_u32 vcc, 0, v244
    s_cbranch_vccnz Lrare_t2t0_0
Lback_t2t0_0:
    s_waitcnt lgkmcnt(8)
    v_cmp_ne_u32 vcc, 0, v237
    s_cbranch_vccnz Lrestart
    v_mfma_f32_16x16x32_bf16 a[240:243], v[228:231], v[144:147], a[240:243]
    v_xor_b32 v184, 0, v240
    v_mfma_f32_16x16x32_bf16 a[244:247], v[228:231], v[148:151], a[244:247]
    s_waitcnt lgkmcnt(6)
    v_xor_b32 v185, 32, v240
    v_mfma_f32_16x16x32_bf16 a[0:3], a[160:163], v[144:147], a[0:3]
    v_xor_b32 v186, 64, v240
    v_mfma_f32_16x16x32_bf16 a[4:7], a[164:167], v[144:147], a[4:7]
    v_xor_b32 v187, 96, v240
    v_mfma_f32_16x16x32_bf16 a[8:11], a[168:171], v[144:147], a[8:11]
    v_mfma_f32_16x16x32_bf16 a[12:15], a[172:175], v[144:147], a[12:15]
    v_xor_b32 v188, 128, v240
    v_mfma_f32_16x16x32_bf16 a[16:19], a[176:179], v[144:147], a[16:19]
    s_waitcnt lgkmcnt(0)
    v_xor_b32 v189, 160, v240
    v_mfma_f32_16x16x32_bf16 a[20:23], a[180:183], v[144:147], a[20:23]
    v_xor_b32 v190, 192, v240
    v_mfma_f32_16x16x32_bf16 a[24:27], a[184:187], v[144:147], a[24:27]
    v_xor_b32 v191, 224, v240
    v_mfma_f32_16x16x32_bf16 a[28:31], a[188:191], v[144:147], a[28:31]
    v_mfma_f32_16x16x32_bf16 a[32:35], a[160:163], v[148:151], a[32:35]
    v_accvgpr_read_b32 v244, a240
    v_accvgpr_read_b32 v245, a244
    v_rcp_f32 v192, v244
    v_rcp_f32 v193, v245
    v_accvgpr_read_b32 v0, a0
    v_mfma_f32_16x16x32_bf16 a[36:39], a[164:167], v[148:151], a[36:39]
    v_accvgpr_read_b32 v1, a1
    v_accvgpr_read_b32 v2, a2
    v_accvgpr_read_b32 v3, a3
    v_accvgpr_read_b32 v4, a4
    v_mfma_f32_16x16x32_bf16 a[40:43], a[168:171], v[148:151], a[40:43]
    v_accvgpr_read_b32 v5, a5
    v_accvgpr_read_b32 v6, a6
    v_accvgpr_read_b32 v7, a7
    v_accvgpr_read_b32 v8, a8
    v_accvgpr_read_b32 v9, a9
    v_mfma_f32_16x16x32_bf16 a[44:47], a[172:175], v[148:151], a[44:47]
    v_accvgpr_read_b32 v10, a10
    v_accvgpr_read_b32 v11, a11
    v_accvgpr_read_b32 v12, a12
    v_accvgpr_read_b32 v13, a13
    v_mfma_f32_16x16x32_bf16 a[48:51], a[176:179], v[148:151], a[48:51]
    v_accvgpr_read_b32 v14, a14
    v_accvgpr_read_b32 v15, a15
    v_accvgpr_read_b32 v16, a16
    v_accvgpr_read_b32 v17, a17
    v_accvgpr_read_b32 v18, a18
    v_mfma_f32_16x16x32_bf16 a[52:55], a[180:183], v[148:151], a[52:55]
    v_accvgpr_read_b32 v19, a19
    v_accvgpr_read_b32 v20, a20
    v_accvgpr_read_b32 v21, a21
    v_accvgpr_read_b32 v22, a22
    v_mfma_f32_16x16x32_bf16 a[56:59], a[184:187], v[148:151], a[56:59]
    v_accvgpr_read_b32 v23, a23
    v_accvgpr_read_b32 v24, a24
    v_accvgpr_read_b32 v25, a25
    v_accvgpr_read_b32 v26, a26
    v_accvgpr_read_b32 v27, a27
    v_mfma_f32_16x16x32_bf16 a[60:63], a[188:191], v[148:151], a[60:63]
    v_accvgpr_read_b32 v28, a28
    v_accvgpr_read_b32 v29, a29
    v_accvgpr_read_b32 v30, a30
    v_accvgpr_read_b32 v31, a31
    s_branch Lepi2
Lepi2:
    v_pk_mul_f32 v[0:1], v[0:1], v[192:193] op_sel_hi:[1,0]
    v_pk_mul_f32 v[2:3], v[2:3], v[192:193] op_sel_hi:[1,0]
    v_pk_mul_f32 v[4:5], v[4:5], v[192:193] op_sel_hi:[1,0]
    v_pk_mul_f32 v[6:7], v[6:7], v[192:193] op_sel_hi:[1,0]
    v_cvt_pk_bf16_f32 v32, v0, v1
    v_cvt_pk_bf16_f32 v33, v2, v3
    v_cvt_pk_bf16_f32 v34, v4, v5
    v_cvt_pk_bf16_f32 v35, v6, v7
    ds_write_b64 v184, v[32:33]
    ds_write_b64 v185, v[34:35]
    v_pk_mul_f32 v[8:9], v[8:9], v[192:193] op_sel_hi:[1,0]
    v_pk_mul_f32 v[10:11], v[10:11], v[192:193] op_sel_hi:[1,0]
    v_pk_mul_f32 v[12:13], v[12:13], v[192:193] op_sel_hi:[1,0]
    v_pk_mul_f32 v[14:15], v[14:15], v[192:193] op_sel_hi:[1,0]
    v_cvt_pk_bf16_f32 v36, v8, v9
    v_cvt_pk_bf16_f32 v37, v10, v11
    v_cvt_pk_bf16_f32 v38, v12, v13
    v_cvt_pk_bf16_f32 v39, v14, v15
    ds_write_b64 v186, v[36:37]
    ds_write_b64 v187, v[38:39]
    v_pk_mul_f32 v[16:17], v[16:17], v[192:193] op_sel_hi:[1,0]
    v_pk_mul_f32 v[18:19], v[18:19], v[192:193] op_sel_hi:[1,0]
    v_pk_mul_f32 v[20:21], v[20:21], v[192:193] op_sel_hi:[1,0]
    v_pk_mul_f32 v[22:23], v[22:23], v[192:193] op_sel_hi:[1,0]
    v_cvt_pk_bf16_f32 v40, v16, v17
    v_cvt_pk_bf16_f32 v41, v18, v19
    v_cvt_pk_bf16_f32 v42, v20, v21
    v_cvt_pk_bf16_f32 v43, v22, v23
    ds_write_b64 v188, v[40:41]
    ds_write_b64 v189, v[42:43]
    v_pk_mul_f32 v[24:25], v[24:25], v[192:193] op_sel_hi:[1,0]
    v_pk_mul_f32 v[26:27], v[26:27], v[192:193] op_sel_hi:[1,0]
    v_pk_mul_f32 v[28:29], v[28:29], v[192:193] op_sel_hi:[1,0]
    v_pk_mul_f32 v[30:31], v[30:31], v[192:193] op_sel_hi:[1,0]
    v_cvt_pk_bf16_f32 v44, v24, v25
    v_cvt_pk_bf16_f32 v45, v26, v27
    v_cvt_pk_bf16_f32 v46, v28, v29
    v_cvt_pk_bf16_f32 v47, v30, v31
    ds_write_b64 v190, v[44:45]
    ds_write_b64 v191, v[46:47]
    ds_read_b128 v[64:67], v241 offset:0
    ds_read_b128 v[68:71], v241 offset:1024
    ds_read_b128 v[72:75], v241 offset:2048
    ds_read_b128 v[76:79], v241 offset:3072
    v_accvgpr_read_b32 v0, a32
    v_accvgpr_read_b32 v1, a33
    v_accvgpr_read_b32 v2, a34
    v_accvgpr_read_b32 v3, a35
    v_accvgpr_read_b32 v4, a36
    v_accvgpr_read_b32 v5, a37
    v_accvgpr_read_b32 v6, a38
    v_accvgpr_read_b32 v7, a39
    v_pk_mul_f32 v[0:1], v[0:1], v[192:193] op_sel:[0,1] op_sel_hi:[1,1]
    v_pk_mul_f32 v[2:3], v[2:3], v[192:193] op_sel:[0,1] op_sel_hi:[1,1]
    v_pk_mul_f32 v[4:5], v[4:5], v[192:193] op_sel:[0,1] op_sel_hi:[1,1]
    v_pk_mul_f32 v[6:7], v[6:7], v[192:193] op_sel:[0,1] op_sel_hi:[1,1]
    v_cvt_pk_bf16_f32 v48, v0, v1
    v_cvt_pk_bf16_f32 v49, v2, v3
    v_cvt_pk_bf16_f32 v50, v4, v5
    v_cvt_pk_bf16_f32 v51, v6, v7
    ds_write_b64 v184, v[48:49]
    ds_write_b64 v185, v[50:51]
    v_accvgpr_read_b32 v8, a40
    v_accvgpr_read_b32 v9, a41
    v_accvgpr_read_b32 v10, a42
    v_accvgpr_read_b32 v11, a43
    v_accvgpr_read_b32 v12, a44
    v_accvgpr_read_b32 v13, a45
    v_accvgpr_read_b32 v14, a46
    v_accvgpr_read_b32 v15, a47
    s_add_u32 s61, s56, 0
    s_waitcnt lgkmcnt(2)
    buffer_store_dwordx4 v[64:67], v220, s[24:27], s61 offen offset:0 sc0 sc1
    v_pk_mul_f32 v[8:9], v[8:9], v[192:193] op_sel:[0,1] op_sel_hi:[1,1]
    v_pk_mul_f32 v[10:11], v[10:11], v[192:193] op_sel:[0,1] op_sel_hi:[1,1]
    v_pk_mul_f32 v[12:13], v[12:13], v[192:193] op_sel:[0,1] op_sel_hi:[1,1]
    v_pk_mul_f32 v[14:15], v[14:15], v[192:193] op_sel:[0,1] op_sel_hi:[1,1]
    v_cvt_pk_bf16_f32 v52, v8, v9
    v_cvt_pk_bf16_f32 v53, v10, v11
    v_cvt_pk_bf16_f32 v54, v12, v13
    v_cvt_pk_bf16_f32 v55, v14, v15
    ds_write_b64 v186, v[52:53]
    ds_write_b64 v187, v[54:55]
    v_accvgpr_read_b32 v16, a48
    v_accvgpr_read_b32 v17, a49
    v_accvgpr_read_b32 v18, a50
    v_accvgpr_read_b32 v19, a51
    v_accvgpr_read_b32 v20, a52
    v_accvgpr_read_b32 v21, a53
    v_accvgpr_read_b32 v22, a54
    v_accvgpr_read_b32 v23, a55
    buffer_store_dwordx4 v[68:71], v221, s[24:27], s61 offen offset:1024 sc0 sc1
    v_pk_mul_f32 v[16:17], v[16:17], v[192:193] op_sel:[0,1] op_sel_hi:[1,1]
    v_pk_mul_f32 v[18:19], v[18:19], v[192:193] op_sel:[0,1] op_sel_hi:[1,1]
    v_pk_mul_f32 v[20:21], v[20:21], v[192:193] op_sel:[0,1] op_sel_hi:[1,1]
    v_pk_mul_f32 v[22:23], v[22:23], v[192:193] op_sel:[0,1] op_sel_hi:[1,1]
    v_cvt_pk_bf16_f32 v56, v16, v17
    v_cvt_pk_bf16_f32 v57, v18, v19
    v_cvt_pk_bf16_f32 v58, v20, v21
    v_cvt_pk_bf16_f32 v59, v22, v23
    ds_write_b64 v188, v[56:57]
    ds_write_b64 v189, v[58:59]
    v_accvgpr_read_b32 v24, a56
    v_accvgpr_read_b32 v25, a57
    v_accvgpr_read_b32 v26, a58
    v_accvgpr_read_b32 v27, a59
    v_accvgpr_read_b32 v28, a60
    v_accvgpr_read_b32 v29, a61
    v_accvgpr_read_b32 v30, a62
    v_accvgpr_read_b32 v31, a63
    buffer_store_dwordx4 v[72:75], v222, s[24:27], s61 offen offset:2048 sc0 sc1
    v_pk_mul_f32 v[24:25], v[24:25], v[192:193] op_sel:[0,1] op_sel_hi:[1,1]
    v_pk_mul_f32 v[26:27], v[26:27], v[192:193] op_sel:[0,1] op_sel_hi:[1,1]
    v_pk_mul_f32 v[28:29], v[28:29], v[192:193] op_sel:[0,1] op_sel_hi:[1,1]
    v_pk_mul_f32 v[30:31], v[30:31], v[192:193] op_sel:[0,1] op_sel_hi:[1,1]
    v_cvt_pk_bf16_f32 v60, v24, v25
    v_cvt_pk_bf16_f32 v61, v26, v27
    v_cvt_pk_bf16_f32 v62, v28, v29
    v_cvt_pk_bf16_f32 v63, v30, v31
    ds_write_b64 v190, v[60:61]
    ds_write_b64 v191, v[62:63]
    ds_read_b128 v[80:83], v241 offset:0
    ds_read_b128 v[84:87], v241 offset:1024
    ds_read_b128 v[88:91], v241 offset:2048
    ds_read_b128 v[92:95], v241 offset:3072
    buffer_store_dwordx4 v[76:79], v223, s[24:27], s61 offen offset:3072 sc0 sc1
    s_add_u32 s62, s56, 65536
    s_waitcnt lgkmcnt(3)
    buffer_store_dwordx4 v[80:83], v220, s[24:27], s62 offen offset:0 sc0 sc1
    s_waitcnt lgkmcnt(2)
    buffer_store_dwordx4 v[84:87], v221, s[24:27], s62 offen offset:1024 sc0 sc1
    s_waitcnt lgkmcnt(1)
    buffer_store_dwordx4 v[88:91], v222, s[24:27], s62 offen offset:2048 sc0 sc1
    s_waitcnt lgkmcnt(0)
    buffer_store_dwordx4 v[92:95], v223, s[24:27], s62 offen offset:3072 sc0 sc1
    s_cmp_eq_u32 s29, 0
    s_cbranch_scc1 Ldone
    s_mov_b32 s64, 0
    s_mov_b32 s65, 0
    s_waitcnt vmcnt(8)
    s_branch Lstart
Lrare_t4p1:
    s_call_b64 s[48:49], Lresc_1
    s_branch Lback_t4p1
Lrare_x4_0:
    s_call_b64 s[48:49], Lresc_0
    s_branch Lback_x4_0
Lrare_x4_1:
    s_call_b64 s[48:49], Lresc_1
    s_branch Lback_x4_1
Lrare_x4_2:
    s_call_b64 s[48:49], Lresc_0
    s_branch Lback_x4_2
Lrare_x4_3:
    s_call_b64 s[48:49], Lresc_1
    s_branch Lback_x4_3
Lrare_t4t2_0:
    s_call_b64 s[48:49], Lresc_0
    s_branch Lback_t4t2_0
Lrare_t4t2_1:
    s_call_b64 s[48:49], Lresc_0
    s_branch Lback_t4t2_1
Lrare_t4t3_0:
    s_call_b64 s[48:49], Lresc_1
    s_branch Lback_t4t3_0
Lrare_t5p1:
    s_call_b64 s[48:49], Lresc_1
    s_branch Lback_t5p1
Lrare_x5_0:
    s_call_b64 s[48:49], Lresc_0
    s_branch Lback_x5_0
Lrare_x5_1:
    s_call_b64 s[48:49], Lresc_1
    s_branch Lback_x5_1
Lrare_x5_2:
    s_call_b64 s[48:49], Lresc_0
    s_branch Lback_x5_2
Lrare_x5_3:
    s_call_b64 s[48:49], Lresc_1
    s_branch Lback_x5_3
Lrare_t5t0_0:
    s_call_b64 s[48:49], Lresc_0
    s_branch Lback_t5t0_0
Lrare_t3p1:
    s_call_b64 s[48:49], Lresc_1
    s_branch Lback_t3p1
Lrare_x3_0:
    s_call_b64 s[48:49], Lresc_0
    s_branch Lback_x3_0
Lrare_x3_1:
    s_call_b64 s[48:49], Lresc_1
    s_branch Lback_x3_1
Lrare_x3_2:
    s_call_b64 s[48:49], Lresc_0
    s_branch Lback_x3_2
Lrare_x3_3:
    s_call_b64 s[48:49], Lresc_1
    s_branch Lback_x3_3
Lrare_t3t1_1:
    s_call_b64 s[48:49], Lresc_1
    s_branch Lback_t3t1_1
Lrare_t3t0_0:
    s_call_b64 s[48:49], Lresc_0
    s_branch Lback_t3t0_0
Lrare_t3t0_1:
    s_call_b64 s[48:49], Lresc_0
    s_branch Lback_t3t0_1
Lrare_t2p1:
    s_call_b64 s[48:49], Lresc_1
    s_branch Lback_t2p1
Lrare_x2_0:
    s_call_b64 s[48:49], Lresc_0
    s_branch Lback_x2_0
Lrare_x2_1:
    s_call_b64 s[48:49], Lresc_1
    s_branch Lback_x2_1
Lrare_x2_2:
    s_call_b64 s[48:49], Lresc_0
    s_branch Lback_x2_2
Lrare_x2_3:
    s_call_b64 s[48:49], Lresc_1
    s_branch Lback_x2_3
Lrare_t2t2_0:
    s_call_b64 s[48:49], Lresc_0
    s_branch Lback_t2t2_0
Lrare_t2t3_1:
    s_call_b64 s[48:49], Lresc_1
    s_branch Lback_t2t3_1
Lrare_t2t0_0:
    s_call_b64 s[48:49], Lresc_0
    s_branch Lback_t2t0_0
Lresc_0:
    s_nop 15
    v_max3_f32 v244, v64, v65, v66
    v_max3_f32 v244, v244, v67, v68
    v_max3_f32 v244, v244, v69, v70
    v_max_f32 v244, v244, v71
    v_add_f32 v244, s44, v244
    v_max_f32 v244, 0, v244
    v_mov_b32 v245, v244
    s_nop 1
    v_permlane32_swap_b32 v244, v245
    s_nop 1
    v_max_f32 v244, v244, v245
    v_mov_b32 v245, v244
    s_nop 1
    v_permlane16_swap_b32 v244, v245
    s_nop 1
    v_max_f32 v244, v244, v245
    v_sub_f32 v252, 0, v244
    v_exp_f32 v252, v252
    v_sub_f32 v64, v64, v244
    v_sub_f32 v104, v104, v244
    v_sub_f32 v65, v65, v244
    v_sub_f32 v105, v105, v244
    v_sub_f32 v66, v66, v244
    v_sub_f32 v106, v106, v244
    v_sub_f32 v67, v67, v244
    v_sub_f32 v107, v107, v244
    v_sub_f32 v68, v68, v244
    v_sub_f32 v108, v108, v244
    v_sub_f32 v69, v69, v244
    v_sub_f32 v109, v109, v244
    v_sub_f32 v70, v70, v244
    v_sub_f32 v110, v110, v244
    v_sub_f32 v71, v71, v244
    v_sub_f32 v111, v111, v244
    v_sub_f32 v184, v184, v244
    v_sub_f32 v185, v185, v244
    v_sub_f32 v186, v186, v244
    v_sub_f32 v187, v187, v244
    v_accvgpr_read_b32 v245, a240
    v_mul_f32 v245, v245, v252
    v_accvgpr_write_b32 a240, v245
    v_accvgpr_read_b32 v245, a241
    v_mul_f32 v245, v245, v252
    v_accvgpr_write_b32 a241, v245
    v_accvgpr_read_b32 v245, a242
    v_mul_f32 v245, v245, v252
    v_accvgpr_write_b32 a242, v245
    v_accvgpr_read_b32 v245, a243
    v_mul_f32 v245, v245, v252
    v_accvgpr_write_b32 a243, v245
    v_max3_f32 v244, v72, v73, v74
    v_max3_f32 v244, v244, v75, v76
    v_max3_f32 v244, v244, v77, v78
    v_max_f32 v244, v244, v79
    v_add_f32 v244, s44, v244
    v_max_f32 v244, 0, v244
    v_mov_b32 v245, v244
    s_nop 1
    v_permlane32_swap_b32 v244, v245
    s_nop 1
    v_max_f32 v244, v244, v245
    v_mov_b32 v245, v244
    s_nop 1
    v_permlane16_swap_b32 v244, v245
    s_nop 1
    v_max_f32 v244, v244, v245
    v_sub_f32 v253, 0, v244
    v_exp_f32 v253, v253
    v_sub_f32 v72, v72, v244
    v_sub_f32 v112, v112, v244
    v_sub_f32 v73, v73, v244
    v_sub_f32 v113, v113, v244
    v_sub_f32 v74, v74, v244
    v_sub_f32 v114, v114, v244
    v_sub_f32 v75, v75, v244
    v_sub_f32 v115, v115, v244
    v_sub_f32 v76, v76, v244
    v_sub_f32 v116, v116, v244
    v_sub_f32 v77, v77, v244
    v_sub_f32 v117, v117, v244
    v_sub_f32 v78, v78, v244
    v_sub_f32 v118, v118, v244
    v_sub_f32 v79, v79, v244
    v_sub_f32 v119, v119, v244
    v_sub_f32 v188, v188, v244
    v_sub_f32 v189, v189, v244
    v_sub_f32 v190, v190, v244
    v_sub_f32 v191, v191, v244
    v_accvgpr_read_b32 v245, a244
    v_mul_f32 v245, v245, v253
    v_accvgpr_write_b32 a244, v245
    v_accvgpr_read_b32 v245, a245
    v_mul_f32 v245, v245, v253
    v_accvgpr_write_b32 a245, v245
    v_accvgpr_read_b32 v245, a246
    v_mul_f32 v245, v245, v253
    v_accvgpr_write_b32 a246, v245
    v_accvgpr_read_b32 v245, a247
    v_mul_f32 v245, v245, v253
    v_accvgpr_write_b32 a247, v245
    v_max3_f32 v244, v80, v81, v82
    v_max3_f32 v244, v244, v83, v84
    v_max3_f32 v244, v244, v85, v86
    v_max_f32 v244, v244, v87
    v_add_f32 v244, s44, v244
    v_max_f32 v244, 0, v244
    v_mov_b32 v245, v244
    s_nop 1
    v_permlane32_swap_b32 v244, v245
    s_nop 1
    v_max_f32 v244, v244, v245
    v_mov_b32 v245, v244
    s_nop 1
    v_permlane16_swap_b32 v244, v245
    s_nop 1
    v_max_f32 v244, v244, v245
    v_sub_f32 v254, 0, v244
    v_exp_f32 v254, v254
    v_sub_f32 v80, v80, v244
    v_sub_f32 v120, v120, v244
    v_sub_f32 v81, v81, v244
    v_sub_f32 v121, v121, v244
    v_sub_f32 v82, v82, v244
    v_sub_f32 v122, v122, v244
    v_sub_f32 v83, v83, v244
    v_sub_f32 v123, v123, v244
    v_sub_f32 v84, v84, v244
    v_sub_f32 v124, v124, v244
    v_sub_f32 v85, v85, v244
    v_sub_f32 v125, v125, v244
    v_sub_f32 v86, v86, v244
    v_sub_f32 v126, v126, v244
    v_sub_f32 v87, v87, v244
    v_sub_f32 v127, v127, v244
    v_sub_f32 v192, v192, v244
    v_sub_f32 v193, v193, v244
    v_sub_f32 v194, v194, v244
    v_sub_f32 v195, v195, v244
    v_accvgpr_read_b32 v245, a248
    v_mul_f32 v245, v245, v254
    v_accvgpr_write_b32 a248, v245
    v_accvgpr_read_b32 v245, a249
    v_mul_f32 v245, v245, v254
    v_accvgpr_write_b32 a249, v245
    v_accvgpr_read_b32 v245, a250
    v_mul_f32 v245, v245, v254
    v_accvgpr_write_b32 a250, v245
    v_accvgpr_read_b32 v245, a251
    v_mul_f32 v245, v245, v254
    v_accvgpr_write_b32 a251, v245
    v_max3_f32 v244, v88, v89, v90
    v_max3_f32 v244, v244, v91, v92
    v_max3_f32 v244, v244, v93, v94
    v_max_f32 v244, v244, v95
    v_add_f32 v244, s44, v244
    v_max_f32 v244, 0, v244
    v_mov_b32 v245, v244
    s_nop 1
    v_permlane32_swap_b32 v244, v245
    s_nop 1
    v_max_f32 v244, v244, v245
    v_mov_b32 v245, v244
    s_nop 1
    v_permlane16_swap_b32 v244, v245
    s_nop 1
    v_max_f32 v244, v244, v245
    v_sub_f32 v255, 0, v244
    v_exp_f32 v255, v255
    v_sub_f32 v88, v88, v244
    v_sub_f32 v128, v128, v244
    v_sub_f32 v89, v89, v244
    v_sub_f32 v129, v129, v244
    v_sub_f32 v90, v90, v244
    v_sub_f32 v130, v130, v244
    v_sub_f32 v91, v91, v244
    v_sub_f32 v131, v131, v244
    v_sub_f32 v92, v92, v244
    v_sub_f32 v132, v132, v244
    v_sub_f32 v93, v93, v244
    v_sub_f32 v133, v133, v244
    v_sub_f32 v94, v94, v244
    v_sub_f32 v134, v134, v244
    v_sub_f32 v95, v95, v244
    v_sub_f32 v135, v135, v244
    v_sub_f32 v196, v196, v244
    v_sub_f32 v197, v197, v244
    v_sub_f32 v198, v198, v244
    v_sub_f32 v199, v199, v244
    v_mul_f32 v233, v233, v255
    v_accvgpr_read_b32 v245, a252
    v_mul_f32 v245, v245, v255
    v_accvgpr_write_b32 a252, v245
    v_accvgpr_read_b32 v245, a253
    v_mul_f32 v245, v245, v255
    v_accvgpr_write_b32 a253, v245
    v_accvgpr_read_b32 v245, a254
    v_mul_f32 v245, v245, v255
    v_accvgpr_write_b32 a254, v245
    v_accvgpr_read_b32 v245, a255
    v_mul_f32 v245, v245, v255
    v_accvgpr_write_b32 a255, v245
    v_max3_f32 v244, v96, v97, v98
    v_max3_f32 v244, v244, v99, v100
    v_max3_f32 v244, v244, v101, v102
    v_max_f32 v244, v244, v103
    v_add_f32 v244, s44, v244
    v_max_f32 v244, 0, v244
    v_mov_b32 v245, v244
    s_nop 1
    v_permlane32_swap_b32 v244, v245
    s_nop 1
    v_max_f32 v244, v244, v245
    v_mov_b32 v245, v244
    s_nop 1
    v_permlane16_swap_b32 v244, v245
    s_nop 1
    v_max_f32 v244, v244, v245
    v_sub_f32 v246, 0, v244
    v_exp_f32 v246, v246
    v_sub_f32 v96, v96, v244
    v_sub_f32 v136, v136, v244
    v_sub_f32 v97, v97, v244
    v_sub_f32 v137, v137, v244
    v_sub_f32 v98, v98, v244
    v_sub_f32 v138, v138, v244
    v_sub_f32 v99, v99, v244
    v_sub_f32 v139, v139, v244
    v_sub_f32 v100, v100, v244
    v_sub_f32 v140, v140, v244
    v_sub_f32 v101, v101, v244
    v_sub_f32 v141, v141, v244
    v_sub_f32 v102, v102, v244
    v_sub_f32 v142, v142, v244
    v_sub_f32 v103, v103, v244
    v_sub_f32 v143, v143, v244
    v_sub_f32 v200, v200, v244
    v_sub_f32 v201, v201, v244
    v_sub_f32 v202, v202, v244
    v_sub_f32 v203, v203, v244
    v_mul_f32 v235, v235, v246
    v_exp_f32 v224, v96
    v_exp_f32 v225, v97
    v_exp_f32 v226, v98
    v_exp_f32 v227, v99
    v_cvt_pk_bf16_f32 v160, v224, v225
    v_add_f32 v234, v224, v225
    v_exp_f32 v248, v100
    v_exp_f32 v249, v101
    v_cvt_pk_bf16_f32 v161, v226, v227
    v_add_f32 v247, v226, v227
    v_add_f32 v234, v234, v247
    v_exp_f32 v250, v102
    v_exp_f32 v251, v103
    v_cvt_pk_bf16_f32 v162, v248, v249
    v_add_f32 v247, v248, v249
    v_add_f32 v234, v234, v247
    v_exp_f32 v224, v88
    v_exp_f32 v225, v89
    v_cvt_pk_bf16_f32 v163, v250, v251
    v_add_f32 v247, v250, v251
    v_add_f32 v234, v234, v247
    v_exp_f32 v226, v90
    v_exp_f32 v227, v91
    v_cvt_pk_bf16_f32 v156, v224, v225
    v_add_f32 v232, v224, v225
    v_exp_f32 v248, v92
    v_exp_f32 v249, v93
    v_cvt_pk_bf16_f32 v157, v226, v227
    v_add_f32 v247, v226, v227
    v_add_f32 v232, v232, v247
    v_exp_f32 v250, v94
    v_exp_f32 v251, v95
    v_cvt_pk_bf16_f32 v158, v248, v249
    v_add_f32 v247, v248, v249
    v_add_f32 v232, v232, v247
    v_exp_f32 v224, v80
    v_exp_f32 v225, v81
    v_cvt_pk_bf16_f32 v159, v250, v251
    v_add_f32 v247, v250, v251
    v_add_f32 v232, v232, v247
    v_exp_f32 v226, v82
    v_exp_f32 v227, v83
    v_cvt_pk_bf16_f32 v152, v224, v225
    v_exp_f32 v248, v84
    v_exp_f32 v249, v85
    v_cvt_pk_bf16_f32 v153, v226, v227
    v_exp_f32 v250, v86
    v_exp_f32 v251, v87
    v_cvt_pk_bf16_f32 v154, v248, v249
    v_exp_f32 v224, v72
    v_exp_f32 v225, v73
    v_cvt_pk_bf16_f32 v155, v250, v251
    v_exp_f32 v226, v74
    v_exp_f32 v227, v75
    v_cvt_pk_bf16_f32 v148, v224, v225
    v_exp_f32 v248, v76
    v_exp_f32 v249, v77
    v_cvt_pk_bf16_f32 v149, v226, v227
    v_exp_f32 v250, v78
    v_exp_f32 v251, v79
    v_cvt_pk_bf16_f32 v150, v248, v249
    v_exp_f32 v224, v64
    v_exp_f32 v225, v65
    v_cvt_pk_bf16_f32 v151, v250, v251
    v_exp_f32 v226, v66
    v_exp_f32 v227, v67
    v_cvt_pk_bf16_f32 v144, v224, v225
    v_exp_f32 v248, v68
    v_exp_f32 v249, v69
    v_cvt_pk_bf16_f32 v145, v226, v227
    v_exp_f32 v250, v70
    v_exp_f32 v251, v71
    v_cvt_pk_bf16_f32 v146, v248, v249
    v_cvt_pk_bf16_f32 v147, v250, v251
    s_branch LrescO
Lresc_1:
    s_nop 15
    v_max3_f32 v244, v104, v105, v106
    v_max3_f32 v244, v244, v107, v108
    v_max3_f32 v244, v244, v109, v110
    v_max_f32 v244, v244, v111
    v_add_f32 v244, s44, v244
    v_max_f32 v244, 0, v244
    v_mov_b32 v245, v244
    s_nop 1
    v_permlane32_swap_b32 v244, v245
    s_nop 1
    v_max_f32 v244, v244, v245
    v_mov_b32 v245, v244
    s_nop 1
    v_permlane16_swap_b32 v244, v245
    s_nop 1
    v_max_f32 v244, v244, v245
    v_sub_f32 v252, 0, v244
    v_exp_f32 v252, v252
    v_sub_f32 v104, v104, v244
    v_sub_f32 v64, v64, v244
    v_sub_f32 v105, v105, v244
    v_sub_f32 v65, v65, v244
    v_sub_f32 v106, v106, v244
    v_sub_f32 v66, v66, v244
    v_sub_f32 v107, v107, v244
    v_sub_f32 v67, v67, v244
    v_sub_f32 v108, v108, v244
    v_sub_f32 v68, v68, v244
    v_sub_f32 v109, v109, v244
    v_sub_f32 v69, v69, v244
    v_sub_f32 v110, v110, v244
    v_sub_f32 v70, v70, v244
    v_sub_f32 v111, v111, v244
    v_sub_f32 v71, v71, v244
    v_sub_f32 v184, v184, v244
    v_sub_f32 v185, v185, v244
    v_sub_f32 v186, v186, v244
    v_sub_f32 v187, v187, v244
    v_accvgpr_read_b32 v245, a240
    v_mul_f32 v245, v245, v252
    v_accvgpr_write_b32 a240, v245
    v_accvgpr_read_b32 v245, a241
    v_mul_f32 v245, v245, v252
    v_accvgpr_write_b32 a241, v245
    v_accvgpr_read_b32 v245, a242
    v_mul_f32 v245, v245, v252
    v_accvgpr_write_b32 a242, v245
    v_accvgpr_read_b32 v245, a243
    v_mul_f32 v245, v245, v252
    v_accvgpr_write_b32 a243, v245
    v_max3_f32 v244, v112, v113, v114
    v_max3_f32 v244, v244, v115, v116
    v_max3_f32 v244, v244, v117, v118
    v_max_f32 v244, v244, v119
    v_add_f32 v244, s44, v244
    v_max_f32 v244, 0, v244
    v_mov_b32 v245, v244
    s_nop 1
    v_permlane32_swap_b32 v244, v245
    s_nop 1
    v_max_f32 v244, v244, v245
    v_mov_b32 v245, v244
    s_nop 1
    v_permlane16_swap_b32 v244, v245
    s_nop 1
    v_max_f32 v244, v244, v245
    v_sub_f32 v253, 0, v244
    v_exp_f32 v253, v253
    v_sub_f32 v112, v112, v244
    v_sub_f32 v72, v72, v244
    v_sub_f32 v113, v113, v244
    v_sub_f32 v73, v73, v244
    v_sub_f32 v114, v114, v244
    v_sub_f32 v74, v74, v244
    v_sub_f32 v115, v115, v244
    v_sub_f32 v75, v75, v244
    v_sub_f32 v116, v116, v244
    v_sub_f32 v76, v76, v244
    v_sub_f32 v117, v117, v244
    v_sub_f32 v77, v77, v244
    v_sub_f32 v118, v118, v244
    v_sub_f32 v78, v78, v244
    v_sub_f32 v119, v119, v244
    v_sub_f32 v79, v79, v244
    v_sub_f32 v188, v188, v244
    v_sub_f32 v189, v189, v244
    v_sub_f32 v190, v190, v244
    v_sub_f32 v191, v191, v244
    v_accvgpr_read_b32 v245, a244
    v_mul_f32 v245, v245, v253
    v_accvgpr_write_b32 a244, v245
    v_accvgpr_read_b32 v245, a245
    v_mul_f32 v245, v245, v253
    v_accvgpr_write_b32 a245, v245
    v_accvgpr_read_b32 v245, a246
    v_mul_f32 v245, v245, v253
    v_accvgpr_write_b32 a246, v245
    v_accvgpr_read_b32 v245, a247
    v_mul_f32 v245, v245, v253
    v_accvgpr_write_b32 a247, v245
    v_max3_f32 v244, v120, v121, v122
    v_max3_f32 v244, v244, v123, v124
    v_max3_f32 v244, v244, v125, v126
    v_max_f32 v244, v244, v127
    v_add_f32 v244, s44, v244
    v_max_f32 v244, 0, v244
    v_mov_b32 v245, v244
    s_nop 1
    v_permlane32_swap_b32 v244, v245
    s_nop 1
    v_max_f32 v244, v244, v245
    v_mov_b32 v245, v244
    s_nop 1
    v_permlane16_swap_b32 v244, v245
    s_nop 1
    v_max_f32 v244, v244, v245
    v_sub_f32 v254, 0, v244
    v_exp_f32 v254, v254
    v_sub_f32 v120, v120, v244
    v_sub_f32 v80, v80, v244
    v_sub_f32 v121, v121, v244
    v_sub_f32 v81, v81, v244
    v_sub_f32 v122, v122, v244
    v_sub_f32 v82, v82, v244
    v_sub_f32 v123, v123, v244
    v_sub_f32 v83, v83, v244
    v_sub_f32 v124, v124, v244
    v_sub_f32 v84, v84, v244
    v_sub_f32 v125, v125, v244
    v_sub_f32 v85, v85, v244
    v_sub_f32 v126, v126, v244
    v_sub_f32 v86, v86, v244
    v_sub_f32 v127, v127, v244
    v_sub_f32 v87, v87, v244
    v_sub_f32 v192, v192, v244
    v_sub_f32 v193, v193, v244
    v_sub_f32 v194, v194, v244
    v_sub_f32 v195, v195, v244
    v_accvgpr_read_b32 v245, a248
    v_mul_f32 v245, v245, v254
    v_accvgpr_write_b32 a248, v245
    v_accvgpr_read_b32 v245, a249
    v_mul_f32 v245, v245, v254
    v_accvgpr_write_b32 a249, v245
    v_accvgpr_read_b32 v245, a250
    v_mul_f32 v245, v245, v254
    v_accvgpr_write_b32 a250, v245
    v_accvgpr_read_b32 v245, a251
    v_mul_f32 v245, v245, v254
    v_accvgpr_write_b32 a251, v245
    v_max3_f32 v244, v128, v129, v130
    v_max3_f32 v244, v244, v131, v132
    v_max3_f32 v244, v244, v133, v134
    v_max_f32 v244, v244, v135
    v_add_f32 v244, s44, v244
    v_max_f32 v244, 0, v244
    v_mov_b32 v245, v244
    s_nop 1
    v_permlane32_swap_b32 v244, v245
    s_nop 1
    v_max_f32 v244, v244, v245
    v_mov_b32 v245, v244
    s_nop 1
    v_permlane16_swap_b32 v244, v245
    s_nop 1
    v_max_f32 v244, v244, v245
    v_sub_f32 v255, 0, v244
    v_exp_f32 v255, v255
    v_sub_f32 v128, v128, v244
    v_sub_f32 v88, v88, v244
    v_sub_f32 v129, v129, v244
    v_sub_f32 v89, v89, v244
    v_sub_f32 v130, v130, v244
    v_sub_f32 v90, v90, v244
    v_sub_f32 v131, v131, v244
    v_sub_f32 v91, v91, v244
    v_sub_f32 v132, v132, v244
    v_sub_f32 v92, v92, v244
    v_sub_f32 v133, v133, v244
    v_sub_f32 v93, v93, v244
    v_sub_f32 v134, v134, v244
    v_sub_f32 v94, v94, v244
    v_sub_f32 v135, v135, v244
    v_sub_f32 v95, v95, v244
    v_sub_f32 v196, v196, v244
    v_sub_f32 v197, v197, v244
    v_sub_f32 v198, v198, v244
    v_sub_f32 v199, v199, v244
    v_mul_f32 v233, v233, v255
    v_accvgpr_read_b32 v245, a252
    v_mul_f32 v245, v245, v255
    v_accvgpr_write_b32 a252, v245
    v_accvgpr_read_b32 v245, a253
    v_mul_f32 v245, v245, v255
    v_accvgpr_write_b32 a253, v245
    v_accvgpr_read_b32 v245, a254
    v_mul_f32 v245, v245, v255
    v_accvgpr_write_b32 a254, v245
    v_accvgpr_read_b32 v245, a255
    v_mul_f32 v245, v245, v255
    v_accvgpr_write_b32 a255, v245
    v_max3_f32 v244, v136, v137, v138
    v_max3_f32 v244, v244, v139, v140
    v_max3_f32 v244, v244, v141, v142
    v_max_f32 v244, v244, v143
    v_add_f32 v244, s44, v244
    v_max_f32 v244, 0, v244
    v_mov_b32 v245, v244
    s_nop 1
    v_permlane32_swap_b32 v244, v245
    s_nop 1
    v_max_f32 v244, v244, v245
    v_mov_b32 v245, v244
    s_nop 1
    v_permlane16_swap_b32 v244, v245
    s_nop 1
    v_max_f32 v244, v244, v245
    v_sub_f32 v246, 0, v244
    v_exp_f32 v246, v246
    v_sub_f32 v136, v136, v244
    v_sub_f32 v96, v96, v244
    v_sub_f32 v137, v137, v244
    v_sub_f32 v97, v97, v244
    v_sub_f32 v138, v138, v244
    v_sub_f32 v98, v98, v244
    v_sub_f32 v139, v139, v244
    v_sub_f32 v99, v99, v244
    v_sub_f32 v140, v140, v244
    v_sub_f32 v100, v100, v244
    v_sub_f32 v141, v141, v244
    v_sub_f32 v101, v101, v244
    v_sub_f32 v142, v142, v244
    v_sub_f32 v102, v102, v244
    v_sub_f32 v143, v143, v244
    v_sub_f32 v103, v103, v244
    v_sub_f32 v200, v200, v244
    v_sub_f32 v201, v201, v244
    v_sub_f32 v202, v202, v244
    v_sub_f32 v203, v203, v244
    v_mul_f32 v235, v235, v246
    v_exp_f32 v224, v136
    v_exp_f32 v225, v137
    v_exp_f32 v226, v138
    v_exp_f32 v227, v139
    v_cvt_pk_bf16_f32 v180, v224, v225
    v_add_f32 v234, v224, v225
    v_exp_f32 v248, v140
    v_exp_f32 v249, v141
    v_cvt_pk_bf16_f32 v181, v226, v227
    v_add_f32 v247, v226, v227
    v_add_f32 v234, v234, v247
    v_exp_f32 v250, v142
    v_exp_f32 v251, v143
    v_cvt_pk_bf16_f32 v182, v248, v249
    v_add_f32 v247, v248, v249
    v_add_f32 v234, v234, v247
    v_exp_f32 v224, v128
    v_exp_f32 v225, v129
    v_cvt_pk_bf16_f32 v183, v250, v251
    v_add_f32 v247, v250, v251
    v_add_f32 v234, v234, v247
    v_exp_f32 v226, v130
    v_exp_f32 v227, v131
    v_cvt_pk_bf16_f32 v176, v224, v225
    v_add_f32 v232, v224, v225
    v_exp_f32 v248, v132
    v_exp_f32 v249, v133
    v_cvt_pk_bf16_f32 v177, v226, v227
    v_add_f32 v247, v226, v227
    v_add_f32 v232, v232, v247
    v_exp_f32 v250, v134
    v_exp_f32 v251, v135
    v_cvt_pk_bf16_f32 v178, v248, v249
    v_add_f32 v247, v248, v249
    v_add_f32 v232, v232, v247
    v_exp_f32 v224, v120
    v_exp_f32 v225, v121
    v_cvt_pk_bf16_f32 v179, v250, v251
    v_add_f32 v247, v250, v251
    v_add_f32 v232, v232, v247
    v_exp_f32 v226, v122
    v_exp_f32 v227, v123
    v_cvt_pk_bf16_f32 v172, v224, v225
    v_exp_f32 v248, v124
    v_exp_f32 v249, v125
    v_cvt_pk_bf16_f32 v173, v226, v227
    v_exp_f32 v250, v126
    v_exp_f32 v251, v127
    v_cvt_pk_bf16_f32 v174, v248, v249
    v_exp_f32 v224, v112
    v_exp_f32 v225, v113
    v_cvt_pk_bf16_f32 v175, v250, v251
    v_exp_f32 v226, v114
    v_exp_f32 v227, v115
    v_cvt_pk_bf16_f32 v168, v224, v225
    v_exp_f32 v248, v116
    v_exp_f32 v249, v117
    v_cvt_pk_bf16_f32 v169, v226, v227
    v_exp_f32 v250, v118
    v_exp_f32 v251, v119
    v_cvt_pk_bf16_f32 v170, v248, v249
    v_exp_f32 v224, v104
    v_exp_f32 v225, v105
    v_cvt_pk_bf16_f32 v171, v250, v251
    v_exp_f32 v226, v106
    v_exp_f32 v227, v107
    v_cvt_pk_bf16_f32 v164, v224, v225
    v_exp_f32 v248, v108
    v_exp_f32 v249, v109
    v_cvt_pk_bf16_f32 v165, v226, v227
    v_exp_f32 v250, v110
    v_exp_f32 v251, v111
    v_cvt_pk_bf16_f32 v166, v248, v249
    v_cvt_pk_bf16_f32 v167, v250, v251
LrescO:
    v_accvgpr_read_b32 v248, a0
    v_accvgpr_read_b32 v249, a1
    v_accvgpr_read_b32 v250, a2
    v_accvgpr_read_b32 v251, a3
    v_mul_f32 v248, v248, v252
    v_mul_f32 v249, v249, v252
    v_mul_f32 v250, v250, v252
    v_mul_f32 v251, v251, v252
    v_accvgpr_write_b32 a0, v248
    v_accvgpr_write_b32 a1, v249
    v_accvgpr_write_b32 a2, v250
    v_accvgpr_write_b32 a3, v251
    v_accvgpr_read_b32 v248, a4
    v_accvgpr_read_b32 v249, a5
    v_accvgpr_read_b32 v250, a6
    v_accvgpr_read_b32 v251, a7
    v_mul_f32 v248, v248, v252
    v_mul_f32 v249, v249, v252
    v_mul_f32 v250, v250, v252
    v_mul_f32 v251, v251, v252
    v_accvgpr_write_b32 a4, v248
    v_accvgpr_write_b32 a5, v249
    v_accvgpr_write_b32 a6, v250
    v_accvgpr_write_b32 a7, v251
    v_accvgpr_read_b32 v248, a8
    v_accvgpr_read_b32 v249, a9
    v_accvgpr_read_b32 v250, a10
    v_accvgpr_read_b32 v251, a11
    v_mul_f32 v248, v248, v252
    v_mul_f32 v249, v249, v252
    v_mul_f32 v250, v250, v252
    v_mul_f32 v251, v251, v252
    v_accvgpr_write_b32 a8, v248
    v_accvgpr_write_b32 a9, v249
    v_accvgpr_write_b32 a10, v250
    v_accvgpr_write_b32 a11, v251
    v_accvgpr_read_b32 v248, a12
    v_accvgpr_read_b32 v249, a13
    v_accvgpr_read_b32 v250, a14
    v_accvgpr_read_b32 v251, a15
    v_mul_f32 v248, v248, v252
    v_mul_f32 v249, v249, v252
    v_mul_f32 v250, v250, v252
    v_mul_f32 v251, v251, v252
    v_accvgpr_write_b32 a12, v248
    v_accvgpr_write_b32 a13, v249
    v_accvgpr_write_b32 a14, v250
    v_accvgpr_write_b32 a15, v251
    v_accvgpr_read_b32 v248, a16
    v_accvgpr_read_b32 v249, a17
    v_accvgpr_read_b32 v250, a18
    v_accvgpr_read_b32 v251, a19
    v_mul_f32 v248, v248, v252
    v_mul_f32 v249, v249, v252
    v_mul_f32 v250, v250, v252
    v_mul_f32 v251, v251, v252
    v_accvgpr_write_b32 a16, v248
    v_accvgpr_write_b32 a17, v249
    v_accvgpr_write_b32 a18, v250
    v_accvgpr_write_b32 a19, v251
    v_accvgpr_read_b32 v248, a20
    v_accvgpr_read_b32 v249, a21
    v_accvgpr_read_b32 v250, a22
    v_accvgpr_read_b32 v251, a23
    v_mul_f32 v248, v248, v252
    v_mul_f32 v249, v249, v252
    v_mul_f32 v250, v250, v252
    v_mul_f32 v251, v251, v252
    v_accvgpr_write_b32 a20, v248
    v_accvgpr_write_b32 a21, v249
    v_accvgpr_write_b32 a22, v250
    v_accvgpr_write_b32 a23, v251
    v_accvgpr_read_b32 v248, a24
    v_accvgpr_read_b32 v249, a25
    v_accvgpr_read_b32 v250, a26
    v_accvgpr_read_b32 v251, a27
    v_mul_f32 v248, v248, v252
    v_mul_f32 v249, v249, v252
    v_mul_f32 v250, v250, v252
    v_mul_f32 v251, v251, v252
    v_accvgpr_write_b32 a24, v248
    v_accvgpr_write_b32 a25, v249
    v_accvgpr_write_b32 a26, v250
    v_accvgpr_write_b32 a27, v251
    v_accvgpr_read_b32 v248, a28
    v_accvgpr_read_b32 v249, a29
    v_accvgpr_read_b32 v250, a30
    v_accvgpr_read_b32 v251, a31
    v_mul_f32 v248, v248, v252
    v_mul_f32 v249, v249, v252
    v_mul_f32 v250, v250, v252
    v_mul_f32 v251, v251, v252
    v_accvgpr_write_b32 a28, v248
    v_accvgpr_write_b32 a29, v249
    v_accvgpr_write_b32 a30, v250
    v_accvgpr_write_b32 a31, v251
    v_accvgpr_read_b32 v248, a32
    v_accvgpr_read_b32 v249, a33
    v_accvgpr_read_b32 v250, a34
    v_accvgpr_read_b32 v251, a35
    v_mul_f32 v248, v248, v253
    v_mul_f32 v249, v249, v253
    v_mul_f32 v250, v250, v253
    v_mul_f32 v251, v251, v253
    v_accvgpr_write_b32 a32, v248
    v_accvgpr_write_b32 a33, v249
    v_accvgpr_write_b32 a34, v250
    v_accvgpr_write_b32 a35, v251
    v_accvgpr_read_b32 v248, a36
    v_accvgpr_read_b32 v249, a37
    v_accvgpr_read_b32 v250, a38
    v_accvgpr_read_b32 v251, a39
    v_mul_f32 v248, v248, v253
    v_mul_f32 v249, v249, v253
    v_mul_f32 v250, v250, v253
    v_mul_f32 v251, v251, v253
    v_accvgpr_write_b32 a36, v248
    v_accvgpr_write_b32 a37, v249
    v_accvgpr_write_b32 a38, v250
    v_accvgpr_write_b32 a39, v251
    v_accvgpr_read_b32 v248, a40
    v_accvgpr_read_b32 v249, a41
    v_accvgpr_read_b32 v250, a42
    v_accvgpr_read_b32 v251, a43
    v_mul_f32 v248, v248, v253
    v_mul_f32 v249, v249, v253
    v_mul_f32 v250, v250, v253
    v_mul_f32 v251, v251, v253
    v_accvgpr_write_b32 a40, v248
    v_accvgpr_write_b32 a41, v249
    v_accvgpr_write_b32 a42, v250
    v_accvgpr_write_b32 a43, v251
    v_accvgpr_read_b32 v248, a44
    v_accvgpr_read_b32 v249, a45
    v_accvgpr_read_b32 v250, a46
    v_accvgpr_read_b32 v251, a47
    v_mul_f32 v248, v248, v253
    v_mul_f32 v249, v249, v253
    v_mul_f32 v250, v250, v253
    v_mul_f32 v251, v251, v253
    v_accvgpr_write_b32 a44, v248
    v_accvgpr_write_b32 a45, v249
    v_accvgpr_write_b32 a46, v250
    v_accvgpr_write_b32 a47, v251
    v_accvgpr_read_b32 v248, a48
    v_accvgpr_read_b32 v249, a49
    v_accvgpr_read_b32 v250, a50
    v_accvgpr_read_b32 v251, a51
    v_mul_f32 v248, v248, v253
    v_mul_f32 v249, v249, v253
    v_mul_f32 v250, v250, v253
    v_mul_f32 v251, v251, v253
    v_accvgpr_write_b32 a48, v248
    v_accvgpr_write_b32 a49, v249
    v_accvgpr_write_b32 a50, v250
    v_accvgpr_write_b32 a51, v251
    v_accvgpr_read_b32 v248, a52
    v_accvgpr_read_b32 v249, a53
    v_accvgpr_read_b32 v250, a54
    v_accvgpr_read_b32 v251, a55
    v_mul_f32 v248, v248, v253
    v_mul_f32 v249, v249, v253
    v_mul_f32 v250, v250, v253
    v_mul_f32 v251, v251, v253
    v_accvgpr_write_b32 a52, v248
    v_accvgpr_write_b32 a53, v249
    v_accvgpr_write_b32 a54, v250
    v_accvgpr_write_b32 a55, v251
    v_accvgpr_read_b32 v248, a56
    v_accvgpr_read_b32 v249, a57
    v_accvgpr_read_b32 v250, a58
    v_accvgpr_read_b32 v251, a59
    v_mul_f32 v248, v248, v253
    v_mul_f32 v249, v249, v253
    v_mul_f32 v250, v250, v253
    v_mul_f32 v251, v251, v253
    v_accvgpr_write_b32 a56, v248
    v_accvgpr_write_b32 a57, v249
    v_accvgpr_write_b32 a58, v250
    v_accvgpr_write_b32 a59, v251
    v_accvgpr_read_b32 v248, a60
    v_accvgpr_read_b32 v249, a61
    v_accvgpr_read_b32 v250, a62
    v_accvgpr_read_b32 v251, a63
    v_mul_f32 v248, v248, v253
    v_mul_f32 v249, v249, v253
    v_mul_f32 v250, v250, v253
    v_mul_f32 v251, v251, v253
    v_accvgpr_write_b32 a60, v248
    v_accvgpr_write_b32 a61, v249
    v_accvgpr_write_b32 a62, v250
    v_accvgpr_write_b32 a63, v251
    v_accvgpr_read_b32 v248, a64
    v_accvgpr_read_b32 v249, a65
    v_accvgpr_read_b32 v250, a66
    v_accvgpr_read_b32 v251, a67
    v_mul_f32 v248, v248, v254
    v_mul_f32 v249, v249, v254
    v_mul_f32 v250, v250, v254
    v_mul_f32 v251, v251, v254
    v_accvgpr_write_b32 a64, v248
    v_accvgpr_write_b32 a65, v249
    v_accvgpr_write_b32 a66, v250
    v_accvgpr_write_b32 a67, v251
    v_accvgpr_read_b32 v248, a68
    v_accvgpr_read_b32 v249, a69
    v_accvgpr_read_b32 v250, a70
    v_accvgpr_read_b32 v251, a71
    v_mul_f32 v248, v248, v254
    v_mul_f32 v249, v249, v254
    v_mul_f32 v250, v250, v254
    v_mul_f32 v251, v251, v254
    v_accvgpr_write_b32 a68, v248
    v_accvgpr_write_b32 a69, v249
    v_accvgpr_write_b32 a70, v250
    v_accvgpr_write_b32 a71, v251
    v_accvgpr_read_b32 v248, a72
    v_accvgpr_read_b32 v249, a73
    v_accvgpr_read_b32 v250, a74
    v_accvgpr_read_b32 v251, a75
    v_mul_f32 v248, v248, v254
    v_mul_f32 v249, v249, v254
    v_mul_f32 v250, v250, v254
    v_mul_f32 v251, v251, v254
    v_accvgpr_write_b32 a72, v248
    v_accvgpr_write_b32 a73, v249
    v_accvgpr_write_b32 a74, v250
    v_accvgpr_write_b32 a75, v251
    v_accvgpr_read_b32 v248, a76
    v_accvgpr_read_b32 v249, a77
    v_accvgpr_read_b32 v250, a78
    v_accvgpr_read_b32 v251, a79
    v_mul_f32 v248, v248, v254
    v_mul_f32 v249, v249, v254
    v_mul_f32 v250, v250, v254
    v_mul_f32 v251, v251, v254
    v_accvgpr_write_b32 a76, v248
    v_accvgpr_write_b32 a77, v249
    v_accvgpr_write_b32 a78, v250
    v_accvgpr_write_b32 a79, v251
    v_accvgpr_read_b32 v248, a80
    v_accvgpr_read_b32 v249, a81
    v_accvgpr_read_b32 v250, a82
    v_accvgpr_read_b32 v251, a83
    v_mul_f32 v248, v248, v254
    v_mul_f32 v249, v249, v254
    v_mul_f32 v250, v250, v254
    v_mul_f32 v251, v251, v254
    v_accvgpr_write_b32 a80, v248
    v_accvgpr_write_b32 a81, v249
    v_accvgpr_write_b32 a82, v250
    v_accvgpr_write_b32 a83, v251
    v_accvgpr_read_b32 v248, a84
    v_accvgpr_read_b32 v249, a85
    v_accvgpr_read_b32 v250, a86
    v_accvgpr_read_b32 v251, a87
    v_mul_f32 v248, v248, v254
    v_mul_f32 v249, v249, v254
    v_mul_f32 v250, v250, v254
    v_mul_f32 v251, v251, v254
    v_accvgpr_write_b32 a84, v248
    v_accvgpr_write_b32 a85, v249
    v_accvgpr_write_b32 a86, v250
    v_accvgpr_write_b32 a87, v251
    v_accvgpr_read_b32 v248, a88
    v_accvgpr_read_b32 v249, a89
    v_accvgpr_read_b32 v250, a90
    v_accvgpr_read_b32 v251, a91
    v_mul_f32 v248, v248, v254
    v_mul_f32 v249, v249, v254
    v_mul_f32 v250, v250, v254
    v_mul_f32 v251, v251, v254
    v_accvgpr_write_b32 a88, v248
    v_accvgpr_write_b32 a89, v249
    v_accvgpr_write_b32 a90, v250
    v_accvgpr_write_b32 a91, v251
    v_accvgpr_read_b32 v248, a92
    v_accvgpr_read_b32 v249, a93
    v_accvgpr_read_b32 v250, a94
    v_accvgpr_read_b32 v251, a95
    v_mul_f32 v248, v248, v254
    v_mul_f32 v249, v249, v254
    v_mul_f32 v250, v250, v254
    v_mul_f32 v251, v251, v254
    v_accvgpr_write_b32 a92, v248
    v_accvgpr_write_b32 a93, v249
    v_accvgpr_write_b32 a94, v250
    v_accvgpr_write_b32 a95, v251
    v_accvgpr_read_b32 v248, a96
    v_accvgpr_read_b32 v249, a97
    v_accvgpr_read_b32 v250, a98
    v_accvgpr_read_b32 v251, a99
    v_mul_f32 v248, v248, v255
    v_mul_f32 v249, v249, v255
    v_mul_f32 v250, v250, v255
    v_mul_f32 v251, v251, v255
    v_accvgpr_write_b32 a96, v248
    v_accvgpr_write_b32 a97, v249
    v_accvgpr_write_b32 a98, v250
    v_accvgpr_write_b32 a99, v251
    v_accvgpr_read_b32 v248, a100
    v_accvgpr_read_b32 v249, a101
    v_accvgpr_read_b32 v250, a102
    v_accvgpr_read_b32 v251, a103
    v_mul_f32 v248, v248, v255
    v_mul_f32 v249, v249, v255
    v_mul_f32 v250, v250, v255
    v_mul_f32 v251, v251, v255
    v_accvgpr_write_b32 a100, v248
    v_accvgpr_write_b32 a101, v249
    v_accvgpr_write_b32 a102, v250
    v_accvgpr_write_b32 a103, v251
    v_accvgpr_read_b32 v248, a104
    v_accvgpr_read_b32 v249, a105
    v_accvgpr_read_b32 v250, a106
    v_accvgpr_read_b32 v251, a107
    v_mul_f32 v248, v248, v255
    v_mul_f32 v249, v249, v255
    v_mul_f32 v250, v250, v255
    v_mul_f32 v251, v251, v255
    v_accvgpr_write_b32 a104, v248
    v_accvgpr_write_b32 a105, v249
    v_accvgpr_write_b32 a106, v250
    v_accvgpr_write_b32 a107, v251
    v_accvgpr_read_b32 v248, a108
    v_accvgpr_read_b32 v249, a109
    v_accvgpr_read_b32 v250, a110
    v_accvgpr_read_b32 v251, a111
    v_mul_f32 v248, v248, v255
    v_mul_f32 v249, v249, v255
    v_mul_f32 v250, v250, v255
    v_mul_f32 v251, v251, v255
    v_accvgpr_write_b32 a108, v248
    v_accvgpr_write_b32 a109, v249
    v_accvgpr_write_b32 a110, v250
    v_accvgpr_write_b32 a111, v251
    v_accvgpr_read_b32 v248, a112
    v_accvgpr_read_b32 v249, a113
    v_accvgpr_read_b32 v250, a114
    v_accvgpr_read_b32 v251, a115
    v_mul_f32 v248, v248, v255
    v_mul_f32 v249, v249, v255
    v_mul_f32 v250, v250, v255
    v_mul_f32 v251, v251, v255
    v_accvgpr_write_b32 a112, v248
    v_accvgpr_write_b32 a113, v249
    v_accvgpr_write_b32 a114, v250
    v_accvgpr_write_b32 a115, v251
    v_accvgpr_read_b32 v248, a116
    v_accvgpr_read_b32 v249, a117
    v_accvgpr_read_b32 v250, a118
    v_accvgpr_read_b32 v251, a119
    v_mul_f32 v248, v248, v255
    v_mul_f32 v249, v249, v255
    v_mul_f32 v250, v250, v255
    v_mul_f32 v251, v251, v255
    v_accvgpr_write_b32 a116, v248
    v_accvgpr_write_b32 a117, v249
    v_accvgpr_write_b32 a118, v250
    v_accvgpr_write_b32 a119, v251
    v_accvgpr_read_b32 v248, a120
    v_accvgpr_read_b32 v249, a121
    v_accvgpr_read_b32 v250, a122
    v_accvgpr_read_b32 v251, a123
    v_mul_f32 v248, v248, v255
    v_mul_f32 v249, v249, v255
    v_mul_f32 v250, v250, v255
    v_mul_f32 v251, v251, v255
    v_accvgpr_write_b32 a120, v248
    v_accvgpr_write_b32 a121, v249
    v_accvgpr_write_b32 a122, v250
    v_accvgpr_write_b32 a123, v251
    v_accvgpr_read_b32 v248, a124
    v_accvgpr_read_b32 v249, a125
    v_accvgpr_read_b32 v250, a126
    v_accvgpr_read_b32 v251, a127
    v_mul_f32 v248, v248, v255
    v_mul_f32 v249, v249, v255
    v_mul_f32 v250, v250, v255
    v_mul_f32 v251, v251, v255
    v_accvgpr_write_b32 a124, v248
    v_accvgpr_write_b32 a125, v249
    v_accvgpr_write_b32 a126, v250
    v_accvgpr_write_b32 a127, v251
    v_accvgpr_read_b32 v248, a128
    v_accvgpr_read_b32 v249, a129
    v_accvgpr_read_b32 v250, a130
    v_accvgpr_read_b32 v251, a131
    v_mul_f32 v248, v248, v246
    v_mul_f32 v249, v249, v246
    v_mul_f32 v250, v250, v246
    v_mul_f32 v251, v251, v246
    v_accvgpr_write_b32 a128, v248
    v_accvgpr_write_b32 a129, v249
    v_accvgpr_write_b32 a130, v250
    v_accvgpr_write_b32 a131, v251
    v_accvgpr_read_b32 v248, a132
    v_accvgpr_read_b32 v249, a133
    v_accvgpr_read_b32 v250, a134
    v_accvgpr_read_b32 v251, a135
    v_mul_f32 v248, v248, v246
    v_mul_f32 v249, v249, v246
    v_mul_f32 v250, v250, v246
    v_mul_f32 v251, v251, v246
    v_accvgpr_write_b32 a132, v248
    v_accvgpr_write_b32 a133, v249
    v_accvgpr_write_b32 a134, v250
    v_accvgpr_write_b32 a135, v251
    v_accvgpr_read_b32 v248, a136
    v_accvgpr_read_b32 v249, a137
    v_accvgpr_read_b32 v250, a138
    v_accvgpr_read_b32 v251, a139
    v_mul_f32 v248, v248, v246
    v_mul_f32 v249, v249, v246
    v_mul_f32 v250, v250, v246
    v_mul_f32 v251, v251, v246
    v_accvgpr_write_b32 a136, v248
    v_accvgpr_write_b32 a137, v249
    v_accvgpr_write_b32 a138, v250
    v_accvgpr_write_b32 a139, v251
    v_accvgpr_read_b32 v248, a140
    v_accvgpr_read_b32 v249, a141
    v_accvgpr_read_b32 v250, a142
    v_accvgpr_read_b32 v251, a143
    v_mul_f32 v248, v248, v246
    v_mul_f32 v249, v249, v246
    v_mul_f32 v250, v250, v246
    v_mul_f32 v251, v251, v246
    v_accvgpr_write_b32 a140, v248
    v_accvgpr_write_b32 a141, v249
    v_accvgpr_write_b32 a142, v250
    v_accvgpr_write_b32 a143, v251
    v_accvgpr_read_b32 v248, a144
    v_accvgpr_read_b32 v249, a145
    v_accvgpr_read_b32 v250, a146
    v_accvgpr_read_b32 v251, a147
    v_mul_f32 v248, v248, v246
    v_mul_f32 v249, v249, v246
    v_mul_f32 v250, v250, v246
    v_mul_f32 v251, v251, v246
    v_accvgpr_write_b32 a144, v248
    v_accvgpr_write_b32 a145, v249
    v_accvgpr_write_b32 a146, v250
    v_accvgpr_write_b32 a147, v251
    v_accvgpr_read_b32 v248, a148
    v_accvgpr_read_b32 v249, a149
    v_accvgpr_read_b32 v250, a150
    v_accvgpr_read_b32 v251, a151
    v_mul_f32 v248, v248, v246
    v_mul_f32 v249, v249, v246
    v_mul_f32 v250, v250, v246
    v_mul_f32 v251, v251, v246
    v_accvgpr_write_b32 a148, v248
    v_accvgpr_write_b32 a149, v249
    v_accvgpr_write_b32 a150, v250
    v_accvgpr_write_b32 a151, v251
    v_accvgpr_read_b32 v248, a152
    v_accvgpr_read_b32 v249, a153
    v_accvgpr_read_b32 v250, a154
    v_accvgpr_read_b32 v251, a155
    v_mul_f32 v248, v248, v246
    v_mul_f32 v249, v249, v246
    v_mul_f32 v250, v250, v246
    v_mul_f32 v251, v251, v246
    v_accvgpr_write_b32 a152, v248
    v_accvgpr_write_b32 a153, v249
    v_accvgpr_write_b32 a154, v250
    v_accvgpr_write_b32 a155, v251
    v_accvgpr_read_b32 v248, a156
    v_accvgpr_read_b32 v249, a157
    v_accvgpr_read_b32 v250, a158
    v_accvgpr_read_b32 v251, a159
    v_mul_f32 v248, v248, v246
    v_mul_f32 v249, v249, v246
    v_mul_f32 v250, v250, v246
    v_mul_f32 v251, v251, v246
    v_accvgpr_write_b32 a156, v248
    v_accvgpr_write_b32 a157, v249
    v_accvgpr_write_b32 a158, v250
    v_accvgpr_write_b32 a159, v251
    s_nop 1
    s_setpc_b64 s[48:49]
    .p2align 5
.type Ltab,@object
Ltab:
    .long 7020544, 67108957, 10952960, 10952704, 0, 0, 0, 0
    .long 7021056, 67108957, 10953472, 10953216, 0, 0, 0, 0
    .long 7021568, 67108957, 10953984, 10953728, 0, 0, 0, 0
    .long 7022080, 67108957, 10954496, 10954240, 0, 0, 0, 0
    .long 7022592, 67108957, 10955008, 10954752, 0, 0, 0, 0
    .long 7023104, 67108957, 10955520, 10955264, 0, 0, 0, 0
    .long 7023616, 67108957, 10956032, 10955776, 0, 0, 0, 0
    .long 7024128, 67108957, 10956544, 10956288, 0, 0, 0, 0
    .long 7020800, 67108957, 10953216, 10952960, 0, 0, 0, 0
    .long 7021312, 67108957, 10953728, 10953472, 0, 0, 0, 0
    .long 7021824, 67108957, 10954240, 10953984, 0, 0, 0, 0
    .long 7022336, 67108957, 10954752, 10954496, 0, 0, 0, 0
    .long 7022848, 67108957, 10955264, 10955008, 0, 0, 0, 0
    .long 7023360, 67108957, 10955776, 10955520, 0, 0, 0, 0
    .long 7023872, 67108957, 10956288, 10956032, 0, 0, 0, 0
    .long 7024384, 67108957, 10956800, 10956544, 0, 0, 0, 0
    .long 7020544, 68157533, 10952960, 10952704, 0, 0, 0, 0
    .long 7021056, 68157533, 10953472, 10953216, 0, 0, 0, 0
    .long 7021568, 68157533, 10953984, 10953728, 0, 0, 0, 0
    .long 7022080, 68157533, 10954496, 10954240, 0, 0, 0, 0
    .long 7022592, 68157533, 10955008, 10954752, 0, 0, 0, 0
    .long 7023104, 68157533, 10955520, 10955264, 0, 0, 0, 0
    .long 7023616, 68157533, 10956032, 10955776, 0, 0, 0, 0
    .long 7024128, 68157533, 10956544, 10956288, 0, 0, 0, 0
    .long 7020800, 68157533, 10953216, 10952960, 0, 0, 0, 0
    .long 7021312, 68157533, 10953728, 10953472, 0, 0, 0, 0
    .long 7021824, 68157533, 10954240, 10953984, 0, 0, 0, 0
    .long 7022336, 68157533, 10954752, 10954496, 0, 0, 0, 0
    .long 7022848, 68157533, 10955264, 10955008, 0, 0, 0, 0
    .long 7023360, 68157533, 10955776, 10955520, 0, 0, 0, 0
    .long 7023872, 68157533, 10956288, 10956032, 0, 0, 0, 0
    .long 7024384, 68157533, 10956800, 10956544, 0, 0, 0, 0
    .long 7020544, 69206109, 10952960, 10952704, 0, 0, 0, 0
    .long 7021056, 69206109, 10953472, 10953216, 0, 0, 0, 0
    .long 7021568, 69206109, 10953984, 10953728, 0, 0, 0, 0
    .long 7022080, 69206109, 10954496, 10954240, 0, 0, 0, 0
    .long 7022592, 69206109, 10955008, 10954752, 0, 0, 0, 0
    .long 7023104, 69206109, 10955520, 10955264, 0, 0, 0, 0
    .long 7023616, 69206109, 10956032, 10955776, 0, 0, 0, 0
    .long 7024128, 69206109, 10956544, 10956288, 0, 0, 0, 0
    .long 7020800, 69206109, 10953216, 10952960, 0, 0, 0, 0
    .long 7021312, 69206109, 10953728, 10953472, 0, 0, 0, 0
    .long 7021824, 69206109, 10954240, 10953984, 0, 0, 0, 0
    .long 7022336, 69206109, 10954752, 10954496, 0, 0, 0, 0
    .long 7022848, 69206109, 10955264, 10955008, 0, 0, 0, 0
    .long 7023360, 69206109, 10955776, 10955520, 0, 0, 0, 0
    .long 7023872, 69206109, 10956288, 10956032, 0, 0, 0, 0
    .long 7024384, 69206109, 10956800, 10956544, 0, 0, 0, 0
    .long 7020544, 70254685, 10952960, 10952704, 0, 0, 0, 0
    .long 7021056, 70254685, 10953472, 10953216, 0, 0, 0, 0
    .long 7021568, 70254685, 10953984, 10953728, 0, 0, 0, 0
    .long 7022080, 70254685, 10954496, 10954240, 0, 0, 0, 0
    .long 7022592, 70254685, 10955008, 10954752, 0, 0, 0, 0
    .long 7023104, 70254685, 10955520, 10955264, 0, 0, 0, 0
    .long 7023616, 70254685, 10956032, 10955776, 0, 0, 0, 0
    .long 7024128, 70254685, 10956544, 10956288, 0, 0, 0, 0
    .long 7020800, 70254685, 10953216, 10952960, 0, 0, 0, 0
    .long 7021312, 70254685, 10953728, 10953472, 0, 0, 0, 0
    .long 7021824, 70254685, 10954240, 10953984, 0, 0, 0, 0
    .long 7022336, 70254685, 10954752, 10954496, 0, 0, 0, 0
    .long 7022848, 70254685, 10955264, 10955008, 0, 0, 0, 0
    .long 7023360, 70254685, 10955776, 10955520, 0, 0, 0, 0
    .long 7023872, 70254685, 10956288, 10956032, 0, 0, 0, 0
    .long 7024384, 70254685, 10956800, 10956544, 0, 0, 0, 0
    .long 10956800, 84674199, 14205184, 14102528, 0, 0, 0, 0
    .long 10957312, 84674199, 14205696, 14103040, 0, 0, 0, 0
    .long 10957824, 84674199, 14206208, 14103552, 0, 0, 0, 0
    .long 10958336, 84674199, 14206720, 14104064, 0, 0, 0, 0
    .long 10958848, 84674199, 14207232, 14104576, 0, 0, 0, 0
    .long 10959360, 84674199, 14207744, 14105088, 0, 0, 0, 0
    .long 10959872, 84674199, 14208256, 14105600, 0, 0, 0, 0
    .long 10960384, 84674199, 14208768, 14106112, 0, 0, 0, 0
    .long 10957056, 84674199, 14205440, 14102784, 0, 0, 0, 0
    .long 10957568, 84674199, 14205952, 14103296, 0, 0, 0, 0
    .long 10958080, 84674199, 14206464, 14103808, 0, 0, 0, 0
    .long 10958592, 84674199, 14206976, 14104320, 0, 0, 0, 0
    .long 10959104, 84674199, 14207488, 14104832, 0, 0, 0, 0
    .long 10959616, 84674199, 14208000, 14105344, 0, 0, 0, 0
    .long 10960128, 84674199, 14208512, 14105856, 0, 0, 0, 0
    .long 10960640, 84674199, 14209024, 14106368, 0, 0, 0, 0
    .long 10956800, 85984919, 14205184, 14102528, 0, 0, 0, 0
    .long 10957312, 85984919, 14205696, 14103040, 0, 0, 0, 0
    .long 10957824, 85984919, 14206208, 14103552, 0, 0, 0, 0
    .long 10958336, 85984919, 14206720, 14104064, 0, 0, 0, 0
    .long 10958848, 85984919, 14207232, 14104576, 0, 0, 0, 0
    .long 10959360, 85984919, 14207744, 14105088, 0, 0, 0, 0
    .long 10959872, 85984919, 14208256, 14105600, 0, 0, 0, 0
    .long 10960384, 85984919, 14208768, 14106112, 0, 0, 0, 0
    .long 10957056, 85984919, 14205440, 14102784, 0, 0, 0, 0
    .long 10957568, 85984919, 14205952, 14103296, 0, 0, 0, 0
    .long 10958080, 85984919, 14206464, 14103808, 0, 0, 0, 0
    .long 10958592, 85984919, 14206976, 14104320, 0, 0, 0, 0
    .long 10959104, 85984919, 14207488, 14104832, 0, 0, 0, 0
    .long 10959616, 85984919, 14208000, 14105344, 0, 0, 0, 0
    .long 10960128, 85984919, 14208512, 14105856, 0, 0, 0, 0
    .long 10960640, 85984919, 14209024, 14106368, 0, 0, 0, 0
    .long 10956800, 50333335, 14205184, 14102528, 18956288, 67110469, 19841280, 19742720
    .long 10957312, 50333335, 14205696, 14103040, 18956800, 67110469, 19841792, 19743232
    .long 10957824, 50333335, 14206208, 14103552, 18957312, 67110469, 19842304, 19743744
    .long 10958336, 50333335, 14206720, 14104064, 18957824, 67110469, 19842816, 19744256
    .long 10958848, 50333335, 14207232, 14104576, 18958336, 67110469, 19843328, 19744768
    .long 10959360, 50333335, 14207744, 14105088, 18958848, 67110469, 19843840, 19745280
    .long 10959872, 50333335, 14208256, 14105600, 18959360, 67110469, 19844352, 19745792
    .long 10960384, 50333335, 14208768, 14106112, 18959872, 67110469, 19844864, 19746304
    .long 10957056, 50333335, 14205440, 14102784, 18956544, 67110469, 19841536, 19742976
    .long 10957568, 50333335, 14205952, 14103296, 18957056, 67110469, 19842048, 19743488
    .long 10958080, 50333335, 14206464, 14103808, 18957568, 67110469, 19842560, 19744000
    .long 10958592, 50333335, 14206976, 14104320, 18958080, 67110469, 19843072, 19744512
    .long 10959104, 50333335, 14207488, 14104832, 18958592, 67110469, 19843584, 19745024
    .long 10959616, 50333335, 14208000, 14105344, 18959104, 67110469, 19844096, 19745536
    .long 10960128, 50333335, 14208512, 14105856, 18959616, 67110469, 19844608, 19746048
    .long 10960640, 50333335, 14209024, 14106368, 18960128, 67110469, 19845120, 19746560
    .long 14209024, 50333136, 16527616, 16437248, 0, 50333071, 2183424, 2097152
    .long 14209536, 50333136, 16528128, 16437760, 512, 50333071, 2183936, 2097664
    .long 14210048, 50333136, 16528640, 16438272, 1024, 50333071, 2184448, 2098176
    .long 14210560, 50333136, 16529152, 16438784, 1536, 50333071, 2184960, 2098688
    .long 14211072, 50333136, 16529664, 16439296, 2048, 50333071, 2185472, 2099200
    .long 14211584, 50333136, 16530176, 16439808, 2560, 50333071, 2185984, 2099712
    .long 14212096, 50333136, 16530688, 16440320, 3072, 50333071, 2186496, 2100224
    .long 14212608, 50333136, 16531200, 16440832, 3584, 50333071, 2187008, 2100736
    .long 14209280, 50333136, 16527872, 16437504, 256, 50333071, 2183680, 2097408
    .long 14209792, 50333136, 16528384, 16438016, 768, 50333071, 2184192, 2097920
    .long 14210304, 50333136, 16528896, 16438528, 1280, 50333071, 2184704, 2098432
    .long 14210816, 50333136, 16529408, 16439040, 1792, 50333071, 2185216, 2098944
    .long 14211328, 50333136, 16529920, 16439552, 2304, 50333071, 2185728, 2099456
    .long 14211840, 50333136, 16530432, 16440064, 2816, 50333071, 2186240, 2099968
    .long 14212352, 50333136, 16530944, 16440576, 3328, 50333071, 2186752, 2100480
    .long 14212864, 50333136, 16531456, 16441088, 3840, 50333071, 2187264, 2100992
    .long 14209024, 51119568, 16527616, 16437248, 0, 51119503, 2183424, 2097152
    .long 14209536, 51119568, 16528128, 16437760, 512, 51119503, 2183936, 2097664
    .long 14210048, 51119568, 16528640, 16438272, 1024, 51119503, 2184448, 2098176
    .long 14210560, 51119568, 16529152, 16438784, 1536, 51119503, 2184960, 2098688
    .long 14211072, 51119568, 16529664, 16439296, 2048, 51119503, 2185472, 2099200
    .long 14211584, 51119568, 16530176, 16439808, 2560, 51119503, 2185984, 2099712
    .long 14212096, 51119568, 16530688, 16440320, 3072, 51119503, 2186496, 2100224
    .long 14212608, 51119568, 16531200, 16440832, 3584, 51119503, 2187008, 2100736
    .long 14209280, 51119568, 16527872, 16437504, 256, 51119503, 2183680, 2097408
    .long 14209792, 51119568, 16528384, 16438016, 768, 51119503, 2184192, 2097920
    .long 14210304, 51119568, 16528896, 16438528, 1280, 51119503, 2184704, 2098432
    .long 14210816, 51119568, 16529408, 16439040, 1792, 51119503, 2185216, 2098944
    .long 14211328, 51119568, 16529920, 16439552, 2304, 51119503, 2185728, 2099456
    .long 14211840, 51119568, 16530432, 16440064, 2816, 51119503, 2186240, 2099968
    .long 14212352, 51119568, 16530944, 16440576, 3328, 51119503, 2186752, 2100480
    .long 14212864, 51119568, 16531456, 16441088, 3840, 51119503, 2187264, 2100992
    .long 14209024, 51906000, 16527616, 16437248, 0, 51905935, 2183424, 2097152
    .long 14209536, 51906000, 16528128, 16437760, 512, 51905935, 2183936, 2097664
    .long 14210048, 51906000, 16528640, 16438272, 1024, 51905935, 2184448, 2098176
    .long 14210560, 51906000, 16529152, 16438784, 1536, 51905935, 2184960, 2098688
    .long 14211072, 51906000, 16529664, 16439296, 2048, 51905935, 2185472, 2099200
    .long 14211584, 51906000, 16530176, 16439808, 2560, 51905935, 2185984, 2099712
    .long 14212096, 51906000, 16530688, 16440320, 3072, 51905935, 2186496, 2100224
    .long 14212608, 51906000, 16531200, 16440832, 3584, 51905935, 2187008, 2100736
    .long 14209280, 51906000, 16527872, 16437504, 256, 51905935, 2183680, 2097408
    .long 14209792, 51906000, 16528384, 16438016, 768, 51905935, 2184192, 2097920
    .long 14210304, 51906000, 16528896, 16438528, 1280, 51905935, 2184704, 2098432
    .long 14210816, 51906000, 16529408, 16439040, 1792, 51905935, 2185216, 2098944
    .long 14211328, 51906000, 16529920, 16439552, 2304, 51905935, 2185728, 2099456
    .long 14211840, 51906000, 16530432, 16440064, 2816, 51905935, 2186240, 2099968
    .long 14212352, 51906000, 16530944, 16440576, 3328, 51905935, 2186752, 2100480
    .long 14212864, 51906000, 16531456, 16441088, 3840, 51905935, 2187264, 2100992
    .long 16531456, 67634193, 18952448, 18890752, 5840896, 50857991, 7016704, 6889472
    .long 16531968, 67634193, 18952960, 18891264, 5841408, 50857991, 7017216, 6889984
    .long 16532480, 67634193, 18953472, 18891776, 5841920, 50857991, 7017728, 6890496
    .long 16532992, 67634193, 18953984, 18892288, 5842432, 50857991, 7018240, 6891008
    .long 16533504, 67634193, 18954496, 18892800, 5842944, 50857991, 7018752, 6891520
    .long 16534016, 67634193, 18955008, 18893312, 5843456, 50857991, 7019264, 6892032
    .long 16534528, 67634193, 18955520, 18893824, 5843968, 50857991, 7019776, 6892544
    .long 16535040, 67634193, 18956032, 18894336, 5844480, 50857991, 7020288, 6893056
    .long 16531712, 67634193, 18952704, 18891008, 5841152, 50857991, 7016960, 6889728
    .long 16532224, 67634193, 18953216, 18891520, 5841664, 50857991, 7017472, 6890240
    .long 16532736, 67634193, 18953728, 18892032, 5842176, 50857991, 7017984, 6890752
    .long 16533248, 67634193, 18954240, 18892544, 5842688, 50857991, 7018496, 6891264
    .long 16533760, 67634193, 18954752, 18893056, 5843200, 50857991, 7019008, 6891776
    .long 16534272, 67634193, 18955264, 18893568, 5843712, 50857991, 7019520, 6892288
    .long 16534784, 67634193, 18955776, 18894080, 5844224, 50857991, 7020032, 6892800
    .long 16535296, 67634193, 18956288, 18894592, 5844736, 50857991, 7020544, 6893312
    .long 2187264, 33556250, 5837056, 5726208, 16531456, 33555473, 18952448, 18890752
    .long 2187776, 33556250, 5837568, 5726720, 16531968, 33555473, 18952960, 18891264
    .long 2188288, 33556250, 5838080, 5727232, 16532480, 33555473, 18953472, 18891776
    .long 2188800, 33556250, 5838592, 5727744, 16532992, 33555473, 18953984, 18892288
    .long 2189312, 33556250, 5839104, 5728256, 16533504, 33555473, 18954496, 18892800
    .long 2189824, 33556250, 5839616, 5728768, 16534016, 33555473, 18955008, 18893312
    .long 2190336, 33556250, 5840128, 5729280, 16534528, 33555473, 18955520, 18893824
    .long 2190848, 33556250, 5840640, 5729792, 16535040, 33555473, 18956032, 18894336
    .long 2187520, 33556250, 5837312, 5726464, 16531712, 33555473, 18952704, 18891008
    .long 2188032, 33556250, 5837824, 5726976, 16532224, 33555473, 18953216, 18891520
    .long 2188544, 33556250, 5838336, 5727488, 16532736, 33555473, 18953728, 18892032
    .long 2189056, 33556250, 5838848, 5728000, 16533248, 33555473, 18954240, 18892544
    .long 2189568, 33556250, 5839360, 5728512, 16533760, 33555473, 18954752, 18893056
    .long 2190080, 33556250, 5839872, 5729024, 16534272, 33555473, 18955264, 18893568
    .long 2190592, 33556250, 5840384, 5729536, 16534784, 33555473, 18955776, 18894080
    .long 2191104, 33556250, 5840896, 5730048, 16535296, 33555473, 18956288, 18894592
    .long 16531456, 68682769, 18952448, 18890752, 5840896, 33556487, 7016704, 6889472
    .long 16531968, 68682769, 18952960, 18891264, 5841408, 33556487, 7017216, 6889984
    .long 16532480, 68682769, 18953472, 18891776, 5841920, 33556487, 7017728, 6890496
    .long 16532992, 68682769, 18953984, 18892288, 5842432, 33556487, 7018240, 6891008
    .long 16533504, 68682769, 18954496, 18892800, 5842944, 33556487, 7018752, 6891520
    .long 16534016, 68682769, 18955008, 18893312, 5843456, 33556487, 7019264, 6892032
    .long 16534528, 68682769, 18955520, 18893824, 5843968, 33556487, 7019776, 6892544
    .long 16535040, 68682769, 18956032, 18894336, 5844480, 33556487, 7020288, 6893056
    .long 16531712, 68682769, 18952704, 18891008, 5841152, 33556487, 7016960, 6889728
    .long 16532224, 68682769, 18953216, 18891520, 5841664, 33556487, 7017472, 6890240
    .long 16532736, 68682769, 18953728, 18892032, 5842176, 33556487, 7017984, 6890752
    .long 16533248, 68682769, 18954240, 18892544, 5842688, 33556487, 7018496, 6891264
    .long 16533760, 68682769, 18954752, 18893056, 5843200, 33556487, 7019008, 6891776
    .long 16534272, 68682769, 18955264, 18893568, 5843712, 33556487, 7019520, 6892288
    .long 16534784, 68682769, 18955776, 18894080, 5844224, 33556487, 7020032, 6892800
    .long 16535296, 68682769, 18956288, 18894592, 5844736, 33556487, 7020544, 6893312
    .long 2187264, 67634970, 5837056, 5726208, 0, 0, 0, 0
    .long 2187776, 67634970, 5837568, 5726720, 0, 0, 0, 0
    .long 2188288, 67634970, 5838080, 5727232, 0, 0, 0, 0
    .long 2188800, 67634970, 5838592, 5727744, 0, 0, 0, 0
    .long 2189312, 67634970, 5839104, 5728256, 0, 0, 0, 0
    .long 2189824, 67634970, 5839616, 5728768, 0, 0, 0, 0
    .long 2190336, 67634970, 5840128, 5729280, 0, 0, 0, 0
    .long 2190848, 67634970, 5840640, 5729792, 0, 0, 0, 0
    .long 2187520, 67634970, 5837312, 5726464, 0, 0, 0, 0
    .long 2188032, 67634970, 5837824, 5726976, 0, 0, 0, 0
    .long 2188544, 67634970, 5838336, 5727488, 0, 0, 0, 0
    .long 2189056, 67634970, 5838848, 5728000, 0, 0, 0, 0
    .long 2189568, 67634970, 5839360, 5728512, 0, 0, 0, 0
    .long 2190080, 67634970, 5839872, 5729024, 0, 0, 0, 0
    .long 2190592, 67634970, 5840384, 5729536, 0, 0, 0, 0
    .long 2191104, 67634970, 5840896, 5730048, 0, 0, 0, 0
    .long 2187264, 68683546, 5837056, 5726208, 0, 0, 0, 0
    .long 2187776, 68683546, 5837568, 5726720, 0, 0, 0, 0
    .long 2188288, 68683546, 5838080, 5727232, 0, 0, 0, 0
    .long 2188800, 68683546, 5838592, 5727744, 0, 0, 0, 0
    .long 2189312, 68683546, 5839104, 5728256, 0, 0, 0, 0
    .long 2189824, 68683546, 5839616, 5728768, 0, 0, 0, 0
    .long 2190336, 68683546, 5840128, 5729280, 0, 0, 0, 0
    .long 2190848, 68683546, 5840640, 5729792, 0, 0, 0, 0
    .long 2187520, 68683546, 5837312, 5726464, 0, 0, 0, 0
    .long 2188032, 68683546, 5837824, 5726976, 0, 0, 0, 0
    .long 2188544, 68683546, 5838336, 5727488, 0, 0, 0, 0
    .long 2189056, 68683546, 5838848, 5728000, 0, 0, 0, 0
    .long 2189568, 68683546, 5839360, 5728512, 0, 0, 0, 0
    .long 2190080, 68683546, 5839872, 5729024, 0, 0, 0, 0
    .long 2190592, 68683546, 5840384, 5729536, 0, 0, 0, 0
    .long 2191104, 68683546, 5840896, 5730048, 0, 0, 0, 0
    .long 2187264, 69732122, 5837056, 5726208, 0, 0, 0, 0
    .long 2187776, 69732122, 5837568, 5726720, 0, 0, 0, 0
    .long 2188288, 69732122, 5838080, 5727232, 0, 0, 0, 0
    .long 2188800, 69732122, 5838592, 5727744, 0, 0, 0, 0
    .long 2189312, 69732122, 5839104, 5728256, 0, 0, 0, 0
    .long 2189824, 69732122, 5839616, 5728768, 0, 0, 0, 0
    .long 2190336, 69732122, 5840128, 5729280, 0, 0, 0, 0
    .long 2190848, 69732122, 5840640, 5729792, 0, 0, 0, 0
    .long 2187520, 69732122, 5837312, 5726464, 0, 0, 0, 0
    .long 2188032, 69732122, 5837824, 5726976, 0, 0, 0, 0
    .long 2188544, 69732122, 5838336, 5727488, 0, 0, 0, 0
    .long 2189056, 69732122, 5838848, 5728000, 0, 0, 0, 0
    .long 2189568, 69732122, 5839360, 5728512, 0, 0, 0, 0
    .long 2190080, 69732122, 5839872, 5729024, 0, 0, 0, 0
    .long 2190592, 69732122, 5840384, 5729536, 0, 0, 0, 0
    .long 2191104, 69732122, 5840896, 5730048, 0, 0, 0, 0
.section .rodata,"a"
.p2align 6
.amdhsa_kernel standalone__varlen_attn_packed__ragged_kernel
  .amdhsa_next_free_vgpr 512
  .amdhsa_next_free_sgpr 102
  .amdhsa_accum_offset 256
  .amdhsa_group_segment_fixed_size 0
  .amdhsa_kernarg_size 56
  .amdhsa_user_sgpr_count 2
  .amdhsa_user_sgpr_kernarg_segment_ptr 1
  .amdhsa_system_sgpr_workgroup_id_x 1
.end_amdhsa_kernel
```
